```python
import torch

def _softmax(x, axis=-1):
    return torch.softmax(x, dim=axis)

def _gelu(x):
    return torch.nn.functional.gelu(x, approximate='tanh')

def _silu(x):
    return torch.nn.functional.silu(x)

def _sigmoid(x):
    return torch.sigmoid(x)

def _layernorm(x, axis=-1, eps=1e-05):
    m = x.mean(dim=axis, keepdim=True)
    v = x.var(dim=axis, keepdim=True, unbiased=False)
    return (x - m) / torch.sqrt(v + eps)

def _scatter_add(tgt, idx, src, axis=0):
    return tgt.clone().index_add_(axis, idx, src)

def _segment_sum(src, seg, n):
    out = torch.zeros((n,) + src.shape[1:], dtype=src.dtype)
    return out.index_add_(0, seg, src)

def _pad(x, pw):
    flat = tuple((v for pair in reversed(pw) for v in pair))
    return torch.nn.functional.pad(x, flat)
kernel_name = 'adaLN_cond__memory_aug_recurrent_mem_tr__glu_gated_glu__prompt'

def setup_inputs():

    _w = lambda a: (lambda t: t.to(torch.bfloat16) if t.is_floating_point() else t)(torch.as_tensor(a))

    def _A_setup():
        B, S, Dm = (1, 2048, 576)
        H, Dh = (32, 128)
        M, seg = (8, 32)
        seg = min(seg, S)
        S = S // seg * seg
        return {'x': _w((lambda *s: torch.randn(*s, dtype=torch.bfloat16) * 0.05)(B, S, Dm)), 'mem0': _w((lambda *s: torch.randn(*s, dtype=torch.bfloat16) * 0.4)(B, M, Dm)), 'Wq': _w((lambda *s: torch.randn(*s, dtype=torch.bfloat16) * 3.2)(Dm, H, Dh) * Dm ** (-0.5)), 'Wk': _w((lambda *s: torch.randn(*s, dtype=torch.bfloat16) * 3.2)(Dm, H, Dh) * Dm ** (-0.5)), 'Wv': _w((lambda *s: torch.randn(*s, dtype=torch.bfloat16) * 0.4)(Dm, H, Dh) * Dm ** (-0.5)), 'Wo': _w((lambda *s: torch.randn(*s, dtype=torch.bfloat16) * 0.4)(H, Dh, Dm) * (H * Dh) ** (-0.5)), 'seg_len': seg}
    _A_in = _A_setup()

    def _B_setup():
        B, S, D, F = (1, 2048, 576, 4608)
        return {'x': _w((lambda *s: torch.randn(*s, dtype=torch.bfloat16) * 0.05)(B, S, D)), 'w_gate': _w((lambda *s: torch.randn(*s, dtype=torch.bfloat16) * 0.05)(D, F)), 'w_up': _w((lambda *s: torch.randn(*s, dtype=torch.bfloat16) * 0.05)(D, F)), 'w_down': _w((lambda *s: torch.randn(*s, dtype=torch.bfloat16) * 0.05)(F, D))}
    _B_in = _B_setup()
    return {'A_x': _A_in['x'], 'A_mem0': _A_in['mem0'], 'A_Wq': _A_in['Wq'], 'A_Wk': _A_in['Wk'], 'A_Wv': _A_in['Wv'], 'A_Wo': _A_in['Wo'], 'A_seg_len': _A_in['seg_len'], 'B_x': _B_in['x'], 'B_w_gate': _B_in['w_gate'], 'B_w_up': _B_in['w_up'], 'B_w_down': _B_in['w_down'], 'c': _w((lambda *s: torch.randn(*s, dtype=torch.bfloat16) * 0.1)(1, 576) * 8.0), 'w_mod': _w((lambda *s: torch.randn(*s, dtype=torch.bfloat16) * 0.1)(576, 6 * 576) * 576 ** (-0.5) * 8.0)}

def reference(A_x, A_mem0, A_Wq, A_Wk, A_Wv, A_Wo, A_seg_len, B_x, B_w_gate, B_w_up, B_w_down, c, w_mod):

    def _A_ref(x, mem0, Wq, Wk, Wv, Wo, seg_len):
        B, S, Dm = x.shape
        H, Dh = (Wq.shape[1], Wq.shape[2])
        M = mem0.shape[1]
        scale = Dh ** (-0.5)
        n_seg = S // seg_len
        L = M + seg_len
        idx = torch.arange(L)
        mask = (idx[:, None] < M) | (idx[:, None] >= idx[None, :])
        mem = mem0
        outs = []
        for s in range(n_seg):
            xs = x[:, s * seg_len:(s + 1) * seg_len, :].clone()
            h = torch.concatenate([mem, xs], axis=1)
            q = torch.einsum('btd,dhe->bhte', h, Wq)
            k = torch.einsum('btd,dhe->bhte', h, Wk)
            v = torch.einsum('btd,dhe->bhte', h, Wv)
            scores = torch.einsum('bhqe,bhke->bhqk', q, k) * scale
            scores = torch.where(mask[None, None], scores, -1000000000.0)
            p = _softmax(scores, axis=-1)
            o = torch.einsum('bhqk,bhke->bhqe', p, v)
            o = torch.einsum('bhte,hed->btd', o, Wo)
            mem = o[:, :M, :].clone()
            outs.append(o[:, M:, :])
        return torch.concatenate(outs, axis=1)

    def _B_ref(x, w_gate, w_up, w_down):
        g = torch.einsum('bsd,df->bsf', x, w_gate)
        u = torch.einsum('bsd,df->bsf', x, w_up)
        h = _sigmoid(g) * u
        return torch.einsum('bsf,fd->bsd', h, w_down)
    x = A_x
    mod = (_silu(c) @ w_mod).reshape(c.shape[0], 6, 1, -1)
    sa, ca, ga, sb, cb, gb = (mod[:, 0].clone(), mod[:, 1].clone(), mod[:, 2].clone(), mod[:, 3].clone(), mod[:, 4].clone(), mod[:, 5].clone())
    h = _layernorm(x, axis=-1) * (1 + ca) + sa
    x = x + ga * _A_ref(h, A_mem0, A_Wq, A_Wk, A_Wv, A_Wo, A_seg_len)
    h = _layernorm(x, axis=-1) * (1 + cb) + sb
    x = x + gb * _B_ref(h, B_w_gate, B_w_up, B_w_down)
    return x
```

```asm
; @launch grid=(256,1,1) block=(256,1,1) lds=163840
.amdgcn_target "amdgcn-amd-amdhsa--gfx950"
.text
.globl adaLN_cond__memory_aug_recurrent_mem_tr__glu_gated_glu__prompt_kernel
.p2align 8
.type adaLN_cond__memory_aug_recurrent_mem_tr__glu_gated_glu__prompt_kernel,@function
adaLN_cond__memory_aug_recurrent_mem_tr__glu_gated_glu__prompt_kernel:
  s_cmp_ge_u32 s2, 256
  s_cbranch_scc1 Lend
  s_load_dwordx2 s[8:9], s[0:1], 120
  s_load_dwordx2 s[16:17], s[0:1], 112
  s_mov_b32 s10, 268435456
  s_mov_b32 s11, 0x20000
  s_getreg_b32 s47, hwreg(HW_REG_XCC_ID)
  s_and_b32 s47, s47, 15
  v_lshrrev_b32 v1, 6, v0
  s_nop 0
  v_readfirstlane_b32 s13, v1
  s_lshr_b32 s12, s2, 3
  s_mov_b32 s15, 400000
  s_waitcnt lgkmcnt(0)
  s_and_b32 s3, s2, 7
  s_cmp_eq_u32 s3, 0
  s_cbranch_scc1 Lchain
  s_cmp_le_u32 s3, 2
  s_cbranch_scc1 Lqkva
  s_cmp_eq_u32 s3, 3
  s_cbranch_scc0 Lg_1
  s_mov_b32 s34, 2
  s_add_u32 s35, s12, -24
  s_mov_b32 s36, 0
  s_cmp_lt_u32 s12, 24
  s_cselect_b32 s34, 0, s34
  s_cselect_b32 s36, 1, s36
  s_sub_u32 s42, s12, 12
  s_cmp_lt_u32 s12, 24
  s_cselect_b32 s35, s42, s35
  s_cmp_lt_u32 s12, 12
  s_cselect_b32 s34, 0, s34
  s_cselect_b32 s36, 0, s36
  s_cselect_b32 s35, s12, s35
Lg_1:
  s_cmp_eq_u32 s3, 4
  s_cbranch_scc0 Lg_2
  s_mov_b32 s34, 2
  s_add_u32 s35, s12, -4
  s_mov_b32 s36, 0
  s_cmp_lt_u32 s12, 12
  s_cselect_b32 s34, 0, s34
  s_cselect_b32 s36, 2, s36
  s_cselect_b32 s35, s12, s35
Lg_2:
  s_cmp_eq_u32 s3, 5
  s_cbranch_scc0 Lg_3
  s_mov_b32 s34, 2
  s_add_u32 s35, s12, 4
  s_mov_b32 s36, 0
  s_cmp_lt_u32 s12, 24
  s_cselect_b32 s34, 1, s34
  s_cselect_b32 s36, 1, s36
  s_sub_u32 s42, s12, 12
  s_cmp_lt_u32 s12, 24
  s_cselect_b32 s35, s42, s35
  s_cmp_lt_u32 s12, 12
  s_cselect_b32 s34, 1, s34
  s_cselect_b32 s36, 0, s36
  s_cselect_b32 s35, s12, s35
Lg_3:
  s_cmp_eq_u32 s3, 6
  s_cbranch_scc0 Lg_4
  s_mov_b32 s34, 2
  s_add_u32 s35, s12, 12
  s_mov_b32 s36, 0
  s_cmp_lt_u32 s12, 24
  s_cselect_b32 s34, 1, s34
  s_cselect_b32 s36, 3, s36
  s_sub_u32 s42, s12, 12
  s_cmp_lt_u32 s12, 24
  s_cselect_b32 s35, s42, s35
  s_cmp_lt_u32 s12, 12
  s_cselect_b32 s34, 1, s34
  s_cselect_b32 s36, 2, s36
  s_cselect_b32 s35, s12, s35
Lg_4:
  s_cmp_eq_u32 s3, 7
  s_cbranch_scc0 Lg_5
  s_mov_b32 s34, 2
  s_add_u32 s35, s12, 44
  s_mov_b32 s36, 0
  s_cmp_ge_u32 s12, 28
  s_cselect_b32 s34, 3, s34
Lg_5:
  s_cmp_eq_u32 s34, 3
  s_cbranch_scc0 Lnoinit
  s_sub_u32 s14, s12, 28
  v_lshlrev_b32 v1, 4, v0
  v_mov_b32 v4, 0
  v_mov_b32 v5, 0
  v_mov_b32 v6, 0
  v_mov_b32 v7, 0
  v_mov_b64 v[8:9], -1
  v_mov_b64 v[10:11], -1
  s_lshl_b32 s42, s14, 14
  buffer_store_dwordx4 v[4:7], v1, s[8:11], s42 offen sc1
  s_add_u32 s42, s42, 4096
  buffer_store_dwordx4 v[4:7], v1, s[8:11], s42 offen sc1
  s_add_u32 s42, s42, 4096
  buffer_store_dwordx4 v[4:7], v1, s[8:11], s42 offen sc1
  s_add_u32 s42, s42, 4096
  buffer_store_dwordx4 v[4:7], v1, s[8:11], s42 offen sc1
  s_add_u32 s42, s42, 4096
  s_mul_i32 s42, s14, 86016
  s_add_u32 s42, s42, 262144
  buffer_store_dwordx4 v[8:11], v1, s[8:11], s42 offen sc1
  s_add_u32 s42, s42, 4096
  buffer_store_dwordx4 v[8:11], v1, s[8:11], s42 offen sc1
  s_add_u32 s42, s42, 4096
  buffer_store_dwordx4 v[8:11], v1, s[8:11], s42 offen sc1
  s_add_u32 s42, s42, 4096
  buffer_store_dwordx4 v[8:11], v1, s[8:11], s42 offen sc1
  s_add_u32 s42, s42, 4096
  buffer_store_dwordx4 v[8:11], v1, s[8:11], s42 offen sc1
  s_add_u32 s42, s42, 4096
  buffer_store_dwordx4 v[8:11], v1, s[8:11], s42 offen sc1
  s_add_u32 s42, s42, 4096
  buffer_store_dwordx4 v[8:11], v1, s[8:11], s42 offen sc1
  s_add_u32 s42, s42, 4096
  buffer_store_dwordx4 v[8:11], v1, s[8:11], s42 offen sc1
  s_add_u32 s42, s42, 4096
  buffer_store_dwordx4 v[8:11], v1, s[8:11], s42 offen sc1
  s_add_u32 s42, s42, 4096
  buffer_store_dwordx4 v[8:11], v1, s[8:11], s42 offen sc1
  s_add_u32 s42, s42, 4096
  buffer_store_dwordx4 v[8:11], v1, s[8:11], s42 offen sc1
  s_add_u32 s42, s42, 4096
  buffer_store_dwordx4 v[8:11], v1, s[8:11], s42 offen sc1
  s_add_u32 s42, s42, 4096
  buffer_store_dwordx4 v[8:11], v1, s[8:11], s42 offen sc1
  s_add_u32 s42, s42, 4096
  buffer_store_dwordx4 v[8:11], v1, s[8:11], s42 offen sc1
  s_add_u32 s42, s42, 4096
  buffer_store_dwordx4 v[8:11], v1, s[8:11], s42 offen sc1
  s_add_u32 s42, s42, 4096
  buffer_store_dwordx4 v[8:11], v1, s[8:11], s42 offen sc1
  s_add_u32 s42, s42, 4096
  buffer_store_dwordx4 v[8:11], v1, s[8:11], s42 offen sc1
  s_add_u32 s42, s42, 4096
  buffer_store_dwordx4 v[8:11], v1, s[8:11], s42 offen sc1
  s_add_u32 s42, s42, 4096
  buffer_store_dwordx4 v[8:11], v1, s[8:11], s42 offen sc1
  s_add_u32 s42, s42, 4096
  buffer_store_dwordx4 v[8:11], v1, s[8:11], s42 offen sc1
  s_add_u32 s42, s42, 4096
  buffer_store_dwordx4 v[8:11], v1, s[8:11], s42 offen sc1
  s_add_u32 s42, s42, 4096
  s_lshl_b32 s42, s14, 13
  s_add_u32 s42, s42, 1572864
  buffer_store_dwordx4 v[8:11], v1, s[8:11], s42 offen sc1
  s_add_u32 s42, s42, 4096
  buffer_store_dwordx4 v[8:11], v1, s[8:11], s42 offen sc1
  s_add_u32 s42, s42, 4096
  s_waitcnt vmcnt(0)
  s_barrier
  v_mov_b32 v1, 0x80
  v_mov_b32 v2, s14
  v_cmp_eq_u32 vcc, 0, v0
  s_and_saveexec_b64 s[42:43], vcc
  s_cbranch_execz Lend
  global_store_byte v2, v1, s[16:17] sc0 sc1
  s_branch Lend
Lnoinit:
  s_getpc_b64 s[20:21]
Lpc_6:
  s_add_u32 s20, s20, Lpf0-Lpc_6
  s_addc_u32 s21, s21, 0
  v_and_b32 v251, 63, v0
  v_lshlrev_b32 v251, 6, v251
  s_lshl_b32 s22, s13, 12
  v_add_u32 v251, s22, v251
  global_load_dword v250, v251, s[20:21]
  v_add_u32 v251, 16384, v251
  global_load_dword v250, v251, s[20:21]
  v_add_u32 v251, 16384, v251
  global_load_dword v250, v251, s[20:21]
Lpf0:
  s_cmp_le_u32 s3, 4
  s_cbranch_scc1 Lmodt
  s_cmp_eq_u32 s3, 7
  s_cbranch_scc1 Lpredone
  s_lshl_b32 s14, s12, 1
  s_add_u32 s14, s14, s3
  s_sub_u32 s14, s14, 5
  s_load_dwordx2 s[4:5], s[0:1], 0
  s_mov_b32 s6, 2359296
  s_mov_b32 s7, 0x20000
  v_and_b32 v1, 31, v0
  v_lshrrev_b32 v2, 5, v0
  v_mul_u32_u24 v3, 1152, v1
  v_lshl_add_u32 v3, v2, 4, v3
  s_mul_i32 s42, s14, 36864
  v_and_b32 v5, 63, v0
  v_lshlrev_b32 v5, 4, v5
  s_waitcnt lgkmcnt(0)
  buffer_load_dwordx4 v[110:113], v3, s[4:7], s42 offen offset:0
  buffer_load_dwordx4 v[114:117], v3, s[4:7], s42 offen offset:128
  buffer_load_dwordx4 v[118:121], v3, s[4:7], s42 offen offset:256
  buffer_load_dwordx4 v[122:125], v3, s[4:7], s42 offen offset:384
  buffer_load_dwordx4 v[126:129], v3, s[4:7], s42 offen offset:512
  buffer_load_dwordx4 v[130:133], v3, s[4:7], s42 offen offset:640
  buffer_load_dwordx4 v[134:137], v3, s[4:7], s42 offen offset:768
  buffer_load_dwordx4 v[138:141], v3, s[4:7], s42 offen offset:896
  buffer_load_dwordx4 v[142:145], v3, s[4:7], s42 offen offset:1024
  s_waitcnt vmcnt(8)
  v_lshlrev_b32 v32, 16, v110
  v_and_b32 v33, 0xffff0000, v110
  v_lshlrev_b32 v34, 16, v111
  v_and_b32 v35, 0xffff0000, v111
  v_lshlrev_b32 v36, 16, v112
  v_and_b32 v37, 0xffff0000, v112
  v_lshlrev_b32 v38, 16, v113
  v_and_b32 v39, 0xffff0000, v113
  s_waitcnt vmcnt(7)
  v_lshlrev_b32 v40, 16, v114
  v_and_b32 v41, 0xffff0000, v114
  v_lshlrev_b32 v42, 16, v115
  v_and_b32 v43, 0xffff0000, v115
  v_lshlrev_b32 v44, 16, v116
  v_and_b32 v45, 0xffff0000, v116
  v_lshlrev_b32 v46, 16, v117
  v_and_b32 v47, 0xffff0000, v117
  s_waitcnt vmcnt(6)
  v_lshlrev_b32 v48, 16, v118
  v_and_b32 v49, 0xffff0000, v118
  v_lshlrev_b32 v50, 16, v119
  v_and_b32 v51, 0xffff0000, v119
  v_lshlrev_b32 v52, 16, v120
  v_and_b32 v53, 0xffff0000, v120
  v_lshlrev_b32 v54, 16, v121
  v_and_b32 v55, 0xffff0000, v121
  s_waitcnt vmcnt(5)
  v_lshlrev_b32 v56, 16, v122
  v_and_b32 v57, 0xffff0000, v122
  v_lshlrev_b32 v58, 16, v123
  v_and_b32 v59, 0xffff0000, v123
  v_lshlrev_b32 v60, 16, v124
  v_and_b32 v61, 0xffff0000, v124
  v_lshlrev_b32 v62, 16, v125
  v_and_b32 v63, 0xffff0000, v125
  s_waitcnt vmcnt(4)
  v_lshlrev_b32 v64, 16, v126
  v_and_b32 v65, 0xffff0000, v126
  v_lshlrev_b32 v66, 16, v127
  v_and_b32 v67, 0xffff0000, v127
  v_lshlrev_b32 v68, 16, v128
  v_and_b32 v69, 0xffff0000, v128
  v_lshlrev_b32 v70, 16, v129
  v_and_b32 v71, 0xffff0000, v129
  s_waitcnt vmcnt(3)
  v_lshlrev_b32 v72, 16, v130
  v_and_b32 v73, 0xffff0000, v130
  v_lshlrev_b32 v74, 16, v131
  v_and_b32 v75, 0xffff0000, v131
  v_lshlrev_b32 v76, 16, v132
  v_and_b32 v77, 0xffff0000, v132
  v_lshlrev_b32 v78, 16, v133
  v_and_b32 v79, 0xffff0000, v133
  s_waitcnt vmcnt(2)
  v_lshlrev_b32 v80, 16, v134
  v_and_b32 v81, 0xffff0000, v134
  v_lshlrev_b32 v82, 16, v135
  v_and_b32 v83, 0xffff0000, v135
  v_lshlrev_b32 v84, 16, v136
  v_and_b32 v85, 0xffff0000, v136
  v_lshlrev_b32 v86, 16, v137
  v_and_b32 v87, 0xffff0000, v137
  s_waitcnt vmcnt(1)
  v_lshlrev_b32 v88, 16, v138
  v_and_b32 v89, 0xffff0000, v138
  v_lshlrev_b32 v90, 16, v139
  v_and_b32 v91, 0xffff0000, v139
  v_lshlrev_b32 v92, 16, v140
  v_and_b32 v93, 0xffff0000, v140
  v_lshlrev_b32 v94, 16, v141
  v_and_b32 v95, 0xffff0000, v141
  s_waitcnt vmcnt(0)
  v_lshlrev_b32 v96, 16, v142
  v_and_b32 v97, 0xffff0000, v142
  v_lshlrev_b32 v98, 16, v143
  v_and_b32 v99, 0xffff0000, v143
  v_lshlrev_b32 v100, 16, v144
  v_and_b32 v101, 0xffff0000, v144
  v_lshlrev_b32 v102, 16, v145
  v_and_b32 v103, 0xffff0000, v145
  v_add_f32 v8, v32, v33
  v_add_f32 v9, v34, v35
  v_add_f32 v8, v8, v36
  v_add_f32 v9, v9, v37
  v_add_f32 v8, v8, v38
  v_add_f32 v9, v9, v39
  v_add_f32 v8, v8, v40
  v_add_f32 v9, v9, v41
  v_add_f32 v8, v8, v42
  v_add_f32 v9, v9, v43
  v_add_f32 v8, v8, v44
  v_add_f32 v9, v9, v45
  v_add_f32 v8, v8, v46
  v_add_f32 v9, v9, v47
  v_add_f32 v8, v8, v48
  v_add_f32 v9, v9, v49
  v_add_f32 v8, v8, v50
  v_add_f32 v9, v9, v51
  v_add_f32 v8, v8, v52
  v_add_f32 v9, v9, v53
  v_add_f32 v8, v8, v54
  v_add_f32 v9, v9, v55
  v_add_f32 v8, v8, v56
  v_add_f32 v9, v9, v57
  v_add_f32 v8, v8, v58
  v_add_f32 v9, v9, v59
  v_add_f32 v8, v8, v60
  v_add_f32 v9, v9, v61
  v_add_f32 v8, v8, v62
  v_add_f32 v9, v9, v63
  v_add_f32 v8, v8, v64
  v_add_f32 v9, v9, v65
  v_add_f32 v8, v8, v66
  v_add_f32 v9, v9, v67
  v_add_f32 v8, v8, v68
  v_add_f32 v9, v9, v69
  v_add_f32 v8, v8, v70
  v_add_f32 v9, v9, v71
  v_add_f32 v8, v8, v72
  v_add_f32 v9, v9, v73
  v_add_f32 v8, v8, v74
  v_add_f32 v9, v9, v75
  v_add_f32 v8, v8, v76
  v_add_f32 v9, v9, v77
  v_add_f32 v8, v8, v78
  v_add_f32 v9, v9, v79
  v_add_f32 v8, v8, v80
  v_add_f32 v9, v9, v81
  v_add_f32 v8, v8, v82
  v_add_f32 v9, v9, v83
  v_add_f32 v8, v8, v84
  v_add_f32 v9, v9, v85
  v_add_f32 v8, v8, v86
  v_add_f32 v9, v9, v87
  v_add_f32 v8, v8, v88
  v_add_f32 v9, v9, v89
  v_add_f32 v8, v8, v90
  v_add_f32 v9, v9, v91
  v_add_f32 v8, v8, v92
  v_add_f32 v9, v9, v93
  v_add_f32 v8, v8, v94
  v_add_f32 v9, v9, v95
  v_add_f32 v8, v8, v96
  v_add_f32 v9, v9, v97
  v_add_f32 v8, v8, v98
  v_add_f32 v9, v9, v99
  v_add_f32 v8, v8, v100
  v_add_f32 v9, v9, v101
  v_add_f32 v8, v8, v102
  v_add_f32 v9, v9, v103
  v_add_f32 v8, v8, v9
  v_mov_b32 v12, v8
  s_nop 1
  v_permlane32_swap_b32 v8, v12
  v_add_f32 v8, v8, v12
  s_lshl_b32 s43, s13, 7
  v_lshlrev_b32 v13, 2, v1
  v_add_u32 v14, s43, v13
  ds_write_b32 v14, v8 offset:0
  s_waitcnt lgkmcnt(0)
  s_barrier
  ds_read_b32 v16, v13 offset:0
  ds_read_b32 v17, v13 offset:128
  ds_read_b32 v18, v13 offset:256
  ds_read_b32 v19, v13 offset:384
  s_waitcnt lgkmcnt(2)
  v_add_f32 v16, v16, v17
  s_waitcnt lgkmcnt(0)
  v_add_f32 v18, v18, v19
  v_add_f32 v8, v16, v18
  s_mov_b32 s24, 0x3ae38e39
  v_mul_f32 v8, s24, v8
  v_sub_f32 v32, v32, v8
  v_sub_f32 v33, v33, v8
  v_sub_f32 v34, v34, v8
  v_sub_f32 v35, v35, v8
  v_sub_f32 v36, v36, v8
  v_sub_f32 v37, v37, v8
  v_sub_f32 v38, v38, v8
  v_sub_f32 v39, v39, v8
  v_sub_f32 v40, v40, v8
  v_sub_f32 v41, v41, v8
  v_sub_f32 v42, v42, v8
  v_sub_f32 v43, v43, v8
  v_sub_f32 v44, v44, v8
  v_sub_f32 v45, v45, v8
  v_sub_f32 v46, v46, v8
  v_sub_f32 v47, v47, v8
  v_sub_f32 v48, v48, v8
  v_sub_f32 v49, v49, v8
  v_sub_f32 v50, v50, v8
  v_sub_f32 v51, v51, v8
  v_sub_f32 v52, v52, v8
  v_sub_f32 v53, v53, v8
  v_sub_f32 v54, v54, v8
  v_sub_f32 v55, v55, v8
  v_sub_f32 v56, v56, v8
  v_sub_f32 v57, v57, v8
  v_sub_f32 v58, v58, v8
  v_sub_f32 v59, v59, v8
  v_sub_f32 v60, v60, v8
  v_sub_f32 v61, v61, v8
  v_sub_f32 v62, v62, v8
  v_sub_f32 v63, v63, v8
  v_sub_f32 v64, v64, v8
  v_sub_f32 v65, v65, v8
  v_sub_f32 v66, v66, v8
  v_sub_f32 v67, v67, v8
  v_sub_f32 v68, v68, v8
  v_sub_f32 v69, v69, v8
  v_sub_f32 v70, v70, v8
  v_sub_f32 v71, v71, v8
  v_sub_f32 v72, v72, v8
  v_sub_f32 v73, v73, v8
  v_sub_f32 v74, v74, v8
  v_sub_f32 v75, v75, v8
  v_sub_f32 v76, v76, v8
  v_sub_f32 v77, v77, v8
  v_sub_f32 v78, v78, v8
  v_sub_f32 v79, v79, v8
  v_sub_f32 v80, v80, v8
  v_sub_f32 v81, v81, v8
  v_sub_f32 v82, v82, v8
  v_sub_f32 v83, v83, v8
  v_sub_f32 v84, v84, v8
  v_sub_f32 v85, v85, v8
  v_sub_f32 v86, v86, v8
  v_sub_f32 v87, v87, v8
  v_sub_f32 v88, v88, v8
  v_sub_f32 v89, v89, v8
  v_sub_f32 v90, v90, v8
  v_sub_f32 v91, v91, v8
  v_sub_f32 v92, v92, v8
  v_sub_f32 v93, v93, v8
  v_sub_f32 v94, v94, v8
  v_sub_f32 v95, v95, v8
  v_sub_f32 v96, v96, v8
  v_sub_f32 v97, v97, v8
  v_sub_f32 v98, v98, v8
  v_sub_f32 v99, v99, v8
  v_sub_f32 v100, v100, v8
  v_sub_f32 v101, v101, v8
  v_sub_f32 v102, v102, v8
  v_sub_f32 v103, v103, v8
  v_mul_f32 v9, v32, v32
  v_mul_f32 v10, v33, v33
  v_fmac_f32 v9, v34, v34
  v_fmac_f32 v10, v35, v35
  v_fmac_f32 v9, v36, v36
  v_fmac_f32 v10, v37, v37
  v_fmac_f32 v9, v38, v38
  v_fmac_f32 v10, v39, v39
  v_fmac_f32 v9, v40, v40
  v_fmac_f32 v10, v41, v41
  v_fmac_f32 v9, v42, v42
  v_fmac_f32 v10, v43, v43
  v_fmac_f32 v9, v44, v44
  v_fmac_f32 v10, v45, v45
  v_fmac_f32 v9, v46, v46
  v_fmac_f32 v10, v47, v47
  v_fmac_f32 v9, v48, v48
  v_fmac_f32 v10, v49, v49
  v_fmac_f32 v9, v50, v50
  v_fmac_f32 v10, v51, v51
  v_fmac_f32 v9, v52, v52
  v_fmac_f32 v10, v53, v53
  v_fmac_f32 v9, v54, v54
  v_fmac_f32 v10, v55, v55
  v_fmac_f32 v9, v56, v56
  v_fmac_f32 v10, v57, v57
  v_fmac_f32 v9, v58, v58
  v_fmac_f32 v10, v59, v59
  v_fmac_f32 v9, v60, v60
  v_fmac_f32 v10, v61, v61
  v_fmac_f32 v9, v62, v62
  v_fmac_f32 v10, v63, v63
  v_fmac_f32 v9, v64, v64
  v_fmac_f32 v10, v65, v65
  v_fmac_f32 v9, v66, v66
  v_fmac_f32 v10, v67, v67
  v_fmac_f32 v9, v68, v68
  v_fmac_f32 v10, v69, v69
  v_fmac_f32 v9, v70, v70
  v_fmac_f32 v10, v71, v71
  v_fmac_f32 v9, v72, v72
  v_fmac_f32 v10, v73, v73
  v_fmac_f32 v9, v74, v74
  v_fmac_f32 v10, v75, v75
  v_fmac_f32 v9, v76, v76
  v_fmac_f32 v10, v77, v77
  v_fmac_f32 v9, v78, v78
  v_fmac_f32 v10, v79, v79
  v_fmac_f32 v9, v80, v80
  v_fmac_f32 v10, v81, v81
  v_fmac_f32 v9, v82, v82
  v_fmac_f32 v10, v83, v83
  v_fmac_f32 v9, v84, v84
  v_fmac_f32 v10, v85, v85
  v_fmac_f32 v9, v86, v86
  v_fmac_f32 v10, v87, v87
  v_fmac_f32 v9, v88, v88
  v_fmac_f32 v10, v89, v89
  v_fmac_f32 v9, v90, v90
  v_fmac_f32 v10, v91, v91
  v_fmac_f32 v9, v92, v92
  v_fmac_f32 v10, v93, v93
  v_fmac_f32 v9, v94, v94
  v_fmac_f32 v10, v95, v95
  v_fmac_f32 v9, v96, v96
  v_fmac_f32 v10, v97, v97
  v_fmac_f32 v9, v98, v98
  v_fmac_f32 v10, v99, v99
  v_fmac_f32 v9, v100, v100
  v_fmac_f32 v10, v101, v101
  v_fmac_f32 v9, v102, v102
  v_fmac_f32 v10, v103, v103
  v_add_f32 v9, v9, v10
  v_mov_b32 v12, v9
  s_nop 1
  v_permlane32_swap_b32 v9, v12
  v_add_f32 v9, v9, v12
  s_lshl_b32 s43, s13, 7
  v_lshlrev_b32 v13, 2, v1
  v_add_u32 v14, s43, v13
  ds_write_b32 v14, v9 offset:512
  s_waitcnt lgkmcnt(0)
  s_barrier
  ds_read_b32 v16, v13 offset:512
  ds_read_b32 v17, v13 offset:640
  ds_read_b32 v18, v13 offset:768
  ds_read_b32 v19, v13 offset:896
  s_waitcnt lgkmcnt(2)
  v_add_f32 v16, v16, v17
  s_waitcnt lgkmcnt(0)
  v_add_f32 v18, v18, v19
  v_add_f32 v9, v16, v18
  v_mov_b32 v10, 0x3727c5ac
  v_fmac_f32 v10, s24, v9
  v_rsq_f32 v10, v10
  s_nop 0
  v_mul_f32 v32, v32, v10
  v_mul_f32 v33, v33, v10
  v_mul_f32 v34, v34, v10
  v_mul_f32 v35, v35, v10
  v_mul_f32 v36, v36, v10
  v_mul_f32 v37, v37, v10
  v_mul_f32 v38, v38, v10
  v_mul_f32 v39, v39, v10
  v_mul_f32 v40, v40, v10
  v_mul_f32 v41, v41, v10
  v_mul_f32 v42, v42, v10
  v_mul_f32 v43, v43, v10
  v_mul_f32 v44, v44, v10
  v_mul_f32 v45, v45, v10
  v_mul_f32 v46, v46, v10
  v_mul_f32 v47, v47, v10
  v_mul_f32 v48, v48, v10
  v_mul_f32 v49, v49, v10
  v_mul_f32 v50, v50, v10
  v_mul_f32 v51, v51, v10
  v_mul_f32 v52, v52, v10
  v_mul_f32 v53, v53, v10
  v_mul_f32 v54, v54, v10
  v_mul_f32 v55, v55, v10
  v_mul_f32 v56, v56, v10
  v_mul_f32 v57, v57, v10
  v_mul_f32 v58, v58, v10
  v_mul_f32 v59, v59, v10
  v_mul_f32 v60, v60, v10
  v_mul_f32 v61, v61, v10
  v_mul_f32 v62, v62, v10
  v_mul_f32 v63, v63, v10
  v_mul_f32 v64, v64, v10
  v_mul_f32 v65, v65, v10
  v_mul_f32 v66, v66, v10
  v_mul_f32 v67, v67, v10
  v_mul_f32 v68, v68, v10
  v_mul_f32 v69, v69, v10
  v_mul_f32 v70, v70, v10
  v_mul_f32 v71, v71, v10
  v_mul_f32 v72, v72, v10
  v_mul_f32 v73, v73, v10
  v_mul_f32 v74, v74, v10
  v_mul_f32 v75, v75, v10
  v_mul_f32 v76, v76, v10
  v_mul_f32 v77, v77, v10
  v_mul_f32 v78, v78, v10
  v_mul_f32 v79, v79, v10
  v_mul_f32 v80, v80, v10
  v_mul_f32 v81, v81, v10
  v_mul_f32 v82, v82, v10
  v_mul_f32 v83, v83, v10
  v_mul_f32 v84, v84, v10
  v_mul_f32 v85, v85, v10
  v_mul_f32 v86, v86, v10
  v_mul_f32 v87, v87, v10
  v_mul_f32 v88, v88, v10
  v_mul_f32 v89, v89, v10
  v_mul_f32 v90, v90, v10
  v_mul_f32 v91, v91, v10
  v_mul_f32 v92, v92, v10
  v_mul_f32 v93, v93, v10
  v_mul_f32 v94, v94, v10
  v_mul_f32 v95, v95, v10
  v_mul_f32 v96, v96, v10
  v_mul_f32 v97, v97, v10
  v_mul_f32 v98, v98, v10
  v_mul_f32 v99, v99, v10
  v_mul_f32 v100, v100, v10
  v_mul_f32 v101, v101, v10
  v_mul_f32 v102, v102, v10
  v_mul_f32 v103, v103, v10
  s_cmp_eq_u32 s13, 3
  s_cbranch_scc0 Low_7
  v_mov_b32 v22, 0
  s_mov_b32 s42, 0x80808080
Lcw_8:
  global_load_dword v20, v22, s[16:17] sc0 sc1
  s_waitcnt vmcnt(0)
  v_and_b32 v21, s42, v20
  v_cmp_ne_u32 vcc, s42, v21
  s_cbranch_vccz Lcwo_9
  s_sleep 4
  s_sub_u32 s15, s15, 1
  s_cbranch_scc0 Lcw_8
  s_mov_b32 s15, 0
Lcwo_9:
  v_lshrrev_b32 v21, 4, v5
  v_min_u32 v21, 17, v21
  v_lshlrev_b32 v21, 7, v21
  s_mov_b32 s44, 40960
Lp_10:
  buffer_load_dword v20, v21, s[8:11], s44 offen sc1
  s_waitcnt vmcnt(0)
  v_cmp_gt_u32 vcc, 1, v20
  s_cbranch_vccz Lpo_11
  s_sleep 4
  s_sub_u32 s15, s15, 1
  s_cbranch_scc0 Lp_10
  s_mov_b32 s15, 0
Lpo_11:
Low_7:
  s_barrier
  v_lshlrev_b32 v4, 5, v2
  s_mov_b32 s42, 65536
  s_mov_b32 s43, 67840
  buffer_load_dwordx4 v[110:113], v4, s[8:11], s42 offen offset:0 sc1
  buffer_load_dwordx4 v[114:117], v4, s[8:11], s42 offen offset:16 sc1
  buffer_load_dwordx4 v[182:185], v4, s[8:11], s43 offen offset:0 sc1
  buffer_load_dwordx4 v[186:189], v4, s[8:11], s43 offen offset:16 sc1
  buffer_load_dwordx4 v[118:121], v4, s[8:11], s42 offen offset:256 sc1
  buffer_load_dwordx4 v[122:125], v4, s[8:11], s42 offen offset:272 sc1
  buffer_load_dwordx4 v[190:193], v4, s[8:11], s43 offen offset:256 sc1
  buffer_load_dwordx4 v[194:197], v4, s[8:11], s43 offen offset:272 sc1
  buffer_load_dwordx4 v[126:129], v4, s[8:11], s42 offen offset:512 sc1
  buffer_load_dwordx4 v[130:133], v4, s[8:11], s42 offen offset:528 sc1
  buffer_load_dwordx4 v[198:201], v4, s[8:11], s43 offen offset:512 sc1
  buffer_load_dwordx4 v[202:205], v4, s[8:11], s43 offen offset:528 sc1
  buffer_load_dwordx4 v[134:137], v4, s[8:11], s42 offen offset:768 sc1
  buffer_load_dwordx4 v[138:141], v4, s[8:11], s42 offen offset:784 sc1
  buffer_load_dwordx4 v[206:209], v4, s[8:11], s43 offen offset:768 sc1
  buffer_load_dwordx4 v[210:213], v4, s[8:11], s43 offen offset:784 sc1
  buffer_load_dwordx4 v[142:145], v4, s[8:11], s42 offen offset:1024 sc1
  buffer_load_dwordx4 v[146:149], v4, s[8:11], s42 offen offset:1040 sc1
  buffer_load_dwordx4 v[214:217], v4, s[8:11], s43 offen offset:1024 sc1
  buffer_load_dwordx4 v[218:221], v4, s[8:11], s43 offen offset:1040 sc1
  buffer_load_dwordx4 v[150:153], v4, s[8:11], s42 offen offset:1280 sc1
  buffer_load_dwordx4 v[154:157], v4, s[8:11], s42 offen offset:1296 sc1
  buffer_load_dwordx4 v[222:225], v4, s[8:11], s43 offen offset:1280 sc1
  buffer_load_dwordx4 v[226:229], v4, s[8:11], s43 offen offset:1296 sc1
  buffer_load_dwordx4 v[158:161], v4, s[8:11], s42 offen offset:1536 sc1
  buffer_load_dwordx4 v[162:165], v4, s[8:11], s42 offen offset:1552 sc1
  buffer_load_dwordx4 v[230:233], v4, s[8:11], s43 offen offset:1536 sc1
  buffer_load_dwordx4 v[234:237], v4, s[8:11], s43 offen offset:1552 sc1
  buffer_load_dwordx4 v[166:169], v4, s[8:11], s42 offen offset:1792 sc1
  buffer_load_dwordx4 v[170:173], v4, s[8:11], s42 offen offset:1808 sc1
  buffer_load_dwordx4 v[238:241], v4, s[8:11], s43 offen offset:1792 sc1
  buffer_load_dwordx4 v[242:245], v4, s[8:11], s43 offen offset:1808 sc1
  buffer_load_dwordx4 v[174:177], v4, s[8:11], s42 offen offset:2048 sc1
  buffer_load_dwordx4 v[178:181], v4, s[8:11], s42 offen offset:2064 sc1
  buffer_load_dwordx4 v[246:249], v4, s[8:11], s43 offen offset:2048 sc1
  buffer_load_dwordx4 v[250:253], v4, s[8:11], s43 offen offset:2064 sc1
  s_mul_i32 s44, s14, 36864
  s_lshl_b32 s45, s13, 10
  s_add_u32 s44, s44, s45
  s_add_u32 s44, s44, 2097152
  s_waitcnt vmcnt(33)
  v_fmac_f32 v110, v32, v182
  v_add_f32 v32, v32, v110
  v_fmac_f32 v111, v33, v183
  v_add_f32 v33, v33, v111
  v_fmac_f32 v112, v34, v184
  v_add_f32 v34, v34, v112
  v_fmac_f32 v113, v35, v185
  v_add_f32 v35, v35, v113
  s_waitcnt vmcnt(32)
  v_fmac_f32 v114, v36, v186
  v_add_f32 v36, v36, v114
  v_fmac_f32 v115, v37, v187
  v_add_f32 v37, v37, v115
  v_fmac_f32 v116, v38, v188
  v_add_f32 v38, v38, v116
  v_fmac_f32 v117, v39, v189
  v_add_f32 v39, v39, v117
  v_cvt_pk_bf16_f32 v24, v32, v33
  v_cvt_pk_bf16_f32 v25, v34, v35
  v_cvt_pk_bf16_f32 v26, v36, v37
  v_cvt_pk_bf16_f32 v27, v38, v39
  buffer_store_dwordx4 v[24:27], v5, s[8:11], s44 offen sc1
  s_add_u32 s44, s44, 4096
  s_waitcnt vmcnt(30)
  v_fmac_f32 v118, v40, v190
  v_add_f32 v40, v40, v118
  v_fmac_f32 v119, v41, v191
  v_add_f32 v41, v41, v119
  v_fmac_f32 v120, v42, v192
  v_add_f32 v42, v42, v120
  v_fmac_f32 v121, v43, v193
  v_add_f32 v43, v43, v121
  s_waitcnt vmcnt(29)
  v_fmac_f32 v122, v44, v194
  v_add_f32 v44, v44, v122
  v_fmac_f32 v123, v45, v195
  v_add_f32 v45, v45, v123
  v_fmac_f32 v124, v46, v196
  v_add_f32 v46, v46, v124
  v_fmac_f32 v125, v47, v197
  v_add_f32 v47, v47, v125
  v_cvt_pk_bf16_f32 v24, v40, v41
  v_cvt_pk_bf16_f32 v25, v42, v43
  v_cvt_pk_bf16_f32 v26, v44, v45
  v_cvt_pk_bf16_f32 v27, v46, v47
  buffer_store_dwordx4 v[24:27], v5, s[8:11], s44 offen sc1
  s_add_u32 s44, s44, 4096
  s_waitcnt vmcnt(27)
  v_fmac_f32 v126, v48, v198
  v_add_f32 v48, v48, v126
  v_fmac_f32 v127, v49, v199
  v_add_f32 v49, v49, v127
  v_fmac_f32 v128, v50, v200
  v_add_f32 v50, v50, v128
  v_fmac_f32 v129, v51, v201
  v_add_f32 v51, v51, v129
  s_waitcnt vmcnt(26)
  v_fmac_f32 v130, v52, v202
  v_add_f32 v52, v52, v130
  v_fmac_f32 v131, v53, v203
  v_add_f32 v53, v53, v131
  v_fmac_f32 v132, v54, v204
  v_add_f32 v54, v54, v132
  v_fmac_f32 v133, v55, v205
  v_add_f32 v55, v55, v133
  v_cvt_pk_bf16_f32 v24, v48, v49
  v_cvt_pk_bf16_f32 v25, v50, v51
  v_cvt_pk_bf16_f32 v26, v52, v53
  v_cvt_pk_bf16_f32 v27, v54, v55
  buffer_store_dwordx4 v[24:27], v5, s[8:11], s44 offen sc1
  s_add_u32 s44, s44, 4096
  s_waitcnt vmcnt(24)
  v_fmac_f32 v134, v56, v206
  v_add_f32 v56, v56, v134
  v_fmac_f32 v135, v57, v207
  v_add_f32 v57, v57, v135
  v_fmac_f32 v136, v58, v208
  v_add_f32 v58, v58, v136
  v_fmac_f32 v137, v59, v209
  v_add_f32 v59, v59, v137
  s_waitcnt vmcnt(23)
  v_fmac_f32 v138, v60, v210
  v_add_f32 v60, v60, v138
  v_fmac_f32 v139, v61, v211
  v_add_f32 v61, v61, v139
  v_fmac_f32 v140, v62, v212
  v_add_f32 v62, v62, v140
  v_fmac_f32 v141, v63, v213
  v_add_f32 v63, v63, v141
  v_cvt_pk_bf16_f32 v24, v56, v57
  v_cvt_pk_bf16_f32 v25, v58, v59
  v_cvt_pk_bf16_f32 v26, v60, v61
  v_cvt_pk_bf16_f32 v27, v62, v63
  buffer_store_dwordx4 v[24:27], v5, s[8:11], s44 offen sc1
  s_add_u32 s44, s44, 4096
  s_waitcnt vmcnt(21)
  v_fmac_f32 v142, v64, v214
  v_add_f32 v64, v64, v142
  v_fmac_f32 v143, v65, v215
  v_add_f32 v65, v65, v143
  v_fmac_f32 v144, v66, v216
  v_add_f32 v66, v66, v144
  v_fmac_f32 v145, v67, v217
  v_add_f32 v67, v67, v145
  s_waitcnt vmcnt(20)
  v_fmac_f32 v146, v68, v218
  v_add_f32 v68, v68, v146
  v_fmac_f32 v147, v69, v219
  v_add_f32 v69, v69, v147
  v_fmac_f32 v148, v70, v220
  v_add_f32 v70, v70, v148
  v_fmac_f32 v149, v71, v221
  v_add_f32 v71, v71, v149
  v_cvt_pk_bf16_f32 v24, v64, v65
  v_cvt_pk_bf16_f32 v25, v66, v67
  v_cvt_pk_bf16_f32 v26, v68, v69
  v_cvt_pk_bf16_f32 v27, v70, v71
  buffer_store_dwordx4 v[24:27], v5, s[8:11], s44 offen sc1
  s_add_u32 s44, s44, 4096
  s_waitcnt vmcnt(18)
  v_fmac_f32 v150, v72, v222
  v_add_f32 v72, v72, v150
  v_fmac_f32 v151, v73, v223
  v_add_f32 v73, v73, v151
  v_fmac_f32 v152, v74, v224
  v_add_f32 v74, v74, v152
  v_fmac_f32 v153, v75, v225
  v_add_f32 v75, v75, v153
  s_waitcnt vmcnt(17)
  v_fmac_f32 v154, v76, v226
  v_add_f32 v76, v76, v154
  v_fmac_f32 v155, v77, v227
  v_add_f32 v77, v77, v155
  v_fmac_f32 v156, v78, v228
  v_add_f32 v78, v78, v156
  v_fmac_f32 v157, v79, v229
  v_add_f32 v79, v79, v157
  v_cvt_pk_bf16_f32 v24, v72, v73
  v_cvt_pk_bf16_f32 v25, v74, v75
  v_cvt_pk_bf16_f32 v26, v76, v77
  v_cvt_pk_bf16_f32 v27, v78, v79
  buffer_store_dwordx4 v[24:27], v5, s[8:11], s44 offen sc1
  s_add_u32 s44, s44, 4096
  s_waitcnt vmcnt(15)
  v_fmac_f32 v158, v80, v230
  v_add_f32 v80, v80, v158
  v_fmac_f32 v159, v81, v231
  v_add_f32 v81, v81, v159
  v_fmac_f32 v160, v82, v232
  v_add_f32 v82, v82, v160
  v_fmac_f32 v161, v83, v233
  v_add_f32 v83, v83, v161
  s_waitcnt vmcnt(14)
  v_fmac_f32 v162, v84, v234
  v_add_f32 v84, v84, v162
  v_fmac_f32 v163, v85, v235
  v_add_f32 v85, v85, v163
  v_fmac_f32 v164, v86, v236
  v_add_f32 v86, v86, v164
  v_fmac_f32 v165, v87, v237
  v_add_f32 v87, v87, v165
  v_cvt_pk_bf16_f32 v24, v80, v81
  v_cvt_pk_bf16_f32 v25, v82, v83
  v_cvt_pk_bf16_f32 v26, v84, v85
  v_cvt_pk_bf16_f32 v27, v86, v87
  buffer_store_dwordx4 v[24:27], v5, s[8:11], s44 offen sc1
  s_add_u32 s44, s44, 4096
  s_waitcnt vmcnt(12)
  v_fmac_f32 v166, v88, v238
  v_add_f32 v88, v88, v166
  v_fmac_f32 v167, v89, v239
  v_add_f32 v89, v89, v167
  v_fmac_f32 v168, v90, v240
  v_add_f32 v90, v90, v168
  v_fmac_f32 v169, v91, v241
  v_add_f32 v91, v91, v169
  s_waitcnt vmcnt(11)
  v_fmac_f32 v170, v92, v242
  v_add_f32 v92, v92, v170
  v_fmac_f32 v171, v93, v243
  v_add_f32 v93, v93, v171
  v_fmac_f32 v172, v94, v244
  v_add_f32 v94, v94, v172
  v_fmac_f32 v173, v95, v245
  v_add_f32 v95, v95, v173
  v_cvt_pk_bf16_f32 v24, v88, v89
  v_cvt_pk_bf16_f32 v25, v90, v91
  v_cvt_pk_bf16_f32 v26, v92, v93
  v_cvt_pk_bf16_f32 v27, v94, v95
  buffer_store_dwordx4 v[24:27], v5, s[8:11], s44 offen sc1
  s_add_u32 s44, s44, 4096
  s_waitcnt vmcnt(9)
  v_fmac_f32 v174, v96, v246
  v_add_f32 v96, v96, v174
  v_fmac_f32 v175, v97, v247
  v_add_f32 v97, v97, v175
  v_fmac_f32 v176, v98, v248
  v_add_f32 v98, v98, v176
  v_fmac_f32 v177, v99, v249
  v_add_f32 v99, v99, v177
  s_waitcnt vmcnt(8)
  v_fmac_f32 v178, v100, v250
  v_add_f32 v100, v100, v178
  v_fmac_f32 v179, v101, v251
  v_add_f32 v101, v101, v179
  v_fmac_f32 v180, v102, v252
  v_add_f32 v102, v102, v180
  v_fmac_f32 v181, v103, v253
  v_add_f32 v103, v103, v181
  v_cvt_pk_bf16_f32 v24, v96, v97
  v_cvt_pk_bf16_f32 v25, v98, v99
  v_cvt_pk_bf16_f32 v26, v100, v101
  v_cvt_pk_bf16_f32 v27, v102, v103
  buffer_store_dwordx4 v[24:27], v5, s[8:11], s44 offen sc1
  s_add_u32 s44, s44, 4096
  s_lshl_b32 s44, s14, 7
  s_add_u32 s44, s44, 47872
  s_waitcnt vmcnt(0)
  s_barrier
  s_cmp_eq_u32 s13, 0
  s_cbranch_scc0 Lfs_12
  v_mov_b32 v20, 1
  s_mov_b64 exec, 1
  buffer_store_dword v20, off, s[8:11], s44 sc1
  s_mov_b64 exec, -1
Lfs_12:
  s_branch Lpredone
Lmodt:
  s_cmp_ge_u32 s12, 27
  s_cbranch_scc1 Lpredone
  s_sub_u32 s14, s3, 3
  s_mul_i32 s14, s14, 27
  s_add_u32 s14, s14, s12
  s_load_dwordx2 s[4:5], s[0:1], 88
  s_mov_b32 s6, 1152
  s_mov_b32 s7, 0x20000
  s_load_dwordx2 s[20:21], s[0:1], 96
  s_mov_b32 s22, 3981312
  s_mov_b32 s23, 0x20000
  v_lshlrev_b32 v1, 1, v0
  v_and_b32 v2, 7, v0
  v_lshrrev_b32 v3, 3, v0
  v_mul_u32_u24 v4, 6912, v3
  v_lshl_add_u32 v4, v2, 4, v4
  s_lshl_b32 s42, s14, 7
  s_waitcnt lgkmcnt(0)
  buffer_load_ushort v8, v1, s[4:7], 0 offen
  buffer_load_ushort v9, v1, s[4:7], 0 offen offset:512
  buffer_load_ushort v10, v1, s[4:7], 0 offen offset:1024
  s_add_u32 s43, s42, 0
  buffer_load_dwordx4 v[32:35], v4, s[20:23], s43 offen
  s_add_u32 s43, s42, 221184
  buffer_load_dwordx4 v[36:39], v4, s[20:23], s43 offen
  s_add_u32 s43, s42, 442368
  buffer_load_dwordx4 v[40:43], v4, s[20:23], s43 offen
  s_add_u32 s43, s42, 663552
  buffer_load_dwordx4 v[44:47], v4, s[20:23], s43 offen
  s_add_u32 s43, s42, 884736
  buffer_load_dwordx4 v[48:51], v4, s[20:23], s43 offen
  s_add_u32 s43, s42, 1105920
  buffer_load_dwordx4 v[52:55], v4, s[20:23], s43 offen
  s_add_u32 s43, s42, 1327104
  buffer_load_dwordx4 v[56:59], v4, s[20:23], s43 offen
  s_add_u32 s43, s42, 1548288
  buffer_load_dwordx4 v[60:63], v4, s[20:23], s43 offen
  s_add_u32 s43, s42, 1769472
  buffer_load_dwordx4 v[64:67], v4, s[20:23], s43 offen
  s_add_u32 s43, s42, 1990656
  buffer_load_dwordx4 v[68:71], v4, s[20:23], s43 offen
  s_add_u32 s43, s42, 2211840
  buffer_load_dwordx4 v[72:75], v4, s[20:23], s43 offen
  s_add_u32 s43, s42, 2433024
  buffer_load_dwordx4 v[76:79], v4, s[20:23], s43 offen
  s_add_u32 s43, s42, 2654208
  buffer_load_dwordx4 v[80:83], v4, s[20:23], s43 offen
  s_add_u32 s43, s42, 2875392
  buffer_load_dwordx4 v[84:87], v4, s[20:23], s43 offen
  s_add_u32 s43, s42, 3096576
  buffer_load_dwordx4 v[88:91], v4, s[20:23], s43 offen
  s_add_u32 s43, s42, 3317760
  buffer_load_dwordx4 v[92:95], v4, s[20:23], s43 offen
  s_add_u32 s43, s42, 3538944
  buffer_load_dwordx4 v[96:99], v4, s[20:23], s43 offen
  s_add_u32 s43, s42, 3760128
  buffer_load_dwordx4 v[100:103], v4, s[20:23], s43 offen
  s_mov_b32 s24, 0xbfb8aa3b
  s_waitcnt vmcnt(20)
  v_lshlrev_b32 v8, 16, v8
  v_mul_f32 v12, s24, v8
  v_exp_f32 v12, v12
  s_nop 0
  v_add_f32 v12, 1.0, v12
  v_rcp_f32 v12, v12
  s_nop 0
  v_mul_f32 v8, v8, v12
  v_cvt_pk_bf16_f32 v8, v8, v8
  v_and_b32 v8, 0xffff0000, v8
  s_waitcnt vmcnt(19)
  v_lshlrev_b32 v9, 16, v9
  v_mul_f32 v12, s24, v9
  v_exp_f32 v12, v12
  s_nop 0
  v_add_f32 v12, 1.0, v12
  v_rcp_f32 v12, v12
  s_nop 0
  v_mul_f32 v9, v9, v12
  v_cvt_pk_bf16_f32 v9, v9, v9
  v_and_b32 v9, 0xffff0000, v9
  s_waitcnt vmcnt(18)
  v_lshlrev_b32 v10, 16, v10
  v_mul_f32 v12, s24, v10
  v_exp_f32 v12, v12
  s_nop 0
  v_add_f32 v12, 1.0, v12
  v_rcp_f32 v12, v12
  s_nop 0
  v_mul_f32 v10, v10, v12
  v_cvt_pk_bf16_f32 v10, v10, v10
  v_and_b32 v10, 0xffff0000, v10
  v_lshlrev_b32 v1, 2, v0
  ds_write_b32 v1, v8
  ds_write_b32 v1, v9 offset:1024
  ds_write_b32 v1, v10 offset:2048
  v_lshlrev_b32 v5, 2, v3
  s_waitcnt lgkmcnt(0)
  s_barrier
  ds_read_b32 v110, v5 offset:0
  ds_read_b32 v111, v5 offset:128
  ds_read_b32 v112, v5 offset:256
  ds_read_b32 v113, v5 offset:384
  ds_read_b32 v114, v5 offset:512
  ds_read_b32 v115, v5 offset:640
  ds_read_b32 v116, v5 offset:768
  ds_read_b32 v117, v5 offset:896
  ds_read_b32 v118, v5 offset:1024
  ds_read_b32 v119, v5 offset:1152
  ds_read_b32 v120, v5 offset:1280
  ds_read_b32 v121, v5 offset:1408
  ds_read_b32 v122, v5 offset:1536
  ds_read_b32 v123, v5 offset:1664
  ds_read_b32 v124, v5 offset:1792
  ds_read_b32 v125, v5 offset:1920
  ds_read_b32 v126, v5 offset:2048
  ds_read_b32 v127, v5 offset:2176
  v_mov_b32 v16, 0
  v_mov_b32 v17, 0
  v_mov_b32 v18, 0
  v_mov_b32 v19, 0
  v_mov_b32 v20, 0
  v_mov_b32 v21, 0
  v_mov_b32 v22, 0
  v_mov_b32 v23, 0
  s_waitcnt vmcnt(17)
  v_lshlrev_b32 v12, 16, v32
  v_and_b32 v13, 0xffff0000, v32
  s_waitcnt lgkmcnt(15)
  v_fmac_f32 v16, v12, v110
  v_fmac_f32 v17, v13, v110
  v_lshlrev_b32 v12, 16, v33
  v_and_b32 v13, 0xffff0000, v33
  v_fmac_f32 v18, v12, v110
  v_fmac_f32 v19, v13, v110
  v_lshlrev_b32 v12, 16, v34
  v_and_b32 v13, 0xffff0000, v34
  v_fmac_f32 v20, v12, v110
  v_fmac_f32 v21, v13, v110
  v_lshlrev_b32 v12, 16, v35
  v_and_b32 v13, 0xffff0000, v35
  v_fmac_f32 v22, v12, v110
  v_fmac_f32 v23, v13, v110
  s_waitcnt vmcnt(16)
  v_lshlrev_b32 v12, 16, v36
  v_and_b32 v13, 0xffff0000, v36
  v_fmac_f32 v16, v12, v111
  v_fmac_f32 v17, v13, v111
  v_lshlrev_b32 v12, 16, v37
  v_and_b32 v13, 0xffff0000, v37
  v_fmac_f32 v18, v12, v111
  v_fmac_f32 v19, v13, v111
  v_lshlrev_b32 v12, 16, v38
  v_and_b32 v13, 0xffff0000, v38
  v_fmac_f32 v20, v12, v111
  v_fmac_f32 v21, v13, v111
  v_lshlrev_b32 v12, 16, v39
  v_and_b32 v13, 0xffff0000, v39
  v_fmac_f32 v22, v12, v111
  v_fmac_f32 v23, v13, v111
  s_waitcnt vmcnt(15)
  v_lshlrev_b32 v12, 16, v40
  v_and_b32 v13, 0xffff0000, v40
  v_fmac_f32 v16, v12, v112
  v_fmac_f32 v17, v13, v112
  v_lshlrev_b32 v12, 16, v41
  v_and_b32 v13, 0xffff0000, v41
  v_fmac_f32 v18, v12, v112
  v_fmac_f32 v19, v13, v112
  v_lshlrev_b32 v12, 16, v42
  v_and_b32 v13, 0xffff0000, v42
  v_fmac_f32 v20, v12, v112
  v_fmac_f32 v21, v13, v112
  v_lshlrev_b32 v12, 16, v43
  v_and_b32 v13, 0xffff0000, v43
  v_fmac_f32 v22, v12, v112
  v_fmac_f32 v23, v13, v112
  s_waitcnt vmcnt(14)
  v_lshlrev_b32 v12, 16, v44
  v_and_b32 v13, 0xffff0000, v44
  s_waitcnt lgkmcnt(14)
  v_fmac_f32 v16, v12, v113
  v_fmac_f32 v17, v13, v113
  v_lshlrev_b32 v12, 16, v45
  v_and_b32 v13, 0xffff0000, v45
  v_fmac_f32 v18, v12, v113
  v_fmac_f32 v19, v13, v113
  v_lshlrev_b32 v12, 16, v46
  v_and_b32 v13, 0xffff0000, v46
  v_fmac_f32 v20, v12, v113
  v_fmac_f32 v21, v13, v113
  v_lshlrev_b32 v12, 16, v47
  v_and_b32 v13, 0xffff0000, v47
  v_fmac_f32 v22, v12, v113
  v_fmac_f32 v23, v13, v113
  s_waitcnt vmcnt(13)
  v_lshlrev_b32 v12, 16, v48
  v_and_b32 v13, 0xffff0000, v48
  s_waitcnt lgkmcnt(13)
  v_fmac_f32 v16, v12, v114
  v_fmac_f32 v17, v13, v114
  v_lshlrev_b32 v12, 16, v49
  v_and_b32 v13, 0xffff0000, v49
  v_fmac_f32 v18, v12, v114
  v_fmac_f32 v19, v13, v114
  v_lshlrev_b32 v12, 16, v50
  v_and_b32 v13, 0xffff0000, v50
  v_fmac_f32 v20, v12, v114
  v_fmac_f32 v21, v13, v114
  v_lshlrev_b32 v12, 16, v51
  v_and_b32 v13, 0xffff0000, v51
  v_fmac_f32 v22, v12, v114
  v_fmac_f32 v23, v13, v114
  s_waitcnt vmcnt(12)
  v_lshlrev_b32 v12, 16, v52
  v_and_b32 v13, 0xffff0000, v52
  s_waitcnt lgkmcnt(12)
  v_fmac_f32 v16, v12, v115
  v_fmac_f32 v17, v13, v115
  v_lshlrev_b32 v12, 16, v53
  v_and_b32 v13, 0xffff0000, v53
  v_fmac_f32 v18, v12, v115
  v_fmac_f32 v19, v13, v115
  v_lshlrev_b32 v12, 16, v54
  v_and_b32 v13, 0xffff0000, v54
  v_fmac_f32 v20, v12, v115
  v_fmac_f32 v21, v13, v115
  v_lshlrev_b32 v12, 16, v55
  v_and_b32 v13, 0xffff0000, v55
  v_fmac_f32 v22, v12, v115
  v_fmac_f32 v23, v13, v115
  s_waitcnt vmcnt(11)
  v_lshlrev_b32 v12, 16, v56
  v_and_b32 v13, 0xffff0000, v56
  s_waitcnt lgkmcnt(11)
  v_fmac_f32 v16, v12, v116
  v_fmac_f32 v17, v13, v116
  v_lshlrev_b32 v12, 16, v57
  v_and_b32 v13, 0xffff0000, v57
  v_fmac_f32 v18, v12, v116
  v_fmac_f32 v19, v13, v116
  v_lshlrev_b32 v12, 16, v58
  v_and_b32 v13, 0xffff0000, v58
  v_fmac_f32 v20, v12, v116
  v_fmac_f32 v21, v13, v116
  v_lshlrev_b32 v12, 16, v59
  v_and_b32 v13, 0xffff0000, v59
  v_fmac_f32 v22, v12, v116
  v_fmac_f32 v23, v13, v116
  s_waitcnt vmcnt(10)
  v_lshlrev_b32 v12, 16, v60
  v_and_b32 v13, 0xffff0000, v60
  s_waitcnt lgkmcnt(10)
  v_fmac_f32 v16, v12, v117
  v_fmac_f32 v17, v13, v117
  v_lshlrev_b32 v12, 16, v61
  v_and_b32 v13, 0xffff0000, v61
  v_fmac_f32 v18, v12, v117
  v_fmac_f32 v19, v13, v117
  v_lshlrev_b32 v12, 16, v62
  v_and_b32 v13, 0xffff0000, v62
  v_fmac_f32 v20, v12, v117
  v_fmac_f32 v21, v13, v117
  v_lshlrev_b32 v12, 16, v63
  v_and_b32 v13, 0xffff0000, v63
  v_fmac_f32 v22, v12, v117
  v_fmac_f32 v23, v13, v117
  s_waitcnt vmcnt(9)
  v_lshlrev_b32 v12, 16, v64
  v_and_b32 v13, 0xffff0000, v64
  s_waitcnt lgkmcnt(9)
  v_fmac_f32 v16, v12, v118
  v_fmac_f32 v17, v13, v118
  v_lshlrev_b32 v12, 16, v65
  v_and_b32 v13, 0xffff0000, v65
  v_fmac_f32 v18, v12, v118
  v_fmac_f32 v19, v13, v118
  v_lshlrev_b32 v12, 16, v66
  v_and_b32 v13, 0xffff0000, v66
  v_fmac_f32 v20, v12, v118
  v_fmac_f32 v21, v13, v118
  v_lshlrev_b32 v12, 16, v67
  v_and_b32 v13, 0xffff0000, v67
  v_fmac_f32 v22, v12, v118
  v_fmac_f32 v23, v13, v118
  s_waitcnt vmcnt(8)
  v_lshlrev_b32 v12, 16, v68
  v_and_b32 v13, 0xffff0000, v68
  s_waitcnt lgkmcnt(8)
  v_fmac_f32 v16, v12, v119
  v_fmac_f32 v17, v13, v119
  v_lshlrev_b32 v12, 16, v69
  v_and_b32 v13, 0xffff0000, v69
  v_fmac_f32 v18, v12, v119
  v_fmac_f32 v19, v13, v119
  v_lshlrev_b32 v12, 16, v70
  v_and_b32 v13, 0xffff0000, v70
  v_fmac_f32 v20, v12, v119
  v_fmac_f32 v21, v13, v119
  v_lshlrev_b32 v12, 16, v71
  v_and_b32 v13, 0xffff0000, v71
  v_fmac_f32 v22, v12, v119
  v_fmac_f32 v23, v13, v119
  s_waitcnt vmcnt(7)
  v_lshlrev_b32 v12, 16, v72
  v_and_b32 v13, 0xffff0000, v72
  s_waitcnt lgkmcnt(7)
  v_fmac_f32 v16, v12, v120
  v_fmac_f32 v17, v13, v120
  v_lshlrev_b32 v12, 16, v73
  v_and_b32 v13, 0xffff0000, v73
  v_fmac_f32 v18, v12, v120
  v_fmac_f32 v19, v13, v120
  v_lshlrev_b32 v12, 16, v74
  v_and_b32 v13, 0xffff0000, v74
  v_fmac_f32 v20, v12, v120
  v_fmac_f32 v21, v13, v120
  v_lshlrev_b32 v12, 16, v75
  v_and_b32 v13, 0xffff0000, v75
  v_fmac_f32 v22, v12, v120
  v_fmac_f32 v23, v13, v120
  s_waitcnt vmcnt(6)
  v_lshlrev_b32 v12, 16, v76
  v_and_b32 v13, 0xffff0000, v76
  s_waitcnt lgkmcnt(6)
  v_fmac_f32 v16, v12, v121
  v_fmac_f32 v17, v13, v121
  v_lshlrev_b32 v12, 16, v77
  v_and_b32 v13, 0xffff0000, v77
  v_fmac_f32 v18, v12, v121
  v_fmac_f32 v19, v13, v121
  v_lshlrev_b32 v12, 16, v78
  v_and_b32 v13, 0xffff0000, v78
  v_fmac_f32 v20, v12, v121
  v_fmac_f32 v21, v13, v121
  v_lshlrev_b32 v12, 16, v79
  v_and_b32 v13, 0xffff0000, v79
  v_fmac_f32 v22, v12, v121
  v_fmac_f32 v23, v13, v121
  s_waitcnt vmcnt(5)
  v_lshlrev_b32 v12, 16, v80
  v_and_b32 v13, 0xffff0000, v80
  s_waitcnt lgkmcnt(5)
  v_fmac_f32 v16, v12, v122
  v_fmac_f32 v17, v13, v122
  v_lshlrev_b32 v12, 16, v81
  v_and_b32 v13, 0xffff0000, v81
  v_fmac_f32 v18, v12, v122
  v_fmac_f32 v19, v13, v122
  v_lshlrev_b32 v12, 16, v82
  v_and_b32 v13, 0xffff0000, v82
  v_fmac_f32 v20, v12, v122
  v_fmac_f32 v21, v13, v122
  v_lshlrev_b32 v12, 16, v83
  v_and_b32 v13, 0xffff0000, v83
  v_fmac_f32 v22, v12, v122
  v_fmac_f32 v23, v13, v122
  s_waitcnt vmcnt(4)
  v_lshlrev_b32 v12, 16, v84
  v_and_b32 v13, 0xffff0000, v84
  s_waitcnt lgkmcnt(4)
  v_fmac_f32 v16, v12, v123
  v_fmac_f32 v17, v13, v123
  v_lshlrev_b32 v12, 16, v85
  v_and_b32 v13, 0xffff0000, v85
  v_fmac_f32 v18, v12, v123
  v_fmac_f32 v19, v13, v123
  v_lshlrev_b32 v12, 16, v86
  v_and_b32 v13, 0xffff0000, v86
  v_fmac_f32 v20, v12, v123
  v_fmac_f32 v21, v13, v123
  v_lshlrev_b32 v12, 16, v87
  v_and_b32 v13, 0xffff0000, v87
  v_fmac_f32 v22, v12, v123
  v_fmac_f32 v23, v13, v123
  s_waitcnt vmcnt(3)
  v_lshlrev_b32 v12, 16, v88
  v_and_b32 v13, 0xffff0000, v88
  s_waitcnt lgkmcnt(3)
  v_fmac_f32 v16, v12, v124
  v_fmac_f32 v17, v13, v124
  v_lshlrev_b32 v12, 16, v89
  v_and_b32 v13, 0xffff0000, v89
  v_fmac_f32 v18, v12, v124
  v_fmac_f32 v19, v13, v124
  v_lshlrev_b32 v12, 16, v90
  v_and_b32 v13, 0xffff0000, v90
  v_fmac_f32 v20, v12, v124
  v_fmac_f32 v21, v13, v124
  v_lshlrev_b32 v12, 16, v91
  v_and_b32 v13, 0xffff0000, v91
  v_fmac_f32 v22, v12, v124
  v_fmac_f32 v23, v13, v124
  s_waitcnt vmcnt(2)
  v_lshlrev_b32 v12, 16, v92
  v_and_b32 v13, 0xffff0000, v92
  s_waitcnt lgkmcnt(2)
  v_fmac_f32 v16, v12, v125
  v_fmac_f32 v17, v13, v125
  v_lshlrev_b32 v12, 16, v93
  v_and_b32 v13, 0xffff0000, v93
  v_fmac_f32 v18, v12, v125
  v_fmac_f32 v19, v13, v125
  v_lshlrev_b32 v12, 16, v94
  v_and_b32 v13, 0xffff0000, v94
  v_fmac_f32 v20, v12, v125
  v_fmac_f32 v21, v13, v125
  v_lshlrev_b32 v12, 16, v95
  v_and_b32 v13, 0xffff0000, v95
  v_fmac_f32 v22, v12, v125
  v_fmac_f32 v23, v13, v125
  s_waitcnt vmcnt(1)
  v_lshlrev_b32 v12, 16, v96
  v_and_b32 v13, 0xffff0000, v96
  s_waitcnt lgkmcnt(1)
  v_fmac_f32 v16, v12, v126
  v_fmac_f32 v17, v13, v126
  v_lshlrev_b32 v12, 16, v97
  v_and_b32 v13, 0xffff0000, v97
  v_fmac_f32 v18, v12, v126
  v_fmac_f32 v19, v13, v126
  v_lshlrev_b32 v12, 16, v98
  v_and_b32 v13, 0xffff0000, v98
  v_fmac_f32 v20, v12, v126
  v_fmac_f32 v21, v13, v126
  v_lshlrev_b32 v12, 16, v99
  v_and_b32 v13, 0xffff0000, v99
  v_fmac_f32 v22, v12, v126
  v_fmac_f32 v23, v13, v126
  s_waitcnt vmcnt(0)
  v_lshlrev_b32 v12, 16, v100
  v_and_b32 v13, 0xffff0000, v100
  s_waitcnt lgkmcnt(0)
  v_fmac_f32 v16, v12, v127
  v_fmac_f32 v17, v13, v127
  v_lshlrev_b32 v12, 16, v101
  v_and_b32 v13, 0xffff0000, v101
  v_fmac_f32 v18, v12, v127
  v_fmac_f32 v19, v13, v127
  v_lshlrev_b32 v12, 16, v102
  v_and_b32 v13, 0xffff0000, v102
  v_fmac_f32 v20, v12, v127
  v_fmac_f32 v21, v13, v127
  v_lshlrev_b32 v12, 16, v103
  v_and_b32 v13, 0xffff0000, v103
  v_fmac_f32 v22, v12, v127
  v_fmac_f32 v23, v13, v127
  v_add_f32_dpp v16, v16, v16 row_ror:8 row_mask:0xf bank_mask:0xf
  v_mov_b32 v12, v16
  s_nop 1
  v_permlane16_swap_b32 v16, v12
  v_add_f32 v16, v16, v12
  v_mov_b32 v12, v16
  s_nop 1
  v_permlane32_swap_b32 v16, v12
  v_add_f32 v16, v16, v12
  v_add_f32_dpp v17, v17, v17 row_ror:8 row_mask:0xf bank_mask:0xf
  v_mov_b32 v12, v17
  s_nop 1
  v_permlane16_swap_b32 v17, v12
  v_add_f32 v17, v17, v12
  v_mov_b32 v12, v17
  s_nop 1
  v_permlane32_swap_b32 v17, v12
  v_add_f32 v17, v17, v12
  v_add_f32_dpp v18, v18, v18 row_ror:8 row_mask:0xf bank_mask:0xf
  v_mov_b32 v12, v18
  s_nop 1
  v_permlane16_swap_b32 v18, v12
  v_add_f32 v18, v18, v12
  v_mov_b32 v12, v18
  s_nop 1
  v_permlane32_swap_b32 v18, v12
  v_add_f32 v18, v18, v12
  v_add_f32_dpp v19, v19, v19 row_ror:8 row_mask:0xf bank_mask:0xf
  v_mov_b32 v12, v19
  s_nop 1
  v_permlane16_swap_b32 v19, v12
  v_add_f32 v19, v19, v12
  v_mov_b32 v12, v19
  s_nop 1
  v_permlane32_swap_b32 v19, v12
  v_add_f32 v19, v19, v12
  v_add_f32_dpp v20, v20, v20 row_ror:8 row_mask:0xf bank_mask:0xf
  v_mov_b32 v12, v20
  s_nop 1
  v_permlane16_swap_b32 v20, v12
  v_add_f32 v20, v20, v12
  v_mov_b32 v12, v20
  s_nop 1
  v_permlane32_swap_b32 v20, v12
  v_add_f32 v20, v20, v12
  v_add_f32_dpp v21, v21, v21 row_ror:8 row_mask:0xf bank_mask:0xf
  v_mov_b32 v12, v21
  s_nop 1
  v_permlane16_swap_b32 v21, v12
  v_add_f32 v21, v21, v12
  v_mov_b32 v12, v21
  s_nop 1
  v_permlane32_swap_b32 v21, v12
  v_add_f32 v21, v21, v12
  v_add_f32_dpp v22, v22, v22 row_ror:8 row_mask:0xf bank_mask:0xf
  v_mov_b32 v12, v22
  s_nop 1
  v_permlane16_swap_b32 v22, v12
  v_add_f32 v22, v22, v12
  v_mov_b32 v12, v22
  s_nop 1
  v_permlane32_swap_b32 v22, v12
  v_add_f32 v22, v22, v12
  v_add_f32_dpp v23, v23, v23 row_ror:8 row_mask:0xf bank_mask:0xf
  v_mov_b32 v12, v23
  s_nop 1
  v_permlane16_swap_b32 v23, v12
  v_add_f32 v23, v23, v12
  v_mov_b32 v12, v23
  s_nop 1
  v_permlane32_swap_b32 v23, v12
  v_add_f32 v23, v23, v12
  s_lshl_b32 s42, s13, 8
  v_lshlrev_b32 v1, 5, v2
  v_add_u32 v1, s42, v1
  ds_write_b128 v1, v[16:19] offset:4096
  ds_write_b128 v1, v[20:23] offset:4112
  v_and_b32 v1, 63, v0
  v_lshlrev_b32 v1, 2, v1
  s_waitcnt lgkmcnt(0)
  s_barrier
  ds_read_b32 v8, v1 offset:4096
  ds_read_b32 v9, v1 offset:4352
  ds_read_b32 v10, v1 offset:4608
  ds_read_b32 v11, v1 offset:4864
  s_lshl_b32 s42, s14, 8
  s_add_u32 s42, s42, 65536
  s_waitcnt lgkmcnt(2)
  v_add_f32 v8, v8, v9
  s_waitcnt lgkmcnt(0)
  v_add_f32 v10, v10, v11
  v_add_f32 v8, v8, v10
  v_cvt_pk_bf16_f32 v8, v8, v8
  v_and_b32 v8, 0xffff0000, v8
  buffer_store_dword v8, v1, s[8:11], s42 offen sc1
  s_cmp_eq_u32 s13, 0
  s_cbranch_scc0 Low_13
  v_mov_b32 v22, 0
  s_mov_b32 s42, 0x80808080
Lcw_14:
  global_load_dword v20, v22, s[16:17] sc0 sc1
  s_waitcnt vmcnt(0)
  v_and_b32 v21, s42, v20
  v_cmp_ne_u32 vcc, s42, v21
  s_cbranch_vccz Lcwo_15
  s_sleep 4
  s_sub_u32 s15, s15, 1
  s_cbranch_scc0 Lcw_14
  s_mov_b32 s15, 0
Lcwo_15:
Low_13:
  s_lshl_b32 s44, s14, 7
  s_add_u32 s44, s44, 40960
  s_waitcnt vmcnt(0)
  s_barrier
  s_cmp_eq_u32 s13, 0
  s_cbranch_scc0 Lfs_16
  v_mov_b32 v20, 1
  s_mov_b64 exec, 1
  buffer_store_dword v20, off, s[8:11], s44 sc1
  s_mov_b64 exec, -1
Lfs_16:
Lpredone:
  s_barrier
  v_mbcnt_lo_u32_b32 v0, -1, 0
  v_mbcnt_hi_u32_b32 v0, -1, v0
  s_mov_b32 s12, s35
  s_mov_b32 s14, s36
  s_cmp_eq_u32 s34, 0
  s_cbranch_scc1 Lwo
  s_cmp_eq_u32 s34, 1
  s_cbranch_scc1 Ldn
  s_cmp_eq_u32 s34, 2
  s_cbranch_scc0 Lend
  v_and_b32 v30, 63, v0
  v_lshlrev_b32 v0, 4, v30
  v_min_u32 v31, 35, v30
  v_lshlrev_b32 v2, 7, v31
  v_mul_u32_u24 v31, 43, v31
  v_lshrrev_b32 v31, 9, v31
  v_sub_u32 v1, 4, v31
  v_and_b32 v31, 15, v30
  v_mul_u32_u24 v31, 96, v31
  v_lshrrev_b32 v32, 4, v30
  v_mul_u32_u24 v32, 24, v32
  v_add_u32 v3, v31, v32
  s_lshl_b32 s19, s12, 7
  s_add_u32 s19, s19, 28672
  v_lshrrev_b32 v30, 4, v0
  v_lshrrev_b32 v31, 3, v30
  v_and_b32 v32, 7, v30
  v_lshrrev_b32 v33, 1, v32
  v_bfe_u32 v34, v30, 4, 1
  v_xor_b32 v33, v33, v34
  v_mul_u32_u24 v31, 9216, v31
  v_lshl_add_u32 v31, v33, 5, v31
  v_and_b32 v32, 1, v32
  v_lshl_add_u32 v24, v32, 4, v31
  v_xor_b32 v25, 64, v24
  v_lshrrev_b32 v31, 4, v30
  v_bfe_u32 v32, v30, 2, 2
  v_lshl_add_u32 v33, v31, 3, v32
  v_lshlrev_b32 v33, 7, v33
  v_lshrrev_b32 v32, 1, v32
  v_and_b32 v31, 1, v31
  v_lshl_add_u32 v32, v31, 1, v32
  v_xor_b32 v32, s13, v32
  v_lshl_add_u32 v33, v32, 5, v33
  v_and_b32 v32, 3, v30
  v_lshl_add_u32 v26, v32, 3, v33
  s_load_dwordx2 s[4:5], s[0:1], 64
  s_mov_b32 s6, 5308416
  s_mov_b32 s7, 0x20000
  s_load_dwordx2 s[28:29], s[0:1], 72
  s_mov_b32 s30, 5308416
  s_mov_b32 s31, 0x20000
  s_mul_i32 s32, s13, 1327104
  s_lshl_b32 s42, s12, 7
  s_add_u32 s32, s32, s42
  s_mul_i32 s33, s13, 18432
  s_waitcnt lgkmcnt(0)
  s_add_u32 m0, s33, 0
  s_add_u32 s42, s32, 0
  buffer_load_dwordx4 v24, s[4:7], s42 offen nt lds
  s_add_u32 m0, s33, 1024
  s_add_u32 s42, s32, 73728
  buffer_load_dwordx4 v25, s[4:7], s42 offen nt lds
  s_add_u32 m0, s33, 2048
  s_add_u32 s42, s32, 147456
  buffer_load_dwordx4 v24, s[4:7], s42 offen nt lds
  s_add_u32 m0, s33, 3072
  s_add_u32 s42, s32, 221184
  buffer_load_dwordx4 v25, s[4:7], s42 offen nt lds
  s_add_u32 m0, s33, 4096
  s_add_u32 s42, s32, 294912
  buffer_load_dwordx4 v24, s[4:7], s42 offen nt lds
  s_add_u32 m0, s33, 5120
  s_add_u32 s42, s32, 368640
  buffer_load_dwordx4 v25, s[4:7], s42 offen nt lds
  s_add_u32 m0, s33, 6144
  s_add_u32 s42, s32, 442368
  buffer_load_dwordx4 v24, s[4:7], s42 offen nt lds
  s_add_u32 m0, s33, 7168
  s_add_u32 s42, s32, 516096
  buffer_load_dwordx4 v25, s[4:7], s42 offen nt lds
  s_add_u32 m0, s33, 8192
  s_add_u32 s42, s32, 589824
  buffer_load_dwordx4 v24, s[4:7], s42 offen nt lds
  s_add_u32 m0, s33, 9216
  s_add_u32 s42, s32, 663552
  buffer_load_dwordx4 v25, s[4:7], s42 offen nt lds
  s_add_u32 m0, s33, 10240
  s_add_u32 s42, s32, 737280
  buffer_load_dwordx4 v24, s[4:7], s42 offen nt lds
  s_add_u32 m0, s33, 11264
  s_add_u32 s42, s32, 811008
  buffer_load_dwordx4 v25, s[4:7], s42 offen nt lds
  s_add_u32 m0, s33, 12288
  s_add_u32 s42, s32, 884736
  buffer_load_dwordx4 v24, s[4:7], s42 offen nt lds
  s_add_u32 m0, s33, 13312
  s_add_u32 s42, s32, 958464
  buffer_load_dwordx4 v25, s[4:7], s42 offen nt lds
  s_add_u32 m0, s33, 14336
  s_add_u32 s42, s32, 1032192
  buffer_load_dwordx4 v24, s[4:7], s42 offen nt lds
  s_add_u32 m0, s33, 15360
  s_add_u32 s42, s32, 1105920
  buffer_load_dwordx4 v25, s[4:7], s42 offen nt lds
  s_add_u32 m0, s33, 16384
  s_add_u32 s42, s32, 1179648
  buffer_load_dwordx4 v24, s[4:7], s42 offen nt lds
  s_add_u32 m0, s33, 17408
  s_add_u32 s42, s32, 1253376
  buffer_load_dwordx4 v25, s[4:7], s42 offen nt lds
  s_add_u32 m0, s33, 73728
  s_add_u32 s42, s32, 0
  buffer_load_dwordx4 v24, s[28:31], s42 offen nt lds
  s_add_u32 m0, s33, 74752
  s_add_u32 s42, s32, 73728
  buffer_load_dwordx4 v25, s[28:31], s42 offen nt lds
  s_add_u32 m0, s33, 75776
  s_add_u32 s42, s32, 147456
  buffer_load_dwordx4 v24, s[28:31], s42 offen nt lds
  s_add_u32 m0, s33, 76800
  s_add_u32 s42, s32, 221184
  buffer_load_dwordx4 v25, s[28:31], s42 offen nt lds
  s_add_u32 m0, s33, 77824
  s_add_u32 s42, s32, 294912
  buffer_load_dwordx4 v24, s[28:31], s42 offen nt lds
  s_add_u32 m0, s33, 78848
  s_add_u32 s42, s32, 368640
  buffer_load_dwordx4 v25, s[28:31], s42 offen nt lds
  s_add_u32 m0, s33, 79872
  s_add_u32 s42, s32, 442368
  buffer_load_dwordx4 v24, s[28:31], s42 offen nt lds
  s_add_u32 m0, s33, 80896
  s_add_u32 s42, s32, 516096
  buffer_load_dwordx4 v25, s[28:31], s42 offen nt lds
  s_add_u32 m0, s33, 81920
  s_add_u32 s42, s32, 589824
  buffer_load_dwordx4 v24, s[28:31], s42 offen nt lds
  s_add_u32 m0, s33, 82944
  s_add_u32 s42, s32, 663552
  buffer_load_dwordx4 v25, s[28:31], s42 offen nt lds
  s_add_u32 m0, s33, 83968
  s_add_u32 s42, s32, 737280
  buffer_load_dwordx4 v24, s[28:31], s42 offen nt lds
  s_add_u32 m0, s33, 84992
  s_add_u32 s42, s32, 811008
  buffer_load_dwordx4 v25, s[28:31], s42 offen nt lds
  s_add_u32 m0, s33, 86016
  s_add_u32 s42, s32, 884736
  buffer_load_dwordx4 v24, s[28:31], s42 offen nt lds
  s_add_u32 m0, s33, 87040
  s_add_u32 s42, s32, 958464
  buffer_load_dwordx4 v25, s[28:31], s42 offen nt lds
  s_add_u32 m0, s33, 88064
  s_add_u32 s42, s32, 1032192
  buffer_load_dwordx4 v24, s[28:31], s42 offen nt lds
  s_add_u32 m0, s33, 89088
  s_add_u32 s42, s32, 1105920
  buffer_load_dwordx4 v25, s[28:31], s42 offen nt lds
  s_add_u32 m0, s33, 90112
  s_add_u32 s42, s32, 1179648
  buffer_load_dwordx4 v24, s[28:31], s42 offen nt lds
  s_add_u32 m0, s33, 91136
  s_add_u32 s42, s32, 1253376
  buffer_load_dwordx4 v25, s[28:31], s42 offen nt lds
  s_waitcnt vmcnt(0)
  s_barrier
  v_add_u32 v27, 0, v26
  ds_read_b64_tr_b16 v[112:113], v27 offset:0
  ds_read_b64_tr_b16 v[114:115], v27 offset:512
  ds_read_b64_tr_b16 v[116:117], v27 offset:4096
  ds_read_b64_tr_b16 v[118:119], v27 offset:4608
  ds_read_b64_tr_b16 v[120:121], v27 offset:8192
  ds_read_b64_tr_b16 v[122:123], v27 offset:8704
  ds_read_b64_tr_b16 v[124:125], v27 offset:12288
  ds_read_b64_tr_b16 v[126:127], v27 offset:12800
  ds_read_b64_tr_b16 v[128:129], v27 offset:16384
  ds_read_b64_tr_b16 v[130:131], v27 offset:16896
  ds_read_b64_tr_b16 v[132:133], v27 offset:20480
  ds_read_b64_tr_b16 v[134:135], v27 offset:20992
  ds_read_b64_tr_b16 v[136:137], v27 offset:24576
  ds_read_b64_tr_b16 v[138:139], v27 offset:25088
  ds_read_b64_tr_b16 v[140:141], v27 offset:28672
  ds_read_b64_tr_b16 v[142:143], v27 offset:29184
  ds_read_b64_tr_b16 v[144:145], v27 offset:32768
  ds_read_b64_tr_b16 v[146:147], v27 offset:33280
  v_add_u32 v27, 36864, v26
  ds_read_b64_tr_b16 v[148:149], v27 offset:0
  ds_read_b64_tr_b16 v[150:151], v27 offset:512
  ds_read_b64_tr_b16 v[152:153], v27 offset:4096
  ds_read_b64_tr_b16 v[154:155], v27 offset:4608
  ds_read_b64_tr_b16 v[156:157], v27 offset:8192
  ds_read_b64_tr_b16 v[158:159], v27 offset:8704
  ds_read_b64_tr_b16 v[160:161], v27 offset:12288
  ds_read_b64_tr_b16 v[162:163], v27 offset:12800
  ds_read_b64_tr_b16 v[164:165], v27 offset:16384
  ds_read_b64_tr_b16 v[166:167], v27 offset:16896
  ds_read_b64_tr_b16 v[168:169], v27 offset:20480
  ds_read_b64_tr_b16 v[170:171], v27 offset:20992
  ds_read_b64_tr_b16 v[172:173], v27 offset:24576
  ds_read_b64_tr_b16 v[174:175], v27 offset:25088
  ds_read_b64_tr_b16 v[176:177], v27 offset:28672
  ds_read_b64_tr_b16 v[178:179], v27 offset:29184
  ds_read_b64_tr_b16 v[180:181], v27 offset:32768
  ds_read_b64_tr_b16 v[182:183], v27 offset:33280
  v_add_u32 v27, 73728, v26
  ds_read_b64_tr_b16 v[184:185], v27 offset:0
  ds_read_b64_tr_b16 v[186:187], v27 offset:512
  ds_read_b64_tr_b16 v[188:189], v27 offset:4096
  ds_read_b64_tr_b16 v[190:191], v27 offset:4608
  ds_read_b64_tr_b16 v[192:193], v27 offset:8192
  ds_read_b64_tr_b16 v[194:195], v27 offset:8704
  ds_read_b64_tr_b16 v[196:197], v27 offset:12288
  ds_read_b64_tr_b16 v[198:199], v27 offset:12800
  ds_read_b64_tr_b16 v[200:201], v27 offset:16384
  ds_read_b64_tr_b16 v[202:203], v27 offset:16896
  ds_read_b64_tr_b16 v[204:205], v27 offset:20480
  ds_read_b64_tr_b16 v[206:207], v27 offset:20992
  ds_read_b64_tr_b16 v[208:209], v27 offset:24576
  ds_read_b64_tr_b16 v[210:211], v27 offset:25088
  ds_read_b64_tr_b16 v[212:213], v27 offset:28672
  ds_read_b64_tr_b16 v[214:215], v27 offset:29184
  ds_read_b64_tr_b16 v[216:217], v27 offset:32768
  ds_read_b64_tr_b16 v[218:219], v27 offset:33280
  v_add_u32 v27, 110592, v26
  ds_read_b64_tr_b16 v[220:221], v27 offset:0
  ds_read_b64_tr_b16 v[222:223], v27 offset:512
  ds_read_b64_tr_b16 v[224:225], v27 offset:4096
  ds_read_b64_tr_b16 v[226:227], v27 offset:4608
  ds_read_b64_tr_b16 v[228:229], v27 offset:8192
  ds_read_b64_tr_b16 v[230:231], v27 offset:8704
  ds_read_b64_tr_b16 v[232:233], v27 offset:12288
  ds_read_b64_tr_b16 v[234:235], v27 offset:12800
  ds_read_b64_tr_b16 v[236:237], v27 offset:16384
  ds_read_b64_tr_b16 v[238:239], v27 offset:16896
  ds_read_b64_tr_b16 v[240:241], v27 offset:20480
  ds_read_b64_tr_b16 v[242:243], v27 offset:20992
  ds_read_b64_tr_b16 v[244:245], v27 offset:24576
  ds_read_b64_tr_b16 v[246:247], v27 offset:25088
  ds_read_b64_tr_b16 v[248:249], v27 offset:28672
  ds_read_b64_tr_b16 v[250:251], v27 offset:29184
  ds_read_b64_tr_b16 v[252:253], v27 offset:32768
  ds_read_b64_tr_b16 v[254:255], v27 offset:33280
  s_waitcnt lgkmcnt(0)
  s_barrier
  s_cmp_eq_u32 s13, 3
  s_cbranch_scc0 Low_17
  v_mov_b32 v26, 0
  s_mov_b32 s42, 0x80808080
Lcw_18:
  global_load_dword v24, v26, s[16:17] sc0 sc1
  s_waitcnt vmcnt(0)
  v_and_b32 v25, s42, v24
  v_cmp_ne_u32 vcc, s42, v25
  s_cbranch_vccz Lcwo_19
  s_sleep 4
  s_sub_u32 s15, s15, 1
  s_cbranch_scc0 Lcw_18
  s_mov_b32 s15, 0
Lcwo_19:
  v_lshrrev_b32 v25, 4, v0
  v_min_u32 v25, 53, v25
  v_lshlrev_b32 v25, 7, v25
  s_mov_b32 s44, 40960
Lp_20:
  buffer_load_dword v24, v25, s[8:11], s44 offen sc1
  s_waitcnt vmcnt(0)
  v_cmp_gt_u32 vcc, 1, v24
  s_cbranch_vccz Lpo_21
  s_sleep 4
  s_sub_u32 s15, s15, 1
  s_cbranch_scc0 Lp_20
  s_mov_b32 s15, 0
Lpo_21:
Low_17:
  s_barrier
  v_lshrrev_b32 v24, 8, v0
  v_lshlrev_b32 v24, 5, v24
  s_mov_b32 s42, 72448
  s_mov_b32 s43, 74752
  v_mov_b32 v28, 0x3f803f80
  v_mov_b32 v29, 0x3f803f80
  v_mov_b32 v30, 0x3f803f80
  v_mov_b32 v31, 0x3f803f80
  buffer_load_dwordx4 v[32:35], v24, s[8:11], s42 offen offset:0 sc1
  buffer_load_dwordx4 v[36:39], v24, s[8:11], s42 offen offset:16 sc1
  buffer_load_dwordx4 v[48:51], v24, s[8:11], s43 offen offset:0 sc1
  buffer_load_dwordx4 v[52:55], v24, s[8:11], s43 offen offset:16 sc1
  buffer_load_dwordx4 v[64:67], v24, s[8:11], s42 offen offset:128 sc1
  buffer_load_dwordx4 v[68:71], v24, s[8:11], s42 offen offset:144 sc1
  buffer_load_dwordx4 v[80:83], v24, s[8:11], s43 offen offset:128 sc1
  buffer_load_dwordx4 v[84:87], v24, s[8:11], s43 offen offset:144 sc1
  s_waitcnt vmcnt(7)
  v_cvt_pk_bf16_f32 v96, v32, v33
  v_cvt_pk_bf16_f32 v97, v34, v35
  s_waitcnt vmcnt(6)
  v_cvt_pk_bf16_f32 v98, v36, v37
  v_cvt_pk_bf16_f32 v99, v38, v39
  s_waitcnt vmcnt(5)
  v_add_f32 v48, 1.0, v48
  v_add_f32 v49, 1.0, v49
  v_add_f32 v50, 1.0, v50
  v_add_f32 v51, 1.0, v51
  s_waitcnt vmcnt(4)
  v_add_f32 v52, 1.0, v52
  v_add_f32 v53, 1.0, v53
  v_add_f32 v54, 1.0, v54
  v_add_f32 v55, 1.0, v55
  v_mfma_f32_16x16x32_bf16 v[16:19], v[112:115], v[96:99], 0
  v_mfma_f32_16x16x32_bf16 v[20:23], v[184:187], v[96:99], 0
  v_lshlrev_b32 v100, 16, v112
  v_and_b32 v101, 0xffff0000, v112
  v_mul_f32 v100, v100, v48
  v_mul_f32 v101, v101, v49
  v_cvt_pk_bf16_f32 v112, v100, v101
  v_lshlrev_b32 v100, 16, v113
  v_and_b32 v101, 0xffff0000, v113
  v_mul_f32 v100, v100, v50
  v_mul_f32 v101, v101, v51
  v_cvt_pk_bf16_f32 v113, v100, v101
  v_lshlrev_b32 v100, 16, v114
  v_and_b32 v101, 0xffff0000, v114
  v_mul_f32 v100, v100, v52
  v_mul_f32 v101, v101, v53
  v_cvt_pk_bf16_f32 v114, v100, v101
  v_lshlrev_b32 v100, 16, v115
  v_and_b32 v101, 0xffff0000, v115
  v_mul_f32 v100, v100, v54
  v_mul_f32 v101, v101, v55
  v_cvt_pk_bf16_f32 v115, v100, v101
  v_lshlrev_b32 v100, 16, v184
  v_and_b32 v101, 0xffff0000, v184
  v_mul_f32 v100, v100, v48
  v_mul_f32 v101, v101, v49
  v_cvt_pk_bf16_f32 v184, v100, v101
  v_lshlrev_b32 v100, 16, v185
  v_and_b32 v101, 0xffff0000, v185
  v_mul_f32 v100, v100, v50
  v_mul_f32 v101, v101, v51
  v_cvt_pk_bf16_f32 v185, v100, v101
  v_lshlrev_b32 v100, 16, v186
  v_and_b32 v101, 0xffff0000, v186
  v_mul_f32 v100, v100, v52
  v_mul_f32 v101, v101, v53
  v_cvt_pk_bf16_f32 v186, v100, v101
  v_lshlrev_b32 v100, 16, v187
  v_and_b32 v101, 0xffff0000, v187
  v_mul_f32 v100, v100, v54
  v_mul_f32 v101, v101, v55
  v_cvt_pk_bf16_f32 v187, v100, v101
  v_mfma_f32_16x16x32_bf16 v[8:11], v[112:115], v[28:31], 0
  s_nop 0
  v_mfma_f32_16x16x32_bf16 v[12:15], v[184:187], v[28:31], 0
  buffer_load_dwordx4 v[32:35], v24, s[8:11], s42 offen offset:256 sc1
  buffer_load_dwordx4 v[36:39], v24, s[8:11], s42 offen offset:272 sc1
  buffer_load_dwordx4 v[48:51], v24, s[8:11], s43 offen offset:256 sc1
  buffer_load_dwordx4 v[52:55], v24, s[8:11], s43 offen offset:272 sc1
  s_waitcnt vmcnt(7)
  v_cvt_pk_bf16_f32 v96, v64, v65
  v_cvt_pk_bf16_f32 v97, v66, v67
  s_waitcnt vmcnt(6)
  v_cvt_pk_bf16_f32 v98, v68, v69
  v_cvt_pk_bf16_f32 v99, v70, v71
  s_waitcnt vmcnt(5)
  v_add_f32 v80, 1.0, v80
  v_add_f32 v81, 1.0, v81
  v_add_f32 v82, 1.0, v82
  v_add_f32 v83, 1.0, v83
  s_waitcnt vmcnt(4)
  v_add_f32 v84, 1.0, v84
  v_add_f32 v85, 1.0, v85
  v_add_f32 v86, 1.0, v86
  v_add_f32 v87, 1.0, v87
  v_mfma_f32_16x16x32_bf16 v[16:19], v[116:119], v[96:99], v[16:19]
  v_mfma_f32_16x16x32_bf16 v[20:23], v[188:191], v[96:99], v[20:23]
  v_lshlrev_b32 v100, 16, v116
  v_and_b32 v101, 0xffff0000, v116
  v_mul_f32 v100, v100, v80
  v_mul_f32 v101, v101, v81
  v_cvt_pk_bf16_f32 v116, v100, v101
  v_lshlrev_b32 v100, 16, v117
  v_and_b32 v101, 0xffff0000, v117
  v_mul_f32 v100, v100, v82
  v_mul_f32 v101, v101, v83
  v_cvt_pk_bf16_f32 v117, v100, v101
  v_lshlrev_b32 v100, 16, v118
  v_and_b32 v101, 0xffff0000, v118
  v_mul_f32 v100, v100, v84
  v_mul_f32 v101, v101, v85
  v_cvt_pk_bf16_f32 v118, v100, v101
  v_lshlrev_b32 v100, 16, v119
  v_and_b32 v101, 0xffff0000, v119
  v_mul_f32 v100, v100, v86
  v_mul_f32 v101, v101, v87
  v_cvt_pk_bf16_f32 v119, v100, v101
  v_lshlrev_b32 v100, 16, v188
  v_and_b32 v101, 0xffff0000, v188
  v_mul_f32 v100, v100, v80
  v_mul_f32 v101, v101, v81
  v_cvt_pk_bf16_f32 v188, v100, v101
  v_lshlrev_b32 v100, 16, v189
  v_and_b32 v101, 0xffff0000, v189
  v_mul_f32 v100, v100, v82
  v_mul_f32 v101, v101, v83
  v_cvt_pk_bf16_f32 v189, v100, v101
  v_lshlrev_b32 v100, 16, v190
  v_and_b32 v101, 0xffff0000, v190
  v_mul_f32 v100, v100, v84
  v_mul_f32 v101, v101, v85
  v_cvt_pk_bf16_f32 v190, v100, v101
  v_lshlrev_b32 v100, 16, v191
  v_and_b32 v101, 0xffff0000, v191
  v_mul_f32 v100, v100, v86
  v_mul_f32 v101, v101, v87
  v_cvt_pk_bf16_f32 v191, v100, v101
  v_mfma_f32_16x16x32_bf16 v[8:11], v[116:119], v[28:31], v[8:11]
  s_nop 0
  v_mfma_f32_16x16x32_bf16 v[12:15], v[188:191], v[28:31], v[12:15]
  buffer_load_dwordx4 v[64:67], v24, s[8:11], s42 offen offset:384 sc1
  buffer_load_dwordx4 v[68:71], v24, s[8:11], s42 offen offset:400 sc1
  buffer_load_dwordx4 v[80:83], v24, s[8:11], s43 offen offset:384 sc1
  buffer_load_dwordx4 v[84:87], v24, s[8:11], s43 offen offset:400 sc1
  s_waitcnt vmcnt(7)
  v_cvt_pk_bf16_f32 v96, v32, v33
  v_cvt_pk_bf16_f32 v97, v34, v35
  s_waitcnt vmcnt(6)
  v_cvt_pk_bf16_f32 v98, v36, v37
  v_cvt_pk_bf16_f32 v99, v38, v39
  s_waitcnt vmcnt(5)
  v_add_f32 v48, 1.0, v48
  v_add_f32 v49, 1.0, v49
  v_add_f32 v50, 1.0, v50
  v_add_f32 v51, 1.0, v51
  s_waitcnt vmcnt(4)
  v_add_f32 v52, 1.0, v52
  v_add_f32 v53, 1.0, v53
  v_add_f32 v54, 1.0, v54
  v_add_f32 v55, 1.0, v55
  v_mfma_f32_16x16x32_bf16 v[16:19], v[120:123], v[96:99], v[16:19]
  v_mfma_f32_16x16x32_bf16 v[20:23], v[192:195], v[96:99], v[20:23]
  v_lshlrev_b32 v100, 16, v120
  v_and_b32 v101, 0xffff0000, v120
  v_mul_f32 v100, v100, v48
  v_mul_f32 v101, v101, v49
  v_cvt_pk_bf16_f32 v120, v100, v101
  v_lshlrev_b32 v100, 16, v121
  v_and_b32 v101, 0xffff0000, v121
  v_mul_f32 v100, v100, v50
  v_mul_f32 v101, v101, v51
  v_cvt_pk_bf16_f32 v121, v100, v101
  v_lshlrev_b32 v100, 16, v122
  v_and_b32 v101, 0xffff0000, v122
  v_mul_f32 v100, v100, v52
  v_mul_f32 v101, v101, v53
  v_cvt_pk_bf16_f32 v122, v100, v101
  v_lshlrev_b32 v100, 16, v123
  v_and_b32 v101, 0xffff0000, v123
  v_mul_f32 v100, v100, v54
  v_mul_f32 v101, v101, v55
  v_cvt_pk_bf16_f32 v123, v100, v101
  v_lshlrev_b32 v100, 16, v192
  v_and_b32 v101, 0xffff0000, v192
  v_mul_f32 v100, v100, v48
  v_mul_f32 v101, v101, v49
  v_cvt_pk_bf16_f32 v192, v100, v101
  v_lshlrev_b32 v100, 16, v193
  v_and_b32 v101, 0xffff0000, v193
  v_mul_f32 v100, v100, v50
  v_mul_f32 v101, v101, v51
  v_cvt_pk_bf16_f32 v193, v100, v101
  v_lshlrev_b32 v100, 16, v194
  v_and_b32 v101, 0xffff0000, v194
  v_mul_f32 v100, v100, v52
  v_mul_f32 v101, v101, v53
  v_cvt_pk_bf16_f32 v194, v100, v101
  v_lshlrev_b32 v100, 16, v195
  v_and_b32 v101, 0xffff0000, v195
  v_mul_f32 v100, v100, v54
  v_mul_f32 v101, v101, v55
  v_cvt_pk_bf16_f32 v195, v100, v101
  v_mfma_f32_16x16x32_bf16 v[8:11], v[120:123], v[28:31], v[8:11]
  s_nop 0
  v_mfma_f32_16x16x32_bf16 v[12:15], v[192:195], v[28:31], v[12:15]
  buffer_load_dwordx4 v[32:35], v24, s[8:11], s42 offen offset:512 sc1
  buffer_load_dwordx4 v[36:39], v24, s[8:11], s42 offen offset:528 sc1
  buffer_load_dwordx4 v[48:51], v24, s[8:11], s43 offen offset:512 sc1
  buffer_load_dwordx4 v[52:55], v24, s[8:11], s43 offen offset:528 sc1
  s_waitcnt vmcnt(7)
  v_cvt_pk_bf16_f32 v96, v64, v65
  v_cvt_pk_bf16_f32 v97, v66, v67
  s_waitcnt vmcnt(6)
  v_cvt_pk_bf16_f32 v98, v68, v69
  v_cvt_pk_bf16_f32 v99, v70, v71
  s_waitcnt vmcnt(5)
  v_add_f32 v80, 1.0, v80
  v_add_f32 v81, 1.0, v81
  v_add_f32 v82, 1.0, v82
  v_add_f32 v83, 1.0, v83
  s_waitcnt vmcnt(4)
  v_add_f32 v84, 1.0, v84
  v_add_f32 v85, 1.0, v85
  v_add_f32 v86, 1.0, v86
  v_add_f32 v87, 1.0, v87
  v_mfma_f32_16x16x32_bf16 v[16:19], v[124:127], v[96:99], v[16:19]
  v_mfma_f32_16x16x32_bf16 v[20:23], v[196:199], v[96:99], v[20:23]
  v_lshlrev_b32 v100, 16, v124
  v_and_b32 v101, 0xffff0000, v124
  v_mul_f32 v100, v100, v80
  v_mul_f32 v101, v101, v81
  v_cvt_pk_bf16_f32 v124, v100, v101
  v_lshlrev_b32 v100, 16, v125
  v_and_b32 v101, 0xffff0000, v125
  v_mul_f32 v100, v100, v82
  v_mul_f32 v101, v101, v83
  v_cvt_pk_bf16_f32 v125, v100, v101
  v_lshlrev_b32 v100, 16, v126
  v_and_b32 v101, 0xffff0000, v126
  v_mul_f32 v100, v100, v84
  v_mul_f32 v101, v101, v85
  v_cvt_pk_bf16_f32 v126, v100, v101
  v_lshlrev_b32 v100, 16, v127
  v_and_b32 v101, 0xffff0000, v127
  v_mul_f32 v100, v100, v86
  v_mul_f32 v101, v101, v87
  v_cvt_pk_bf16_f32 v127, v100, v101
  v_lshlrev_b32 v100, 16, v196
  v_and_b32 v101, 0xffff0000, v196
  v_mul_f32 v100, v100, v80
  v_mul_f32 v101, v101, v81
  v_cvt_pk_bf16_f32 v196, v100, v101
  v_lshlrev_b32 v100, 16, v197
  v_and_b32 v101, 0xffff0000, v197
  v_mul_f32 v100, v100, v82
  v_mul_f32 v101, v101, v83
  v_cvt_pk_bf16_f32 v197, v100, v101
  v_lshlrev_b32 v100, 16, v198
  v_and_b32 v101, 0xffff0000, v198
  v_mul_f32 v100, v100, v84
  v_mul_f32 v101, v101, v85
  v_cvt_pk_bf16_f32 v198, v100, v101
  v_lshlrev_b32 v100, 16, v199
  v_and_b32 v101, 0xffff0000, v199
  v_mul_f32 v100, v100, v86
  v_mul_f32 v101, v101, v87
  v_cvt_pk_bf16_f32 v199, v100, v101
  v_mfma_f32_16x16x32_bf16 v[8:11], v[124:127], v[28:31], v[8:11]
  s_nop 0
  v_mfma_f32_16x16x32_bf16 v[12:15], v[196:199], v[28:31], v[12:15]
  buffer_load_dwordx4 v[64:67], v24, s[8:11], s42 offen offset:640 sc1
  buffer_load_dwordx4 v[68:71], v24, s[8:11], s42 offen offset:656 sc1
  buffer_load_dwordx4 v[80:83], v24, s[8:11], s43 offen offset:640 sc1
  buffer_load_dwordx4 v[84:87], v24, s[8:11], s43 offen offset:656 sc1
  s_waitcnt vmcnt(7)
  v_cvt_pk_bf16_f32 v96, v32, v33
  v_cvt_pk_bf16_f32 v97, v34, v35
  s_waitcnt vmcnt(6)
  v_cvt_pk_bf16_f32 v98, v36, v37
  v_cvt_pk_bf16_f32 v99, v38, v39
  s_waitcnt vmcnt(5)
  v_add_f32 v48, 1.0, v48
  v_add_f32 v49, 1.0, v49
  v_add_f32 v50, 1.0, v50
  v_add_f32 v51, 1.0, v51
  s_waitcnt vmcnt(4)
  v_add_f32 v52, 1.0, v52
  v_add_f32 v53, 1.0, v53
  v_add_f32 v54, 1.0, v54
  v_add_f32 v55, 1.0, v55
  v_mfma_f32_16x16x32_bf16 v[16:19], v[128:131], v[96:99], v[16:19]
  v_mfma_f32_16x16x32_bf16 v[20:23], v[200:203], v[96:99], v[20:23]
  v_lshlrev_b32 v100, 16, v128
  v_and_b32 v101, 0xffff0000, v128
  v_mul_f32 v100, v100, v48
  v_mul_f32 v101, v101, v49
  v_cvt_pk_bf16_f32 v128, v100, v101
  v_lshlrev_b32 v100, 16, v129
  v_and_b32 v101, 0xffff0000, v129
  v_mul_f32 v100, v100, v50
  v_mul_f32 v101, v101, v51
  v_cvt_pk_bf16_f32 v129, v100, v101
  v_lshlrev_b32 v100, 16, v130
  v_and_b32 v101, 0xffff0000, v130
  v_mul_f32 v100, v100, v52
  v_mul_f32 v101, v101, v53
  v_cvt_pk_bf16_f32 v130, v100, v101
  v_lshlrev_b32 v100, 16, v131
  v_and_b32 v101, 0xffff0000, v131
  v_mul_f32 v100, v100, v54
  v_mul_f32 v101, v101, v55
  v_cvt_pk_bf16_f32 v131, v100, v101
  v_lshlrev_b32 v100, 16, v200
  v_and_b32 v101, 0xffff0000, v200
  v_mul_f32 v100, v100, v48
  v_mul_f32 v101, v101, v49
  v_cvt_pk_bf16_f32 v200, v100, v101
  v_lshlrev_b32 v100, 16, v201
  v_and_b32 v101, 0xffff0000, v201
  v_mul_f32 v100, v100, v50
  v_mul_f32 v101, v101, v51
  v_cvt_pk_bf16_f32 v201, v100, v101
  v_lshlrev_b32 v100, 16, v202
  v_and_b32 v101, 0xffff0000, v202
  v_mul_f32 v100, v100, v52
  v_mul_f32 v101, v101, v53
  v_cvt_pk_bf16_f32 v202, v100, v101
  v_lshlrev_b32 v100, 16, v203
  v_and_b32 v101, 0xffff0000, v203
  v_mul_f32 v100, v100, v54
  v_mul_f32 v101, v101, v55
  v_cvt_pk_bf16_f32 v203, v100, v101
  v_mfma_f32_16x16x32_bf16 v[8:11], v[128:131], v[28:31], v[8:11]
  s_nop 0
  v_mfma_f32_16x16x32_bf16 v[12:15], v[200:203], v[28:31], v[12:15]
  buffer_load_dwordx4 v[32:35], v24, s[8:11], s42 offen offset:768 sc1
  buffer_load_dwordx4 v[36:39], v24, s[8:11], s42 offen offset:784 sc1
  buffer_load_dwordx4 v[48:51], v24, s[8:11], s43 offen offset:768 sc1
  buffer_load_dwordx4 v[52:55], v24, s[8:11], s43 offen offset:784 sc1
  s_waitcnt vmcnt(7)
  v_cvt_pk_bf16_f32 v96, v64, v65
  v_cvt_pk_bf16_f32 v97, v66, v67
  s_waitcnt vmcnt(6)
  v_cvt_pk_bf16_f32 v98, v68, v69
  v_cvt_pk_bf16_f32 v99, v70, v71
  s_waitcnt vmcnt(5)
  v_add_f32 v80, 1.0, v80
  v_add_f32 v81, 1.0, v81
  v_add_f32 v82, 1.0, v82
  v_add_f32 v83, 1.0, v83
  s_waitcnt vmcnt(4)
  v_add_f32 v84, 1.0, v84
  v_add_f32 v85, 1.0, v85
  v_add_f32 v86, 1.0, v86
  v_add_f32 v87, 1.0, v87
  v_mfma_f32_16x16x32_bf16 v[16:19], v[132:135], v[96:99], v[16:19]
  v_mfma_f32_16x16x32_bf16 v[20:23], v[204:207], v[96:99], v[20:23]
  v_lshlrev_b32 v100, 16, v132
  v_and_b32 v101, 0xffff0000, v132
  v_mul_f32 v100, v100, v80
  v_mul_f32 v101, v101, v81
  v_cvt_pk_bf16_f32 v132, v100, v101
  v_lshlrev_b32 v100, 16, v133
  v_and_b32 v101, 0xffff0000, v133
  v_mul_f32 v100, v100, v82
  v_mul_f32 v101, v101, v83
  v_cvt_pk_bf16_f32 v133, v100, v101
  v_lshlrev_b32 v100, 16, v134
  v_and_b32 v101, 0xffff0000, v134
  v_mul_f32 v100, v100, v84
  v_mul_f32 v101, v101, v85
  v_cvt_pk_bf16_f32 v134, v100, v101
  v_lshlrev_b32 v100, 16, v135
  v_and_b32 v101, 0xffff0000, v135
  v_mul_f32 v100, v100, v86
  v_mul_f32 v101, v101, v87
  v_cvt_pk_bf16_f32 v135, v100, v101
  v_lshlrev_b32 v100, 16, v204
  v_and_b32 v101, 0xffff0000, v204
  v_mul_f32 v100, v100, v80
  v_mul_f32 v101, v101, v81
  v_cvt_pk_bf16_f32 v204, v100, v101
  v_lshlrev_b32 v100, 16, v205
  v_and_b32 v101, 0xffff0000, v205
  v_mul_f32 v100, v100, v82
  v_mul_f32 v101, v101, v83
  v_cvt_pk_bf16_f32 v205, v100, v101
  v_lshlrev_b32 v100, 16, v206
  v_and_b32 v101, 0xffff0000, v206
  v_mul_f32 v100, v100, v84
  v_mul_f32 v101, v101, v85
  v_cvt_pk_bf16_f32 v206, v100, v101
  v_lshlrev_b32 v100, 16, v207
  v_and_b32 v101, 0xffff0000, v207
  v_mul_f32 v100, v100, v86
  v_mul_f32 v101, v101, v87
  v_cvt_pk_bf16_f32 v207, v100, v101
  v_mfma_f32_16x16x32_bf16 v[8:11], v[132:135], v[28:31], v[8:11]
  s_nop 0
  v_mfma_f32_16x16x32_bf16 v[12:15], v[204:207], v[28:31], v[12:15]
  buffer_load_dwordx4 v[64:67], v24, s[8:11], s42 offen offset:896 sc1
  buffer_load_dwordx4 v[68:71], v24, s[8:11], s42 offen offset:912 sc1
  buffer_load_dwordx4 v[80:83], v24, s[8:11], s43 offen offset:896 sc1
  buffer_load_dwordx4 v[84:87], v24, s[8:11], s43 offen offset:912 sc1
  s_waitcnt vmcnt(7)
  v_cvt_pk_bf16_f32 v96, v32, v33
  v_cvt_pk_bf16_f32 v97, v34, v35
  s_waitcnt vmcnt(6)
  v_cvt_pk_bf16_f32 v98, v36, v37
  v_cvt_pk_bf16_f32 v99, v38, v39
  s_waitcnt vmcnt(5)
  v_add_f32 v48, 1.0, v48
  v_add_f32 v49, 1.0, v49
  v_add_f32 v50, 1.0, v50
  v_add_f32 v51, 1.0, v51
  s_waitcnt vmcnt(4)
  v_add_f32 v52, 1.0, v52
  v_add_f32 v53, 1.0, v53
  v_add_f32 v54, 1.0, v54
  v_add_f32 v55, 1.0, v55
  v_mfma_f32_16x16x32_bf16 v[16:19], v[136:139], v[96:99], v[16:19]
  v_mfma_f32_16x16x32_bf16 v[20:23], v[208:211], v[96:99], v[20:23]
  v_lshlrev_b32 v100, 16, v136
  v_and_b32 v101, 0xffff0000, v136
  v_mul_f32 v100, v100, v48
  v_mul_f32 v101, v101, v49
  v_cvt_pk_bf16_f32 v136, v100, v101
  v_lshlrev_b32 v100, 16, v137
  v_and_b32 v101, 0xffff0000, v137
  v_mul_f32 v100, v100, v50
  v_mul_f32 v101, v101, v51
  v_cvt_pk_bf16_f32 v137, v100, v101
  v_lshlrev_b32 v100, 16, v138
  v_and_b32 v101, 0xffff0000, v138
  v_mul_f32 v100, v100, v52
  v_mul_f32 v101, v101, v53
  v_cvt_pk_bf16_f32 v138, v100, v101
  v_lshlrev_b32 v100, 16, v139
  v_and_b32 v101, 0xffff0000, v139
  v_mul_f32 v100, v100, v54
  v_mul_f32 v101, v101, v55
  v_cvt_pk_bf16_f32 v139, v100, v101
  v_lshlrev_b32 v100, 16, v208
  v_and_b32 v101, 0xffff0000, v208
  v_mul_f32 v100, v100, v48
  v_mul_f32 v101, v101, v49
  v_cvt_pk_bf16_f32 v208, v100, v101
  v_lshlrev_b32 v100, 16, v209
  v_and_b32 v101, 0xffff0000, v209
  v_mul_f32 v100, v100, v50
  v_mul_f32 v101, v101, v51
  v_cvt_pk_bf16_f32 v209, v100, v101
  v_lshlrev_b32 v100, 16, v210
  v_and_b32 v101, 0xffff0000, v210
  v_mul_f32 v100, v100, v52
  v_mul_f32 v101, v101, v53
  v_cvt_pk_bf16_f32 v210, v100, v101
  v_lshlrev_b32 v100, 16, v211
  v_and_b32 v101, 0xffff0000, v211
  v_mul_f32 v100, v100, v54
  v_mul_f32 v101, v101, v55
  v_cvt_pk_bf16_f32 v211, v100, v101
  v_mfma_f32_16x16x32_bf16 v[8:11], v[136:139], v[28:31], v[8:11]
  s_nop 0
  v_mfma_f32_16x16x32_bf16 v[12:15], v[208:211], v[28:31], v[12:15]
  buffer_load_dwordx4 v[32:35], v24, s[8:11], s42 offen offset:1024 sc1
  buffer_load_dwordx4 v[36:39], v24, s[8:11], s42 offen offset:1040 sc1
  buffer_load_dwordx4 v[48:51], v24, s[8:11], s43 offen offset:1024 sc1
  buffer_load_dwordx4 v[52:55], v24, s[8:11], s43 offen offset:1040 sc1
  s_waitcnt vmcnt(7)
  v_cvt_pk_bf16_f32 v96, v64, v65
  v_cvt_pk_bf16_f32 v97, v66, v67
  s_waitcnt vmcnt(6)
  v_cvt_pk_bf16_f32 v98, v68, v69
  v_cvt_pk_bf16_f32 v99, v70, v71
  s_waitcnt vmcnt(5)
  v_add_f32 v80, 1.0, v80
  v_add_f32 v81, 1.0, v81
  v_add_f32 v82, 1.0, v82
  v_add_f32 v83, 1.0, v83
  s_waitcnt vmcnt(4)
  v_add_f32 v84, 1.0, v84
  v_add_f32 v85, 1.0, v85
  v_add_f32 v86, 1.0, v86
  v_add_f32 v87, 1.0, v87
  v_mfma_f32_16x16x32_bf16 v[16:19], v[140:143], v[96:99], v[16:19]
  v_mfma_f32_16x16x32_bf16 v[20:23], v[212:215], v[96:99], v[20:23]
  v_lshlrev_b32 v100, 16, v140
  v_and_b32 v101, 0xffff0000, v140
  v_mul_f32 v100, v100, v80
  v_mul_f32 v101, v101, v81
  v_cvt_pk_bf16_f32 v140, v100, v101
  v_lshlrev_b32 v100, 16, v141
  v_and_b32 v101, 0xffff0000, v141
  v_mul_f32 v100, v100, v82
  v_mul_f32 v101, v101, v83
  v_cvt_pk_bf16_f32 v141, v100, v101
  v_lshlrev_b32 v100, 16, v142
  v_and_b32 v101, 0xffff0000, v142
  v_mul_f32 v100, v100, v84
  v_mul_f32 v101, v101, v85
  v_cvt_pk_bf16_f32 v142, v100, v101
  v_lshlrev_b32 v100, 16, v143
  v_and_b32 v101, 0xffff0000, v143
  v_mul_f32 v100, v100, v86
  v_mul_f32 v101, v101, v87
  v_cvt_pk_bf16_f32 v143, v100, v101
  v_lshlrev_b32 v100, 16, v212
  v_and_b32 v101, 0xffff0000, v212
  v_mul_f32 v100, v100, v80
  v_mul_f32 v101, v101, v81
  v_cvt_pk_bf16_f32 v212, v100, v101
  v_lshlrev_b32 v100, 16, v213
  v_and_b32 v101, 0xffff0000, v213
  v_mul_f32 v100, v100, v82
  v_mul_f32 v101, v101, v83
  v_cvt_pk_bf16_f32 v213, v100, v101
  v_lshlrev_b32 v100, 16, v214
  v_and_b32 v101, 0xffff0000, v214
  v_mul_f32 v100, v100, v84
  v_mul_f32 v101, v101, v85
  v_cvt_pk_bf16_f32 v214, v100, v101
  v_lshlrev_b32 v100, 16, v215
  v_and_b32 v101, 0xffff0000, v215
  v_mul_f32 v100, v100, v86
  v_mul_f32 v101, v101, v87
  v_cvt_pk_bf16_f32 v215, v100, v101
  v_mfma_f32_16x16x32_bf16 v[8:11], v[140:143], v[28:31], v[8:11]
  s_nop 0
  v_mfma_f32_16x16x32_bf16 v[12:15], v[212:215], v[28:31], v[12:15]
  buffer_load_dwordx4 v[64:67], v24, s[8:11], s42 offen offset:1152 sc1
  buffer_load_dwordx4 v[68:71], v24, s[8:11], s42 offen offset:1168 sc1
  buffer_load_dwordx4 v[80:83], v24, s[8:11], s43 offen offset:1152 sc1
  buffer_load_dwordx4 v[84:87], v24, s[8:11], s43 offen offset:1168 sc1
  s_waitcnt vmcnt(7)
  v_cvt_pk_bf16_f32 v96, v32, v33
  v_cvt_pk_bf16_f32 v97, v34, v35
  s_waitcnt vmcnt(6)
  v_cvt_pk_bf16_f32 v98, v36, v37
  v_cvt_pk_bf16_f32 v99, v38, v39
  s_waitcnt vmcnt(5)
  v_add_f32 v48, 1.0, v48
  v_add_f32 v49, 1.0, v49
  v_add_f32 v50, 1.0, v50
  v_add_f32 v51, 1.0, v51
  s_waitcnt vmcnt(4)
  v_add_f32 v52, 1.0, v52
  v_add_f32 v53, 1.0, v53
  v_add_f32 v54, 1.0, v54
  v_add_f32 v55, 1.0, v55
  v_mfma_f32_16x16x32_bf16 v[16:19], v[144:147], v[96:99], v[16:19]
  v_mfma_f32_16x16x32_bf16 v[20:23], v[216:219], v[96:99], v[20:23]
  v_lshlrev_b32 v100, 16, v144
  v_and_b32 v101, 0xffff0000, v144
  v_mul_f32 v100, v100, v48
  v_mul_f32 v101, v101, v49
  v_cvt_pk_bf16_f32 v144, v100, v101
  v_lshlrev_b32 v100, 16, v145
  v_and_b32 v101, 0xffff0000, v145
  v_mul_f32 v100, v100, v50
  v_mul_f32 v101, v101, v51
  v_cvt_pk_bf16_f32 v145, v100, v101
  v_lshlrev_b32 v100, 16, v146
  v_and_b32 v101, 0xffff0000, v146
  v_mul_f32 v100, v100, v52
  v_mul_f32 v101, v101, v53
  v_cvt_pk_bf16_f32 v146, v100, v101
  v_lshlrev_b32 v100, 16, v147
  v_and_b32 v101, 0xffff0000, v147
  v_mul_f32 v100, v100, v54
  v_mul_f32 v101, v101, v55
  v_cvt_pk_bf16_f32 v147, v100, v101
  v_lshlrev_b32 v100, 16, v216
  v_and_b32 v101, 0xffff0000, v216
  v_mul_f32 v100, v100, v48
  v_mul_f32 v101, v101, v49
  v_cvt_pk_bf16_f32 v216, v100, v101
  v_lshlrev_b32 v100, 16, v217
  v_and_b32 v101, 0xffff0000, v217
  v_mul_f32 v100, v100, v50
  v_mul_f32 v101, v101, v51
  v_cvt_pk_bf16_f32 v217, v100, v101
  v_lshlrev_b32 v100, 16, v218
  v_and_b32 v101, 0xffff0000, v218
  v_mul_f32 v100, v100, v52
  v_mul_f32 v101, v101, v53
  v_cvt_pk_bf16_f32 v218, v100, v101
  v_lshlrev_b32 v100, 16, v219
  v_and_b32 v101, 0xffff0000, v219
  v_mul_f32 v100, v100, v54
  v_mul_f32 v101, v101, v55
  v_cvt_pk_bf16_f32 v219, v100, v101
  v_mfma_f32_16x16x32_bf16 v[8:11], v[144:147], v[28:31], v[8:11]
  s_nop 0
  v_mfma_f32_16x16x32_bf16 v[12:15], v[216:219], v[28:31], v[12:15]
  buffer_load_dwordx4 v[32:35], v24, s[8:11], s42 offen offset:1280 sc1
  buffer_load_dwordx4 v[36:39], v24, s[8:11], s42 offen offset:1296 sc1
  buffer_load_dwordx4 v[48:51], v24, s[8:11], s43 offen offset:1280 sc1
  buffer_load_dwordx4 v[52:55], v24, s[8:11], s43 offen offset:1296 sc1
  s_waitcnt vmcnt(7)
  v_cvt_pk_bf16_f32 v96, v64, v65
  v_cvt_pk_bf16_f32 v97, v66, v67
  s_waitcnt vmcnt(6)
  v_cvt_pk_bf16_f32 v98, v68, v69
  v_cvt_pk_bf16_f32 v99, v70, v71
  s_waitcnt vmcnt(5)
  v_add_f32 v80, 1.0, v80
  v_add_f32 v81, 1.0, v81
  v_add_f32 v82, 1.0, v82
  v_add_f32 v83, 1.0, v83
  s_waitcnt vmcnt(4)
  v_add_f32 v84, 1.0, v84
  v_add_f32 v85, 1.0, v85
  v_add_f32 v86, 1.0, v86
  v_add_f32 v87, 1.0, v87
  v_mfma_f32_16x16x32_bf16 v[16:19], v[148:151], v[96:99], v[16:19]
  v_mfma_f32_16x16x32_bf16 v[20:23], v[220:223], v[96:99], v[20:23]
  v_lshlrev_b32 v100, 16, v148
  v_and_b32 v101, 0xffff0000, v148
  v_mul_f32 v100, v100, v80
  v_mul_f32 v101, v101, v81
  v_cvt_pk_bf16_f32 v148, v100, v101
  v_lshlrev_b32 v100, 16, v149
  v_and_b32 v101, 0xffff0000, v149
  v_mul_f32 v100, v100, v82
  v_mul_f32 v101, v101, v83
  v_cvt_pk_bf16_f32 v149, v100, v101
  v_lshlrev_b32 v100, 16, v150
  v_and_b32 v101, 0xffff0000, v150
  v_mul_f32 v100, v100, v84
  v_mul_f32 v101, v101, v85
  v_cvt_pk_bf16_f32 v150, v100, v101
  v_lshlrev_b32 v100, 16, v151
  v_and_b32 v101, 0xffff0000, v151
  v_mul_f32 v100, v100, v86
  v_mul_f32 v101, v101, v87
  v_cvt_pk_bf16_f32 v151, v100, v101
  v_lshlrev_b32 v100, 16, v220
  v_and_b32 v101, 0xffff0000, v220
  v_mul_f32 v100, v100, v80
  v_mul_f32 v101, v101, v81
  v_cvt_pk_bf16_f32 v220, v100, v101
  v_lshlrev_b32 v100, 16, v221
  v_and_b32 v101, 0xffff0000, v221
  v_mul_f32 v100, v100, v82
  v_mul_f32 v101, v101, v83
  v_cvt_pk_bf16_f32 v221, v100, v101
  v_lshlrev_b32 v100, 16, v222
  v_and_b32 v101, 0xffff0000, v222
  v_mul_f32 v100, v100, v84
  v_mul_f32 v101, v101, v85
  v_cvt_pk_bf16_f32 v222, v100, v101
  v_lshlrev_b32 v100, 16, v223
  v_and_b32 v101, 0xffff0000, v223
  v_mul_f32 v100, v100, v86
  v_mul_f32 v101, v101, v87
  v_cvt_pk_bf16_f32 v223, v100, v101
  v_mfma_f32_16x16x32_bf16 v[8:11], v[148:151], v[28:31], v[8:11]
  s_nop 0
  v_mfma_f32_16x16x32_bf16 v[12:15], v[220:223], v[28:31], v[12:15]
  buffer_load_dwordx4 v[64:67], v24, s[8:11], s42 offen offset:1408 sc1
  buffer_load_dwordx4 v[68:71], v24, s[8:11], s42 offen offset:1424 sc1
  buffer_load_dwordx4 v[80:83], v24, s[8:11], s43 offen offset:1408 sc1
  buffer_load_dwordx4 v[84:87], v24, s[8:11], s43 offen offset:1424 sc1
  s_waitcnt vmcnt(7)
  v_cvt_pk_bf16_f32 v96, v32, v33
  v_cvt_pk_bf16_f32 v97, v34, v35
  s_waitcnt vmcnt(6)
  v_cvt_pk_bf16_f32 v98, v36, v37
  v_cvt_pk_bf16_f32 v99, v38, v39
  s_waitcnt vmcnt(5)
  v_add_f32 v48, 1.0, v48
  v_add_f32 v49, 1.0, v49
  v_add_f32 v50, 1.0, v50
  v_add_f32 v51, 1.0, v51
  s_waitcnt vmcnt(4)
  v_add_f32 v52, 1.0, v52
  v_add_f32 v53, 1.0, v53
  v_add_f32 v54, 1.0, v54
  v_add_f32 v55, 1.0, v55
  v_mfma_f32_16x16x32_bf16 v[16:19], v[152:155], v[96:99], v[16:19]
  v_mfma_f32_16x16x32_bf16 v[20:23], v[224:227], v[96:99], v[20:23]
  v_lshlrev_b32 v100, 16, v152
  v_and_b32 v101, 0xffff0000, v152
  v_mul_f32 v100, v100, v48
  v_mul_f32 v101, v101, v49
  v_cvt_pk_bf16_f32 v152, v100, v101
  v_lshlrev_b32 v100, 16, v153
  v_and_b32 v101, 0xffff0000, v153
  v_mul_f32 v100, v100, v50
  v_mul_f32 v101, v101, v51
  v_cvt_pk_bf16_f32 v153, v100, v101
  v_lshlrev_b32 v100, 16, v154
  v_and_b32 v101, 0xffff0000, v154
  v_mul_f32 v100, v100, v52
  v_mul_f32 v101, v101, v53
  v_cvt_pk_bf16_f32 v154, v100, v101
  v_lshlrev_b32 v100, 16, v155
  v_and_b32 v101, 0xffff0000, v155
  v_mul_f32 v100, v100, v54
  v_mul_f32 v101, v101, v55
  v_cvt_pk_bf16_f32 v155, v100, v101
  v_lshlrev_b32 v100, 16, v224
  v_and_b32 v101, 0xffff0000, v224
  v_mul_f32 v100, v100, v48
  v_mul_f32 v101, v101, v49
  v_cvt_pk_bf16_f32 v224, v100, v101
  v_lshlrev_b32 v100, 16, v225
  v_and_b32 v101, 0xffff0000, v225
  v_mul_f32 v100, v100, v50
  v_mul_f32 v101, v101, v51
  v_cvt_pk_bf16_f32 v225, v100, v101
  v_lshlrev_b32 v100, 16, v226
  v_and_b32 v101, 0xffff0000, v226
  v_mul_f32 v100, v100, v52
  v_mul_f32 v101, v101, v53
  v_cvt_pk_bf16_f32 v226, v100, v101
  v_lshlrev_b32 v100, 16, v227
  v_and_b32 v101, 0xffff0000, v227
  v_mul_f32 v100, v100, v54
  v_mul_f32 v101, v101, v55
  v_cvt_pk_bf16_f32 v227, v100, v101
  v_mfma_f32_16x16x32_bf16 v[8:11], v[152:155], v[28:31], v[8:11]
  s_nop 0
  v_mfma_f32_16x16x32_bf16 v[12:15], v[224:227], v[28:31], v[12:15]
  buffer_load_dwordx4 v[32:35], v24, s[8:11], s42 offen offset:1536 sc1
  buffer_load_dwordx4 v[36:39], v24, s[8:11], s42 offen offset:1552 sc1
  buffer_load_dwordx4 v[48:51], v24, s[8:11], s43 offen offset:1536 sc1
  buffer_load_dwordx4 v[52:55], v24, s[8:11], s43 offen offset:1552 sc1
  s_waitcnt vmcnt(7)
  v_cvt_pk_bf16_f32 v96, v64, v65
  v_cvt_pk_bf16_f32 v97, v66, v67
  s_waitcnt vmcnt(6)
  v_cvt_pk_bf16_f32 v98, v68, v69
  v_cvt_pk_bf16_f32 v99, v70, v71
  s_waitcnt vmcnt(5)
  v_add_f32 v80, 1.0, v80
  v_add_f32 v81, 1.0, v81
  v_add_f32 v82, 1.0, v82
  v_add_f32 v83, 1.0, v83
  s_waitcnt vmcnt(4)
  v_add_f32 v84, 1.0, v84
  v_add_f32 v85, 1.0, v85
  v_add_f32 v86, 1.0, v86
  v_add_f32 v87, 1.0, v87
  v_mfma_f32_16x16x32_bf16 v[16:19], v[156:159], v[96:99], v[16:19]
  v_mfma_f32_16x16x32_bf16 v[20:23], v[228:231], v[96:99], v[20:23]
  v_lshlrev_b32 v100, 16, v156
  v_and_b32 v101, 0xffff0000, v156
  v_mul_f32 v100, v100, v80
  v_mul_f32 v101, v101, v81
  v_cvt_pk_bf16_f32 v156, v100, v101
  v_lshlrev_b32 v100, 16, v157
  v_and_b32 v101, 0xffff0000, v157
  v_mul_f32 v100, v100, v82
  v_mul_f32 v101, v101, v83
  v_cvt_pk_bf16_f32 v157, v100, v101
  v_lshlrev_b32 v100, 16, v158
  v_and_b32 v101, 0xffff0000, v158
  v_mul_f32 v100, v100, v84
  v_mul_f32 v101, v101, v85
  v_cvt_pk_bf16_f32 v158, v100, v101
  v_lshlrev_b32 v100, 16, v159
  v_and_b32 v101, 0xffff0000, v159
  v_mul_f32 v100, v100, v86
  v_mul_f32 v101, v101, v87
  v_cvt_pk_bf16_f32 v159, v100, v101
  v_lshlrev_b32 v100, 16, v228
  v_and_b32 v101, 0xffff0000, v228
  v_mul_f32 v100, v100, v80
  v_mul_f32 v101, v101, v81
  v_cvt_pk_bf16_f32 v228, v100, v101
  v_lshlrev_b32 v100, 16, v229
  v_and_b32 v101, 0xffff0000, v229
  v_mul_f32 v100, v100, v82
  v_mul_f32 v101, v101, v83
  v_cvt_pk_bf16_f32 v229, v100, v101
  v_lshlrev_b32 v100, 16, v230
  v_and_b32 v101, 0xffff0000, v230
  v_mul_f32 v100, v100, v84
  v_mul_f32 v101, v101, v85
  v_cvt_pk_bf16_f32 v230, v100, v101
  v_lshlrev_b32 v100, 16, v231
  v_and_b32 v101, 0xffff0000, v231
  v_mul_f32 v100, v100, v86
  v_mul_f32 v101, v101, v87
  v_cvt_pk_bf16_f32 v231, v100, v101
  v_mfma_f32_16x16x32_bf16 v[8:11], v[156:159], v[28:31], v[8:11]
  s_nop 0
  v_mfma_f32_16x16x32_bf16 v[12:15], v[228:231], v[28:31], v[12:15]
  buffer_load_dwordx4 v[64:67], v24, s[8:11], s42 offen offset:1664 sc1
  buffer_load_dwordx4 v[68:71], v24, s[8:11], s42 offen offset:1680 sc1
  buffer_load_dwordx4 v[80:83], v24, s[8:11], s43 offen offset:1664 sc1
  buffer_load_dwordx4 v[84:87], v24, s[8:11], s43 offen offset:1680 sc1
  s_waitcnt vmcnt(7)
  v_cvt_pk_bf16_f32 v96, v32, v33
  v_cvt_pk_bf16_f32 v97, v34, v35
  s_waitcnt vmcnt(6)
  v_cvt_pk_bf16_f32 v98, v36, v37
  v_cvt_pk_bf16_f32 v99, v38, v39
  s_waitcnt vmcnt(5)
  v_add_f32 v48, 1.0, v48
  v_add_f32 v49, 1.0, v49
  v_add_f32 v50, 1.0, v50
  v_add_f32 v51, 1.0, v51
  s_waitcnt vmcnt(4)
  v_add_f32 v52, 1.0, v52
  v_add_f32 v53, 1.0, v53
  v_add_f32 v54, 1.0, v54
  v_add_f32 v55, 1.0, v55
  v_mfma_f32_16x16x32_bf16 v[16:19], v[160:163], v[96:99], v[16:19]
  v_mfma_f32_16x16x32_bf16 v[20:23], v[232:235], v[96:99], v[20:23]
  v_lshlrev_b32 v100, 16, v160
  v_and_b32 v101, 0xffff0000, v160
  v_mul_f32 v100, v100, v48
  v_mul_f32 v101, v101, v49
  v_cvt_pk_bf16_f32 v160, v100, v101
  v_lshlrev_b32 v100, 16, v161
  v_and_b32 v101, 0xffff0000, v161
  v_mul_f32 v100, v100, v50
  v_mul_f32 v101, v101, v51
  v_cvt_pk_bf16_f32 v161, v100, v101
  v_lshlrev_b32 v100, 16, v162
  v_and_b32 v101, 0xffff0000, v162
  v_mul_f32 v100, v100, v52
  v_mul_f32 v101, v101, v53
  v_cvt_pk_bf16_f32 v162, v100, v101
  v_lshlrev_b32 v100, 16, v163
  v_and_b32 v101, 0xffff0000, v163
  v_mul_f32 v100, v100, v54
  v_mul_f32 v101, v101, v55
  v_cvt_pk_bf16_f32 v163, v100, v101
  v_lshlrev_b32 v100, 16, v232
  v_and_b32 v101, 0xffff0000, v232
  v_mul_f32 v100, v100, v48
  v_mul_f32 v101, v101, v49
  v_cvt_pk_bf16_f32 v232, v100, v101
  v_lshlrev_b32 v100, 16, v233
  v_and_b32 v101, 0xffff0000, v233
  v_mul_f32 v100, v100, v50
  v_mul_f32 v101, v101, v51
  v_cvt_pk_bf16_f32 v233, v100, v101
  v_lshlrev_b32 v100, 16, v234
  v_and_b32 v101, 0xffff0000, v234
  v_mul_f32 v100, v100, v52
  v_mul_f32 v101, v101, v53
  v_cvt_pk_bf16_f32 v234, v100, v101
  v_lshlrev_b32 v100, 16, v235
  v_and_b32 v101, 0xffff0000, v235
  v_mul_f32 v100, v100, v54
  v_mul_f32 v101, v101, v55
  v_cvt_pk_bf16_f32 v235, v100, v101
  v_mfma_f32_16x16x32_bf16 v[8:11], v[160:163], v[28:31], v[8:11]
  s_nop 0
  v_mfma_f32_16x16x32_bf16 v[12:15], v[232:235], v[28:31], v[12:15]
  buffer_load_dwordx4 v[32:35], v24, s[8:11], s42 offen offset:1792 sc1
  buffer_load_dwordx4 v[36:39], v24, s[8:11], s42 offen offset:1808 sc1
  buffer_load_dwordx4 v[48:51], v24, s[8:11], s43 offen offset:1792 sc1
  buffer_load_dwordx4 v[52:55], v24, s[8:11], s43 offen offset:1808 sc1
  s_waitcnt vmcnt(7)
  v_cvt_pk_bf16_f32 v96, v64, v65
  v_cvt_pk_bf16_f32 v97, v66, v67
  s_waitcnt vmcnt(6)
  v_cvt_pk_bf16_f32 v98, v68, v69
  v_cvt_pk_bf16_f32 v99, v70, v71
  s_waitcnt vmcnt(5)
  v_add_f32 v80, 1.0, v80
  v_add_f32 v81, 1.0, v81
  v_add_f32 v82, 1.0, v82
  v_add_f32 v83, 1.0, v83
  s_waitcnt vmcnt(4)
  v_add_f32 v84, 1.0, v84
  v_add_f32 v85, 1.0, v85
  v_add_f32 v86, 1.0, v86
  v_add_f32 v87, 1.0, v87
  v_mfma_f32_16x16x32_bf16 v[16:19], v[164:167], v[96:99], v[16:19]
  v_mfma_f32_16x16x32_bf16 v[20:23], v[236:239], v[96:99], v[20:23]
  v_lshlrev_b32 v100, 16, v164
  v_and_b32 v101, 0xffff0000, v164
  v_mul_f32 v100, v100, v80
  v_mul_f32 v101, v101, v81
  v_cvt_pk_bf16_f32 v164, v100, v101
  v_lshlrev_b32 v100, 16, v165
  v_and_b32 v101, 0xffff0000, v165
  v_mul_f32 v100, v100, v82
  v_mul_f32 v101, v101, v83
  v_cvt_pk_bf16_f32 v165, v100, v101
  v_lshlrev_b32 v100, 16, v166
  v_and_b32 v101, 0xffff0000, v166
  v_mul_f32 v100, v100, v84
  v_mul_f32 v101, v101, v85
  v_cvt_pk_bf16_f32 v166, v100, v101
  v_lshlrev_b32 v100, 16, v167
  v_and_b32 v101, 0xffff0000, v167
  v_mul_f32 v100, v100, v86
  v_mul_f32 v101, v101, v87
  v_cvt_pk_bf16_f32 v167, v100, v101
  v_lshlrev_b32 v100, 16, v236
  v_and_b32 v101, 0xffff0000, v236
  v_mul_f32 v100, v100, v80
  v_mul_f32 v101, v101, v81
  v_cvt_pk_bf16_f32 v236, v100, v101
  v_lshlrev_b32 v100, 16, v237
  v_and_b32 v101, 0xffff0000, v237
  v_mul_f32 v100, v100, v82
  v_mul_f32 v101, v101, v83
  v_cvt_pk_bf16_f32 v237, v100, v101
  v_lshlrev_b32 v100, 16, v238
  v_and_b32 v101, 0xffff0000, v238
  v_mul_f32 v100, v100, v84
  v_mul_f32 v101, v101, v85
  v_cvt_pk_bf16_f32 v238, v100, v101
  v_lshlrev_b32 v100, 16, v239
  v_and_b32 v101, 0xffff0000, v239
  v_mul_f32 v100, v100, v86
  v_mul_f32 v101, v101, v87
  v_cvt_pk_bf16_f32 v239, v100, v101
  v_mfma_f32_16x16x32_bf16 v[8:11], v[164:167], v[28:31], v[8:11]
  s_nop 0
  v_mfma_f32_16x16x32_bf16 v[12:15], v[236:239], v[28:31], v[12:15]
  buffer_load_dwordx4 v[64:67], v24, s[8:11], s42 offen offset:1920 sc1
  buffer_load_dwordx4 v[68:71], v24, s[8:11], s42 offen offset:1936 sc1
  buffer_load_dwordx4 v[80:83], v24, s[8:11], s43 offen offset:1920 sc1
  buffer_load_dwordx4 v[84:87], v24, s[8:11], s43 offen offset:1936 sc1
  s_waitcnt vmcnt(7)
  v_cvt_pk_bf16_f32 v96, v32, v33
  v_cvt_pk_bf16_f32 v97, v34, v35
  s_waitcnt vmcnt(6)
  v_cvt_pk_bf16_f32 v98, v36, v37
  v_cvt_pk_bf16_f32 v99, v38, v39
  s_waitcnt vmcnt(5)
  v_add_f32 v48, 1.0, v48
  v_add_f32 v49, 1.0, v49
  v_add_f32 v50, 1.0, v50
  v_add_f32 v51, 1.0, v51
  s_waitcnt vmcnt(4)
  v_add_f32 v52, 1.0, v52
  v_add_f32 v53, 1.0, v53
  v_add_f32 v54, 1.0, v54
  v_add_f32 v55, 1.0, v55
  v_mfma_f32_16x16x32_bf16 v[16:19], v[168:171], v[96:99], v[16:19]
  v_mfma_f32_16x16x32_bf16 v[20:23], v[240:243], v[96:99], v[20:23]
  v_lshlrev_b32 v100, 16, v168
  v_and_b32 v101, 0xffff0000, v168
  v_mul_f32 v100, v100, v48
  v_mul_f32 v101, v101, v49
  v_cvt_pk_bf16_f32 v168, v100, v101
  v_lshlrev_b32 v100, 16, v169
  v_and_b32 v101, 0xffff0000, v169
  v_mul_f32 v100, v100, v50
  v_mul_f32 v101, v101, v51
  v_cvt_pk_bf16_f32 v169, v100, v101
  v_lshlrev_b32 v100, 16, v170
  v_and_b32 v101, 0xffff0000, v170
  v_mul_f32 v100, v100, v52
  v_mul_f32 v101, v101, v53
  v_cvt_pk_bf16_f32 v170, v100, v101
  v_lshlrev_b32 v100, 16, v171
  v_and_b32 v101, 0xffff0000, v171
  v_mul_f32 v100, v100, v54
  v_mul_f32 v101, v101, v55
  v_cvt_pk_bf16_f32 v171, v100, v101
  v_lshlrev_b32 v100, 16, v240
  v_and_b32 v101, 0xffff0000, v240
  v_mul_f32 v100, v100, v48
  v_mul_f32 v101, v101, v49
  v_cvt_pk_bf16_f32 v240, v100, v101
  v_lshlrev_b32 v100, 16, v241
  v_and_b32 v101, 0xffff0000, v241
  v_mul_f32 v100, v100, v50
  v_mul_f32 v101, v101, v51
  v_cvt_pk_bf16_f32 v241, v100, v101
  v_lshlrev_b32 v100, 16, v242
  v_and_b32 v101, 0xffff0000, v242
  v_mul_f32 v100, v100, v52
  v_mul_f32 v101, v101, v53
  v_cvt_pk_bf16_f32 v242, v100, v101
  v_lshlrev_b32 v100, 16, v243
  v_and_b32 v101, 0xffff0000, v243
  v_mul_f32 v100, v100, v54
  v_mul_f32 v101, v101, v55
  v_cvt_pk_bf16_f32 v243, v100, v101
  v_mfma_f32_16x16x32_bf16 v[8:11], v[168:171], v[28:31], v[8:11]
  s_nop 0
  v_mfma_f32_16x16x32_bf16 v[12:15], v[240:243], v[28:31], v[12:15]
  buffer_load_dwordx4 v[32:35], v24, s[8:11], s42 offen offset:2048 sc1
  buffer_load_dwordx4 v[36:39], v24, s[8:11], s42 offen offset:2064 sc1
  buffer_load_dwordx4 v[48:51], v24, s[8:11], s43 offen offset:2048 sc1
  buffer_load_dwordx4 v[52:55], v24, s[8:11], s43 offen offset:2064 sc1
  s_waitcnt vmcnt(7)
  v_cvt_pk_bf16_f32 v96, v64, v65
  v_cvt_pk_bf16_f32 v97, v66, v67
  s_waitcnt vmcnt(6)
  v_cvt_pk_bf16_f32 v98, v68, v69
  v_cvt_pk_bf16_f32 v99, v70, v71
  s_waitcnt vmcnt(5)
  v_add_f32 v80, 1.0, v80
  v_add_f32 v81, 1.0, v81
  v_add_f32 v82, 1.0, v82
  v_add_f32 v83, 1.0, v83
  s_waitcnt vmcnt(4)
  v_add_f32 v84, 1.0, v84
  v_add_f32 v85, 1.0, v85
  v_add_f32 v86, 1.0, v86
  v_add_f32 v87, 1.0, v87
  v_mfma_f32_16x16x32_bf16 v[16:19], v[172:175], v[96:99], v[16:19]
  v_mfma_f32_16x16x32_bf16 v[20:23], v[244:247], v[96:99], v[20:23]
  v_lshlrev_b32 v100, 16, v172
  v_and_b32 v101, 0xffff0000, v172
  v_mul_f32 v100, v100, v80
  v_mul_f32 v101, v101, v81
  v_cvt_pk_bf16_f32 v172, v100, v101
  v_lshlrev_b32 v100, 16, v173
  v_and_b32 v101, 0xffff0000, v173
  v_mul_f32 v100, v100, v82
  v_mul_f32 v101, v101, v83
  v_cvt_pk_bf16_f32 v173, v100, v101
  v_lshlrev_b32 v100, 16, v174
  v_and_b32 v101, 0xffff0000, v174
  v_mul_f32 v100, v100, v84
  v_mul_f32 v101, v101, v85
  v_cvt_pk_bf16_f32 v174, v100, v101
  v_lshlrev_b32 v100, 16, v175
  v_and_b32 v101, 0xffff0000, v175
  v_mul_f32 v100, v100, v86
  v_mul_f32 v101, v101, v87
  v_cvt_pk_bf16_f32 v175, v100, v101
  v_lshlrev_b32 v100, 16, v244
  v_and_b32 v101, 0xffff0000, v244
  v_mul_f32 v100, v100, v80
  v_mul_f32 v101, v101, v81
  v_cvt_pk_bf16_f32 v244, v100, v101
  v_lshlrev_b32 v100, 16, v245
  v_and_b32 v101, 0xffff0000, v245
  v_mul_f32 v100, v100, v82
  v_mul_f32 v101, v101, v83
  v_cvt_pk_bf16_f32 v245, v100, v101
  v_lshlrev_b32 v100, 16, v246
  v_and_b32 v101, 0xffff0000, v246
  v_mul_f32 v100, v100, v84
  v_mul_f32 v101, v101, v85
  v_cvt_pk_bf16_f32 v246, v100, v101
  v_lshlrev_b32 v100, 16, v247
  v_and_b32 v101, 0xffff0000, v247
  v_mul_f32 v100, v100, v86
  v_mul_f32 v101, v101, v87
  v_cvt_pk_bf16_f32 v247, v100, v101
  v_mfma_f32_16x16x32_bf16 v[8:11], v[172:175], v[28:31], v[8:11]
  s_nop 0
  v_mfma_f32_16x16x32_bf16 v[12:15], v[244:247], v[28:31], v[12:15]
  buffer_load_dwordx4 v[64:67], v24, s[8:11], s42 offen offset:2176 sc1
  buffer_load_dwordx4 v[68:71], v24, s[8:11], s42 offen offset:2192 sc1
  buffer_load_dwordx4 v[80:83], v24, s[8:11], s43 offen offset:2176 sc1
  buffer_load_dwordx4 v[84:87], v24, s[8:11], s43 offen offset:2192 sc1
  s_waitcnt vmcnt(7)
  v_cvt_pk_bf16_f32 v96, v32, v33
  v_cvt_pk_bf16_f32 v97, v34, v35
  s_waitcnt vmcnt(6)
  v_cvt_pk_bf16_f32 v98, v36, v37
  v_cvt_pk_bf16_f32 v99, v38, v39
  s_waitcnt vmcnt(5)
  v_add_f32 v48, 1.0, v48
  v_add_f32 v49, 1.0, v49
  v_add_f32 v50, 1.0, v50
  v_add_f32 v51, 1.0, v51
  s_waitcnt vmcnt(4)
  v_add_f32 v52, 1.0, v52
  v_add_f32 v53, 1.0, v53
  v_add_f32 v54, 1.0, v54
  v_add_f32 v55, 1.0, v55
  v_mfma_f32_16x16x32_bf16 v[16:19], v[176:179], v[96:99], v[16:19]
  v_mfma_f32_16x16x32_bf16 v[20:23], v[248:251], v[96:99], v[20:23]
  v_lshlrev_b32 v100, 16, v176
  v_and_b32 v101, 0xffff0000, v176
  v_mul_f32 v100, v100, v48
  v_mul_f32 v101, v101, v49
  v_cvt_pk_bf16_f32 v176, v100, v101
  v_lshlrev_b32 v100, 16, v177
  v_and_b32 v101, 0xffff0000, v177
  v_mul_f32 v100, v100, v50
  v_mul_f32 v101, v101, v51
  v_cvt_pk_bf16_f32 v177, v100, v101
  v_lshlrev_b32 v100, 16, v178
  v_and_b32 v101, 0xffff0000, v178
  v_mul_f32 v100, v100, v52
  v_mul_f32 v101, v101, v53
  v_cvt_pk_bf16_f32 v178, v100, v101
  v_lshlrev_b32 v100, 16, v179
  v_and_b32 v101, 0xffff0000, v179
  v_mul_f32 v100, v100, v54
  v_mul_f32 v101, v101, v55
  v_cvt_pk_bf16_f32 v179, v100, v101
  v_lshlrev_b32 v100, 16, v248
  v_and_b32 v101, 0xffff0000, v248
  v_mul_f32 v100, v100, v48
  v_mul_f32 v101, v101, v49
  v_cvt_pk_bf16_f32 v248, v100, v101
  v_lshlrev_b32 v100, 16, v249
  v_and_b32 v101, 0xffff0000, v249
  v_mul_f32 v100, v100, v50
  v_mul_f32 v101, v101, v51
  v_cvt_pk_bf16_f32 v249, v100, v101
  v_lshlrev_b32 v100, 16, v250
  v_and_b32 v101, 0xffff0000, v250
  v_mul_f32 v100, v100, v52
  v_mul_f32 v101, v101, v53
  v_cvt_pk_bf16_f32 v250, v100, v101
  v_lshlrev_b32 v100, 16, v251
  v_and_b32 v101, 0xffff0000, v251
  v_mul_f32 v100, v100, v54
  v_mul_f32 v101, v101, v55
  v_cvt_pk_bf16_f32 v251, v100, v101
  v_mfma_f32_16x16x32_bf16 v[8:11], v[176:179], v[28:31], v[8:11]
  s_nop 0
  v_mfma_f32_16x16x32_bf16 v[12:15], v[248:251], v[28:31], v[12:15]
  s_waitcnt vmcnt(3)
  v_cvt_pk_bf16_f32 v96, v64, v65
  v_cvt_pk_bf16_f32 v97, v66, v67
  s_waitcnt vmcnt(2)
  v_cvt_pk_bf16_f32 v98, v68, v69
  v_cvt_pk_bf16_f32 v99, v70, v71
  s_waitcnt vmcnt(1)
  v_add_f32 v80, 1.0, v80
  v_add_f32 v81, 1.0, v81
  v_add_f32 v82, 1.0, v82
  v_add_f32 v83, 1.0, v83
  s_waitcnt vmcnt(0)
  v_add_f32 v84, 1.0, v84
  v_add_f32 v85, 1.0, v85
  v_add_f32 v86, 1.0, v86
  v_add_f32 v87, 1.0, v87
  v_mfma_f32_16x16x32_bf16 v[16:19], v[180:183], v[96:99], v[16:19]
  v_mfma_f32_16x16x32_bf16 v[20:23], v[252:255], v[96:99], v[20:23]
  v_lshlrev_b32 v100, 16, v180
  v_and_b32 v101, 0xffff0000, v180
  v_mul_f32 v100, v100, v80
  v_mul_f32 v101, v101, v81
  v_cvt_pk_bf16_f32 v180, v100, v101
  v_lshlrev_b32 v100, 16, v181
  v_and_b32 v101, 0xffff0000, v181
  v_mul_f32 v100, v100, v82
  v_mul_f32 v101, v101, v83
  v_cvt_pk_bf16_f32 v181, v100, v101
  v_lshlrev_b32 v100, 16, v182
  v_and_b32 v101, 0xffff0000, v182
  v_mul_f32 v100, v100, v84
  v_mul_f32 v101, v101, v85
  v_cvt_pk_bf16_f32 v182, v100, v101
  v_lshlrev_b32 v100, 16, v183
  v_and_b32 v101, 0xffff0000, v183
  v_mul_f32 v100, v100, v86
  v_mul_f32 v101, v101, v87
  v_cvt_pk_bf16_f32 v183, v100, v101
  v_lshlrev_b32 v100, 16, v252
  v_and_b32 v101, 0xffff0000, v252
  v_mul_f32 v100, v100, v80
  v_mul_f32 v101, v101, v81
  v_cvt_pk_bf16_f32 v252, v100, v101
  v_lshlrev_b32 v100, 16, v253
  v_and_b32 v101, 0xffff0000, v253
  v_mul_f32 v100, v100, v82
  v_mul_f32 v101, v101, v83
  v_cvt_pk_bf16_f32 v253, v100, v101
  v_lshlrev_b32 v100, 16, v254
  v_and_b32 v101, 0xffff0000, v254
  v_mul_f32 v100, v100, v84
  v_mul_f32 v101, v101, v85
  v_cvt_pk_bf16_f32 v254, v100, v101
  v_lshlrev_b32 v100, 16, v255
  v_and_b32 v101, 0xffff0000, v255
  v_mul_f32 v100, v100, v86
  v_mul_f32 v101, v101, v87
  v_cvt_pk_bf16_f32 v255, v100, v101
  v_mfma_f32_16x16x32_bf16 v[8:11], v[180:183], v[28:31], v[8:11]
  s_nop 0
  v_mfma_f32_16x16x32_bf16 v[12:15], v[252:255], v[28:31], v[12:15]
  s_mov_b32 s24, 0xbfb8aa3b
  s_nop 2
  v_mul_f32 v8, s24, v8
  v_mul_f32 v16, s24, v16
  v_mul_f32 v9, s24, v9
  v_mul_f32 v17, s24, v17
  v_mul_f32 v10, s24, v10
  v_mul_f32 v18, s24, v18
  v_mul_f32 v11, s24, v11
  v_mul_f32 v19, s24, v19
  s_mov_b32 s18, 0
  s_mov_b32 s21, 0
  s_mov_b32 s24, 0xbfb8aa3b
  s_mov_b32 s25, 0x3ae38e39
  s_lshl_b32 s20, s12, 2
  s_add_u32 s20, s20, s13
  s_lshl_b32 s20, s20, 9
  v_lshrrev_b32 v7, 1, v0
  s_add_u32 s20, s20, 83886080
  s_mul_i32 s36, s13, 4608
  s_mov_b32 s22, 4718592
  s_mov_b32 s23, 1310720
  s_mov_b32 s26, 43691
  s_and_b32 s42, s13, 1
  s_mul_i32 s43, s42, 1536
  v_add_u32 v83, s43, v3
  v_lshrrev_b32 v85, 1, v0
  v_add_u32 v85, 80384, v85
  s_lshl_b32 s42, s42, 9
  v_add_u32 v84, s42, v85
  s_mov_b32 s27, 0
  s_mov_b32 s28, 0
  s_mov_b32 s33, 73728
  s_mov_b32 s34, -1
  s_mov_b32 s35, 0xffff
  s_cmp_eq_u32 s13, 3
  s_cbranch_scc0 Low_22
  s_lshl_b32 s42, s27, 1
  v_add_u32 v5, s42, v1
  v_mul_u32_u24 v5, s26, v5
  v_lshrrev_b32 v5, 17, v5
  s_mov_b32 s44, 20480
Lp_23:
  buffer_load_dword v6, v2, s[8:11], s44 offen sc1
  s_waitcnt vmcnt(0)
  v_cmp_gt_u32 vcc, v5, v6
  s_cbranch_vccz Lpo_24
  s_sleep 2
  s_sub_u32 s15, s15, 1
  s_cbranch_scc0 Lp_23
  s_mov_b32 s15, 0
Lpo_24:
Low_22:
  s_barrier
  s_add_u32 s30, s36, 0
  s_add_u32 m0, s30, s21
  s_add_u32 s31, s30, s22
  buffer_load_dwordx4 v0, s[8:11], s31 offen offset:0 sc1 lds
  buffer_load_dwordx4 v0, s[8:11], s31 offen offset:1024 sc1 lds
  buffer_load_dwordx4 v0, s[8:11], s31 offen offset:2048 sc1 lds
  buffer_load_dwordx4 v0, s[8:11], s31 offen offset:3072 sc1 lds
  s_add_u32 m0, m0, 4096
  s_add_u32 s31, s31, 4096
  s_mov_b64 exec, 0xffffffff
  buffer_load_dwordx4 v0, s[8:11], s31 offen offset:0 sc1 lds
  s_mov_b64 exec, -1
  s_mul_i32 s30, s13, 768
  s_add_u32 s31, s30, s23
  s_add_u32 m0, s30, s33
  s_mov_b64 exec, s[34:35]
  buffer_load_dwordx4 v0, s[8:11], s31 offen sc1 lds
  s_mov_b64 exec, -1
  s_add_u32 s30, s36, 18432
  s_add_u32 m0, s30, s21
  s_add_u32 s31, s30, s22
  buffer_load_dwordx4 v0, s[8:11], s31 offen offset:0 sc1 lds
  buffer_load_dwordx4 v0, s[8:11], s31 offen offset:1024 sc1 lds
  buffer_load_dwordx4 v0, s[8:11], s31 offen offset:2048 sc1 lds
  buffer_load_dwordx4 v0, s[8:11], s31 offen offset:3072 sc1 lds
  s_add_u32 m0, m0, 4096
  s_add_u32 s31, s31, 4096
  s_mov_b64 exec, 0xffffffff
  buffer_load_dwordx4 v0, s[8:11], s31 offen offset:0 sc1 lds
  s_mov_b64 exec, -1
  s_add_u32 s27, s27, 1
  s_add_u32 s22, s22, 36864
  s_add_u32 s23, s23, 3072
Lup_loop:
  s_waitcnt vmcnt(5)
Lup_loop2:
  v_add_u32 v4, s21, v0
  v_add_u32 v80, s33, v83
  s_xor_b32 s21, s21, 36864
  s_xor_b32 s33, s33, 3072
  s_barrier
  s_cmp_eq_u32 s13, 3
  s_cbranch_scc0 Low_25
  s_lshl_b32 s42, s27, 1
  v_add_u32 v5, s42, v1
  v_mul_u32_u24 v5, s26, v5
  v_lshrrev_b32 v5, 17, v5
  s_mov_b32 s44, 20480
  buffer_load_dword v6, v2, s[8:11], s44 offen sc1
Low_25:
  ds_read_b128 v[40:43], v4 offset:0
  ds_read_b128 v[44:47], v4 offset:1024
  ds_read_b128 v[48:51], v4 offset:2048
  ds_read_b64 v[56:57], v80 offset:0
  ds_read_b64 v[58:59], v80 offset:8
  ds_read_b64 v[60:61], v80 offset:16
  s_waitcnt lgkmcnt(5)
  v_mfma_f32_16x16x32_bf16 v[24:27], v[112:115], v[40:43], 0
  ds_read_b128 v[52:55], v4 offset:3072
  s_waitcnt lgkmcnt(2)
  v_add_f32 v56, v56, v58
  v_mfma_f32_16x16x32_bf16 v[28:31], v[184:187], v[40:43], 0
  v_add_f32 v57, v57, v59
  s_waitcnt lgkmcnt(1)
  v_add_f32 v56, v56, v60
  v_mfma_f32_16x16x32_bf16 v[24:27], v[116:119], v[44:47], v[24:27]
  ds_read_b128 v[40:43], v4 offset:4096
  v_add_f32 v57, v57, v61
  v_mfma_f32_16x16x32_bf16 v[28:31], v[188:191], v[44:47], v[28:31]
  v_mov_b32 v58, v56
  v_mov_b32 v59, v57
  v_mfma_f32_16x16x32_bf16 v[24:27], v[120:123], v[48:51], v[24:27]
  ds_read_b128 v[44:47], v4 offset:5120
  v_permlane16_swap_b32 v56, v58
  v_mfma_f32_16x16x32_bf16 v[28:31], v[192:195], v[48:51], v[28:31]
  v_permlane16_swap_b32 v57, v59
  v_add_f32 v56, v56, v58
  s_waitcnt lgkmcnt(2)
  v_mfma_f32_16x16x32_bf16 v[24:27], v[124:127], v[52:55], v[24:27]
  ds_read_b128 v[48:51], v4 offset:6144
  v_add_f32 v57, v57, v59
  v_mfma_f32_16x16x32_bf16 v[28:31], v[196:199], v[52:55], v[28:31]
  v_mov_b32 v58, v56
  v_mov_b32 v59, v57
  s_waitcnt lgkmcnt(2)
  v_mfma_f32_16x16x32_bf16 v[24:27], v[128:131], v[40:43], v[24:27]
  ds_read_b128 v[52:55], v4 offset:7168
  v_permlane32_swap_b32 v56, v58
  v_mfma_f32_16x16x32_bf16 v[28:31], v[200:203], v[40:43], v[28:31]
  v_permlane32_swap_b32 v57, v59
  v_add_f32 v56, v56, v58
  s_waitcnt lgkmcnt(2)
  v_mfma_f32_16x16x32_bf16 v[24:27], v[132:135], v[44:47], v[24:27]
  ds_read_b128 v[40:43], v4 offset:8192
  v_add_f32 v57, v57, v59
  v_mfma_f32_16x16x32_bf16 v[28:31], v[204:207], v[44:47], v[28:31]
  v_mul_f32 v58, s25, v56
  v_mul_f32 v59, s25, v57
  s_waitcnt lgkmcnt(2)
  v_mfma_f32_16x16x32_bf16 v[24:27], v[136:139], v[48:51], v[24:27]
  ds_read_b128 v[44:47], v4 offset:9216
  v_fma_f32 v59, -v58, v58, v59
  v_mfma_f32_16x16x32_bf16 v[28:31], v[208:211], v[48:51], v[28:31]
  v_max_f32 v59, 0, v59
  v_add_f32 v59, 0x3727c5ac, v59
  s_waitcnt lgkmcnt(2)
  v_mfma_f32_16x16x32_bf16 v[24:27], v[140:143], v[52:55], v[24:27]
  ds_read_b128 v[48:51], v4 offset:10240
  v_rsq_f32 v56, v59
  v_mfma_f32_16x16x32_bf16 v[28:31], v[212:215], v[52:55], v[28:31]
  v_mul_f32 v57, v56, v58
  v_sub_f32 v57, 0, v57
  s_waitcnt lgkmcnt(2)
  v_mfma_f32_16x16x32_bf16 v[24:27], v[144:147], v[40:43], v[24:27]
  ds_read_b128 v[52:55], v4 offset:11264
  ds_write_b64 v84, v[56:57]
  v_mfma_f32_16x16x32_bf16 v[28:31], v[216:219], v[40:43], v[28:31]
  s_waitcnt lgkmcnt(3)
  v_mfma_f32_16x16x32_bf16 v[24:27], v[148:151], v[44:47], v[24:27]
  ds_read_b128 v[40:43], v4 offset:12288
  v_mfma_f32_16x16x32_bf16 v[28:31], v[220:223], v[44:47], v[28:31]
  s_waitcnt lgkmcnt(3)
  v_mfma_f32_16x16x32_bf16 v[24:27], v[152:155], v[48:51], v[24:27]
  ds_read_b128 v[44:47], v4 offset:13312
  v_mfma_f32_16x16x32_bf16 v[28:31], v[224:227], v[48:51], v[28:31]
  s_waitcnt lgkmcnt(3)
  v_mfma_f32_16x16x32_bf16 v[24:27], v[156:159], v[52:55], v[24:27]
  ds_read_b128 v[48:51], v4 offset:14336
  v_mfma_f32_16x16x32_bf16 v[28:31], v[228:231], v[52:55], v[28:31]
  s_waitcnt lgkmcnt(2)
  v_mfma_f32_16x16x32_bf16 v[24:27], v[160:163], v[40:43], v[24:27]
  ds_read_b128 v[52:55], v4 offset:15360
  v_mfma_f32_16x16x32_bf16 v[28:31], v[232:235], v[40:43], v[28:31]
  s_waitcnt lgkmcnt(2)
  v_mfma_f32_16x16x32_bf16 v[24:27], v[164:167], v[44:47], v[24:27]
  ds_read_b128 v[40:43], v4 offset:16384
  v_mfma_f32_16x16x32_bf16 v[28:31], v[236:239], v[44:47], v[28:31]
  s_waitcnt lgkmcnt(3)
  s_waitcnt vmcnt(0)
  s_cmp_eq_u32 s13, 3
  s_cbranch_scc0 Lw3_26
  v_cmp_gt_u32 vcc, v5, v6
  s_cmp_eq_u64 vcc, 0
  s_cselect_b32 s42, 1, 0
  s_cmp_ge_u32 s27, 64
  s_cselect_b32 s42, 0, s42
  v_mov_b32 v5, 80000
  v_mov_b32 v6, s42
  ds_write_b32 v5, v6
  s_waitcnt lgkmcnt(0)
Lw3_26:
  s_barrier
  v_mov_b32 v5, 80000
  ds_read_b32 v6, v5
  ds_read_b64 v[56:57], v85
  ds_read_b64 v[62:63], v85 offset:512
  s_cmp_eq_u32 s28, 0
  s_cbranch_scc1 Lnp_27
  s_cmp_eq_u32 s13, 0
  s_cbranch_scc0 Lfs_28
  v_mov_b32 v81, s18
  s_mov_b64 exec, 1
  buffer_store_dword v81, off, s[8:11], s19 sc1
  s_mov_b64 exec, -1
Lfs_28:
Lnp_27:
  v_mfma_f32_16x16x32_bf16 v[24:27], v[168:171], v[48:51], v[24:27]
  ds_read_b128 v[44:47], v4 offset:17408
  v_mfma_f32_16x16x32_bf16 v[28:31], v[240:243], v[48:51], v[28:31]
  v_mfma_f32_16x16x32_bf16 v[24:27], v[172:175], v[52:55], v[24:27]
  ds_read_b128 v[48:51], v4 offset:18432
  v_mfma_f32_16x16x32_bf16 v[28:31], v[244:247], v[52:55], v[28:31]
  v_mfma_f32_16x16x32_bf16 v[24:27], v[176:179], v[40:43], v[24:27]
  ds_read_b128 v[52:55], v4 offset:19456
  v_mfma_f32_16x16x32_bf16 v[28:31], v[248:251], v[40:43], v[28:31]
  s_waitcnt lgkmcnt(5)
  v_readfirstlane_b32 s28, v6
  s_cmp_eq_u32 s28, 0
  s_cbranch_scc1 Lup_nopf
  s_waitcnt lgkmcnt(2)
  v_mfma_f32_16x16x32_bf16 v[24:27], v[180:183], v[44:47], v[24:27]
  ds_read_b128 v[40:43], v4 offset:20480
  v_mfma_f32_16x16x32_bf16 v[28:31], v[252:255], v[44:47], v[28:31]
  s_add_u32 s30, s36, 0
  s_add_u32 m0, s30, s21
  s_add_u32 s31, s30, s22
  buffer_load_dwordx4 v0, s[8:11], s31 offen offset:0 sc1 lds
  s_waitcnt lgkmcnt(2)
  v_mfma_f32_16x16x32_bf16 v[32:35], v[112:115], v[48:51], 0
  ds_read_b128 v[44:47], v4 offset:21504
  v_mfma_f32_16x16x32_bf16 v[36:39], v[184:187], v[48:51], 0
  buffer_load_dwordx4 v0, s[8:11], s31 offen offset:1024 sc1 lds
  s_waitcnt lgkmcnt(2)
  v_mfma_f32_16x16x32_bf16 v[32:35], v[116:119], v[52:55], v[32:35]
  ds_read_b128 v[48:51], v4 offset:22528
  v_mfma_f32_16x16x32_bf16 v[36:39], v[188:191], v[52:55], v[36:39]
  buffer_load_dwordx4 v0, s[8:11], s31 offen offset:2048 sc1 lds
  s_waitcnt lgkmcnt(2)
  v_mfma_f32_16x16x32_bf16 v[32:35], v[120:123], v[40:43], v[32:35]
  ds_read_b128 v[52:55], v4 offset:23552
  v_mul_f32 v58, s24, v56
  v_mfma_f32_16x16x32_bf16 v[36:39], v[192:195], v[40:43], v[36:39]
  v_fma_f32 v68, v57, v8, v16
  v_fma_f32 v72, v57, v12, v20
  buffer_load_dwordx4 v0, s[8:11], s31 offen offset:3072 sc1 lds
  s_waitcnt lgkmcnt(2)
  v_mfma_f32_16x16x32_bf16 v[32:35], v[124:127], v[44:47], v[32:35]
  ds_read_b128 v[40:43], v4 offset:24576
  v_fma_f32 v69, v57, v9, v17
  v_mfma_f32_16x16x32_bf16 v[36:39], v[196:199], v[44:47], v[36:39]
  v_fma_f32 v73, v57, v13, v21
  v_fma_f32 v70, v57, v10, v18
  s_add_u32 m0, m0, 4096
  s_add_u32 s31, s31, 4096
  s_mov_b64 exec, 0xffffffff
  buffer_load_dwordx4 v0, s[8:11], s31 offen offset:0 sc1 lds
  s_mov_b64 exec, -1
  s_waitcnt lgkmcnt(2)
  v_mfma_f32_16x16x32_bf16 v[32:35], v[128:131], v[48:51], v[32:35]
  ds_read_b128 v[44:47], v4 offset:25600
  v_fma_f32 v74, v57, v14, v22
  v_mfma_f32_16x16x32_bf16 v[36:39], v[200:203], v[48:51], v[36:39]
  v_fma_f32 v71, v57, v11, v19
  v_fma_f32 v75, v57, v15, v23
  s_mul_i32 s30, s13, 768
  s_add_u32 s31, s30, s23
  s_add_u32 m0, s30, s33
  s_mov_b64 exec, s[34:35]
  buffer_load_dwordx4 v0, s[8:11], s31 offen sc1 lds
  s_mov_b64 exec, -1
  s_waitcnt lgkmcnt(2)
  v_mfma_f32_16x16x32_bf16 v[32:35], v[132:135], v[52:55], v[32:35]
  ds_read_b128 v[48:51], v4 offset:26624
  v_fmac_f32 v68, v58, v24
  v_mfma_f32_16x16x32_bf16 v[36:39], v[204:207], v[52:55], v[36:39]
  v_fmac_f32 v72, v56, v28
  v_fmac_f32 v69, v58, v25
  s_add_u32 s30, s36, 18432
  s_add_u32 m0, s30, s21
  s_add_u32 s31, s30, s22
  buffer_load_dwordx4 v0, s[8:11], s31 offen offset:0 sc1 lds
  s_waitcnt lgkmcnt(2)
  v_mfma_f32_16x16x32_bf16 v[32:35], v[136:139], v[40:43], v[32:35]
  ds_read_b128 v[52:55], v4 offset:27648
  v_fmac_f32 v73, v56, v29
  v_mfma_f32_16x16x32_bf16 v[36:39], v[208:211], v[40:43], v[36:39]
  v_fmac_f32 v70, v58, v26
  v_fmac_f32 v74, v56, v30
  buffer_load_dwordx4 v0, s[8:11], s31 offen offset:1024 sc1 lds
  s_waitcnt lgkmcnt(2)
  v_mfma_f32_16x16x32_bf16 v[32:35], v[140:143], v[44:47], v[32:35]
  ds_read_b128 v[40:43], v4 offset:28672
  v_fmac_f32 v71, v58, v27
  v_mfma_f32_16x16x32_bf16 v[36:39], v[212:215], v[44:47], v[36:39]
  v_fmac_f32 v75, v56, v31
  v_exp_f32 v68, v68
  buffer_load_dwordx4 v0, s[8:11], s31 offen offset:2048 sc1 lds
  s_waitcnt lgkmcnt(2)
  v_mfma_f32_16x16x32_bf16 v[32:35], v[144:147], v[48:51], v[32:35]
  ds_read_b128 v[44:47], v4 offset:29696
  v_exp_f32 v69, v69
  v_mfma_f32_16x16x32_bf16 v[36:39], v[216:219], v[48:51], v[36:39]
  v_exp_f32 v70, v70
  v_exp_f32 v71, v71
  s_waitcnt lgkmcnt(2)
  v_mfma_f32_16x16x32_bf16 v[32:35], v[148:151], v[52:55], v[32:35]
  ds_read_b128 v[48:51], v4 offset:30720
  v_add_f32 v68, 1.0, v68
  v_mfma_f32_16x16x32_bf16 v[36:39], v[220:223], v[52:55], v[36:39]
  v_add_f32 v69, 1.0, v69
  v_add_f32 v70, 1.0, v70
  buffer_load_dwordx4 v0, s[8:11], s31 offen offset:3072 sc1 lds
  s_waitcnt lgkmcnt(2)
  v_mfma_f32_16x16x32_bf16 v[32:35], v[152:155], v[40:43], v[32:35]
  ds_read_b128 v[52:55], v4 offset:31744
  v_add_f32 v71, 1.0, v71
  v_mfma_f32_16x16x32_bf16 v[36:39], v[224:227], v[40:43], v[36:39]
  v_rcp_f32 v68, v68
  v_rcp_f32 v69, v69
  s_waitcnt lgkmcnt(2)
  v_mfma_f32_16x16x32_bf16 v[32:35], v[156:159], v[44:47], v[32:35]
  ds_read_b128 v[40:43], v4 offset:32768
  v_rcp_f32 v70, v70
  v_mfma_f32_16x16x32_bf16 v[36:39], v[228:231], v[44:47], v[36:39]
  v_rcp_f32 v71, v71
  v_mul_f32 v72, v72, v68
  s_add_u32 m0, m0, 4096
  s_add_u32 s31, s31, 4096
  s_mov_b64 exec, 0xffffffff
  buffer_load_dwordx4 v0, s[8:11], s31 offen offset:0 sc1 lds
  s_mov_b64 exec, -1
  s_add_u32 s27, s27, 1
  s_add_u32 s22, s22, 36864
  s_add_u32 s23, s23, 3072
  s_waitcnt lgkmcnt(2)
  v_mfma_f32_16x16x32_bf16 v[32:35], v[160:163], v[48:51], v[32:35]
  ds_read_b128 v[44:47], v4 offset:33792
  v_mul_f32 v73, v73, v69
  v_mfma_f32_16x16x32_bf16 v[36:39], v[232:235], v[48:51], v[36:39]
  v_mul_f32 v74, v74, v70
  v_mul_f32 v75, v75, v71
  s_waitcnt lgkmcnt(2)
  v_mfma_f32_16x16x32_bf16 v[32:35], v[164:167], v[52:55], v[32:35]
  ds_read_b128 v[48:51], v4 offset:34816
  v_cvt_pk_bf16_f32 v76, v72, v73
  v_mfma_f32_16x16x32_bf16 v[36:39], v[236:239], v[52:55], v[36:39]
  v_cvt_pk_bf16_f32 v77, v74, v75
  s_add_u32 s44, s20, 0
  buffer_store_dwordx2 v[76:77], v7, s[8:11], s44 offen sc1
  s_waitcnt lgkmcnt(2)
  v_mfma_f32_16x16x32_bf16 v[32:35], v[168:171], v[40:43], v[32:35]
  ds_read_b128 v[52:55], v4 offset:35840
  v_mfma_f32_16x16x32_bf16 v[36:39], v[240:243], v[40:43], v[36:39]
  s_waitcnt lgkmcnt(2)
  v_mfma_f32_16x16x32_bf16 v[32:35], v[172:175], v[44:47], v[32:35]
  v_mfma_f32_16x16x32_bf16 v[36:39], v[244:247], v[44:47], v[36:39]
  s_waitcnt lgkmcnt(1)
  v_mfma_f32_16x16x32_bf16 v[32:35], v[176:179], v[48:51], v[32:35]
  v_mfma_f32_16x16x32_bf16 v[36:39], v[248:251], v[48:51], v[36:39]
  s_waitcnt lgkmcnt(0)
  v_mfma_f32_16x16x32_bf16 v[32:35], v[180:183], v[52:55], v[32:35]
  v_mfma_f32_16x16x32_bf16 v[36:39], v[252:255], v[52:55], v[36:39]
  v_mul_f32 v64, s24, v62
  v_fma_f32 v68, v63, v8, v16
  v_fma_f32 v72, v63, v12, v20
  v_fma_f32 v69, v63, v9, v17
  v_fma_f32 v73, v63, v13, v21
  v_fma_f32 v70, v63, v10, v18
  v_fma_f32 v74, v63, v14, v22
  v_fma_f32 v71, v63, v11, v19
  v_fma_f32 v75, v63, v15, v23
  v_fmac_f32 v68, v64, v32
  v_fmac_f32 v72, v62, v36
  v_fmac_f32 v69, v64, v33
  v_fmac_f32 v73, v62, v37
  v_fmac_f32 v70, v64, v34
  v_fmac_f32 v74, v62, v38
  v_fmac_f32 v71, v64, v35
  v_fmac_f32 v75, v62, v39
  v_exp_f32 v68, v68
  v_exp_f32 v69, v69
  v_exp_f32 v70, v70
  v_exp_f32 v71, v71
  v_add_f32 v68, 1.0, v68
  v_add_f32 v69, 1.0, v69
  v_add_f32 v70, 1.0, v70
  v_add_f32 v71, 1.0, v71
  v_rcp_f32 v68, v68
  v_rcp_f32 v69, v69
  v_rcp_f32 v70, v70
  v_rcp_f32 v71, v71
  v_mul_f32 v72, v72, v68
  v_mul_f32 v73, v73, v69
  v_mul_f32 v74, v74, v70
  v_mul_f32 v75, v75, v71
  v_cvt_pk_bf16_f32 v78, v72, v73
  v_cvt_pk_bf16_f32 v79, v74, v75
  s_add_u32 s44, s20, 147456
  buffer_store_dwordx2 v[78:79], v7, s[8:11], s44 offen sc1
  s_mov_b32 s29, s18
  s_add_u32 s18, s18, 1
  s_add_u32 s20, s20, 294912
  s_waitcnt vmcnt(2)
  s_branch Lup_loop2
Lup_nopf:
  s_waitcnt lgkmcnt(2)
  v_mfma_f32_16x16x32_bf16 v[24:27], v[180:183], v[44:47], v[24:27]
  ds_read_b128 v[40:43], v4 offset:20480
  v_mfma_f32_16x16x32_bf16 v[28:31], v[252:255], v[44:47], v[28:31]
  s_waitcnt lgkmcnt(2)
  v_mfma_f32_16x16x32_bf16 v[32:35], v[112:115], v[48:51], 0
  ds_read_b128 v[44:47], v4 offset:21504
  v_mfma_f32_16x16x32_bf16 v[36:39], v[184:187], v[48:51], 0
  s_waitcnt lgkmcnt(2)
  v_mfma_f32_16x16x32_bf16 v[32:35], v[116:119], v[52:55], v[32:35]
  ds_read_b128 v[48:51], v4 offset:22528
  v_mfma_f32_16x16x32_bf16 v[36:39], v[188:191], v[52:55], v[36:39]
  s_waitcnt lgkmcnt(2)
  v_mfma_f32_16x16x32_bf16 v[32:35], v[120:123], v[40:43], v[32:35]
  ds_read_b128 v[52:55], v4 offset:23552
  v_mul_f32 v58, s24, v56
  v_mfma_f32_16x16x32_bf16 v[36:39], v[192:195], v[40:43], v[36:39]
  v_fma_f32 v68, v57, v8, v16
  v_fma_f32 v72, v57, v12, v20
  s_waitcnt lgkmcnt(2)
  v_mfma_f32_16x16x32_bf16 v[32:35], v[124:127], v[44:47], v[32:35]
  ds_read_b128 v[40:43], v4 offset:24576
  v_fma_f32 v69, v57, v9, v17
  v_mfma_f32_16x16x32_bf16 v[36:39], v[196:199], v[44:47], v[36:39]
  v_fma_f32 v73, v57, v13, v21
  v_fma_f32 v70, v57, v10, v18
  s_waitcnt lgkmcnt(2)
  v_mfma_f32_16x16x32_bf16 v[32:35], v[128:131], v[48:51], v[32:35]
  ds_read_b128 v[44:47], v4 offset:25600
  v_fma_f32 v74, v57, v14, v22
  v_mfma_f32_16x16x32_bf16 v[36:39], v[200:203], v[48:51], v[36:39]
  v_fma_f32 v71, v57, v11, v19
  v_fma_f32 v75, v57, v15, v23
  s_waitcnt lgkmcnt(2)
  v_mfma_f32_16x16x32_bf16 v[32:35], v[132:135], v[52:55], v[32:35]
  ds_read_b128 v[48:51], v4 offset:26624
  v_fmac_f32 v68, v58, v24
  v_mfma_f32_16x16x32_bf16 v[36:39], v[204:207], v[52:55], v[36:39]
  v_fmac_f32 v72, v56, v28
  v_fmac_f32 v69, v58, v25
  s_waitcnt lgkmcnt(2)
  v_mfma_f32_16x16x32_bf16 v[32:35], v[136:139], v[40:43], v[32:35]
  ds_read_b128 v[52:55], v4 offset:27648
  v_fmac_f32 v73, v56, v29
  v_mfma_f32_16x16x32_bf16 v[36:39], v[208:211], v[40:43], v[36:39]
  v_fmac_f32 v70, v58, v26
  v_fmac_f32 v74, v56, v30
  s_waitcnt lgkmcnt(2)
  v_mfma_f32_16x16x32_bf16 v[32:35], v[140:143], v[44:47], v[32:35]
  ds_read_b128 v[40:43], v4 offset:28672
  v_fmac_f32 v71, v58, v27
  v_mfma_f32_16x16x32_bf16 v[36:39], v[212:215], v[44:47], v[36:39]
  v_fmac_f32 v75, v56, v31
  v_exp_f32 v68, v68
  s_waitcnt lgkmcnt(2)
  v_mfma_f32_16x16x32_bf16 v[32:35], v[144:147], v[48:51], v[32:35]
  ds_read_b128 v[44:47], v4 offset:29696
  v_exp_f32 v69, v69
  v_mfma_f32_16x16x32_bf16 v[36:39], v[216:219], v[48:51], v[36:39]
  v_exp_f32 v70, v70
  v_exp_f32 v71, v71
  s_cmp_eq_u32 s13, 3
  s_cbranch_scc0 Lw3_29
  s_lshl_b32 s42, s27, 1
  v_add_u32 v5, s42, v1
  v_mul_u32_u24 v5, s26, v5
  v_lshrrev_b32 v5, 17, v5
  s_mov_b32 s44, 20480
  buffer_load_dword v6, v2, s[8:11], s44 offen sc1
Lw3_29:
  s_waitcnt lgkmcnt(2)
  v_mfma_f32_16x16x32_bf16 v[32:35], v[148:151], v[52:55], v[32:35]
  ds_read_b128 v[48:51], v4 offset:30720
  v_add_f32 v68, 1.0, v68
  v_mfma_f32_16x16x32_bf16 v[36:39], v[220:223], v[52:55], v[36:39]
  v_add_f32 v69, 1.0, v69
  v_add_f32 v70, 1.0, v70
  s_waitcnt lgkmcnt(2)
  v_mfma_f32_16x16x32_bf16 v[32:35], v[152:155], v[40:43], v[32:35]
  ds_read_b128 v[52:55], v4 offset:31744
  v_add_f32 v71, 1.0, v71
  v_mfma_f32_16x16x32_bf16 v[36:39], v[224:227], v[40:43], v[36:39]
  v_rcp_f32 v68, v68
  v_rcp_f32 v69, v69
  s_waitcnt lgkmcnt(2)
  v_mfma_f32_16x16x32_bf16 v[32:35], v[156:159], v[44:47], v[32:35]
  ds_read_b128 v[40:43], v4 offset:32768
  v_rcp_f32 v70, v70
  v_mfma_f32_16x16x32_bf16 v[36:39], v[228:231], v[44:47], v[36:39]
  v_rcp_f32 v71, v71
  v_mul_f32 v72, v72, v68
  s_waitcnt lgkmcnt(2)
  v_mfma_f32_16x16x32_bf16 v[32:35], v[160:163], v[48:51], v[32:35]
  ds_read_b128 v[44:47], v4 offset:33792
  v_mul_f32 v73, v73, v69
  v_mfma_f32_16x16x32_bf16 v[36:39], v[232:235], v[48:51], v[36:39]
  v_mul_f32 v74, v74, v70
  v_mul_f32 v75, v75, v71
  s_waitcnt lgkmcnt(2)
  v_mfma_f32_16x16x32_bf16 v[32:35], v[164:167], v[52:55], v[32:35]
  ds_read_b128 v[48:51], v4 offset:34816
  v_cvt_pk_bf16_f32 v76, v72, v73
  v_mfma_f32_16x16x32_bf16 v[36:39], v[236:239], v[52:55], v[36:39]
  v_cvt_pk_bf16_f32 v77, v74, v75
  s_add_u32 s44, s20, 0
  buffer_store_dwordx2 v[76:77], v7, s[8:11], s44 offen sc1
  s_waitcnt lgkmcnt(2)
  v_mfma_f32_16x16x32_bf16 v[32:35], v[168:171], v[40:43], v[32:35]
  ds_read_b128 v[52:55], v4 offset:35840
  v_mfma_f32_16x16x32_bf16 v[36:39], v[240:243], v[40:43], v[36:39]
  s_waitcnt lgkmcnt(2)
  v_mfma_f32_16x16x32_bf16 v[32:35], v[172:175], v[44:47], v[32:35]
  v_mfma_f32_16x16x32_bf16 v[36:39], v[244:247], v[44:47], v[36:39]
  s_waitcnt lgkmcnt(1)
  v_mfma_f32_16x16x32_bf16 v[32:35], v[176:179], v[48:51], v[32:35]
  v_mfma_f32_16x16x32_bf16 v[36:39], v[248:251], v[48:51], v[36:39]
  s_waitcnt lgkmcnt(0)
  v_mfma_f32_16x16x32_bf16 v[32:35], v[180:183], v[52:55], v[32:35]
  v_mfma_f32_16x16x32_bf16 v[36:39], v[252:255], v[52:55], v[36:39]
  v_mul_f32 v64, s24, v62
  v_fma_f32 v68, v63, v8, v16
  v_fma_f32 v72, v63, v12, v20
  v_fma_f32 v69, v63, v9, v17
  v_fma_f32 v73, v63, v13, v21
  v_fma_f32 v70, v63, v10, v18
  v_fma_f32 v74, v63, v14, v22
  v_fma_f32 v71, v63, v11, v19
  v_fma_f32 v75, v63, v15, v23
  v_fmac_f32 v68, v64, v32
  v_fmac_f32 v72, v62, v36
  v_fmac_f32 v69, v64, v33
  v_fmac_f32 v73, v62, v37
  v_fmac_f32 v70, v64, v34
  v_fmac_f32 v74, v62, v38
  v_fmac_f32 v71, v64, v35
  v_fmac_f32 v75, v62, v39
  v_exp_f32 v68, v68
  v_exp_f32 v69, v69
  v_exp_f32 v70, v70
  v_exp_f32 v71, v71
  v_add_f32 v68, 1.0, v68
  v_add_f32 v69, 1.0, v69
  v_add_f32 v70, 1.0, v70
  v_add_f32 v71, 1.0, v71
  v_rcp_f32 v68, v68
  v_rcp_f32 v69, v69
  v_rcp_f32 v70, v70
  v_rcp_f32 v71, v71
  v_mul_f32 v72, v72, v68
  v_mul_f32 v73, v73, v69
  v_mul_f32 v74, v74, v70
  v_mul_f32 v75, v75, v71
  v_cvt_pk_bf16_f32 v78, v72, v73
  v_cvt_pk_bf16_f32 v79, v74, v75
  s_add_u32 s44, s20, 147456
  buffer_store_dwordx2 v[78:79], v7, s[8:11], s44 offen sc1
  s_mov_b32 s29, s18
  s_add_u32 s18, s18, 1
  s_add_u32 s20, s20, 294912
  s_cmp_eq_u32 s13, 3
  s_cbranch_scc0 Low_30
  s_waitcnt vmcnt(2)
  v_cmp_gt_u32 vcc, v5, v6
  s_cmp_eq_u64 vcc, 0
  s_cselect_b32 s42, 1, 0
  s_cmp_ge_u32 s27, 64
  s_cselect_b32 s42, 0, s42
  v_mov_b32 v5, 80004
  v_mov_b32 v6, s42
  ds_write_b32 v5, v6
  s_waitcnt lgkmcnt(0)
Low_30:
  s_barrier
  v_mov_b32 v5, 80004
  ds_read_b32 v6, v5
  s_waitcnt lgkmcnt(0)
  v_readfirstlane_b32 s45, v6
  s_cmp_eq_u32 s45, 0
  s_cbranch_scc1 Lup_wait
  s_add_u32 s30, s36, 0
  s_add_u32 m0, s30, s21
  s_add_u32 s31, s30, s22
  buffer_load_dwordx4 v0, s[8:11], s31 offen offset:0 sc1 lds
  buffer_load_dwordx4 v0, s[8:11], s31 offen offset:1024 sc1 lds
  buffer_load_dwordx4 v0, s[8:11], s31 offen offset:2048 sc1 lds
  buffer_load_dwordx4 v0, s[8:11], s31 offen offset:3072 sc1 lds
  s_add_u32 m0, m0, 4096
  s_add_u32 s31, s31, 4096
  s_mov_b64 exec, 0xffffffff
  buffer_load_dwordx4 v0, s[8:11], s31 offen offset:0 sc1 lds
  s_mov_b64 exec, -1
  s_mul_i32 s30, s13, 768
  s_add_u32 s31, s30, s23
  s_add_u32 m0, s30, s33
  s_mov_b64 exec, s[34:35]
  buffer_load_dwordx4 v0, s[8:11], s31 offen sc1 lds
  s_mov_b64 exec, -1
  s_add_u32 s30, s36, 18432
  s_add_u32 m0, s30, s21
  s_add_u32 s31, s30, s22
  buffer_load_dwordx4 v0, s[8:11], s31 offen offset:0 sc1 lds
  buffer_load_dwordx4 v0, s[8:11], s31 offen offset:1024 sc1 lds
  buffer_load_dwordx4 v0, s[8:11], s31 offen offset:2048 sc1 lds
  buffer_load_dwordx4 v0, s[8:11], s31 offen offset:3072 sc1 lds
  s_add_u32 m0, m0, 4096
  s_add_u32 s31, s31, 4096
  s_mov_b64 exec, 0xffffffff
  buffer_load_dwordx4 v0, s[8:11], s31 offen offset:0 sc1 lds
  s_mov_b64 exec, -1
  s_add_u32 s27, s27, 1
  s_add_u32 s22, s22, 36864
  s_add_u32 s23, s23, 3072
  s_waitcnt vmcnt(11)
  s_barrier
  s_cmp_eq_u32 s13, 1
  s_cbranch_scc0 Lfs_31
  v_mov_b32 v6, s18
  s_mov_b64 exec, 1
  buffer_store_dword v6, off, s[8:11], s19 sc1
  s_mov_b64 exec, -1
Lfs_31:
  s_waitcnt vmcnt(6)
  s_cmp_eq_u32 s13, 1
  s_cbranch_scc1 Lup_loop2
  s_branch Lup_loop
Lup_wait:
  s_cmp_eq_u32 s13, 3
  s_cbranch_scc0 Low_32
  s_lshl_b32 s42, s27, 1
  v_add_u32 v5, s42, v1
  v_mul_u32_u24 v5, s26, v5
  v_lshrrev_b32 v5, 17, v5
  s_mov_b32 s44, 20480
  buffer_load_dword v6, v2, s[8:11], s44 offen sc1
  s_waitcnt vmcnt(0)
  v_cmp_gt_u32 vcc, v5, v6
  s_cmp_eq_u64 vcc, 0
  s_cselect_b32 s42, 1, 0
  s_cmp_ge_u32 s27, 64
  s_cselect_b32 s42, 0, s42
  v_mov_b32 v5, 80008
  v_mov_b32 v6, s42
  ds_write_b32 v5, v6
  s_waitcnt lgkmcnt(0)
Low_32:
  s_waitcnt vmcnt(0)
  s_barrier
  s_cmp_eq_u32 s13, 0
  s_cbranch_scc0 Lfs_33
  v_mov_b32 v6, s18
  s_mov_b64 exec, 1
  buffer_store_dword v6, off, s[8:11], s19 sc1
  s_mov_b64 exec, -1
Lfs_33:
  v_mov_b32 v5, 80008
  ds_read_b32 v82, v5
  s_waitcnt lgkmcnt(0)
  v_readfirstlane_b32 s45, v82
  s_cmp_eq_u32 s45, 1
  s_cbranch_scc1 Lup_go
  s_cmp_ge_u32 s18, 64
  s_cbranch_scc1 Lup_end
  s_cmp_eq_u32 s13, 3
  s_cbranch_scc0 Low_34
  s_lshl_b32 s42, s27, 1
  v_add_u32 v5, s42, v1
  v_mul_u32_u24 v5, s26, v5
  v_lshrrev_b32 v5, 17, v5
  s_mov_b32 s44, 20480
Lp_35:
  buffer_load_dword v6, v2, s[8:11], s44 offen sc1
  s_waitcnt vmcnt(0)
  v_cmp_gt_u32 vcc, v5, v6
  s_cbranch_vccz Lpo_36
  s_sleep 2
  s_sub_u32 s15, s15, 1
  s_cbranch_scc0 Lp_35
  s_mov_b32 s15, 0
Lpo_36:
Low_34:
  s_barrier
Lup_go:
  s_add_u32 s30, s36, 0
  s_add_u32 m0, s30, s21
  s_add_u32 s31, s30, s22
  buffer_load_dwordx4 v0, s[8:11], s31 offen offset:0 sc1 lds
  buffer_load_dwordx4 v0, s[8:11], s31 offen offset:1024 sc1 lds
  buffer_load_dwordx4 v0, s[8:11], s31 offen offset:2048 sc1 lds
  buffer_load_dwordx4 v0, s[8:11], s31 offen offset:3072 sc1 lds
  s_add_u32 m0, m0, 4096
  s_add_u32 s31, s31, 4096
  s_mov_b64 exec, 0xffffffff
  buffer_load_dwordx4 v0, s[8:11], s31 offen offset:0 sc1 lds
  s_mov_b64 exec, -1
  s_mul_i32 s30, s13, 768
  s_add_u32 s31, s30, s23
  s_add_u32 m0, s30, s33
  s_mov_b64 exec, s[34:35]
  buffer_load_dwordx4 v0, s[8:11], s31 offen sc1 lds
  s_mov_b64 exec, -1
  s_add_u32 s30, s36, 18432
  s_add_u32 m0, s30, s21
  s_add_u32 s31, s30, s22
  buffer_load_dwordx4 v0, s[8:11], s31 offen offset:0 sc1 lds
  buffer_load_dwordx4 v0, s[8:11], s31 offen offset:1024 sc1 lds
  buffer_load_dwordx4 v0, s[8:11], s31 offen offset:2048 sc1 lds
  buffer_load_dwordx4 v0, s[8:11], s31 offen offset:3072 sc1 lds
  s_add_u32 m0, m0, 4096
  s_add_u32 s31, s31, 4096
  s_mov_b64 exec, 0xffffffff
  buffer_load_dwordx4 v0, s[8:11], s31 offen offset:0 sc1 lds
  s_mov_b64 exec, -1
  s_add_u32 s27, s27, 1
  s_add_u32 s22, s22, 36864
  s_add_u32 s23, s23, 3072
  s_branch Lup_loop
Lup_end:
  s_branch Lend
Lwo:
  v_and_b32 v30, 63, v0
  v_lshlrev_b32 v0, 4, v30
  v_and_b32 v31, 15, v30
  v_lshrrev_b32 v32, 4, v30
  s_lshl_b32 s42, s13, 2
  v_add_u32 v32, s42, v32
  v_cmp_gt_u32 s[28:29], 12, v31
  v_min_u32 v31, 11, v31
  v_lshrrev_b32 v33, 2, v31
  v_and_b32 v34, 3, v31
  v_lshl_add_u32 v34, v34, 4, v32
  v_lshlrev_b32 v34, 4, v34
  v_lshl_add_u32 v1, v33, 10, v34
  v_add_u32 v1, 147456, v1
  s_mul_i32 s42, s12, 48
  v_lshlrev_b32 v33, 2, v31
  v_add_u32 v33, s42, v33
  v_lshrrev_b32 v34, 5, v33
  v_lshlrev_b32 v34, 10, v34
  v_bfe_u32 v35, v33, 3, 2
  v_lshl_add_u32 v35, v35, 4, v32
  v_lshl_add_u32 v34, v35, 4, v34
  v_bfe_u32 v35, v33, 2, 1
  v_lshl_add_u32 v2, v35, 3, v34
  v_mul_u32_u24 v34, 1152, v32
  v_lshl_add_u32 v3, v33, 1, v34
  v_lshlrev_b32 v36, 2, v33
  v_mul_u32_u24 v37, 96, v32
  v_and_b32 v4, 31, v30
  v_lshlrev_b32 v4, 7, v4
  v_mov_b32 v7, v37
  s_mul_i32 s42, s14, 12
  s_add_u32 s42, s42, s12
  s_lshl_b32 s42, s42, 7
  s_add_u32 s21, s42, 20480
  s_cmp_eq_u32 s13, 3
  s_cselect_b32 s42, -1, 0
  v_and_b32 v4, s42, v4
  v_mov_b32 v6, v36
  v_lshrrev_b32 v30, 4, v0
  v_lshrrev_b32 v31, 3, v30
  v_and_b32 v32, 7, v30
  v_lshrrev_b32 v33, 1, v32
  v_bfe_u32 v34, v30, 4, 2
  v_xor_b32 v33, v33, v34
  v_cmp_ne_u32 s[26:27], 3, v33
  v_mul_u32_u24 v31, 1152, v31
  v_lshl_add_u32 v31, v33, 5, v31
  v_and_b32 v32, 1, v32
  v_lshl_add_u32 v26, v32, 4, v31
  v_lshrrev_b32 v31, 4, v30
  v_bfe_u32 v32, v30, 2, 2
  v_lshl_add_u32 v33, v31, 2, v32
  v_lshlrev_b32 v33, 7, v33
  v_lshrrev_b32 v32, 1, v32
  v_lshl_add_u32 v32, v31, 1, v32
  v_and_b32 v32, 3, v32
  v_lshl_add_u32 v33, v32, 5, v33
  v_and_b32 v32, 3, v30
  v_lshl_add_u32 v33, v32, 3, v33
  s_mul_i32 s30, s13, 40960
  v_add_u32 v27, s30, v33
  v_xor_b32 v28, 32, v27
  v_xor_b32 v29, 64, v27
  s_load_dwordx2 s[4:5], s[0:1], 40
  s_mov_b32 s6, 4718592
  s_mov_b32 s7, 0x20000
  s_mul_i32 s31, s13, 1179648
  s_mul_i32 s42, s12, 96
  s_add_u32 s31, s31, s42
  s_waitcnt lgkmcnt(0)
  s_mov_b64 exec, s[26:27]
  s_add_u32 m0, s30, 0
  s_add_u32 s42, s31, 0
  buffer_load_dwordx4 v26, s[4:7], s42 offen lds
  s_add_u32 m0, s30, 1024
  s_add_u32 s42, s31, 9216
  buffer_load_dwordx4 v26, s[4:7], s42 offen lds
  s_add_u32 m0, s30, 2048
  s_add_u32 s42, s31, 18432
  buffer_load_dwordx4 v26, s[4:7], s42 offen lds
  s_add_u32 m0, s30, 3072
  s_add_u32 s42, s31, 27648
  buffer_load_dwordx4 v26, s[4:7], s42 offen lds
  s_mov_b64 exec, -1
  s_mov_b64 exec, s[26:27]
  s_add_u32 m0, s30, 4096
  s_add_u32 s42, s31, 36864
  buffer_load_dwordx4 v26, s[4:7], s42 offen lds
  s_add_u32 m0, s30, 5120
  s_add_u32 s42, s31, 46080
  buffer_load_dwordx4 v26, s[4:7], s42 offen lds
  s_add_u32 m0, s30, 6144
  s_add_u32 s42, s31, 55296
  buffer_load_dwordx4 v26, s[4:7], s42 offen lds
  s_add_u32 m0, s30, 7168
  s_add_u32 s42, s31, 64512
  buffer_load_dwordx4 v26, s[4:7], s42 offen lds
  s_mov_b64 exec, -1
  s_mov_b64 exec, s[26:27]
  s_add_u32 m0, s30, 8192
  s_add_u32 s42, s31, 73728
  buffer_load_dwordx4 v26, s[4:7], s42 offen lds
  s_add_u32 m0, s30, 9216
  s_add_u32 s42, s31, 82944
  buffer_load_dwordx4 v26, s[4:7], s42 offen lds
  s_add_u32 m0, s30, 10240
  s_add_u32 s42, s31, 92160
  buffer_load_dwordx4 v26, s[4:7], s42 offen lds
  s_add_u32 m0, s30, 11264
  s_add_u32 s42, s31, 101376
  buffer_load_dwordx4 v26, s[4:7], s42 offen lds
  s_mov_b64 exec, -1
  s_mov_b64 exec, s[26:27]
  s_add_u32 m0, s30, 12288
  s_add_u32 s42, s31, 110592
  buffer_load_dwordx4 v26, s[4:7], s42 offen lds
  s_add_u32 m0, s30, 13312
  s_add_u32 s42, s31, 119808
  buffer_load_dwordx4 v26, s[4:7], s42 offen lds
  s_add_u32 m0, s30, 14336
  s_add_u32 s42, s31, 129024
  buffer_load_dwordx4 v26, s[4:7], s42 offen lds
  s_add_u32 m0, s30, 15360
  s_add_u32 s42, s31, 138240
  buffer_load_dwordx4 v26, s[4:7], s42 offen lds
  s_mov_b64 exec, -1
  s_mov_b64 exec, s[26:27]
  s_add_u32 m0, s30, 16384
  s_add_u32 s42, s31, 147456
  buffer_load_dwordx4 v26, s[4:7], s42 offen lds
  s_add_u32 m0, s30, 17408
  s_add_u32 s42, s31, 156672
  buffer_load_dwordx4 v26, s[4:7], s42 offen lds
  s_add_u32 m0, s30, 18432
  s_add_u32 s42, s31, 165888
  buffer_load_dwordx4 v26, s[4:7], s42 offen lds
  s_add_u32 m0, s30, 19456
  s_add_u32 s42, s31, 175104
  buffer_load_dwordx4 v26, s[4:7], s42 offen lds
  s_mov_b64 exec, -1
  s_mov_b64 exec, s[26:27]
  s_add_u32 m0, s30, 20480
  s_add_u32 s42, s31, 184320
  buffer_load_dwordx4 v26, s[4:7], s42 offen lds
  s_add_u32 m0, s30, 21504
  s_add_u32 s42, s31, 193536
  buffer_load_dwordx4 v26, s[4:7], s42 offen lds
  s_add_u32 m0, s30, 22528
  s_add_u32 s42, s31, 202752
  buffer_load_dwordx4 v26, s[4:7], s42 offen lds
  s_add_u32 m0, s30, 23552
  s_add_u32 s42, s31, 211968
  buffer_load_dwordx4 v26, s[4:7], s42 offen lds
  s_mov_b64 exec, -1
  s_mov_b64 exec, s[26:27]
  s_add_u32 m0, s30, 24576
  s_add_u32 s42, s31, 221184
  buffer_load_dwordx4 v26, s[4:7], s42 offen lds
  s_add_u32 m0, s30, 25600
  s_add_u32 s42, s31, 230400
  buffer_load_dwordx4 v26, s[4:7], s42 offen lds
  s_add_u32 m0, s30, 26624
  s_add_u32 s42, s31, 239616
  buffer_load_dwordx4 v26, s[4:7], s42 offen lds
  s_add_u32 m0, s30, 27648
  s_add_u32 s42, s31, 248832
  buffer_load_dwordx4 v26, s[4:7], s42 offen lds
  s_mov_b64 exec, -1
  s_mov_b64 exec, s[26:27]
  s_add_u32 m0, s30, 28672
  s_add_u32 s42, s31, 258048
  buffer_load_dwordx4 v26, s[4:7], s42 offen lds
  s_add_u32 m0, s30, 29696
  s_add_u32 s42, s31, 267264
  buffer_load_dwordx4 v26, s[4:7], s42 offen lds
  s_add_u32 m0, s30, 30720
  s_add_u32 s42, s31, 276480
  buffer_load_dwordx4 v26, s[4:7], s42 offen lds
  s_add_u32 m0, s30, 31744
  s_add_u32 s42, s31, 285696
  buffer_load_dwordx4 v26, s[4:7], s42 offen lds
  s_mov_b64 exec, -1
  s_mov_b64 exec, s[26:27]
  s_add_u32 m0, s30, 32768
  s_add_u32 s42, s31, 294912
  buffer_load_dwordx4 v26, s[4:7], s42 offen lds
  s_add_u32 m0, s30, 33792
  s_add_u32 s42, s31, 304128
  buffer_load_dwordx4 v26, s[4:7], s42 offen lds
  s_add_u32 m0, s30, 34816
  s_add_u32 s42, s31, 313344
  buffer_load_dwordx4 v26, s[4:7], s42 offen lds
  s_add_u32 m0, s30, 35840
  s_add_u32 s42, s31, 322560
  buffer_load_dwordx4 v26, s[4:7], s42 offen lds
  s_mov_b64 exec, -1
  s_mov_b64 exec, s[26:27]
  s_add_u32 m0, s30, 36864
  s_add_u32 s42, s31, 331776
  buffer_load_dwordx4 v26, s[4:7], s42 offen lds
  s_add_u32 m0, s30, 37888
  s_add_u32 s42, s31, 340992
  buffer_load_dwordx4 v26, s[4:7], s42 offen lds
  s_add_u32 m0, s30, 38912
  s_add_u32 s42, s31, 350208
  buffer_load_dwordx4 v26, s[4:7], s42 offen lds
  s_add_u32 m0, s30, 39936
  s_add_u32 s42, s31, 359424
  buffer_load_dwordx4 v26, s[4:7], s42 offen lds
  s_mov_b64 exec, -1
  s_waitcnt vmcnt(36)
  ds_read_b64_tr_b16 v[128:129], v27 offset:0
  ds_read_b64_tr_b16 v[130:131], v27 offset:2048
  ds_read_b64_tr_b16 v[132:133], v28 offset:0
  ds_read_b64_tr_b16 v[134:135], v28 offset:2048
  ds_read_b64_tr_b16 v[136:137], v29 offset:0
  ds_read_b64_tr_b16 v[138:139], v29 offset:2048
  s_waitcnt lgkmcnt(0)
  s_mov_b64 exec, s[26:27]
  s_add_u32 m0, s30, 0
  s_add_u32 s42, s31, 368640
  buffer_load_dwordx4 v26, s[4:7], s42 offen lds
  s_add_u32 m0, s30, 1024
  s_add_u32 s42, s31, 377856
  buffer_load_dwordx4 v26, s[4:7], s42 offen lds
  s_add_u32 m0, s30, 2048
  s_add_u32 s42, s31, 387072
  buffer_load_dwordx4 v26, s[4:7], s42 offen lds
  s_add_u32 m0, s30, 3072
  s_add_u32 s42, s31, 396288
  buffer_load_dwordx4 v26, s[4:7], s42 offen lds
  s_mov_b64 exec, -1
  s_waitcnt vmcnt(36)
  ds_read_b64_tr_b16 v[140:141], v27 offset:4096
  ds_read_b64_tr_b16 v[142:143], v27 offset:6144
  ds_read_b64_tr_b16 v[144:145], v28 offset:4096
  ds_read_b64_tr_b16 v[146:147], v28 offset:6144
  ds_read_b64_tr_b16 v[148:149], v29 offset:4096
  ds_read_b64_tr_b16 v[150:151], v29 offset:6144
  s_waitcnt lgkmcnt(0)
  s_mov_b64 exec, s[26:27]
  s_add_u32 m0, s30, 4096
  s_add_u32 s42, s31, 405504
  buffer_load_dwordx4 v26, s[4:7], s42 offen lds
  s_add_u32 m0, s30, 5120
  s_add_u32 s42, s31, 414720
  buffer_load_dwordx4 v26, s[4:7], s42 offen lds
  s_add_u32 m0, s30, 6144
  s_add_u32 s42, s31, 423936
  buffer_load_dwordx4 v26, s[4:7], s42 offen lds
  s_add_u32 m0, s30, 7168
  s_add_u32 s42, s31, 433152
  buffer_load_dwordx4 v26, s[4:7], s42 offen lds
  s_mov_b64 exec, -1
  s_waitcnt vmcnt(36)
  ds_read_b64_tr_b16 v[152:153], v27 offset:8192
  ds_read_b64_tr_b16 v[154:155], v27 offset:10240
  ds_read_b64_tr_b16 v[156:157], v28 offset:8192
  ds_read_b64_tr_b16 v[158:159], v28 offset:10240
  ds_read_b64_tr_b16 v[160:161], v29 offset:8192
  ds_read_b64_tr_b16 v[162:163], v29 offset:10240
  s_waitcnt lgkmcnt(0)
  s_mov_b64 exec, s[26:27]
  s_add_u32 m0, s30, 8192
  s_add_u32 s42, s31, 442368
  buffer_load_dwordx4 v26, s[4:7], s42 offen lds
  s_add_u32 m0, s30, 9216
  s_add_u32 s42, s31, 451584
  buffer_load_dwordx4 v26, s[4:7], s42 offen lds
  s_add_u32 m0, s30, 10240
  s_add_u32 s42, s31, 460800
  buffer_load_dwordx4 v26, s[4:7], s42 offen lds
  s_add_u32 m0, s30, 11264
  s_add_u32 s42, s31, 470016
  buffer_load_dwordx4 v26, s[4:7], s42 offen lds
  s_mov_b64 exec, -1
  s_waitcnt vmcnt(36)
  ds_read_b64_tr_b16 v[164:165], v27 offset:12288
  ds_read_b64_tr_b16 v[166:167], v27 offset:14336
  ds_read_b64_tr_b16 v[168:169], v28 offset:12288
  ds_read_b64_tr_b16 v[170:171], v28 offset:14336
  ds_read_b64_tr_b16 v[172:173], v29 offset:12288
  ds_read_b64_tr_b16 v[174:175], v29 offset:14336
  s_waitcnt lgkmcnt(0)
  s_mov_b64 exec, s[26:27]
  s_add_u32 m0, s30, 12288
  s_add_u32 s42, s31, 479232
  buffer_load_dwordx4 v26, s[4:7], s42 offen lds
  s_add_u32 m0, s30, 13312
  s_add_u32 s42, s31, 488448
  buffer_load_dwordx4 v26, s[4:7], s42 offen lds
  s_add_u32 m0, s30, 14336
  s_add_u32 s42, s31, 497664
  buffer_load_dwordx4 v26, s[4:7], s42 offen lds
  s_add_u32 m0, s30, 15360
  s_add_u32 s42, s31, 506880
  buffer_load_dwordx4 v26, s[4:7], s42 offen lds
  s_mov_b64 exec, -1
  s_waitcnt vmcnt(36)
  ds_read_b64_tr_b16 v[176:177], v27 offset:16384
  ds_read_b64_tr_b16 v[178:179], v27 offset:18432
  ds_read_b64_tr_b16 v[180:181], v28 offset:16384
  ds_read_b64_tr_b16 v[182:183], v28 offset:18432
  ds_read_b64_tr_b16 v[184:185], v29 offset:16384
  ds_read_b64_tr_b16 v[186:187], v29 offset:18432
  s_waitcnt lgkmcnt(0)
  s_mov_b64 exec, s[26:27]
  s_add_u32 m0, s30, 16384
  s_add_u32 s42, s31, 516096
  buffer_load_dwordx4 v26, s[4:7], s42 offen lds
  s_add_u32 m0, s30, 17408
  s_add_u32 s42, s31, 525312
  buffer_load_dwordx4 v26, s[4:7], s42 offen lds
  s_add_u32 m0, s30, 18432
  s_add_u32 s42, s31, 534528
  buffer_load_dwordx4 v26, s[4:7], s42 offen lds
  s_add_u32 m0, s30, 19456
  s_add_u32 s42, s31, 543744
  buffer_load_dwordx4 v26, s[4:7], s42 offen lds
  s_mov_b64 exec, -1
  s_waitcnt vmcnt(36)
  ds_read_b64_tr_b16 v[188:189], v27 offset:20480
  ds_read_b64_tr_b16 v[190:191], v27 offset:22528
  ds_read_b64_tr_b16 v[192:193], v28 offset:20480
  ds_read_b64_tr_b16 v[194:195], v28 offset:22528
  ds_read_b64_tr_b16 v[196:197], v29 offset:20480
  ds_read_b64_tr_b16 v[198:199], v29 offset:22528
  s_waitcnt lgkmcnt(0)
  s_mov_b64 exec, s[26:27]
  s_add_u32 m0, s30, 20480
  s_add_u32 s42, s31, 552960
  buffer_load_dwordx4 v26, s[4:7], s42 offen lds
  s_add_u32 m0, s30, 21504
  s_add_u32 s42, s31, 562176
  buffer_load_dwordx4 v26, s[4:7], s42 offen lds
  s_add_u32 m0, s30, 22528
  s_add_u32 s42, s31, 571392
  buffer_load_dwordx4 v26, s[4:7], s42 offen lds
  s_add_u32 m0, s30, 23552
  s_add_u32 s42, s31, 580608
  buffer_load_dwordx4 v26, s[4:7], s42 offen lds
  s_mov_b64 exec, -1
  s_waitcnt vmcnt(36)
  ds_read_b64_tr_b16 v[200:201], v27 offset:24576
  ds_read_b64_tr_b16 v[202:203], v27 offset:26624
  ds_read_b64_tr_b16 v[204:205], v28 offset:24576
  ds_read_b64_tr_b16 v[206:207], v28 offset:26624
  ds_read_b64_tr_b16 v[208:209], v29 offset:24576
  ds_read_b64_tr_b16 v[210:211], v29 offset:26624
  s_waitcnt lgkmcnt(0)
  s_mov_b64 exec, s[26:27]
  s_add_u32 m0, s30, 24576
  s_add_u32 s42, s31, 589824
  buffer_load_dwordx4 v26, s[4:7], s42 offen lds
  s_add_u32 m0, s30, 25600
  s_add_u32 s42, s31, 599040
  buffer_load_dwordx4 v26, s[4:7], s42 offen lds
  s_add_u32 m0, s30, 26624
  s_add_u32 s42, s31, 608256
  buffer_load_dwordx4 v26, s[4:7], s42 offen lds
  s_add_u32 m0, s30, 27648
  s_add_u32 s42, s31, 617472
  buffer_load_dwordx4 v26, s[4:7], s42 offen lds
  s_mov_b64 exec, -1
  s_waitcnt vmcnt(36)
  ds_read_b64_tr_b16 v[212:213], v27 offset:28672
  ds_read_b64_tr_b16 v[214:215], v27 offset:30720
  ds_read_b64_tr_b16 v[216:217], v28 offset:28672
  ds_read_b64_tr_b16 v[218:219], v28 offset:30720
  ds_read_b64_tr_b16 v[220:221], v29 offset:28672
  ds_read_b64_tr_b16 v[222:223], v29 offset:30720
  s_waitcnt lgkmcnt(0)
  s_mov_b64 exec, s[26:27]
  s_add_u32 m0, s30, 28672
  s_add_u32 s42, s31, 626688
  buffer_load_dwordx4 v26, s[4:7], s42 offen lds
  s_add_u32 m0, s30, 29696
  s_add_u32 s42, s31, 635904
  buffer_load_dwordx4 v26, s[4:7], s42 offen lds
  s_add_u32 m0, s30, 30720
  s_add_u32 s42, s31, 645120
  buffer_load_dwordx4 v26, s[4:7], s42 offen lds
  s_add_u32 m0, s30, 31744
  s_add_u32 s42, s31, 654336
  buffer_load_dwordx4 v26, s[4:7], s42 offen lds
  s_mov_b64 exec, -1
  s_waitcnt vmcnt(36)
  ds_read_b64_tr_b16 v[224:225], v27 offset:32768
  ds_read_b64_tr_b16 v[226:227], v27 offset:34816
  ds_read_b64_tr_b16 v[228:229], v28 offset:32768
  ds_read_b64_tr_b16 v[230:231], v28 offset:34816
  ds_read_b64_tr_b16 v[232:233], v29 offset:32768
  ds_read_b64_tr_b16 v[234:235], v29 offset:34816
  s_waitcnt lgkmcnt(0)
  s_mov_b64 exec, s[26:27]
  s_add_u32 m0, s30, 32768
  s_add_u32 s42, s31, 663552
  buffer_load_dwordx4 v26, s[4:7], s42 offen lds
  s_add_u32 m0, s30, 33792
  s_add_u32 s42, s31, 672768
  buffer_load_dwordx4 v26, s[4:7], s42 offen lds
  s_add_u32 m0, s30, 34816
  s_add_u32 s42, s31, 681984
  buffer_load_dwordx4 v26, s[4:7], s42 offen lds
  s_add_u32 m0, s30, 35840
  s_add_u32 s42, s31, 691200
  buffer_load_dwordx4 v26, s[4:7], s42 offen lds
  s_mov_b64 exec, -1
  s_waitcnt vmcnt(36)
  ds_read_b64_tr_b16 v[236:237], v27 offset:36864
  ds_read_b64_tr_b16 v[238:239], v27 offset:38912
  ds_read_b64_tr_b16 v[240:241], v28 offset:36864
  ds_read_b64_tr_b16 v[242:243], v28 offset:38912
  ds_read_b64_tr_b16 v[244:245], v29 offset:36864
  ds_read_b64_tr_b16 v[246:247], v29 offset:38912
  s_waitcnt lgkmcnt(0)
  s_mov_b64 exec, s[26:27]
  s_add_u32 m0, s30, 36864
  s_add_u32 s42, s31, 700416
  buffer_load_dwordx4 v26, s[4:7], s42 offen lds
  s_add_u32 m0, s30, 37888
  s_add_u32 s42, s31, 709632
  buffer_load_dwordx4 v26, s[4:7], s42 offen lds
  s_add_u32 m0, s30, 38912
  s_add_u32 s42, s31, 718848
  buffer_load_dwordx4 v26, s[4:7], s42 offen lds
  s_add_u32 m0, s30, 39936
  s_add_u32 s42, s31, 728064
  buffer_load_dwordx4 v26, s[4:7], s42 offen lds
  s_mov_b64 exec, -1
  s_waitcnt vmcnt(36)
  ds_read_b64_tr_b16 v[248:249], v27 offset:0
  ds_read_b64_tr_b16 v[250:251], v27 offset:2048
  ds_read_b64_tr_b16 v[252:253], v28 offset:0
  ds_read_b64_tr_b16 v[254:255], v28 offset:2048
  ds_read_b64_tr_b16 a[0:1], v29 offset:0
  ds_read_b64_tr_b16 a[2:3], v29 offset:2048
  s_waitcnt lgkmcnt(0)
  s_mov_b64 exec, s[26:27]
  s_add_u32 m0, s30, 0
  s_add_u32 s42, s31, 737280
  buffer_load_dwordx4 v26, s[4:7], s42 offen lds
  s_add_u32 m0, s30, 1024
  s_add_u32 s42, s31, 746496
  buffer_load_dwordx4 v26, s[4:7], s42 offen lds
  s_add_u32 m0, s30, 2048
  s_add_u32 s42, s31, 755712
  buffer_load_dwordx4 v26, s[4:7], s42 offen lds
  s_add_u32 m0, s30, 3072
  s_add_u32 s42, s31, 764928
  buffer_load_dwordx4 v26, s[4:7], s42 offen lds
  s_mov_b64 exec, -1
  s_waitcnt vmcnt(36)
  ds_read_b64_tr_b16 a[4:5], v27 offset:4096
  ds_read_b64_tr_b16 a[6:7], v27 offset:6144
  ds_read_b64_tr_b16 a[8:9], v28 offset:4096
  ds_read_b64_tr_b16 a[10:11], v28 offset:6144
  ds_read_b64_tr_b16 a[12:13], v29 offset:4096
  ds_read_b64_tr_b16 a[14:15], v29 offset:6144
  s_waitcnt lgkmcnt(0)
  s_mov_b64 exec, s[26:27]
  s_add_u32 m0, s30, 4096
  s_add_u32 s42, s31, 774144
  buffer_load_dwordx4 v26, s[4:7], s42 offen lds
  s_add_u32 m0, s30, 5120
  s_add_u32 s42, s31, 783360
  buffer_load_dwordx4 v26, s[4:7], s42 offen lds
  s_add_u32 m0, s30, 6144
  s_add_u32 s42, s31, 792576
  buffer_load_dwordx4 v26, s[4:7], s42 offen lds
  s_add_u32 m0, s30, 7168
  s_add_u32 s42, s31, 801792
  buffer_load_dwordx4 v26, s[4:7], s42 offen lds
  s_mov_b64 exec, -1
  s_waitcnt vmcnt(36)
  ds_read_b64_tr_b16 a[16:17], v27 offset:8192
  ds_read_b64_tr_b16 a[18:19], v27 offset:10240
  ds_read_b64_tr_b16 a[20:21], v28 offset:8192
  ds_read_b64_tr_b16 a[22:23], v28 offset:10240
  ds_read_b64_tr_b16 a[24:25], v29 offset:8192
  ds_read_b64_tr_b16 a[26:27], v29 offset:10240
  s_waitcnt lgkmcnt(0)
  s_mov_b64 exec, s[26:27]
  s_add_u32 m0, s30, 8192
  s_add_u32 s42, s31, 811008
  buffer_load_dwordx4 v26, s[4:7], s42 offen lds
  s_add_u32 m0, s30, 9216
  s_add_u32 s42, s31, 820224
  buffer_load_dwordx4 v26, s[4:7], s42 offen lds
  s_add_u32 m0, s30, 10240
  s_add_u32 s42, s31, 829440
  buffer_load_dwordx4 v26, s[4:7], s42 offen lds
  s_add_u32 m0, s30, 11264
  s_add_u32 s42, s31, 838656
  buffer_load_dwordx4 v26, s[4:7], s42 offen lds
  s_mov_b64 exec, -1
  s_waitcnt vmcnt(36)
  ds_read_b64_tr_b16 a[28:29], v27 offset:12288
  ds_read_b64_tr_b16 a[30:31], v27 offset:14336
  ds_read_b64_tr_b16 a[32:33], v28 offset:12288
  ds_read_b64_tr_b16 a[34:35], v28 offset:14336
  ds_read_b64_tr_b16 a[36:37], v29 offset:12288
  ds_read_b64_tr_b16 a[38:39], v29 offset:14336
  s_waitcnt lgkmcnt(0)
  s_mov_b64 exec, s[26:27]
  s_add_u32 m0, s30, 12288
  s_add_u32 s42, s31, 847872
  buffer_load_dwordx4 v26, s[4:7], s42 offen lds
  s_add_u32 m0, s30, 13312
  s_add_u32 s42, s31, 857088
  buffer_load_dwordx4 v26, s[4:7], s42 offen lds
  s_add_u32 m0, s30, 14336
  s_add_u32 s42, s31, 866304
  buffer_load_dwordx4 v26, s[4:7], s42 offen lds
  s_add_u32 m0, s30, 15360
  s_add_u32 s42, s31, 875520
  buffer_load_dwordx4 v26, s[4:7], s42 offen lds
  s_mov_b64 exec, -1
  s_waitcnt vmcnt(36)
  ds_read_b64_tr_b16 a[40:41], v27 offset:16384
  ds_read_b64_tr_b16 a[42:43], v27 offset:18432
  ds_read_b64_tr_b16 a[44:45], v28 offset:16384
  ds_read_b64_tr_b16 a[46:47], v28 offset:18432
  ds_read_b64_tr_b16 a[48:49], v29 offset:16384
  ds_read_b64_tr_b16 a[50:51], v29 offset:18432
  s_waitcnt lgkmcnt(0)
  s_mov_b64 exec, s[26:27]
  s_add_u32 m0, s30, 16384
  s_add_u32 s42, s31, 884736
  buffer_load_dwordx4 v26, s[4:7], s42 offen lds
  s_add_u32 m0, s30, 17408
  s_add_u32 s42, s31, 893952
  buffer_load_dwordx4 v26, s[4:7], s42 offen lds
  s_add_u32 m0, s30, 18432
  s_add_u32 s42, s31, 903168
  buffer_load_dwordx4 v26, s[4:7], s42 offen lds
  s_add_u32 m0, s30, 19456
  s_add_u32 s42, s31, 912384
  buffer_load_dwordx4 v26, s[4:7], s42 offen lds
  s_mov_b64 exec, -1
  s_waitcnt vmcnt(36)
  ds_read_b64_tr_b16 a[52:53], v27 offset:20480
  ds_read_b64_tr_b16 a[54:55], v27 offset:22528
  ds_read_b64_tr_b16 a[56:57], v28 offset:20480
  ds_read_b64_tr_b16 a[58:59], v28 offset:22528
  ds_read_b64_tr_b16 a[60:61], v29 offset:20480
  ds_read_b64_tr_b16 a[62:63], v29 offset:22528
  s_waitcnt lgkmcnt(0)
  s_mov_b64 exec, s[26:27]
  s_add_u32 m0, s30, 20480
  s_add_u32 s42, s31, 921600
  buffer_load_dwordx4 v26, s[4:7], s42 offen lds
  s_add_u32 m0, s30, 21504
  s_add_u32 s42, s31, 930816
  buffer_load_dwordx4 v26, s[4:7], s42 offen lds
  s_add_u32 m0, s30, 22528
  s_add_u32 s42, s31, 940032
  buffer_load_dwordx4 v26, s[4:7], s42 offen lds
  s_add_u32 m0, s30, 23552
  s_add_u32 s42, s31, 949248
  buffer_load_dwordx4 v26, s[4:7], s42 offen lds
  s_mov_b64 exec, -1
  s_waitcnt vmcnt(36)
  ds_read_b64_tr_b16 a[64:65], v27 offset:24576
  ds_read_b64_tr_b16 a[66:67], v27 offset:26624
  ds_read_b64_tr_b16 a[68:69], v28 offset:24576
  ds_read_b64_tr_b16 a[70:71], v28 offset:26624
  ds_read_b64_tr_b16 a[72:73], v29 offset:24576
  ds_read_b64_tr_b16 a[74:75], v29 offset:26624
  s_waitcnt lgkmcnt(0)
  s_mov_b64 exec, s[26:27]
  s_add_u32 m0, s30, 24576
  s_add_u32 s42, s31, 958464
  buffer_load_dwordx4 v26, s[4:7], s42 offen lds
  s_add_u32 m0, s30, 25600
  s_add_u32 s42, s31, 967680
  buffer_load_dwordx4 v26, s[4:7], s42 offen lds
  s_add_u32 m0, s30, 26624
  s_add_u32 s42, s31, 976896
  buffer_load_dwordx4 v26, s[4:7], s42 offen lds
  s_add_u32 m0, s30, 27648
  s_add_u32 s42, s31, 986112
  buffer_load_dwordx4 v26, s[4:7], s42 offen lds
  s_mov_b64 exec, -1
  s_waitcnt vmcnt(36)
  ds_read_b64_tr_b16 a[76:77], v27 offset:28672
  ds_read_b64_tr_b16 a[78:79], v27 offset:30720
  ds_read_b64_tr_b16 a[80:81], v28 offset:28672
  ds_read_b64_tr_b16 a[82:83], v28 offset:30720
  ds_read_b64_tr_b16 a[84:85], v29 offset:28672
  ds_read_b64_tr_b16 a[86:87], v29 offset:30720
  s_waitcnt lgkmcnt(0)
  s_mov_b64 exec, s[26:27]
  s_add_u32 m0, s30, 28672
  s_add_u32 s42, s31, 995328
  buffer_load_dwordx4 v26, s[4:7], s42 offen lds
  s_add_u32 m0, s30, 29696
  s_add_u32 s42, s31, 1004544
  buffer_load_dwordx4 v26, s[4:7], s42 offen lds
  s_add_u32 m0, s30, 30720
  s_add_u32 s42, s31, 1013760
  buffer_load_dwordx4 v26, s[4:7], s42 offen lds
  s_add_u32 m0, s30, 31744
  s_add_u32 s42, s31, 1022976
  buffer_load_dwordx4 v26, s[4:7], s42 offen lds
  s_mov_b64 exec, -1
  s_waitcnt vmcnt(36)
  ds_read_b64_tr_b16 a[88:89], v27 offset:32768
  ds_read_b64_tr_b16 a[90:91], v27 offset:34816
  ds_read_b64_tr_b16 a[92:93], v28 offset:32768
  ds_read_b64_tr_b16 a[94:95], v28 offset:34816
  ds_read_b64_tr_b16 a[96:97], v29 offset:32768
  ds_read_b64_tr_b16 a[98:99], v29 offset:34816
  s_waitcnt lgkmcnt(0)
  s_mov_b64 exec, s[26:27]
  s_add_u32 m0, s30, 32768
  s_add_u32 s42, s31, 1032192
  buffer_load_dwordx4 v26, s[4:7], s42 offen lds
  s_add_u32 m0, s30, 33792
  s_add_u32 s42, s31, 1041408
  buffer_load_dwordx4 v26, s[4:7], s42 offen lds
  s_add_u32 m0, s30, 34816
  s_add_u32 s42, s31, 1050624
  buffer_load_dwordx4 v26, s[4:7], s42 offen lds
  s_add_u32 m0, s30, 35840
  s_add_u32 s42, s31, 1059840
  buffer_load_dwordx4 v26, s[4:7], s42 offen lds
  s_mov_b64 exec, -1
  s_waitcnt vmcnt(36)
  ds_read_b64_tr_b16 a[100:101], v27 offset:36864
  ds_read_b64_tr_b16 a[102:103], v27 offset:38912
  ds_read_b64_tr_b16 a[104:105], v28 offset:36864
  ds_read_b64_tr_b16 a[106:107], v28 offset:38912
  ds_read_b64_tr_b16 a[108:109], v29 offset:36864
  ds_read_b64_tr_b16 a[110:111], v29 offset:38912
  s_waitcnt lgkmcnt(0)
  s_mov_b64 exec, s[26:27]
  s_add_u32 m0, s30, 36864
  s_add_u32 s42, s31, 1069056
  buffer_load_dwordx4 v26, s[4:7], s42 offen lds
  s_add_u32 m0, s30, 37888
  s_add_u32 s42, s31, 1078272
  buffer_load_dwordx4 v26, s[4:7], s42 offen lds
  s_add_u32 m0, s30, 38912
  s_add_u32 s42, s31, 1087488
  buffer_load_dwordx4 v26, s[4:7], s42 offen lds
  s_add_u32 m0, s30, 39936
  s_add_u32 s42, s31, 1096704
  buffer_load_dwordx4 v26, s[4:7], s42 offen lds
  s_mov_b64 exec, -1
  s_waitcnt vmcnt(36)
  ds_read_b64_tr_b16 a[112:113], v27 offset:0
  ds_read_b64_tr_b16 a[114:115], v27 offset:2048
  ds_read_b64_tr_b16 a[116:117], v28 offset:0
  ds_read_b64_tr_b16 a[118:119], v28 offset:2048
  ds_read_b64_tr_b16 a[120:121], v29 offset:0
  ds_read_b64_tr_b16 a[122:123], v29 offset:2048
  s_waitcnt lgkmcnt(0)
  s_mov_b64 exec, s[26:27]
  s_add_u32 m0, s30, 0
  s_add_u32 s42, s31, 1105920
  buffer_load_dwordx4 v26, s[4:7], s42 offen lds
  s_add_u32 m0, s30, 1024
  s_add_u32 s42, s31, 1115136
  buffer_load_dwordx4 v26, s[4:7], s42 offen lds
  s_add_u32 m0, s30, 2048
  s_add_u32 s42, s31, 1124352
  buffer_load_dwordx4 v26, s[4:7], s42 offen lds
  s_add_u32 m0, s30, 3072
  s_add_u32 s42, s31, 1133568
  buffer_load_dwordx4 v26, s[4:7], s42 offen lds
  s_mov_b64 exec, -1
  s_waitcnt vmcnt(36)
  ds_read_b64_tr_b16 a[124:125], v27 offset:4096
  ds_read_b64_tr_b16 a[126:127], v27 offset:6144
  ds_read_b64_tr_b16 a[128:129], v28 offset:4096
  ds_read_b64_tr_b16 a[130:131], v28 offset:6144
  ds_read_b64_tr_b16 a[132:133], v29 offset:4096
  ds_read_b64_tr_b16 a[134:135], v29 offset:6144
  s_waitcnt lgkmcnt(0)
  s_mov_b64 exec, s[26:27]
  s_add_u32 m0, s30, 4096
  s_add_u32 s42, s31, 1142784
  buffer_load_dwordx4 v26, s[4:7], s42 offen lds
  s_add_u32 m0, s30, 5120
  s_add_u32 s42, s31, 1152000
  buffer_load_dwordx4 v26, s[4:7], s42 offen lds
  s_add_u32 m0, s30, 6144
  s_add_u32 s42, s31, 1161216
  buffer_load_dwordx4 v26, s[4:7], s42 offen lds
  s_add_u32 m0, s30, 7168
  s_add_u32 s42, s31, 1170432
  buffer_load_dwordx4 v26, s[4:7], s42 offen lds
  s_mov_b64 exec, -1
  s_waitcnt vmcnt(36)
  ds_read_b64_tr_b16 a[136:137], v27 offset:8192
  ds_read_b64_tr_b16 a[138:139], v27 offset:10240
  ds_read_b64_tr_b16 a[140:141], v28 offset:8192
  ds_read_b64_tr_b16 a[142:143], v28 offset:10240
  ds_read_b64_tr_b16 a[144:145], v29 offset:8192
  ds_read_b64_tr_b16 a[146:147], v29 offset:10240
  s_waitcnt vmcnt(32)
  ds_read_b64_tr_b16 a[148:149], v27 offset:12288
  ds_read_b64_tr_b16 a[150:151], v27 offset:14336
  ds_read_b64_tr_b16 a[152:153], v28 offset:12288
  ds_read_b64_tr_b16 a[154:155], v28 offset:14336
  ds_read_b64_tr_b16 a[156:157], v29 offset:12288
  ds_read_b64_tr_b16 a[158:159], v29 offset:14336
  s_waitcnt vmcnt(28)
  ds_read_b64_tr_b16 a[160:161], v27 offset:16384
  ds_read_b64_tr_b16 a[162:163], v27 offset:18432
  ds_read_b64_tr_b16 a[164:165], v28 offset:16384
  ds_read_b64_tr_b16 a[166:167], v28 offset:18432
  ds_read_b64_tr_b16 a[168:169], v29 offset:16384
  ds_read_b64_tr_b16 a[170:171], v29 offset:18432
  s_waitcnt vmcnt(24)
  ds_read_b64_tr_b16 a[172:173], v27 offset:20480
  ds_read_b64_tr_b16 a[174:175], v27 offset:22528
  ds_read_b64_tr_b16 a[176:177], v28 offset:20480
  ds_read_b64_tr_b16 a[178:179], v28 offset:22528
  ds_read_b64_tr_b16 a[180:181], v29 offset:20480
  ds_read_b64_tr_b16 a[182:183], v29 offset:22528
  s_waitcnt vmcnt(20)
  ds_read_b64_tr_b16 a[184:185], v27 offset:24576
  ds_read_b64_tr_b16 a[186:187], v27 offset:26624
  ds_read_b64_tr_b16 a[188:189], v28 offset:24576
  ds_read_b64_tr_b16 a[190:191], v28 offset:26624
  ds_read_b64_tr_b16 a[192:193], v29 offset:24576
  ds_read_b64_tr_b16 a[194:195], v29 offset:26624
  s_waitcnt vmcnt(16)
  ds_read_b64_tr_b16 a[196:197], v27 offset:28672
  ds_read_b64_tr_b16 a[198:199], v27 offset:30720
  ds_read_b64_tr_b16 a[200:201], v28 offset:28672
  ds_read_b64_tr_b16 a[202:203], v28 offset:30720
  ds_read_b64_tr_b16 a[204:205], v29 offset:28672
  ds_read_b64_tr_b16 a[206:207], v29 offset:30720
  s_waitcnt vmcnt(12)
  ds_read_b64_tr_b16 a[208:209], v27 offset:32768
  ds_read_b64_tr_b16 a[210:211], v27 offset:34816
  ds_read_b64_tr_b16 a[212:213], v28 offset:32768
  ds_read_b64_tr_b16 a[214:215], v28 offset:34816
  ds_read_b64_tr_b16 a[216:217], v29 offset:32768
  ds_read_b64_tr_b16 a[218:219], v29 offset:34816
  s_waitcnt vmcnt(8)
  ds_read_b64_tr_b16 a[220:221], v27 offset:36864
  ds_read_b64_tr_b16 a[222:223], v27 offset:38912
  ds_read_b64_tr_b16 a[224:225], v28 offset:36864
  ds_read_b64_tr_b16 a[226:227], v28 offset:38912
  ds_read_b64_tr_b16 a[228:229], v29 offset:36864
  ds_read_b64_tr_b16 a[230:231], v29 offset:38912
  s_waitcnt vmcnt(4)
  ds_read_b64_tr_b16 a[232:233], v27 offset:0
  ds_read_b64_tr_b16 a[234:235], v27 offset:2048
  ds_read_b64_tr_b16 a[236:237], v28 offset:0
  ds_read_b64_tr_b16 a[238:239], v28 offset:2048
  ds_read_b64_tr_b16 a[240:241], v29 offset:0
  ds_read_b64_tr_b16 a[242:243], v29 offset:2048
  s_waitcnt vmcnt(0)
  ds_read_b64_tr_b16 a[244:245], v27 offset:4096
  ds_read_b64_tr_b16 a[246:247], v27 offset:6144
  ds_read_b64_tr_b16 a[248:249], v28 offset:4096
  ds_read_b64_tr_b16 a[250:251], v28 offset:6144
  ds_read_b64_tr_b16 a[252:253], v29 offset:4096
  ds_read_b64_tr_b16 a[254:255], v29 offset:6144
  s_waitcnt lgkmcnt(0)
  s_barrier
  s_cmp_eq_u32 s13, 3
  s_cbranch_scc0 Low_37
  v_mov_b32 v30, 0
  s_mov_b32 s42, 0x80808080
Lcw_38:
  global_load_dword v28, v30, s[16:17] sc0 sc1
  s_waitcnt vmcnt(0)
  v_and_b32 v29, s42, v28
  v_cmp_ne_u32 vcc, s42, v29
  s_cbranch_vccz Lcwo_39
  s_sleep 4
  s_sub_u32 s15, s15, 1
  s_cbranch_scc0 Lcw_38
  s_mov_b32 s15, 0
Lcwo_39:
  v_lshrrev_b32 v29, 4, v0
  v_min_u32 v29, 53, v29
  v_lshlrev_b32 v29, 7, v29
  s_mov_b32 s44, 40960
Lp_40:
  buffer_load_dword v28, v29, s[8:11], s44 offen sc1
  s_waitcnt vmcnt(0)
  v_cmp_gt_u32 vcc, 1, v28
  s_cbranch_vccz Lpo_41
  s_sleep 4
  s_sub_u32 s15, s15, 1
  s_cbranch_scc0 Lp_40
  s_mov_b32 s15, 0
Lpo_41:
Low_37:
  s_barrier
  s_mov_b32 s42, 70144
  buffer_load_dwordx4 v[8:11], v6, s[8:11], s42 offen sc1
  s_load_dwordx2 s[4:5], s[0:1], 0
  s_mov_b32 s6, 2359296
  s_mov_b32 s7, 0x20000
  s_mov_b32 s18, s14
  s_mov_b32 s19, 0
  s_mov_b32 s22, 0
  s_mul_i32 s20, s14, 131072
  s_mul_i32 s42, s13, 32768
  s_add_u32 s20, s20, s42
  s_add_u32 s20, s20, 67108864
  s_waitcnt vmcnt(0) lgkmcnt(0)
  s_mul_i32 s30, s13, 32768
  v_lshrrev_b32 v44, 0, v0
  v_add_u32 v44, s30, v44
  s_mov_b32 s33, 0
  s_cmp_eq_u32 s13, 3
  s_cbranch_scc0 Low_42
  s_lshr_b32 s45, s18, 2
  s_add_u32 s45, s45, 1
  s_bfe_u32 s44, s18, 0x10001
  s_lshl_b32 s44, s44, 12
  s_add_u32 s44, s44, 12288
Lp_43:
  buffer_load_dword v26, v4, s[8:11], s44 offen sc1
  s_waitcnt vmcnt(0)
  v_cmp_gt_u32 vcc, s45, v26
  s_cbranch_vccz Lpo_44
  s_sleep 2
  s_sub_u32 s15, s15, 1
  s_cbranch_scc0 Lp_43
  s_mov_b32 s15, 0
Lpo_44:
Low_42:
  s_barrier
  s_add_u32 s43, s20, 0
  s_add_u32 m0, s30, 0
  s_nop 0
  buffer_load_dwordx4 v0, s[8:11], s43 offen offset:0 sc1 lds
  buffer_load_dwordx4 v0, s[8:11], s43 offen offset:1024 sc1 lds
  buffer_load_dwordx4 v0, s[8:11], s43 offen offset:2048 sc1 lds
  buffer_load_dwordx4 v0, s[8:11], s43 offen offset:3072 sc1 lds
  s_add_u32 s43, s20, 4096
  s_add_u32 m0, s30, 4096
  s_nop 0
  buffer_load_dwordx4 v0, s[8:11], s43 offen offset:0 sc1 lds
  buffer_load_dwordx4 v0, s[8:11], s43 offen offset:1024 sc1 lds
  buffer_load_dwordx4 v0, s[8:11], s43 offen offset:2048 sc1 lds
  buffer_load_dwordx4 v0, s[8:11], s43 offen offset:3072 sc1 lds
  s_add_u32 s43, s20, 8192
  s_add_u32 m0, s30, 8192
  s_nop 0
  buffer_load_dwordx4 v0, s[8:11], s43 offen offset:0 sc1 lds
  buffer_load_dwordx4 v0, s[8:11], s43 offen offset:1024 sc1 lds
  buffer_load_dwordx4 v0, s[8:11], s43 offen offset:2048 sc1 lds
  buffer_load_dwordx4 v0, s[8:11], s43 offen offset:3072 sc1 lds
  s_add_u32 s43, s20, 12288
  s_add_u32 m0, s30, 12288
  s_nop 0
  buffer_load_dwordx4 v0, s[8:11], s43 offen offset:0 sc1 lds
  buffer_load_dwordx4 v0, s[8:11], s43 offen offset:1024 sc1 lds
  buffer_load_dwordx4 v0, s[8:11], s43 offen offset:2048 sc1 lds
  buffer_load_dwordx4 v0, s[8:11], s43 offen offset:3072 sc1 lds
Lwo_loop:
  s_mul_i32 s23, s18, 18432
  s_mov_b32 s34, s18
  s_mov_b32 s37, s20
  s_add_u32 s18, s18, 3
  s_add_u32 s20, s20, 393216
  buffer_load_dwordx2 v[24:25], v3, s[4:7], s23 offen
  s_lshr_b32 s45, s18, 2
  s_add_u32 s45, s45, 1
  s_bfe_u32 s44, s18, 0x10001
  s_lshl_b32 s44, s44, 12
  s_add_u32 s44, s44, 12288
  buffer_load_dword v26, v4, s[8:11], s44 offen sc1
  s_mov_b32 s35, s45
  s_waitcnt vmcnt(17)
  ds_read_b128 v[28:31], v44 offset:0
  s_waitcnt vmcnt(16)
  ds_read_b128 v[32:35], v44 offset:1024
  s_waitcnt vmcnt(15)
  ds_read_b128 v[36:39], v44 offset:2048
  s_cmp_eq_u32 s33, 2
  s_cbranch_scc0 Lnp_45
  s_barrier
  s_cmp_eq_u32 s13, 0
  s_cbranch_scc0 Lfs_46
  v_mov_b32 v5, s19
  s_mov_b64 exec, 1
  buffer_store_dword v5, off, s[8:11], s21 sc1
  s_mov_b64 exec, -1
Lfs_46:
Lnp_45:
  s_waitcnt lgkmcnt(2)
  v_mfma_f32_16x16x32_bf16 v[12:15], v[128:131], v[28:31], 0
  s_add_u32 s43, s37, 16384
  s_add_u32 m0, s30, 16384
  s_nop 0
  buffer_load_dwordx4 v0, s[8:11], s43 offen offset:0 sc1 lds
  v_mfma_f32_16x16x32_bf16 v[16:19], v[132:135], v[28:31], 0
  s_waitcnt vmcnt(15)
  ds_read_b128 v[40:43], v44 offset:3072
  v_mfma_f32_16x16x32_bf16 v[20:23], v[136:139], v[28:31], 0
  s_waitcnt lgkmcnt(2)
  v_mfma_f32_16x16x32_bf16 v[12:15], v[140:143], v[32:35], v[12:15]
  buffer_load_dwordx4 v0, s[8:11], s43 offen offset:1024 sc1 lds
  v_mfma_f32_16x16x32_bf16 v[16:19], v[144:147], v[32:35], v[16:19]
  s_waitcnt vmcnt(15)
  ds_read_b128 v[28:31], v44 offset:4096
  v_mfma_f32_16x16x32_bf16 v[20:23], v[148:151], v[32:35], v[20:23]
  s_waitcnt lgkmcnt(2)
  v_mfma_f32_16x16x32_bf16 v[12:15], v[152:155], v[36:39], v[12:15]
  buffer_load_dwordx4 v0, s[8:11], s43 offen offset:2048 sc1 lds
  v_mfma_f32_16x16x32_bf16 v[16:19], v[156:159], v[36:39], v[16:19]
  s_waitcnt vmcnt(15)
  ds_read_b128 v[32:35], v44 offset:5120
  v_mfma_f32_16x16x32_bf16 v[20:23], v[160:163], v[36:39], v[20:23]
  s_waitcnt lgkmcnt(2)
  v_mfma_f32_16x16x32_bf16 v[12:15], v[164:167], v[40:43], v[12:15]
  buffer_load_dwordx4 v0, s[8:11], s43 offen offset:3072 sc1 lds
  v_mfma_f32_16x16x32_bf16 v[16:19], v[168:171], v[40:43], v[16:19]
  s_waitcnt vmcnt(15)
  ds_read_b128 v[36:39], v44 offset:6144
  v_mfma_f32_16x16x32_bf16 v[20:23], v[172:175], v[40:43], v[20:23]
  s_waitcnt lgkmcnt(2)
  v_mfma_f32_16x16x32_bf16 v[12:15], v[176:179], v[28:31], v[12:15]
  s_add_u32 s43, s37, 20480
  s_add_u32 m0, s30, 20480
  s_nop 0
  buffer_load_dwordx4 v0, s[8:11], s43 offen offset:0 sc1 lds
  v_mfma_f32_16x16x32_bf16 v[16:19], v[180:183], v[28:31], v[16:19]
  s_waitcnt vmcnt(15)
  ds_read_b128 v[40:43], v44 offset:7168
  v_mfma_f32_16x16x32_bf16 v[20:23], v[184:187], v[28:31], v[20:23]
  s_waitcnt lgkmcnt(2)
  v_mfma_f32_16x16x32_bf16 v[12:15], v[188:191], v[32:35], v[12:15]
  buffer_load_dwordx4 v0, s[8:11], s43 offen offset:1024 sc1 lds
  v_mfma_f32_16x16x32_bf16 v[16:19], v[192:195], v[32:35], v[16:19]
  s_waitcnt vmcnt(15)
  ds_read_b128 v[28:31], v44 offset:8192
  v_mfma_f32_16x16x32_bf16 v[20:23], v[196:199], v[32:35], v[20:23]
  s_waitcnt lgkmcnt(2)
  v_mfma_f32_16x16x32_bf16 v[12:15], v[200:203], v[36:39], v[12:15]
  buffer_load_dwordx4 v0, s[8:11], s43 offen offset:2048 sc1 lds
  v_mfma_f32_16x16x32_bf16 v[16:19], v[204:207], v[36:39], v[16:19]
  s_waitcnt vmcnt(15)
  ds_read_b128 v[32:35], v44 offset:9216
  v_mfma_f32_16x16x32_bf16 v[20:23], v[208:211], v[36:39], v[20:23]
  s_waitcnt lgkmcnt(2)
  v_mfma_f32_16x16x32_bf16 v[12:15], v[212:215], v[40:43], v[12:15]
  buffer_load_dwordx4 v0, s[8:11], s43 offen offset:3072 sc1 lds
  v_mfma_f32_16x16x32_bf16 v[16:19], v[216:219], v[40:43], v[16:19]
  s_waitcnt vmcnt(15)
  ds_read_b128 v[36:39], v44 offset:10240
  v_mfma_f32_16x16x32_bf16 v[20:23], v[220:223], v[40:43], v[20:23]
  s_waitcnt lgkmcnt(2)
  v_mfma_f32_16x16x32_bf16 v[12:15], v[224:227], v[28:31], v[12:15]
  s_add_u32 s43, s37, 24576
  s_add_u32 m0, s30, 24576
  s_nop 0
  buffer_load_dwordx4 v0, s[8:11], s43 offen offset:0 sc1 lds
  v_mfma_f32_16x16x32_bf16 v[16:19], v[228:231], v[28:31], v[16:19]
  s_waitcnt vmcnt(15)
  ds_read_b128 v[40:43], v44 offset:11264
  v_mfma_f32_16x16x32_bf16 v[20:23], v[232:235], v[28:31], v[20:23]
  s_waitcnt lgkmcnt(2)
  v_mfma_f32_16x16x32_bf16 v[12:15], v[236:239], v[32:35], v[12:15]
  buffer_load_dwordx4 v0, s[8:11], s43 offen offset:1024 sc1 lds
  v_mfma_f32_16x16x32_bf16 v[16:19], v[240:243], v[32:35], v[16:19]
  s_waitcnt vmcnt(15)
  ds_read_b128 v[28:31], v44 offset:12288
  v_mfma_f32_16x16x32_bf16 v[20:23], v[244:247], v[32:35], v[20:23]
  s_waitcnt lgkmcnt(2)
  v_mfma_f32_16x16x32_bf16 v[12:15], v[248:251], v[36:39], v[12:15]
  buffer_load_dwordx4 v0, s[8:11], s43 offen offset:2048 sc1 lds
  v_mfma_f32_16x16x32_bf16 v[16:19], v[252:255], v[36:39], v[16:19]
  s_waitcnt vmcnt(15)
  ds_read_b128 v[32:35], v44 offset:13312
  v_mfma_f32_16x16x32_bf16 v[20:23], a[0:3], v[36:39], v[20:23]
  s_waitcnt lgkmcnt(2)
  v_mfma_f32_16x16x32_bf16 v[12:15], a[4:7], v[40:43], v[12:15]
  buffer_load_dwordx4 v0, s[8:11], s43 offen offset:3072 sc1 lds
  v_mfma_f32_16x16x32_bf16 v[16:19], a[8:11], v[40:43], v[16:19]
  s_waitcnt vmcnt(15)
  ds_read_b128 v[36:39], v44 offset:14336
  v_mfma_f32_16x16x32_bf16 v[20:23], a[12:15], v[40:43], v[20:23]
  s_waitcnt lgkmcnt(2)
  v_mfma_f32_16x16x32_bf16 v[12:15], a[16:19], v[28:31], v[12:15]
  s_add_u32 s43, s37, 28672
  s_add_u32 m0, s30, 28672
  s_nop 0
  buffer_load_dwordx4 v0, s[8:11], s43 offen offset:0 sc1 lds
  v_mfma_f32_16x16x32_bf16 v[16:19], a[20:23], v[28:31], v[16:19]
  s_waitcnt vmcnt(15)
  ds_read_b128 v[40:43], v44 offset:15360
  v_mfma_f32_16x16x32_bf16 v[20:23], a[24:27], v[28:31], v[20:23]
  s_waitcnt lgkmcnt(2)
  v_mfma_f32_16x16x32_bf16 v[12:15], a[28:31], v[32:35], v[12:15]
  buffer_load_dwordx4 v0, s[8:11], s43 offen offset:1024 sc1 lds
  v_mfma_f32_16x16x32_bf16 v[16:19], a[32:35], v[32:35], v[16:19]
  s_waitcnt vmcnt(13)
  ds_read_b128 v[28:31], v44 offset:16384
  v_mfma_f32_16x16x32_bf16 v[20:23], a[36:39], v[32:35], v[20:23]
  s_waitcnt lgkmcnt(2)
  v_mfma_f32_16x16x32_bf16 v[12:15], a[40:43], v[36:39], v[12:15]
  buffer_load_dwordx4 v0, s[8:11], s43 offen offset:2048 sc1 lds
  v_mfma_f32_16x16x32_bf16 v[16:19], a[44:47], v[36:39], v[16:19]
  s_waitcnt vmcnt(13)
  ds_read_b128 v[32:35], v44 offset:17408
  v_mfma_f32_16x16x32_bf16 v[20:23], a[48:51], v[36:39], v[20:23]
  s_cmp_eq_u32 s13, 3
  s_cbranch_scc0 Lw3_47
  v_cmp_gt_u32 vcc, s35, v26
  s_cmp_eq_u64 vcc, 0
  s_cselect_b32 s42, 1, 0
  s_cmp_ge_u32 s18, 128
  s_cselect_b32 s42, 0, s42
  v_mov_b32 v26, 160000
  v_mov_b32 v27, s42
  ds_write_b32 v26, v27
  s_waitcnt lgkmcnt(0)
Lw3_47:
  s_barrier
  v_mov_b32 v26, 160000
  ds_read_b32 v27, v26
  s_cmp_eq_u32 s33, 1
  s_cbranch_scc0 Lnp_48
  s_cmp_eq_u32 s13, 0
  s_cbranch_scc0 Lfs_49
  v_mov_b32 v5, s19
  s_mov_b64 exec, 1
  buffer_store_dword v5, off, s[8:11], s21 sc1
  s_mov_b64 exec, -1
Lfs_49:
Lnp_48:
  v_mfma_f32_16x16x32_bf16 v[12:15], a[52:55], v[40:43], v[12:15]
  buffer_load_dwordx4 v0, s[8:11], s43 offen offset:3072 sc1 lds
  v_mfma_f32_16x16x32_bf16 v[16:19], a[56:59], v[40:43], v[16:19]
  s_waitcnt vmcnt(13)
  ds_read_b128 v[36:39], v44 offset:18432
  v_mfma_f32_16x16x32_bf16 v[20:23], a[60:63], v[40:43], v[20:23]
  s_waitcnt lgkmcnt(0)
  v_readfirstlane_b32 s33, v27
  s_cmp_eq_u32 s33, 0
  s_cbranch_scc1 Lwo_tn
  v_mfma_f32_16x16x32_bf16 v[12:15], a[64:67], v[28:31], v[12:15]
  s_add_u32 s43, s20, 0
  s_add_u32 m0, s30, 0
  s_nop 0
  buffer_load_dwordx4 v0, s[8:11], s43 offen offset:0 sc1 lds
  v_mfma_f32_16x16x32_bf16 v[16:19], a[68:71], v[28:31], v[16:19]
  s_waitcnt vmcnt(13)
  ds_read_b128 v[40:43], v44 offset:19456
  v_mfma_f32_16x16x32_bf16 v[20:23], a[72:75], v[28:31], v[20:23]
  v_mfma_f32_16x16x32_bf16 v[12:15], a[76:79], v[32:35], v[12:15]
  buffer_load_dwordx4 v0, s[8:11], s43 offen offset:1024 sc1 lds
  v_mfma_f32_16x16x32_bf16 v[16:19], a[80:83], v[32:35], v[16:19]
  s_waitcnt vmcnt(13)
  ds_read_b128 v[28:31], v44 offset:20480
  v_mfma_f32_16x16x32_bf16 v[20:23], a[84:87], v[32:35], v[20:23]
  v_mfma_f32_16x16x32_bf16 v[12:15], a[88:91], v[36:39], v[12:15]
  buffer_load_dwordx4 v0, s[8:11], s43 offen offset:2048 sc1 lds
  v_mfma_f32_16x16x32_bf16 v[16:19], a[92:95], v[36:39], v[16:19]
  s_waitcnt vmcnt(13)
  ds_read_b128 v[32:35], v44 offset:21504
  v_mfma_f32_16x16x32_bf16 v[20:23], a[96:99], v[36:39], v[20:23]
  s_waitcnt lgkmcnt(2)
  v_mfma_f32_16x16x32_bf16 v[12:15], a[100:103], v[40:43], v[12:15]
  buffer_load_dwordx4 v0, s[8:11], s43 offen offset:3072 sc1 lds
  v_mfma_f32_16x16x32_bf16 v[16:19], a[104:107], v[40:43], v[16:19]
  s_waitcnt vmcnt(13)
  ds_read_b128 v[36:39], v44 offset:22528
  v_mfma_f32_16x16x32_bf16 v[20:23], a[108:111], v[40:43], v[20:23]
  s_waitcnt lgkmcnt(2)
  v_mfma_f32_16x16x32_bf16 v[12:15], a[112:115], v[28:31], v[12:15]
  s_add_u32 s43, s20, 4096
  s_add_u32 m0, s30, 4096
  s_nop 0
  buffer_load_dwordx4 v0, s[8:11], s43 offen offset:0 sc1 lds
  v_mfma_f32_16x16x32_bf16 v[16:19], a[116:119], v[28:31], v[16:19]
  s_waitcnt vmcnt(13)
  ds_read_b128 v[40:43], v44 offset:23552
  v_mfma_f32_16x16x32_bf16 v[20:23], a[120:123], v[28:31], v[20:23]
  s_waitcnt lgkmcnt(2)
  v_mfma_f32_16x16x32_bf16 v[12:15], a[124:127], v[32:35], v[12:15]
  buffer_load_dwordx4 v0, s[8:11], s43 offen offset:1024 sc1 lds
  v_mfma_f32_16x16x32_bf16 v[16:19], a[128:131], v[32:35], v[16:19]
  s_waitcnt vmcnt(13)
  ds_read_b128 v[28:31], v44 offset:24576
  v_mfma_f32_16x16x32_bf16 v[20:23], a[132:135], v[32:35], v[20:23]
  s_waitcnt lgkmcnt(2)
  v_mfma_f32_16x16x32_bf16 v[12:15], a[136:139], v[36:39], v[12:15]
  buffer_load_dwordx4 v0, s[8:11], s43 offen offset:2048 sc1 lds
  v_mfma_f32_16x16x32_bf16 v[16:19], a[140:143], v[36:39], v[16:19]
  s_waitcnt vmcnt(13)
  ds_read_b128 v[32:35], v44 offset:25600
  v_mfma_f32_16x16x32_bf16 v[20:23], a[144:147], v[36:39], v[20:23]
  s_waitcnt lgkmcnt(2)
  v_mfma_f32_16x16x32_bf16 v[12:15], a[148:151], v[40:43], v[12:15]
  buffer_load_dwordx4 v0, s[8:11], s43 offen offset:3072 sc1 lds
  v_mfma_f32_16x16x32_bf16 v[16:19], a[152:155], v[40:43], v[16:19]
  s_waitcnt vmcnt(13)
  ds_read_b128 v[36:39], v44 offset:26624
  v_mfma_f32_16x16x32_bf16 v[20:23], a[156:159], v[40:43], v[20:23]
  s_waitcnt lgkmcnt(2)
  v_mfma_f32_16x16x32_bf16 v[12:15], a[160:163], v[28:31], v[12:15]
  s_add_u32 s43, s20, 8192
  s_add_u32 m0, s30, 8192
  s_nop 0
  buffer_load_dwordx4 v0, s[8:11], s43 offen offset:0 sc1 lds
  v_mfma_f32_16x16x32_bf16 v[16:19], a[164:167], v[28:31], v[16:19]
  s_waitcnt vmcnt(13)
  ds_read_b128 v[40:43], v44 offset:27648
  v_mfma_f32_16x16x32_bf16 v[20:23], a[168:171], v[28:31], v[20:23]
  s_waitcnt lgkmcnt(2)
  v_mfma_f32_16x16x32_bf16 v[12:15], a[172:175], v[32:35], v[12:15]
  buffer_load_dwordx4 v0, s[8:11], s43 offen offset:1024 sc1 lds
  v_mfma_f32_16x16x32_bf16 v[16:19], a[176:179], v[32:35], v[16:19]
  s_waitcnt vmcnt(13)
  ds_read_b128 v[28:31], v44 offset:28672
  v_mfma_f32_16x16x32_bf16 v[20:23], a[180:183], v[32:35], v[20:23]
  s_waitcnt lgkmcnt(2)
  v_mfma_f32_16x16x32_bf16 v[12:15], a[184:187], v[36:39], v[12:15]
  buffer_load_dwordx4 v0, s[8:11], s43 offen offset:2048 sc1 lds
  v_mfma_f32_16x16x32_bf16 v[16:19], a[188:191], v[36:39], v[16:19]
  s_waitcnt vmcnt(13)
  ds_read_b128 v[32:35], v44 offset:29696
  v_mfma_f32_16x16x32_bf16 v[20:23], a[192:195], v[36:39], v[20:23]
  s_waitcnt lgkmcnt(2)
  v_mfma_f32_16x16x32_bf16 v[12:15], a[196:199], v[40:43], v[12:15]
  buffer_load_dwordx4 v0, s[8:11], s43 offen offset:3072 sc1 lds
  v_mfma_f32_16x16x32_bf16 v[16:19], a[200:203], v[40:43], v[16:19]
  s_waitcnt vmcnt(13)
  ds_read_b128 v[36:39], v44 offset:30720
  v_mfma_f32_16x16x32_bf16 v[20:23], a[204:207], v[40:43], v[20:23]
  s_waitcnt lgkmcnt(2)
  v_mfma_f32_16x16x32_bf16 v[12:15], a[208:211], v[28:31], v[12:15]
  s_add_u32 s43, s20, 12288
  s_add_u32 m0, s30, 12288
  s_nop 0
  buffer_load_dwordx4 v0, s[8:11], s43 offen offset:0 sc1 lds
  v_mfma_f32_16x16x32_bf16 v[16:19], a[212:215], v[28:31], v[16:19]
  s_waitcnt vmcnt(13)
  ds_read_b128 v[40:43], v44 offset:31744
  v_mfma_f32_16x16x32_bf16 v[20:23], a[216:219], v[28:31], v[20:23]
  s_waitcnt lgkmcnt(2)
  v_mfma_f32_16x16x32_bf16 v[12:15], a[220:223], v[32:35], v[12:15]
  buffer_load_dwordx4 v0, s[8:11], s43 offen offset:1024 sc1 lds
  v_mfma_f32_16x16x32_bf16 v[16:19], a[224:227], v[32:35], v[16:19]
  v_mfma_f32_16x16x32_bf16 v[20:23], a[228:231], v[32:35], v[20:23]
  s_waitcnt lgkmcnt(1)
  v_mfma_f32_16x16x32_bf16 v[12:15], a[232:235], v[36:39], v[12:15]
  buffer_load_dwordx4 v0, s[8:11], s43 offen offset:2048 sc1 lds
  v_mfma_f32_16x16x32_bf16 v[16:19], a[236:239], v[36:39], v[16:19]
  v_mfma_f32_16x16x32_bf16 v[20:23], a[240:243], v[36:39], v[20:23]
  s_waitcnt lgkmcnt(0)
  v_mfma_f32_16x16x32_bf16 v[12:15], a[244:247], v[40:43], v[12:15]
  buffer_load_dwordx4 v0, s[8:11], s43 offen offset:3072 sc1 lds
  v_mfma_f32_16x16x32_bf16 v[16:19], a[248:251], v[40:43], v[16:19]
  v_mfma_f32_16x16x32_bf16 v[20:23], a[252:255], v[40:43], v[20:23]
  s_branch Lwo_tj
Lwo_tn:
  v_mfma_f32_16x16x32_bf16 v[12:15], a[64:67], v[28:31], v[12:15]
  v_mfma_f32_16x16x32_bf16 v[16:19], a[68:71], v[28:31], v[16:19]
  s_waitcnt vmcnt(12)
  ds_read_b128 v[40:43], v44 offset:19456
  v_mfma_f32_16x16x32_bf16 v[20:23], a[72:75], v[28:31], v[20:23]
  v_mfma_f32_16x16x32_bf16 v[12:15], a[76:79], v[32:35], v[12:15]
  v_mfma_f32_16x16x32_bf16 v[16:19], a[80:83], v[32:35], v[16:19]
  s_waitcnt vmcnt(11)
  ds_read_b128 v[28:31], v44 offset:20480
  v_mfma_f32_16x16x32_bf16 v[20:23], a[84:87], v[32:35], v[20:23]
  v_mfma_f32_16x16x32_bf16 v[12:15], a[88:91], v[36:39], v[12:15]
  v_mfma_f32_16x16x32_bf16 v[16:19], a[92:95], v[36:39], v[16:19]
  s_waitcnt vmcnt(10)
  ds_read_b128 v[32:35], v44 offset:21504
  v_mfma_f32_16x16x32_bf16 v[20:23], a[96:99], v[36:39], v[20:23]
  s_waitcnt lgkmcnt(2)
  v_mfma_f32_16x16x32_bf16 v[12:15], a[100:103], v[40:43], v[12:15]
  v_mfma_f32_16x16x32_bf16 v[16:19], a[104:107], v[40:43], v[16:19]
  s_waitcnt vmcnt(9)
  ds_read_b128 v[36:39], v44 offset:22528
  v_mfma_f32_16x16x32_bf16 v[20:23], a[108:111], v[40:43], v[20:23]
  s_waitcnt lgkmcnt(2)
  v_mfma_f32_16x16x32_bf16 v[12:15], a[112:115], v[28:31], v[12:15]
  v_mfma_f32_16x16x32_bf16 v[16:19], a[116:119], v[28:31], v[16:19]
  s_waitcnt vmcnt(8)
  ds_read_b128 v[40:43], v44 offset:23552
  v_mfma_f32_16x16x32_bf16 v[20:23], a[120:123], v[28:31], v[20:23]
  s_waitcnt lgkmcnt(2)
  v_mfma_f32_16x16x32_bf16 v[12:15], a[124:127], v[32:35], v[12:15]
  v_mfma_f32_16x16x32_bf16 v[16:19], a[128:131], v[32:35], v[16:19]
  s_waitcnt vmcnt(7)
  ds_read_b128 v[28:31], v44 offset:24576
  v_mfma_f32_16x16x32_bf16 v[20:23], a[132:135], v[32:35], v[20:23]
  s_waitcnt lgkmcnt(2)
  v_mfma_f32_16x16x32_bf16 v[12:15], a[136:139], v[36:39], v[12:15]
  v_mfma_f32_16x16x32_bf16 v[16:19], a[140:143], v[36:39], v[16:19]
  s_waitcnt vmcnt(6)
  ds_read_b128 v[32:35], v44 offset:25600
  v_mfma_f32_16x16x32_bf16 v[20:23], a[144:147], v[36:39], v[20:23]
  s_waitcnt lgkmcnt(2)
  v_mfma_f32_16x16x32_bf16 v[12:15], a[148:151], v[40:43], v[12:15]
  v_mfma_f32_16x16x32_bf16 v[16:19], a[152:155], v[40:43], v[16:19]
  s_lshr_b32 s45, s18, 2
  s_add_u32 s45, s45, 1
  s_bfe_u32 s44, s18, 0x10001
  s_lshl_b32 s44, s44, 12
  s_add_u32 s44, s44, 12288
  buffer_load_dword v26, v4, s[8:11], s44 offen sc1
  s_waitcnt vmcnt(6)
  ds_read_b128 v[36:39], v44 offset:26624
  v_mfma_f32_16x16x32_bf16 v[20:23], a[156:159], v[40:43], v[20:23]
  s_waitcnt lgkmcnt(2)
  v_mfma_f32_16x16x32_bf16 v[12:15], a[160:163], v[28:31], v[12:15]
  v_mfma_f32_16x16x32_bf16 v[16:19], a[164:167], v[28:31], v[16:19]
  s_waitcnt vmcnt(5)
  ds_read_b128 v[40:43], v44 offset:27648
  v_mfma_f32_16x16x32_bf16 v[20:23], a[168:171], v[28:31], v[20:23]
  s_waitcnt lgkmcnt(2)
  v_mfma_f32_16x16x32_bf16 v[12:15], a[172:175], v[32:35], v[12:15]
  v_mfma_f32_16x16x32_bf16 v[16:19], a[176:179], v[32:35], v[16:19]
  s_waitcnt vmcnt(4)
  ds_read_b128 v[28:31], v44 offset:28672
  v_mfma_f32_16x16x32_bf16 v[20:23], a[180:183], v[32:35], v[20:23]
  s_waitcnt lgkmcnt(2)
  v_mfma_f32_16x16x32_bf16 v[12:15], a[184:187], v[36:39], v[12:15]
  v_mfma_f32_16x16x32_bf16 v[16:19], a[188:191], v[36:39], v[16:19]
  s_waitcnt vmcnt(3)
  ds_read_b128 v[32:35], v44 offset:29696
  v_mfma_f32_16x16x32_bf16 v[20:23], a[192:195], v[36:39], v[20:23]
  s_waitcnt lgkmcnt(2)
  v_mfma_f32_16x16x32_bf16 v[12:15], a[196:199], v[40:43], v[12:15]
  v_mfma_f32_16x16x32_bf16 v[16:19], a[200:203], v[40:43], v[16:19]
  s_waitcnt vmcnt(2)
  ds_read_b128 v[36:39], v44 offset:30720
  v_mfma_f32_16x16x32_bf16 v[20:23], a[204:207], v[40:43], v[20:23]
  s_waitcnt lgkmcnt(2)
  v_mfma_f32_16x16x32_bf16 v[12:15], a[208:211], v[28:31], v[12:15]
  v_mfma_f32_16x16x32_bf16 v[16:19], a[212:215], v[28:31], v[16:19]
  s_waitcnt vmcnt(1)
  ds_read_b128 v[40:43], v44 offset:31744
  v_mfma_f32_16x16x32_bf16 v[20:23], a[216:219], v[28:31], v[20:23]
  s_waitcnt lgkmcnt(2)
  v_mfma_f32_16x16x32_bf16 v[12:15], a[220:223], v[32:35], v[12:15]
  v_mfma_f32_16x16x32_bf16 v[16:19], a[224:227], v[32:35], v[16:19]
  v_mfma_f32_16x16x32_bf16 v[20:23], a[228:231], v[32:35], v[20:23]
  s_waitcnt lgkmcnt(1)
  v_mfma_f32_16x16x32_bf16 v[12:15], a[232:235], v[36:39], v[12:15]
  v_mfma_f32_16x16x32_bf16 v[16:19], a[236:239], v[36:39], v[16:19]
  v_mfma_f32_16x16x32_bf16 v[20:23], a[240:243], v[36:39], v[20:23]
  s_waitcnt lgkmcnt(0)
  v_mfma_f32_16x16x32_bf16 v[12:15], a[244:247], v[40:43], v[12:15]
  v_mfma_f32_16x16x32_bf16 v[16:19], a[248:251], v[40:43], v[16:19]
  v_mfma_f32_16x16x32_bf16 v[20:23], a[252:255], v[40:43], v[20:23]
  s_waitcnt vmcnt(0)
  s_cmp_eq_u32 s13, 3
  s_cbranch_scc0 Lw3_50
  v_cmp_gt_u32 vcc, s35, v26
  s_cmp_eq_u64 vcc, 0
  s_cselect_b32 s42, 1, 0
  s_cmp_ge_u32 s18, 128
  s_cselect_b32 s42, 0, s42
  v_mov_b32 v26, 160004
  v_mov_b32 v27, s42
  ds_write_b32 v26, v27
  s_waitcnt lgkmcnt(0)
Lw3_50:
Lwo_tj:
  s_mul_i32 s42, s13, 3072
  s_add_u32 s42, s42, 147456
  v_add_u32 v5, s42, v0
  ds_write_b128 v5, v[12:15] offset:0
  ds_write_b128 v5, v[16:19] offset:1024
  s_nop 1
  ds_write_b128 v5, v[20:23] offset:2048
  s_waitcnt lgkmcnt(0)
  s_barrier
  v_mov_b32 v26, 160004
  ds_read_b32 v27, v26
  ds_read_b128 v[28:31], v1 offset:0
  ds_read_b128 v[32:35], v1 offset:3072
  ds_read_b128 v[36:39], v1 offset:6144
  ds_read_b128 v[40:43], v1 offset:9216
  v_lshlrev_b32 v12, 16, v24
  v_and_b32 v13, 0xffff0000, v24
  v_lshlrev_b32 v14, 16, v25
  v_and_b32 v15, 0xffff0000, v25
  s_waitcnt lgkmcnt(2)
  v_add_f32 v28, v28, v32
  s_waitcnt lgkmcnt(0)
  v_add_f32 v36, v36, v40
  v_add_f32 v29, v29, v33
  v_add_f32 v37, v37, v41
  v_add_f32 v30, v30, v34
  v_add_f32 v38, v38, v42
  v_add_f32 v31, v31, v35
  v_add_f32 v39, v39, v43
  v_add_f32 v28, v28, v36
  v_add_f32 v29, v29, v37
  v_add_f32 v30, v30, v38
  v_add_f32 v31, v31, v39
  v_fmac_f32 v12, v28, v8
  v_fmac_f32 v13, v29, v9
  v_fmac_f32 v14, v30, v10
  v_fmac_f32 v15, v31, v11
  v_cvt_pk_bf16_f32 v24, v12, v13
  v_cvt_pk_bf16_f32 v25, v14, v15
  s_mov_b64 exec, s[28:29]
  s_add_u32 s44, s23, 4718592
  buffer_store_dwordx2 v[24:25], v2, s[8:11], s44 offen sc1
  s_mov_b64 exec, -1
  v_lshlrev_b32 v28, 16, v24
  v_and_b32 v29, 0xffff0000, v24
  v_lshlrev_b32 v30, 16, v25
  v_and_b32 v31, 0xffff0000, v25
  v_add_f32 v32, v28, v29
  v_add_f32 v34, v30, v31
  v_mul_f32 v33, v28, v28
  v_fmac_f32 v33, v29, v29
  v_fmac_f32 v33, v30, v30
  v_fmac_f32 v33, v31, v31
  v_add_f32 v32, v32, v34
  v_cndmask_b32 v33, 0, v33, s[28:29]
  v_cndmask_b32 v32, 0, v32, s[28:29]
  s_nop 0
  v_add_f32_dpp v33, v33, v33 row_ror:8 row_mask:0xf bank_mask:0xf
  v_add_f32_dpp v32, v32, v32 row_ror:8 row_mask:0xf bank_mask:0xf
  s_nop 0
  v_add_f32_dpp v33, v33, v33 row_ror:4 row_mask:0xf bank_mask:0xf
  v_add_f32_dpp v32, v32, v32 row_ror:4 row_mask:0xf bank_mask:0xf
  s_nop 0
  v_add_f32_dpp v33, v33, v33 row_ror:2 row_mask:0xf bank_mask:0xf
  v_add_f32_dpp v32, v32, v32 row_ror:2 row_mask:0xf bank_mask:0xf
  s_nop 0
  v_add_f32_dpp v33, v33, v33 row_ror:1 row_mask:0xf bank_mask:0xf
  v_add_f32_dpp v32, v32, v32 row_ror:1 row_mask:0xf bank_mask:0xf
  s_mul_i32 s44, s34, 1536
  s_lshl_b32 s42, s12, 3
  s_add_u32 s44, s44, s42
  s_add_u32 s44, s44, 1310720
  s_mov_b32 s42, 0x00010001
  s_mov_b32 s43, 0x00010001
  s_mov_b64 exec, s[42:43]
  buffer_store_dwordx2 v[32:33], v7, s[8:11], s44 offen sc1
  s_mov_b64 exec, -1
  s_add_u32 s19, s19, 1
  s_cmp_eq_u32 s33, 1
  s_cbranch_scc1 Lwo_loop
  v_readfirstlane_b32 s33, v27
  s_lshl_b32 s33, s33, 1
  s_cbranch_scc1 Lwo_go
  s_cmp_eq_u32 s13, 3
  s_cbranch_scc0 Low_51
  s_lshr_b32 s45, s18, 2
  s_add_u32 s45, s45, 1
  s_bfe_u32 s44, s18, 0x10001
  s_lshl_b32 s44, s44, 12
  s_add_u32 s44, s44, 12288
  buffer_load_dword v26, v4, s[8:11], s44 offen sc1
  s_waitcnt vmcnt(0)
  v_cmp_gt_u32 vcc, s35, v26
  s_cmp_eq_u64 vcc, 0
  s_cselect_b32 s42, 1, 0
  s_cmp_ge_u32 s18, 128
  s_cselect_b32 s42, 0, s42
  v_mov_b32 v26, 160008
  v_mov_b32 v27, s42
  ds_write_b32 v26, v27
  s_waitcnt lgkmcnt(0)
Low_51:
  s_waitcnt vmcnt(0)
  s_barrier
  s_cmp_eq_u32 s13, 0
  s_cbranch_scc0 Lfs_52
  v_mov_b32 v5, s19
  s_mov_b64 exec, 1
  buffer_store_dword v5, off, s[8:11], s21 sc1
  s_mov_b64 exec, -1
Lfs_52:
  v_mov_b32 v26, 160008
  ds_read_b32 v27, v26
  s_waitcnt lgkmcnt(0)
  v_readfirstlane_b32 s42, v27
  s_cmp_eq_u32 s42, 1
  s_cbranch_scc1 Lwo_go
  s_cmp_ge_u32 s18, 128
  s_cbranch_scc1 Lwo_end
  s_cmp_eq_u32 s13, 3
  s_cbranch_scc0 Low_53
  s_lshr_b32 s45, s18, 2
  s_add_u32 s45, s45, 1
  s_bfe_u32 s44, s18, 0x10001
  s_lshl_b32 s44, s44, 12
  s_add_u32 s44, s44, 12288
Lp_54:
  buffer_load_dword v26, v4, s[8:11], s44 offen sc1
  s_waitcnt vmcnt(0)
  v_cmp_gt_u32 vcc, s45, v26
  s_cbranch_vccz Lpo_55
  s_sleep 2
  s_sub_u32 s15, s15, 1
  s_cbranch_scc0 Lp_54
  s_mov_b32 s15, 0
Lpo_55:
Low_53:
  s_barrier
Lwo_go:
  s_add_u32 s43, s20, 0
  s_add_u32 m0, s30, 0
  s_nop 0
  buffer_load_dwordx4 v0, s[8:11], s43 offen offset:0 sc1 lds
  buffer_load_dwordx4 v0, s[8:11], s43 offen offset:1024 sc1 lds
  buffer_load_dwordx4 v0, s[8:11], s43 offen offset:2048 sc1 lds
  buffer_load_dwordx4 v0, s[8:11], s43 offen offset:3072 sc1 lds
  s_add_u32 s43, s20, 4096
  s_add_u32 m0, s30, 4096
  s_nop 0
  buffer_load_dwordx4 v0, s[8:11], s43 offen offset:0 sc1 lds
  buffer_load_dwordx4 v0, s[8:11], s43 offen offset:1024 sc1 lds
  buffer_load_dwordx4 v0, s[8:11], s43 offen offset:2048 sc1 lds
  buffer_load_dwordx4 v0, s[8:11], s43 offen offset:3072 sc1 lds
  s_add_u32 s43, s20, 8192
  s_add_u32 m0, s30, 8192
  s_nop 0
  buffer_load_dwordx4 v0, s[8:11], s43 offen offset:0 sc1 lds
  buffer_load_dwordx4 v0, s[8:11], s43 offen offset:1024 sc1 lds
  buffer_load_dwordx4 v0, s[8:11], s43 offen offset:2048 sc1 lds
  buffer_load_dwordx4 v0, s[8:11], s43 offen offset:3072 sc1 lds
  s_add_u32 s43, s20, 12288
  s_add_u32 m0, s30, 12288
  s_nop 0
  buffer_load_dwordx4 v0, s[8:11], s43 offen offset:0 sc1 lds
  buffer_load_dwordx4 v0, s[8:11], s43 offen offset:1024 sc1 lds
  buffer_load_dwordx4 v0, s[8:11], s43 offen offset:2048 sc1 lds
  buffer_load_dwordx4 v0, s[8:11], s43 offen offset:3072 sc1 lds
  s_branch Lwo_loop
Lwo_end:
  s_branch Lend
Ldn:
  v_and_b32 v30, 63, v0
  v_lshlrev_b32 v0, 4, v30
  v_and_b32 v31, 15, v30
  v_lshrrev_b32 v32, 4, v30
  s_lshl_b32 s42, s13, 2
  v_add_u32 v32, s42, v32
  v_cmp_gt_u32 s[28:29], 12, v31
  v_min_u32 v31, 11, v31
  v_lshrrev_b32 v33, 2, v31
  v_and_b32 v34, 3, v31
  v_lshl_add_u32 v34, v34, 4, v32
  v_lshlrev_b32 v34, 4, v34
  v_lshl_add_u32 v1, v33, 10, v34
  v_add_u32 v1, 147456, v1
  s_mul_i32 s42, s12, 48
  v_lshlrev_b32 v33, 2, v31
  v_add_u32 v33, s42, v33
  v_lshrrev_b32 v34, 5, v33
  v_lshlrev_b32 v34, 10, v34
  v_bfe_u32 v35, v33, 3, 2
  v_lshl_add_u32 v35, v35, 4, v32
  v_lshl_add_u32 v34, v35, 4, v34
  v_bfe_u32 v35, v33, 2, 1
  v_lshl_add_u32 v2, v35, 3, v34
  v_mul_u32_u24 v34, 1152, v32
  v_lshl_add_u32 v3, v33, 1, v34
  v_lshlrev_b32 v36, 2, v33
  v_mul_u32_u24 v37, 96, v32
  v_lshlrev_b32 v4, 7, v30
  v_and_b32 v7, 7, v30
  v_lshlrev_b32 v7, 7, v7
  v_add_u32 v7, 8192, v7
  s_cmp_eq_u32 s13, 3
  s_cselect_b32 s42, -1, 0
  v_and_b32 v4, s42, v4
  v_and_b32 v7, s42, v7
  v_mov_b32 v6, v36
  v_lshrrev_b32 v30, 4, v0
  v_lshrrev_b32 v31, 3, v30
  v_and_b32 v32, 7, v30
  v_lshrrev_b32 v33, 1, v32
  v_bfe_u32 v34, v30, 4, 2
  v_xor_b32 v33, v33, v34
  v_cmp_ne_u32 s[26:27], 3, v33
  v_mul_u32_u24 v31, 1152, v31
  v_lshl_add_u32 v31, v33, 5, v31
  v_and_b32 v32, 1, v32
  v_lshl_add_u32 v26, v32, 4, v31
  v_lshrrev_b32 v31, 4, v30
  v_bfe_u32 v32, v30, 2, 2
  v_lshl_add_u32 v33, v31, 2, v32
  v_lshlrev_b32 v33, 7, v33
  v_lshrrev_b32 v32, 1, v32
  v_lshl_add_u32 v32, v31, 1, v32
  v_and_b32 v32, 3, v32
  v_lshl_add_u32 v33, v32, 5, v33
  v_and_b32 v32, 3, v30
  v_lshl_add_u32 v33, v32, 3, v33
  s_mul_i32 s30, s13, 40960
  v_add_u32 v27, s30, v33
  v_xor_b32 v28, 32, v27
  v_xor_b32 v29, 64, v27
  s_load_dwordx2 s[4:5], s[0:1], 80
  s_mov_b32 s6, 5308416
  s_mov_b32 s7, 0x20000
  s_mul_i32 s31, s13, 1327104
  s_mul_i32 s42, s12, 96
  s_add_u32 s31, s31, s42
  s_waitcnt lgkmcnt(0)
  s_mov_b64 exec, s[26:27]
  s_add_u32 m0, s30, 0
  s_add_u32 s42, s31, 0
  buffer_load_dwordx4 v26, s[4:7], s42 offen lds
  s_add_u32 m0, s30, 1024
  s_add_u32 s42, s31, 9216
  buffer_load_dwordx4 v26, s[4:7], s42 offen lds
  s_add_u32 m0, s30, 2048
  s_add_u32 s42, s31, 18432
  buffer_load_dwordx4 v26, s[4:7], s42 offen lds
  s_add_u32 m0, s30, 3072
  s_add_u32 s42, s31, 27648
  buffer_load_dwordx4 v26, s[4:7], s42 offen lds
  s_mov_b64 exec, -1
  s_mov_b64 exec, s[26:27]
  s_add_u32 m0, s30, 4096
  s_add_u32 s42, s31, 36864
  buffer_load_dwordx4 v26, s[4:7], s42 offen lds
  s_add_u32 m0, s30, 5120
  s_add_u32 s42, s31, 46080
  buffer_load_dwordx4 v26, s[4:7], s42 offen lds
  s_add_u32 m0, s30, 6144
  s_add_u32 s42, s31, 55296
  buffer_load_dwordx4 v26, s[4:7], s42 offen lds
  s_add_u32 m0, s30, 7168
  s_add_u32 s42, s31, 64512
  buffer_load_dwordx4 v26, s[4:7], s42 offen lds
  s_mov_b64 exec, -1
  s_mov_b64 exec, s[26:27]
  s_add_u32 m0, s30, 8192
  s_add_u32 s42, s31, 73728
  buffer_load_dwordx4 v26, s[4:7], s42 offen lds
  s_add_u32 m0, s30, 9216
  s_add_u32 s42, s31, 82944
  buffer_load_dwordx4 v26, s[4:7], s42 offen lds
  s_add_u32 m0, s30, 10240
  s_add_u32 s42, s31, 92160
  buffer_load_dwordx4 v26, s[4:7], s42 offen lds
  s_add_u32 m0, s30, 11264
  s_add_u32 s42, s31, 101376
  buffer_load_dwordx4 v26, s[4:7], s42 offen lds
  s_mov_b64 exec, -1
  s_mov_b64 exec, s[26:27]
  s_add_u32 m0, s30, 12288
  s_add_u32 s42, s31, 110592
  buffer_load_dwordx4 v26, s[4:7], s42 offen lds
  s_add_u32 m0, s30, 13312
  s_add_u32 s42, s31, 119808
  buffer_load_dwordx4 v26, s[4:7], s42 offen lds
  s_add_u32 m0, s30, 14336
  s_add_u32 s42, s31, 129024
  buffer_load_dwordx4 v26, s[4:7], s42 offen lds
  s_add_u32 m0, s30, 15360
  s_add_u32 s42, s31, 138240
  buffer_load_dwordx4 v26, s[4:7], s42 offen lds
  s_mov_b64 exec, -1
  s_mov_b64 exec, s[26:27]
  s_add_u32 m0, s30, 16384
  s_add_u32 s42, s31, 147456
  buffer_load_dwordx4 v26, s[4:7], s42 offen lds
  s_add_u32 m0, s30, 17408
  s_add_u32 s42, s31, 156672
  buffer_load_dwordx4 v26, s[4:7], s42 offen lds
  s_add_u32 m0, s30, 18432
  s_add_u32 s42, s31, 165888
  buffer_load_dwordx4 v26, s[4:7], s42 offen lds
  s_add_u32 m0, s30, 19456
  s_add_u32 s42, s31, 175104
  buffer_load_dwordx4 v26, s[4:7], s42 offen lds
  s_mov_b64 exec, -1
  s_mov_b64 exec, s[26:27]
  s_add_u32 m0, s30, 20480
  s_add_u32 s42, s31, 184320
  buffer_load_dwordx4 v26, s[4:7], s42 offen lds
  s_add_u32 m0, s30, 21504
  s_add_u32 s42, s31, 193536
  buffer_load_dwordx4 v26, s[4:7], s42 offen lds
  s_add_u32 m0, s30, 22528
  s_add_u32 s42, s31, 202752
  buffer_load_dwordx4 v26, s[4:7], s42 offen lds
  s_add_u32 m0, s30, 23552
  s_add_u32 s42, s31, 211968
  buffer_load_dwordx4 v26, s[4:7], s42 offen lds
  s_mov_b64 exec, -1
  s_mov_b64 exec, s[26:27]
  s_add_u32 m0, s30, 24576
  s_add_u32 s42, s31, 221184
  buffer_load_dwordx4 v26, s[4:7], s42 offen lds
  s_add_u32 m0, s30, 25600
  s_add_u32 s42, s31, 230400
  buffer_load_dwordx4 v26, s[4:7], s42 offen lds
  s_add_u32 m0, s30, 26624
  s_add_u32 s42, s31, 239616
  buffer_load_dwordx4 v26, s[4:7], s42 offen lds
  s_add_u32 m0, s30, 27648
  s_add_u32 s42, s31, 248832
  buffer_load_dwordx4 v26, s[4:7], s42 offen lds
  s_mov_b64 exec, -1
  s_mov_b64 exec, s[26:27]
  s_add_u32 m0, s30, 28672
  s_add_u32 s42, s31, 258048
  buffer_load_dwordx4 v26, s[4:7], s42 offen lds
  s_add_u32 m0, s30, 29696
  s_add_u32 s42, s31, 267264
  buffer_load_dwordx4 v26, s[4:7], s42 offen lds
  s_add_u32 m0, s30, 30720
  s_add_u32 s42, s31, 276480
  buffer_load_dwordx4 v26, s[4:7], s42 offen lds
  s_add_u32 m0, s30, 31744
  s_add_u32 s42, s31, 285696
  buffer_load_dwordx4 v26, s[4:7], s42 offen lds
  s_mov_b64 exec, -1
  s_mov_b64 exec, s[26:27]
  s_add_u32 m0, s30, 32768
  s_add_u32 s42, s31, 294912
  buffer_load_dwordx4 v26, s[4:7], s42 offen lds
  s_add_u32 m0, s30, 33792
  s_add_u32 s42, s31, 304128
  buffer_load_dwordx4 v26, s[4:7], s42 offen lds
  s_add_u32 m0, s30, 34816
  s_add_u32 s42, s31, 313344
  buffer_load_dwordx4 v26, s[4:7], s42 offen lds
  s_add_u32 m0, s30, 35840
  s_add_u32 s42, s31, 322560
  buffer_load_dwordx4 v26, s[4:7], s42 offen lds
  s_mov_b64 exec, -1
  s_mov_b64 exec, s[26:27]
  s_add_u32 m0, s30, 36864
  s_add_u32 s42, s31, 331776
  buffer_load_dwordx4 v26, s[4:7], s42 offen lds
  s_add_u32 m0, s30, 37888
  s_add_u32 s42, s31, 340992
  buffer_load_dwordx4 v26, s[4:7], s42 offen lds
  s_add_u32 m0, s30, 38912
  s_add_u32 s42, s31, 350208
  buffer_load_dwordx4 v26, s[4:7], s42 offen lds
  s_add_u32 m0, s30, 39936
  s_add_u32 s42, s31, 359424
  buffer_load_dwordx4 v26, s[4:7], s42 offen lds
  s_mov_b64 exec, -1
  s_waitcnt vmcnt(36)
  ds_read_b64_tr_b16 v[80:81], v27 offset:0
  ds_read_b64_tr_b16 v[82:83], v27 offset:2048
  ds_read_b64_tr_b16 v[84:85], v28 offset:0
  ds_read_b64_tr_b16 v[86:87], v28 offset:2048
  ds_read_b64_tr_b16 v[88:89], v29 offset:0
  ds_read_b64_tr_b16 v[90:91], v29 offset:2048
  s_waitcnt lgkmcnt(0)
  s_mov_b64 exec, s[26:27]
  s_add_u32 m0, s30, 0
  s_add_u32 s42, s31, 368640
  buffer_load_dwordx4 v26, s[4:7], s42 offen lds
  s_add_u32 m0, s30, 1024
  s_add_u32 s42, s31, 377856
  buffer_load_dwordx4 v26, s[4:7], s42 offen lds
  s_add_u32 m0, s30, 2048
  s_add_u32 s42, s31, 387072
  buffer_load_dwordx4 v26, s[4:7], s42 offen lds
  s_add_u32 m0, s30, 3072
  s_add_u32 s42, s31, 396288
  buffer_load_dwordx4 v26, s[4:7], s42 offen lds
  s_mov_b64 exec, -1
  s_waitcnt vmcnt(36)
  ds_read_b64_tr_b16 v[92:93], v27 offset:4096
  ds_read_b64_tr_b16 v[94:95], v27 offset:6144
  ds_read_b64_tr_b16 v[96:97], v28 offset:4096
  ds_read_b64_tr_b16 v[98:99], v28 offset:6144
  ds_read_b64_tr_b16 v[100:101], v29 offset:4096
  ds_read_b64_tr_b16 v[102:103], v29 offset:6144
  s_waitcnt lgkmcnt(0)
  s_mov_b64 exec, s[26:27]
  s_add_u32 m0, s30, 4096
  s_add_u32 s42, s31, 405504
  buffer_load_dwordx4 v26, s[4:7], s42 offen lds
  s_add_u32 m0, s30, 5120
  s_add_u32 s42, s31, 414720
  buffer_load_dwordx4 v26, s[4:7], s42 offen lds
  s_add_u32 m0, s30, 6144
  s_add_u32 s42, s31, 423936
  buffer_load_dwordx4 v26, s[4:7], s42 offen lds
  s_add_u32 m0, s30, 7168
  s_add_u32 s42, s31, 433152
  buffer_load_dwordx4 v26, s[4:7], s42 offen lds
  s_mov_b64 exec, -1
  s_waitcnt vmcnt(36)
  ds_read_b64_tr_b16 v[104:105], v27 offset:8192
  ds_read_b64_tr_b16 v[106:107], v27 offset:10240
  ds_read_b64_tr_b16 v[108:109], v28 offset:8192
  ds_read_b64_tr_b16 v[110:111], v28 offset:10240
  ds_read_b64_tr_b16 v[112:113], v29 offset:8192
  ds_read_b64_tr_b16 v[114:115], v29 offset:10240
  s_waitcnt lgkmcnt(0)
  s_mov_b64 exec, s[26:27]
  s_add_u32 m0, s30, 8192
  s_add_u32 s42, s31, 442368
  buffer_load_dwordx4 v26, s[4:7], s42 offen lds
  s_add_u32 m0, s30, 9216
  s_add_u32 s42, s31, 451584
  buffer_load_dwordx4 v26, s[4:7], s42 offen lds
  s_add_u32 m0, s30, 10240
  s_add_u32 s42, s31, 460800
  buffer_load_dwordx4 v26, s[4:7], s42 offen lds
  s_add_u32 m0, s30, 11264
  s_add_u32 s42, s31, 470016
  buffer_load_dwordx4 v26, s[4:7], s42 offen lds
  s_mov_b64 exec, -1
  s_waitcnt vmcnt(36)
  ds_read_b64_tr_b16 v[116:117], v27 offset:12288
  ds_read_b64_tr_b16 v[118:119], v27 offset:14336
  ds_read_b64_tr_b16 v[120:121], v28 offset:12288
  ds_read_b64_tr_b16 v[122:123], v28 offset:14336
  ds_read_b64_tr_b16 v[124:125], v29 offset:12288
  ds_read_b64_tr_b16 v[126:127], v29 offset:14336
  s_waitcnt lgkmcnt(0)
  s_mov_b64 exec, s[26:27]
  s_add_u32 m0, s30, 12288
  s_add_u32 s42, s31, 479232
  buffer_load_dwordx4 v26, s[4:7], s42 offen lds
  s_add_u32 m0, s30, 13312
  s_add_u32 s42, s31, 488448
  buffer_load_dwordx4 v26, s[4:7], s42 offen lds
  s_add_u32 m0, s30, 14336
  s_add_u32 s42, s31, 497664
  buffer_load_dwordx4 v26, s[4:7], s42 offen lds
  s_add_u32 m0, s30, 15360
  s_add_u32 s42, s31, 506880
  buffer_load_dwordx4 v26, s[4:7], s42 offen lds
  s_mov_b64 exec, -1
  s_waitcnt vmcnt(36)
  ds_read_b64_tr_b16 v[128:129], v27 offset:16384
  ds_read_b64_tr_b16 v[130:131], v27 offset:18432
  ds_read_b64_tr_b16 v[132:133], v28 offset:16384
  ds_read_b64_tr_b16 v[134:135], v28 offset:18432
  ds_read_b64_tr_b16 v[136:137], v29 offset:16384
  ds_read_b64_tr_b16 v[138:139], v29 offset:18432
  s_waitcnt lgkmcnt(0)
  s_mov_b64 exec, s[26:27]
  s_add_u32 m0, s30, 16384
  s_add_u32 s42, s31, 516096
  buffer_load_dwordx4 v26, s[4:7], s42 offen lds
  s_add_u32 m0, s30, 17408
  s_add_u32 s42, s31, 525312
  buffer_load_dwordx4 v26, s[4:7], s42 offen lds
  s_add_u32 m0, s30, 18432
  s_add_u32 s42, s31, 534528
  buffer_load_dwordx4 v26, s[4:7], s42 offen lds
  s_add_u32 m0, s30, 19456
  s_add_u32 s42, s31, 543744
  buffer_load_dwordx4 v26, s[4:7], s42 offen lds
  s_mov_b64 exec, -1
  s_waitcnt vmcnt(36)
  ds_read_b64_tr_b16 v[140:141], v27 offset:20480
  ds_read_b64_tr_b16 v[142:143], v27 offset:22528
  ds_read_b64_tr_b16 v[144:145], v28 offset:20480
  ds_read_b64_tr_b16 v[146:147], v28 offset:22528
  ds_read_b64_tr_b16 v[148:149], v29 offset:20480
  ds_read_b64_tr_b16 v[150:151], v29 offset:22528
  s_waitcnt lgkmcnt(0)
  s_mov_b64 exec, s[26:27]
  s_add_u32 m0, s30, 20480
  s_add_u32 s42, s31, 552960
  buffer_load_dwordx4 v26, s[4:7], s42 offen lds
  s_add_u32 m0, s30, 21504
  s_add_u32 s42, s31, 562176
  buffer_load_dwordx4 v26, s[4:7], s42 offen lds
  s_add_u32 m0, s30, 22528
  s_add_u32 s42, s31, 571392
  buffer_load_dwordx4 v26, s[4:7], s42 offen lds
  s_add_u32 m0, s30, 23552
  s_add_u32 s42, s31, 580608
  buffer_load_dwordx4 v26, s[4:7], s42 offen lds
  s_mov_b64 exec, -1
  s_waitcnt vmcnt(36)
  ds_read_b64_tr_b16 v[152:153], v27 offset:24576
  ds_read_b64_tr_b16 v[154:155], v27 offset:26624
  ds_read_b64_tr_b16 v[156:157], v28 offset:24576
  ds_read_b64_tr_b16 v[158:159], v28 offset:26624
  ds_read_b64_tr_b16 v[160:161], v29 offset:24576
  ds_read_b64_tr_b16 v[162:163], v29 offset:26624
  s_waitcnt lgkmcnt(0)
  s_mov_b64 exec, s[26:27]
  s_add_u32 m0, s30, 24576
  s_add_u32 s42, s31, 589824
  buffer_load_dwordx4 v26, s[4:7], s42 offen lds
  s_add_u32 m0, s30, 25600
  s_add_u32 s42, s31, 599040
  buffer_load_dwordx4 v26, s[4:7], s42 offen lds
  s_add_u32 m0, s30, 26624
  s_add_u32 s42, s31, 608256
  buffer_load_dwordx4 v26, s[4:7], s42 offen lds
  s_add_u32 m0, s30, 27648
  s_add_u32 s42, s31, 617472
  buffer_load_dwordx4 v26, s[4:7], s42 offen lds
  s_mov_b64 exec, -1
  s_waitcnt vmcnt(36)
  ds_read_b64_tr_b16 v[164:165], v27 offset:28672
  ds_read_b64_tr_b16 v[166:167], v27 offset:30720
  ds_read_b64_tr_b16 v[168:169], v28 offset:28672
  ds_read_b64_tr_b16 v[170:171], v28 offset:30720
  ds_read_b64_tr_b16 v[172:173], v29 offset:28672
  ds_read_b64_tr_b16 v[174:175], v29 offset:30720
  s_waitcnt lgkmcnt(0)
  s_mov_b64 exec, s[26:27]
  s_add_u32 m0, s30, 28672
  s_add_u32 s42, s31, 626688
  buffer_load_dwordx4 v26, s[4:7], s42 offen lds
  s_add_u32 m0, s30, 29696
  s_add_u32 s42, s31, 635904
  buffer_load_dwordx4 v26, s[4:7], s42 offen lds
  s_add_u32 m0, s30, 30720
  s_add_u32 s42, s31, 645120
  buffer_load_dwordx4 v26, s[4:7], s42 offen lds
  s_add_u32 m0, s30, 31744
  s_add_u32 s42, s31, 654336
  buffer_load_dwordx4 v26, s[4:7], s42 offen lds
  s_mov_b64 exec, -1
  s_waitcnt vmcnt(36)
  ds_read_b64_tr_b16 v[176:177], v27 offset:32768
  ds_read_b64_tr_b16 v[178:179], v27 offset:34816
  ds_read_b64_tr_b16 v[180:181], v28 offset:32768
  ds_read_b64_tr_b16 v[182:183], v28 offset:34816
  ds_read_b64_tr_b16 v[184:185], v29 offset:32768
  ds_read_b64_tr_b16 v[186:187], v29 offset:34816
  s_waitcnt lgkmcnt(0)
  s_mov_b64 exec, s[26:27]
  s_add_u32 m0, s30, 32768
  s_add_u32 s42, s31, 663552
  buffer_load_dwordx4 v26, s[4:7], s42 offen lds
  s_add_u32 m0, s30, 33792
  s_add_u32 s42, s31, 672768
  buffer_load_dwordx4 v26, s[4:7], s42 offen lds
  s_add_u32 m0, s30, 34816
  s_add_u32 s42, s31, 681984
  buffer_load_dwordx4 v26, s[4:7], s42 offen lds
  s_add_u32 m0, s30, 35840
  s_add_u32 s42, s31, 691200
  buffer_load_dwordx4 v26, s[4:7], s42 offen lds
  s_mov_b64 exec, -1
  s_waitcnt vmcnt(36)
  ds_read_b64_tr_b16 v[188:189], v27 offset:36864
  ds_read_b64_tr_b16 v[190:191], v27 offset:38912
  ds_read_b64_tr_b16 v[192:193], v28 offset:36864
  ds_read_b64_tr_b16 v[194:195], v28 offset:38912
  ds_read_b64_tr_b16 v[196:197], v29 offset:36864
  ds_read_b64_tr_b16 v[198:199], v29 offset:38912
  s_waitcnt lgkmcnt(0)
  s_mov_b64 exec, s[26:27]
  s_add_u32 m0, s30, 36864
  s_add_u32 s42, s31, 700416
  buffer_load_dwordx4 v26, s[4:7], s42 offen lds
  s_add_u32 m0, s30, 37888
  s_add_u32 s42, s31, 709632
  buffer_load_dwordx4 v26, s[4:7], s42 offen lds
  s_add_u32 m0, s30, 38912
  s_add_u32 s42, s31, 718848
  buffer_load_dwordx4 v26, s[4:7], s42 offen lds
  s_add_u32 m0, s30, 39936
  s_add_u32 s42, s31, 728064
  buffer_load_dwordx4 v26, s[4:7], s42 offen lds
  s_mov_b64 exec, -1
  s_waitcnt vmcnt(36)
  ds_read_b64_tr_b16 v[200:201], v27 offset:0
  ds_read_b64_tr_b16 v[202:203], v27 offset:2048
  ds_read_b64_tr_b16 v[204:205], v28 offset:0
  ds_read_b64_tr_b16 v[206:207], v28 offset:2048
  ds_read_b64_tr_b16 v[208:209], v29 offset:0
  ds_read_b64_tr_b16 v[210:211], v29 offset:2048
  s_waitcnt lgkmcnt(0)
  s_mov_b64 exec, s[26:27]
  s_add_u32 m0, s30, 0
  s_add_u32 s42, s31, 737280
  buffer_load_dwordx4 v26, s[4:7], s42 offen lds
  s_add_u32 m0, s30, 1024
  s_add_u32 s42, s31, 746496
  buffer_load_dwordx4 v26, s[4:7], s42 offen lds
  s_add_u32 m0, s30, 2048
  s_add_u32 s42, s31, 755712
  buffer_load_dwordx4 v26, s[4:7], s42 offen lds
  s_add_u32 m0, s30, 3072
  s_add_u32 s42, s31, 764928
  buffer_load_dwordx4 v26, s[4:7], s42 offen lds
  s_mov_b64 exec, -1
  s_waitcnt vmcnt(36)
  ds_read_b64_tr_b16 v[212:213], v27 offset:4096
  ds_read_b64_tr_b16 v[214:215], v27 offset:6144
  ds_read_b64_tr_b16 v[216:217], v28 offset:4096
  ds_read_b64_tr_b16 v[218:219], v28 offset:6144
  ds_read_b64_tr_b16 v[220:221], v29 offset:4096
  ds_read_b64_tr_b16 v[222:223], v29 offset:6144
  s_waitcnt lgkmcnt(0)
  s_mov_b64 exec, s[26:27]
  s_add_u32 m0, s30, 4096
  s_add_u32 s42, s31, 774144
  buffer_load_dwordx4 v26, s[4:7], s42 offen lds
  s_add_u32 m0, s30, 5120
  s_add_u32 s42, s31, 783360
  buffer_load_dwordx4 v26, s[4:7], s42 offen lds
  s_add_u32 m0, s30, 6144
  s_add_u32 s42, s31, 792576
  buffer_load_dwordx4 v26, s[4:7], s42 offen lds
  s_add_u32 m0, s30, 7168
  s_add_u32 s42, s31, 801792
  buffer_load_dwordx4 v26, s[4:7], s42 offen lds
  s_mov_b64 exec, -1
  s_waitcnt vmcnt(36)
  ds_read_b64_tr_b16 v[224:225], v27 offset:8192
  ds_read_b64_tr_b16 v[226:227], v27 offset:10240
  ds_read_b64_tr_b16 v[228:229], v28 offset:8192
  ds_read_b64_tr_b16 v[230:231], v28 offset:10240
  ds_read_b64_tr_b16 v[232:233], v29 offset:8192
  ds_read_b64_tr_b16 v[234:235], v29 offset:10240
  s_waitcnt lgkmcnt(0)
  s_mov_b64 exec, s[26:27]
  s_add_u32 m0, s30, 8192
  s_add_u32 s42, s31, 811008
  buffer_load_dwordx4 v26, s[4:7], s42 offen lds
  s_add_u32 m0, s30, 9216
  s_add_u32 s42, s31, 820224
  buffer_load_dwordx4 v26, s[4:7], s42 offen lds
  s_add_u32 m0, s30, 10240
  s_add_u32 s42, s31, 829440
  buffer_load_dwordx4 v26, s[4:7], s42 offen lds
  s_add_u32 m0, s30, 11264
  s_add_u32 s42, s31, 838656
  buffer_load_dwordx4 v26, s[4:7], s42 offen lds
  s_mov_b64 exec, -1
  s_waitcnt vmcnt(36)
  ds_read_b64_tr_b16 v[236:237], v27 offset:12288
  ds_read_b64_tr_b16 v[238:239], v27 offset:14336
  ds_read_b64_tr_b16 v[240:241], v28 offset:12288
  ds_read_b64_tr_b16 v[242:243], v28 offset:14336
  ds_read_b64_tr_b16 v[244:245], v29 offset:12288
  ds_read_b64_tr_b16 v[246:247], v29 offset:14336
  s_waitcnt lgkmcnt(0)
  s_mov_b64 exec, s[26:27]
  s_add_u32 m0, s30, 12288
  s_add_u32 s42, s31, 847872
  buffer_load_dwordx4 v26, s[4:7], s42 offen lds
  s_add_u32 m0, s30, 13312
  s_add_u32 s42, s31, 857088
  buffer_load_dwordx4 v26, s[4:7], s42 offen lds
  s_add_u32 m0, s30, 14336
  s_add_u32 s42, s31, 866304
  buffer_load_dwordx4 v26, s[4:7], s42 offen lds
  s_add_u32 m0, s30, 15360
  s_add_u32 s42, s31, 875520
  buffer_load_dwordx4 v26, s[4:7], s42 offen lds
  s_mov_b64 exec, -1
  s_waitcnt vmcnt(36)
  ds_read_b64_tr_b16 v[248:249], v27 offset:16384
  ds_read_b64_tr_b16 v[250:251], v27 offset:18432
  ds_read_b64_tr_b16 v[252:253], v28 offset:16384
  ds_read_b64_tr_b16 v[254:255], v28 offset:18432
  ds_read_b64_tr_b16 a[0:1], v29 offset:16384
  ds_read_b64_tr_b16 a[2:3], v29 offset:18432
  s_waitcnt lgkmcnt(0)
  s_mov_b64 exec, s[26:27]
  s_add_u32 m0, s30, 16384
  s_add_u32 s42, s31, 884736
  buffer_load_dwordx4 v26, s[4:7], s42 offen lds
  s_add_u32 m0, s30, 17408
  s_add_u32 s42, s31, 893952
  buffer_load_dwordx4 v26, s[4:7], s42 offen lds
  s_add_u32 m0, s30, 18432
  s_add_u32 s42, s31, 903168
  buffer_load_dwordx4 v26, s[4:7], s42 offen lds
  s_add_u32 m0, s30, 19456
  s_add_u32 s42, s31, 912384
  buffer_load_dwordx4 v26, s[4:7], s42 offen lds
  s_mov_b64 exec, -1
  s_waitcnt vmcnt(36)
  ds_read_b64_tr_b16 a[4:5], v27 offset:20480
  ds_read_b64_tr_b16 a[6:7], v27 offset:22528
  ds_read_b64_tr_b16 a[8:9], v28 offset:20480
  ds_read_b64_tr_b16 a[10:11], v28 offset:22528
  ds_read_b64_tr_b16 a[12:13], v29 offset:20480
  ds_read_b64_tr_b16 a[14:15], v29 offset:22528
  s_waitcnt lgkmcnt(0)
  s_mov_b64 exec, s[26:27]
  s_add_u32 m0, s30, 20480
  s_add_u32 s42, s31, 921600
  buffer_load_dwordx4 v26, s[4:7], s42 offen lds
  s_add_u32 m0, s30, 21504
  s_add_u32 s42, s31, 930816
  buffer_load_dwordx4 v26, s[4:7], s42 offen lds
  s_add_u32 m0, s30, 22528
  s_add_u32 s42, s31, 940032
  buffer_load_dwordx4 v26, s[4:7], s42 offen lds
  s_add_u32 m0, s30, 23552
  s_add_u32 s42, s31, 949248
  buffer_load_dwordx4 v26, s[4:7], s42 offen lds
  s_mov_b64 exec, -1
  s_waitcnt vmcnt(36)
  ds_read_b64_tr_b16 a[16:17], v27 offset:24576
  ds_read_b64_tr_b16 a[18:19], v27 offset:26624
  ds_read_b64_tr_b16 a[20:21], v28 offset:24576
  ds_read_b64_tr_b16 a[22:23], v28 offset:26624
  ds_read_b64_tr_b16 a[24:25], v29 offset:24576
  ds_read_b64_tr_b16 a[26:27], v29 offset:26624
  s_waitcnt lgkmcnt(0)
  s_mov_b64 exec, s[26:27]
  s_add_u32 m0, s30, 24576
  s_add_u32 s42, s31, 958464
  buffer_load_dwordx4 v26, s[4:7], s42 offen lds
  s_add_u32 m0, s30, 25600
  s_add_u32 s42, s31, 967680
  buffer_load_dwordx4 v26, s[4:7], s42 offen lds
  s_add_u32 m0, s30, 26624
  s_add_u32 s42, s31, 976896
  buffer_load_dwordx4 v26, s[4:7], s42 offen lds
  s_add_u32 m0, s30, 27648
  s_add_u32 s42, s31, 986112
  buffer_load_dwordx4 v26, s[4:7], s42 offen lds
  s_mov_b64 exec, -1
  s_waitcnt vmcnt(36)
  ds_read_b64_tr_b16 a[28:29], v27 offset:28672
  ds_read_b64_tr_b16 a[30:31], v27 offset:30720
  ds_read_b64_tr_b16 a[32:33], v28 offset:28672
  ds_read_b64_tr_b16 a[34:35], v28 offset:30720
  ds_read_b64_tr_b16 a[36:37], v29 offset:28672
  ds_read_b64_tr_b16 a[38:39], v29 offset:30720
  s_waitcnt lgkmcnt(0)
  s_mov_b64 exec, s[26:27]
  s_add_u32 m0, s30, 28672
  s_add_u32 s42, s31, 995328
  buffer_load_dwordx4 v26, s[4:7], s42 offen lds
  s_add_u32 m0, s30, 29696
  s_add_u32 s42, s31, 1004544
  buffer_load_dwordx4 v26, s[4:7], s42 offen lds
  s_add_u32 m0, s30, 30720
  s_add_u32 s42, s31, 1013760
  buffer_load_dwordx4 v26, s[4:7], s42 offen lds
  s_add_u32 m0, s30, 31744
  s_add_u32 s42, s31, 1022976
  buffer_load_dwordx4 v26, s[4:7], s42 offen lds
  s_mov_b64 exec, -1
  s_waitcnt vmcnt(36)
  ds_read_b64_tr_b16 a[40:41], v27 offset:32768
  ds_read_b64_tr_b16 a[42:43], v27 offset:34816
  ds_read_b64_tr_b16 a[44:45], v28 offset:32768
  ds_read_b64_tr_b16 a[46:47], v28 offset:34816
  ds_read_b64_tr_b16 a[48:49], v29 offset:32768
  ds_read_b64_tr_b16 a[50:51], v29 offset:34816
  s_waitcnt lgkmcnt(0)
  s_mov_b64 exec, s[26:27]
  s_add_u32 m0, s30, 32768
  s_add_u32 s42, s31, 1032192
  buffer_load_dwordx4 v26, s[4:7], s42 offen lds
  s_add_u32 m0, s30, 33792
  s_add_u32 s42, s31, 1041408
  buffer_load_dwordx4 v26, s[4:7], s42 offen lds
  s_add_u32 m0, s30, 34816
  s_add_u32 s42, s31, 1050624
  buffer_load_dwordx4 v26, s[4:7], s42 offen lds
  s_add_u32 m0, s30, 35840
  s_add_u32 s42, s31, 1059840
  buffer_load_dwordx4 v26, s[4:7], s42 offen lds
  s_mov_b64 exec, -1
  s_waitcnt vmcnt(36)
  ds_read_b64_tr_b16 a[52:53], v27 offset:36864
  ds_read_b64_tr_b16 a[54:55], v27 offset:38912
  ds_read_b64_tr_b16 a[56:57], v28 offset:36864
  ds_read_b64_tr_b16 a[58:59], v28 offset:38912
  ds_read_b64_tr_b16 a[60:61], v29 offset:36864
  ds_read_b64_tr_b16 a[62:63], v29 offset:38912
  s_waitcnt lgkmcnt(0)
  s_mov_b64 exec, s[26:27]
  s_add_u32 m0, s30, 36864
  s_add_u32 s42, s31, 1069056
  buffer_load_dwordx4 v26, s[4:7], s42 offen lds
  s_add_u32 m0, s30, 37888
  s_add_u32 s42, s31, 1078272
  buffer_load_dwordx4 v26, s[4:7], s42 offen lds
  s_add_u32 m0, s30, 38912
  s_add_u32 s42, s31, 1087488
  buffer_load_dwordx4 v26, s[4:7], s42 offen lds
  s_add_u32 m0, s30, 39936
  s_add_u32 s42, s31, 1096704
  buffer_load_dwordx4 v26, s[4:7], s42 offen lds
  s_mov_b64 exec, -1
  s_waitcnt vmcnt(36)
  ds_read_b64_tr_b16 a[64:65], v27 offset:0
  ds_read_b64_tr_b16 a[66:67], v27 offset:2048
  ds_read_b64_tr_b16 a[68:69], v28 offset:0
  ds_read_b64_tr_b16 a[70:71], v28 offset:2048
  ds_read_b64_tr_b16 a[72:73], v29 offset:0
  ds_read_b64_tr_b16 a[74:75], v29 offset:2048
  s_waitcnt lgkmcnt(0)
  s_mov_b64 exec, s[26:27]
  s_add_u32 m0, s30, 0
  s_add_u32 s42, s31, 1105920
  buffer_load_dwordx4 v26, s[4:7], s42 offen lds
  s_add_u32 m0, s30, 1024
  s_add_u32 s42, s31, 1115136
  buffer_load_dwordx4 v26, s[4:7], s42 offen lds
  s_add_u32 m0, s30, 2048
  s_add_u32 s42, s31, 1124352
  buffer_load_dwordx4 v26, s[4:7], s42 offen lds
  s_add_u32 m0, s30, 3072
  s_add_u32 s42, s31, 1133568
  buffer_load_dwordx4 v26, s[4:7], s42 offen lds
  s_mov_b64 exec, -1
  s_waitcnt vmcnt(36)
  ds_read_b64_tr_b16 a[76:77], v27 offset:4096
  ds_read_b64_tr_b16 a[78:79], v27 offset:6144
  ds_read_b64_tr_b16 a[80:81], v28 offset:4096
  ds_read_b64_tr_b16 a[82:83], v28 offset:6144
  ds_read_b64_tr_b16 a[84:85], v29 offset:4096
  ds_read_b64_tr_b16 a[86:87], v29 offset:6144
  s_waitcnt lgkmcnt(0)
  s_mov_b64 exec, s[26:27]
  s_add_u32 m0, s30, 4096
  s_add_u32 s42, s31, 1142784
  buffer_load_dwordx4 v26, s[4:7], s42 offen lds
  s_add_u32 m0, s30, 5120
  s_add_u32 s42, s31, 1152000
  buffer_load_dwordx4 v26, s[4:7], s42 offen lds
  s_add_u32 m0, s30, 6144
  s_add_u32 s42, s31, 1161216
  buffer_load_dwordx4 v26, s[4:7], s42 offen lds
  s_add_u32 m0, s30, 7168
  s_add_u32 s42, s31, 1170432
  buffer_load_dwordx4 v26, s[4:7], s42 offen lds
  s_mov_b64 exec, -1
  s_waitcnt vmcnt(36)
  ds_read_b64_tr_b16 a[88:89], v27 offset:8192
  ds_read_b64_tr_b16 a[90:91], v27 offset:10240
  ds_read_b64_tr_b16 a[92:93], v28 offset:8192
  ds_read_b64_tr_b16 a[94:95], v28 offset:10240
  ds_read_b64_tr_b16 a[96:97], v29 offset:8192
  ds_read_b64_tr_b16 a[98:99], v29 offset:10240
  s_waitcnt lgkmcnt(0)
  s_mov_b64 exec, s[26:27]
  s_add_u32 m0, s30, 8192
  s_add_u32 s42, s31, 1179648
  buffer_load_dwordx4 v26, s[4:7], s42 offen lds
  s_add_u32 m0, s30, 9216
  s_add_u32 s42, s31, 1188864
  buffer_load_dwordx4 v26, s[4:7], s42 offen lds
  s_add_u32 m0, s30, 10240
  s_add_u32 s42, s31, 1198080
  buffer_load_dwordx4 v26, s[4:7], s42 offen lds
  s_add_u32 m0, s30, 11264
  s_add_u32 s42, s31, 1207296
  buffer_load_dwordx4 v26, s[4:7], s42 offen lds
  s_mov_b64 exec, -1
  s_waitcnt vmcnt(36)
  ds_read_b64_tr_b16 a[100:101], v27 offset:12288
  ds_read_b64_tr_b16 a[102:103], v27 offset:14336
  ds_read_b64_tr_b16 a[104:105], v28 offset:12288
  ds_read_b64_tr_b16 a[106:107], v28 offset:14336
  ds_read_b64_tr_b16 a[108:109], v29 offset:12288
  ds_read_b64_tr_b16 a[110:111], v29 offset:14336
  s_waitcnt lgkmcnt(0)
  s_mov_b64 exec, s[26:27]
  s_add_u32 m0, s30, 12288
  s_add_u32 s42, s31, 1216512
  buffer_load_dwordx4 v26, s[4:7], s42 offen lds
  s_add_u32 m0, s30, 13312
  s_add_u32 s42, s31, 1225728
  buffer_load_dwordx4 v26, s[4:7], s42 offen lds
  s_add_u32 m0, s30, 14336
  s_add_u32 s42, s31, 1234944
  buffer_load_dwordx4 v26, s[4:7], s42 offen lds
  s_add_u32 m0, s30, 15360
  s_add_u32 s42, s31, 1244160
  buffer_load_dwordx4 v26, s[4:7], s42 offen lds
  s_mov_b64 exec, -1
  s_waitcnt vmcnt(36)
  ds_read_b64_tr_b16 a[112:113], v27 offset:16384
  ds_read_b64_tr_b16 a[114:115], v27 offset:18432
  ds_read_b64_tr_b16 a[116:117], v28 offset:16384
  ds_read_b64_tr_b16 a[118:119], v28 offset:18432
  ds_read_b64_tr_b16 a[120:121], v29 offset:16384
  ds_read_b64_tr_b16 a[122:123], v29 offset:18432
  s_waitcnt lgkmcnt(0)
  s_mov_b64 exec, s[26:27]
  s_add_u32 m0, s30, 16384
  s_add_u32 s42, s31, 1253376
  buffer_load_dwordx4 v26, s[4:7], s42 offen lds
  s_add_u32 m0, s30, 17408
  s_add_u32 s42, s31, 1262592
  buffer_load_dwordx4 v26, s[4:7], s42 offen lds
  s_add_u32 m0, s30, 18432
  s_add_u32 s42, s31, 1271808
  buffer_load_dwordx4 v26, s[4:7], s42 offen lds
  s_add_u32 m0, s30, 19456
  s_add_u32 s42, s31, 1281024
  buffer_load_dwordx4 v26, s[4:7], s42 offen lds
  s_mov_b64 exec, -1
  s_waitcnt vmcnt(36)
  ds_read_b64_tr_b16 a[124:125], v27 offset:20480
  ds_read_b64_tr_b16 a[126:127], v27 offset:22528
  ds_read_b64_tr_b16 a[128:129], v28 offset:20480
  ds_read_b64_tr_b16 a[130:131], v28 offset:22528
  ds_read_b64_tr_b16 a[132:133], v29 offset:20480
  ds_read_b64_tr_b16 a[134:135], v29 offset:22528
  s_waitcnt lgkmcnt(0)
  s_mov_b64 exec, s[26:27]
  s_add_u32 m0, s30, 20480
  s_add_u32 s42, s31, 1290240
  buffer_load_dwordx4 v26, s[4:7], s42 offen lds
  s_add_u32 m0, s30, 21504
  s_add_u32 s42, s31, 1299456
  buffer_load_dwordx4 v26, s[4:7], s42 offen lds
  s_add_u32 m0, s30, 22528
  s_add_u32 s42, s31, 1308672
  buffer_load_dwordx4 v26, s[4:7], s42 offen lds
  s_add_u32 m0, s30, 23552
  s_add_u32 s42, s31, 1317888
  buffer_load_dwordx4 v26, s[4:7], s42 offen lds
  s_mov_b64 exec, -1
  s_waitcnt vmcnt(36)
  ds_read_b64_tr_b16 a[136:137], v27 offset:24576
  ds_read_b64_tr_b16 a[138:139], v27 offset:26624
  ds_read_b64_tr_b16 a[140:141], v28 offset:24576
  ds_read_b64_tr_b16 a[142:143], v28 offset:26624
  ds_read_b64_tr_b16 a[144:145], v29 offset:24576
  ds_read_b64_tr_b16 a[146:147], v29 offset:26624
  s_waitcnt vmcnt(32)
  ds_read_b64_tr_b16 a[148:149], v27 offset:28672
  ds_read_b64_tr_b16 a[150:151], v27 offset:30720
  ds_read_b64_tr_b16 a[152:153], v28 offset:28672
  ds_read_b64_tr_b16 a[154:155], v28 offset:30720
  ds_read_b64_tr_b16 a[156:157], v29 offset:28672
  ds_read_b64_tr_b16 a[158:159], v29 offset:30720
  s_waitcnt vmcnt(28)
  ds_read_b64_tr_b16 a[160:161], v27 offset:32768
  ds_read_b64_tr_b16 a[162:163], v27 offset:34816
  ds_read_b64_tr_b16 a[164:165], v28 offset:32768
  ds_read_b64_tr_b16 a[166:167], v28 offset:34816
  ds_read_b64_tr_b16 a[168:169], v29 offset:32768
  ds_read_b64_tr_b16 a[170:171], v29 offset:34816
  s_waitcnt vmcnt(24)
  ds_read_b64_tr_b16 a[172:173], v27 offset:36864
  ds_read_b64_tr_b16 a[174:175], v27 offset:38912
  ds_read_b64_tr_b16 a[176:177], v28 offset:36864
  ds_read_b64_tr_b16 a[178:179], v28 offset:38912
  ds_read_b64_tr_b16 a[180:181], v29 offset:36864
  ds_read_b64_tr_b16 a[182:183], v29 offset:38912
  s_waitcnt vmcnt(20)
  ds_read_b64_tr_b16 a[184:185], v27 offset:0
  ds_read_b64_tr_b16 a[186:187], v27 offset:2048
  ds_read_b64_tr_b16 a[188:189], v28 offset:0
  ds_read_b64_tr_b16 a[190:191], v28 offset:2048
  ds_read_b64_tr_b16 a[192:193], v29 offset:0
  ds_read_b64_tr_b16 a[194:195], v29 offset:2048
  s_waitcnt vmcnt(16)
  ds_read_b64_tr_b16 a[196:197], v27 offset:4096
  ds_read_b64_tr_b16 a[198:199], v27 offset:6144
  ds_read_b64_tr_b16 a[200:201], v28 offset:4096
  ds_read_b64_tr_b16 a[202:203], v28 offset:6144
  ds_read_b64_tr_b16 a[204:205], v29 offset:4096
  ds_read_b64_tr_b16 a[206:207], v29 offset:6144
  s_waitcnt vmcnt(12)
  ds_read_b64_tr_b16 a[208:209], v27 offset:8192
  ds_read_b64_tr_b16 a[210:211], v27 offset:10240
  ds_read_b64_tr_b16 a[212:213], v28 offset:8192
  ds_read_b64_tr_b16 a[214:215], v28 offset:10240
  ds_read_b64_tr_b16 a[216:217], v29 offset:8192
  ds_read_b64_tr_b16 a[218:219], v29 offset:10240
  s_waitcnt vmcnt(8)
  ds_read_b64_tr_b16 a[220:221], v27 offset:12288
  ds_read_b64_tr_b16 a[222:223], v27 offset:14336
  ds_read_b64_tr_b16 a[224:225], v28 offset:12288
  ds_read_b64_tr_b16 a[226:227], v28 offset:14336
  ds_read_b64_tr_b16 a[228:229], v29 offset:12288
  ds_read_b64_tr_b16 a[230:231], v29 offset:14336
  s_waitcnt vmcnt(4)
  ds_read_b64_tr_b16 a[232:233], v27 offset:16384
  ds_read_b64_tr_b16 a[234:235], v27 offset:18432
  ds_read_b64_tr_b16 a[236:237], v28 offset:16384
  ds_read_b64_tr_b16 a[238:239], v28 offset:18432
  ds_read_b64_tr_b16 a[240:241], v29 offset:16384
  ds_read_b64_tr_b16 a[242:243], v29 offset:18432
  s_waitcnt vmcnt(0)
  ds_read_b64_tr_b16 a[244:245], v27 offset:20480
  ds_read_b64_tr_b16 a[246:247], v27 offset:22528
  ds_read_b64_tr_b16 a[248:249], v28 offset:20480
  ds_read_b64_tr_b16 a[250:251], v28 offset:22528
  ds_read_b64_tr_b16 a[252:253], v29 offset:20480
  ds_read_b64_tr_b16 a[254:255], v29 offset:22528
  s_waitcnt lgkmcnt(0)
  s_barrier
  s_cmp_eq_u32 s13, 3
  s_cbranch_scc0 Low_56
  v_mov_b32 v30, 0
  s_mov_b32 s42, 0x80808080
Lcw_57:
  global_load_dword v28, v30, s[16:17] sc0 sc1
  s_waitcnt vmcnt(0)
  v_and_b32 v29, s42, v28
  v_cmp_ne_u32 vcc, s42, v29
  s_cbranch_vccz Lcwo_58
  s_sleep 4
  s_sub_u32 s15, s15, 1
  s_cbranch_scc0 Lcw_57
  s_mov_b32 s15, 0
Lcwo_58:
  v_lshrrev_b32 v29, 4, v0
  v_min_u32 v29, 53, v29
  v_lshlrev_b32 v29, 7, v29
  s_mov_b32 s44, 40960
Lp_59:
  buffer_load_dword v28, v29, s[8:11], s44 offen sc1
  s_waitcnt vmcnt(0)
  v_cmp_gt_u32 vcc, 1, v28
  s_cbranch_vccz Lpo_60
  s_sleep 4
  s_sub_u32 s15, s15, 1
  s_cbranch_scc0 Lp_59
  s_mov_b32 s15, 0
Lpo_60:
Low_56:
  s_barrier
  s_mov_b32 s42, 77056
  buffer_load_dwordx4 v[8:11], v6, s[8:11], s42 offen sc1
  s_load_dwordx2 s[4:5], s[0:1], 104
  s_mov_b32 s6, 2359296
  s_mov_b32 s7, 0x20000
  s_mov_b32 s18, s14
  s_mov_b32 s19, 0
  s_mov_b32 s22, 0
  s_mul_i32 s20, s14, 147456
  s_mul_i32 s42, s13, 36864
  s_add_u32 s20, s20, s42
  s_add_u32 s20, s20, 83886080
  s_waitcnt vmcnt(0) lgkmcnt(0)
  s_mul_i32 s30, s13, 36864
  v_lshrrev_b32 v44, 1, v0
  v_add_u32 v44, s30, v44
  s_mov_b32 s33, 0
  s_cmp_eq_u32 s13, 3
  s_cbranch_scc0 Low_61
  s_lshr_b32 s45, s18, 1
  s_add_u32 s45, s45, 1
  s_mov_b32 s44, 28672
Lp_62:
  buffer_load_dword v26, v4, s[8:11], s44 offen sc1
  buffer_load_dword v27, v7, s[8:11], s44 offen sc1
  s_waitcnt vmcnt(0)
  v_min_u32 v26, v26, v27
  v_cmp_gt_u32 vcc, s45, v26
  s_cbranch_vccz Lpo_63
  s_sleep 2
  s_sub_u32 s15, s15, 1
  s_cbranch_scc0 Lp_62
  s_mov_b32 s15, 0
Lpo_63:
Low_61:
  s_barrier
  s_add_u32 s43, s20, 0
  s_add_u32 m0, s30, 0
  s_nop 0
  buffer_load_dwordx4 v0, s[8:11], s43 offen offset:0 sc1 lds
  buffer_load_dwordx4 v0, s[8:11], s43 offen offset:1024 sc1 lds
  buffer_load_dwordx4 v0, s[8:11], s43 offen offset:2048 sc1 lds
  buffer_load_dwordx4 v0, s[8:11], s43 offen offset:3072 sc1 lds
  s_add_u32 s43, s20, 4096
  s_add_u32 m0, s30, 4096
  s_nop 0
  buffer_load_dwordx4 v0, s[8:11], s43 offen offset:0 sc1 lds
  buffer_load_dwordx4 v0, s[8:11], s43 offen offset:1024 sc1 lds
  buffer_load_dwordx4 v0, s[8:11], s43 offen offset:2048 sc1 lds
  buffer_load_dwordx4 v0, s[8:11], s43 offen offset:3072 sc1 lds
  s_add_u32 s43, s20, 8192
  s_add_u32 m0, s30, 8192
  s_nop 0
  buffer_load_dwordx4 v0, s[8:11], s43 offen offset:0 sc1 lds
  buffer_load_dwordx4 v0, s[8:11], s43 offen offset:1024 sc1 lds
  buffer_load_dwordx4 v0, s[8:11], s43 offen offset:2048 sc1 lds
  buffer_load_dwordx4 v0, s[8:11], s43 offen offset:3072 sc1 lds
  s_add_u32 s43, s20, 12288
  s_add_u32 m0, s30, 12288
  s_nop 0
  buffer_load_dwordx4 v0, s[8:11], s43 offen offset:0 sc1 lds
  buffer_load_dwordx4 v0, s[8:11], s43 offen offset:1024 sc1 lds
  buffer_load_dwordx4 v0, s[8:11], s43 offen offset:2048 sc1 lds
  buffer_load_dwordx4 v0, s[8:11], s43 offen offset:3072 sc1 lds
Ldn_loop:
  s_mul_i32 s23, s18, 18432
  s_mov_b32 s34, s18
  s_mov_b32 s37, s20
  s_add_u32 s18, s18, 4
  s_add_u32 s20, s20, 589824
  s_add_u32 s44, s23, 4718592
  buffer_load_dwordx2 v[24:25], v2, s[8:11], s44 offen sc1
  s_lshr_b32 s45, s18, 1
  s_add_u32 s45, s45, 1
  s_mov_b32 s44, 28672
  buffer_load_dword v26, v4, s[8:11], s44 offen sc1
  buffer_load_dword v27, v7, s[8:11], s44 offen sc1
  s_mov_b32 s35, s45
  s_waitcnt vmcnt(18)
  ds_read2st64_b64 v[28:31], v44 offset0:0 offset1:1
  s_waitcnt vmcnt(17)
  ds_read2st64_b64 v[32:35], v44 offset0:2 offset1:3
  s_waitcnt vmcnt(16)
  ds_read2st64_b64 v[36:39], v44 offset0:4 offset1:5
  s_waitcnt lgkmcnt(2)
  v_mfma_f32_16x16x32_bf16 v[12:15], v[80:83], v[28:31], 0
  s_add_u32 s43, s37, 16384
  s_add_u32 m0, s30, 16384
  s_nop 0
  buffer_load_dwordx4 v0, s[8:11], s43 offen offset:0 sc1 lds
  v_mfma_f32_16x16x32_bf16 v[16:19], v[84:87], v[28:31], 0
  s_waitcnt vmcnt(16)
  ds_read2st64_b64 v[40:43], v44 offset0:6 offset1:7
  v_mfma_f32_16x16x32_bf16 v[20:23], v[88:91], v[28:31], 0
  s_waitcnt lgkmcnt(2)
  v_mfma_f32_16x16x32_bf16 v[12:15], v[92:95], v[32:35], v[12:15]
  buffer_load_dwordx4 v0, s[8:11], s43 offen offset:1024 sc1 lds
  v_mfma_f32_16x16x32_bf16 v[16:19], v[96:99], v[32:35], v[16:19]
  s_waitcnt vmcnt(16)
  ds_read2st64_b64 v[28:31], v44 offset0:8 offset1:9
  v_mfma_f32_16x16x32_bf16 v[20:23], v[100:103], v[32:35], v[20:23]
  s_waitcnt lgkmcnt(2)
  v_mfma_f32_16x16x32_bf16 v[12:15], v[104:107], v[36:39], v[12:15]
  buffer_load_dwordx4 v0, s[8:11], s43 offen offset:2048 sc1 lds
  v_mfma_f32_16x16x32_bf16 v[16:19], v[108:111], v[36:39], v[16:19]
  s_waitcnt vmcnt(16)
  ds_read2st64_b64 v[32:35], v44 offset0:10 offset1:11
  v_mfma_f32_16x16x32_bf16 v[20:23], v[112:115], v[36:39], v[20:23]
  s_waitcnt lgkmcnt(2)
  v_mfma_f32_16x16x32_bf16 v[12:15], v[116:119], v[40:43], v[12:15]
  buffer_load_dwordx4 v0, s[8:11], s43 offen offset:3072 sc1 lds
  v_mfma_f32_16x16x32_bf16 v[16:19], v[120:123], v[40:43], v[16:19]
  s_waitcnt vmcnt(16)
  ds_read2st64_b64 v[36:39], v44 offset0:12 offset1:13
  v_mfma_f32_16x16x32_bf16 v[20:23], v[124:127], v[40:43], v[20:23]
  s_waitcnt lgkmcnt(2)
  v_mfma_f32_16x16x32_bf16 v[12:15], v[128:131], v[28:31], v[12:15]
  s_add_u32 s43, s37, 20480
  s_add_u32 m0, s30, 20480
  s_nop 0
  buffer_load_dwordx4 v0, s[8:11], s43 offen offset:0 sc1 lds
  v_mfma_f32_16x16x32_bf16 v[16:19], v[132:135], v[28:31], v[16:19]
  s_waitcnt vmcnt(16)
  ds_read2st64_b64 v[40:43], v44 offset0:14 offset1:15
  v_mfma_f32_16x16x32_bf16 v[20:23], v[136:139], v[28:31], v[20:23]
  s_waitcnt lgkmcnt(2)
  v_mfma_f32_16x16x32_bf16 v[12:15], v[140:143], v[32:35], v[12:15]
  buffer_load_dwordx4 v0, s[8:11], s43 offen offset:1024 sc1 lds
  v_mfma_f32_16x16x32_bf16 v[16:19], v[144:147], v[32:35], v[16:19]
  s_waitcnt vmcnt(16)
  ds_read2st64_b64 v[28:31], v44 offset0:16 offset1:17
  v_mfma_f32_16x16x32_bf16 v[20:23], v[148:151], v[32:35], v[20:23]
  s_waitcnt lgkmcnt(2)
  v_mfma_f32_16x16x32_bf16 v[12:15], v[152:155], v[36:39], v[12:15]
  buffer_load_dwordx4 v0, s[8:11], s43 offen offset:2048 sc1 lds
  v_mfma_f32_16x16x32_bf16 v[16:19], v[156:159], v[36:39], v[16:19]
  s_waitcnt vmcnt(16)
  ds_read2st64_b64 v[32:35], v44 offset0:18 offset1:19
  v_mfma_f32_16x16x32_bf16 v[20:23], v[160:163], v[36:39], v[20:23]
  s_waitcnt lgkmcnt(2)
  v_mfma_f32_16x16x32_bf16 v[12:15], v[164:167], v[40:43], v[12:15]
  buffer_load_dwordx4 v0, s[8:11], s43 offen offset:3072 sc1 lds
  v_mfma_f32_16x16x32_bf16 v[16:19], v[168:171], v[40:43], v[16:19]
  s_waitcnt vmcnt(16)
  ds_read2st64_b64 v[36:39], v44 offset0:20 offset1:21
  v_mfma_f32_16x16x32_bf16 v[20:23], v[172:175], v[40:43], v[20:23]
  s_waitcnt lgkmcnt(2)
  v_mfma_f32_16x16x32_bf16 v[12:15], v[176:179], v[28:31], v[12:15]
  s_add_u32 s43, s37, 24576
  s_add_u32 m0, s30, 24576
  s_nop 0
  buffer_load_dwordx4 v0, s[8:11], s43 offen offset:0 sc1 lds
  v_mfma_f32_16x16x32_bf16 v[16:19], v[180:183], v[28:31], v[16:19]
  s_waitcnt vmcnt(16)
  ds_read2st64_b64 v[40:43], v44 offset0:22 offset1:23
  v_mfma_f32_16x16x32_bf16 v[20:23], v[184:187], v[28:31], v[20:23]
  s_waitcnt lgkmcnt(2)
  v_mfma_f32_16x16x32_bf16 v[12:15], v[188:191], v[32:35], v[12:15]
  buffer_load_dwordx4 v0, s[8:11], s43 offen offset:1024 sc1 lds
  v_mfma_f32_16x16x32_bf16 v[16:19], v[192:195], v[32:35], v[16:19]
  s_waitcnt vmcnt(16)
  ds_read2st64_b64 v[28:31], v44 offset0:24 offset1:25
  v_mfma_f32_16x16x32_bf16 v[20:23], v[196:199], v[32:35], v[20:23]
  s_waitcnt lgkmcnt(2)
  v_mfma_f32_16x16x32_bf16 v[12:15], v[200:203], v[36:39], v[12:15]
  buffer_load_dwordx4 v0, s[8:11], s43 offen offset:2048 sc1 lds
  v_mfma_f32_16x16x32_bf16 v[16:19], v[204:207], v[36:39], v[16:19]
  s_waitcnt vmcnt(16)
  ds_read2st64_b64 v[32:35], v44 offset0:26 offset1:27
  v_mfma_f32_16x16x32_bf16 v[20:23], v[208:211], v[36:39], v[20:23]
  s_waitcnt lgkmcnt(2)
  v_mfma_f32_16x16x32_bf16 v[12:15], v[212:215], v[40:43], v[12:15]
  buffer_load_dwordx4 v0, s[8:11], s43 offen offset:3072 sc1 lds
  v_mfma_f32_16x16x32_bf16 v[16:19], v[216:219], v[40:43], v[16:19]
  s_waitcnt vmcnt(16)
  ds_read2st64_b64 v[36:39], v44 offset0:28 offset1:29
  v_mfma_f32_16x16x32_bf16 v[20:23], v[220:223], v[40:43], v[20:23]
  s_waitcnt lgkmcnt(2)
  v_mfma_f32_16x16x32_bf16 v[12:15], v[224:227], v[28:31], v[12:15]
  s_add_u32 s43, s37, 28672
  s_add_u32 m0, s30, 28672
  s_nop 0
  buffer_load_dwordx4 v0, s[8:11], s43 offen offset:0 sc1 lds
  v_mfma_f32_16x16x32_bf16 v[16:19], v[228:231], v[28:31], v[16:19]
  s_waitcnt vmcnt(16)
  ds_read2st64_b64 v[40:43], v44 offset0:30 offset1:31
  v_mfma_f32_16x16x32_bf16 v[20:23], v[232:235], v[28:31], v[20:23]
  s_waitcnt lgkmcnt(2)
  v_mfma_f32_16x16x32_bf16 v[12:15], v[236:239], v[32:35], v[12:15]
  buffer_load_dwordx4 v0, s[8:11], s43 offen offset:1024 sc1 lds
  v_mfma_f32_16x16x32_bf16 v[16:19], v[240:243], v[32:35], v[16:19]
  s_waitcnt vmcnt(13)
  ds_read2st64_b64 v[28:31], v44 offset0:32 offset1:33
  v_mfma_f32_16x16x32_bf16 v[20:23], v[244:247], v[32:35], v[20:23]
  s_waitcnt lgkmcnt(2)
  v_mfma_f32_16x16x32_bf16 v[12:15], v[248:251], v[36:39], v[12:15]
  buffer_load_dwordx4 v0, s[8:11], s43 offen offset:2048 sc1 lds
  v_mfma_f32_16x16x32_bf16 v[16:19], v[252:255], v[36:39], v[16:19]
  s_waitcnt vmcnt(13)
  ds_read2st64_b64 v[32:35], v44 offset0:34 offset1:35
  v_mfma_f32_16x16x32_bf16 v[20:23], a[0:3], v[36:39], v[20:23]
  s_waitcnt lgkmcnt(2)
  v_mfma_f32_16x16x32_bf16 v[12:15], a[4:7], v[40:43], v[12:15]
  buffer_load_dwordx4 v0, s[8:11], s43 offen offset:3072 sc1 lds
  v_mfma_f32_16x16x32_bf16 v[16:19], a[8:11], v[40:43], v[16:19]
  s_waitcnt vmcnt(13)
  ds_read2st64_b64 v[36:39], v44 offset0:36 offset1:37
  v_mfma_f32_16x16x32_bf16 v[20:23], a[12:15], v[40:43], v[20:23]
  s_waitcnt lgkmcnt(2)
  v_mfma_f32_16x16x32_bf16 v[12:15], a[16:19], v[28:31], v[12:15]
  s_add_u32 s43, s37, 32768
  s_add_u32 m0, s30, 32768
  s_nop 0
  buffer_load_dwordx4 v0, s[8:11], s43 offen offset:0 sc1 lds
  v_mfma_f32_16x16x32_bf16 v[16:19], a[20:23], v[28:31], v[16:19]
  s_waitcnt vmcnt(13)
  ds_read2st64_b64 v[40:43], v44 offset0:38 offset1:39
  v_mfma_f32_16x16x32_bf16 v[20:23], a[24:27], v[28:31], v[20:23]
  s_waitcnt lgkmcnt(2)
  v_mfma_f32_16x16x32_bf16 v[12:15], a[28:31], v[32:35], v[12:15]
  buffer_load_dwordx4 v0, s[8:11], s43 offen offset:1024 sc1 lds
  v_mfma_f32_16x16x32_bf16 v[16:19], a[32:35], v[32:35], v[16:19]
  s_waitcnt vmcnt(13)
  ds_read2st64_b64 v[28:31], v44 offset0:40 offset1:41
  v_mfma_f32_16x16x32_bf16 v[20:23], a[36:39], v[32:35], v[20:23]
  s_waitcnt lgkmcnt(2)
  v_mfma_f32_16x16x32_bf16 v[12:15], a[40:43], v[36:39], v[12:15]
  buffer_load_dwordx4 v0, s[8:11], s43 offen offset:2048 sc1 lds
  v_mfma_f32_16x16x32_bf16 v[16:19], a[44:47], v[36:39], v[16:19]
  s_waitcnt vmcnt(13)
  ds_read2st64_b64 v[32:35], v44 offset0:42 offset1:43
  v_mfma_f32_16x16x32_bf16 v[20:23], a[48:51], v[36:39], v[20:23]
  s_cmp_eq_u32 s13, 3
  s_cbranch_scc0 Lw3_64
  v_min_u32 v26, v26, v27
  v_cmp_gt_u32 vcc, s35, v26
  s_cmp_eq_u64 vcc, 0
  s_cselect_b32 s42, 1, 0
  s_cmp_ge_u32 s18, 128
  s_cselect_b32 s42, 0, s42
  v_mov_b32 v26, 160000
  v_mov_b32 v27, s42
  ds_write_b32 v26, v27
  s_waitcnt lgkmcnt(0)
Lw3_64:
  s_barrier
  v_mov_b32 v26, 160000
  ds_read_b32 v27, v26
  v_mfma_f32_16x16x32_bf16 v[12:15], a[52:55], v[40:43], v[12:15]
  buffer_load_dwordx4 v0, s[8:11], s43 offen offset:3072 sc1 lds
  v_mfma_f32_16x16x32_bf16 v[16:19], a[56:59], v[40:43], v[16:19]
  s_waitcnt vmcnt(13)
  ds_read2st64_b64 v[36:39], v44 offset0:44 offset1:45
  v_mfma_f32_16x16x32_bf16 v[20:23], a[60:63], v[40:43], v[20:23]
  s_waitcnt lgkmcnt(0)
  v_readfirstlane_b32 s33, v27
  s_cmp_eq_u32 s33, 0
  s_cbranch_scc1 Ldn_tn
  v_mfma_f32_16x16x32_bf16 v[12:15], a[64:67], v[28:31], v[12:15]
  s_add_u32 s43, s20, 0
  s_add_u32 m0, s30, 0
  s_nop 0
  buffer_load_dwordx4 v0, s[8:11], s43 offen offset:0 sc1 lds
  v_mfma_f32_16x16x32_bf16 v[16:19], a[68:71], v[28:31], v[16:19]
  s_waitcnt vmcnt(13)
  ds_read2st64_b64 v[40:43], v44 offset0:46 offset1:47
  v_mfma_f32_16x16x32_bf16 v[20:23], a[72:75], v[28:31], v[20:23]
  v_mfma_f32_16x16x32_bf16 v[12:15], a[76:79], v[32:35], v[12:15]
  buffer_load_dwordx4 v0, s[8:11], s43 offen offset:1024 sc1 lds
  v_mfma_f32_16x16x32_bf16 v[16:19], a[80:83], v[32:35], v[16:19]
  s_waitcnt vmcnt(13)
  ds_read2st64_b64 v[28:31], v44 offset0:48 offset1:49
  v_mfma_f32_16x16x32_bf16 v[20:23], a[84:87], v[32:35], v[20:23]
  v_mfma_f32_16x16x32_bf16 v[12:15], a[88:91], v[36:39], v[12:15]
  buffer_load_dwordx4 v0, s[8:11], s43 offen offset:2048 sc1 lds
  v_mfma_f32_16x16x32_bf16 v[16:19], a[92:95], v[36:39], v[16:19]
  s_waitcnt vmcnt(13)
  ds_read2st64_b64 v[32:35], v44 offset0:50 offset1:51
  v_mfma_f32_16x16x32_bf16 v[20:23], a[96:99], v[36:39], v[20:23]
  s_waitcnt lgkmcnt(2)
  v_mfma_f32_16x16x32_bf16 v[12:15], a[100:103], v[40:43], v[12:15]
  buffer_load_dwordx4 v0, s[8:11], s43 offen offset:3072 sc1 lds
  v_mfma_f32_16x16x32_bf16 v[16:19], a[104:107], v[40:43], v[16:19]
  s_waitcnt vmcnt(13)
  ds_read2st64_b64 v[36:39], v44 offset0:52 offset1:53
  v_mfma_f32_16x16x32_bf16 v[20:23], a[108:111], v[40:43], v[20:23]
  s_waitcnt lgkmcnt(2)
  v_mfma_f32_16x16x32_bf16 v[12:15], a[112:115], v[28:31], v[12:15]
  s_add_u32 s43, s20, 4096
  s_add_u32 m0, s30, 4096
  s_nop 0
  buffer_load_dwordx4 v0, s[8:11], s43 offen offset:0 sc1 lds
  v_mfma_f32_16x16x32_bf16 v[16:19], a[116:119], v[28:31], v[16:19]
  s_waitcnt vmcnt(13)
  ds_read2st64_b64 v[40:43], v44 offset0:54 offset1:55
  v_mfma_f32_16x16x32_bf16 v[20:23], a[120:123], v[28:31], v[20:23]
  s_waitcnt lgkmcnt(2)
  v_mfma_f32_16x16x32_bf16 v[12:15], a[124:127], v[32:35], v[12:15]
  buffer_load_dwordx4 v0, s[8:11], s43 offen offset:1024 sc1 lds
  v_mfma_f32_16x16x32_bf16 v[16:19], a[128:131], v[32:35], v[16:19]
  s_waitcnt vmcnt(13)
  ds_read2st64_b64 v[28:31], v44 offset0:56 offset1:57
  v_mfma_f32_16x16x32_bf16 v[20:23], a[132:135], v[32:35], v[20:23]
  s_waitcnt lgkmcnt(2)
  v_mfma_f32_16x16x32_bf16 v[12:15], a[136:139], v[36:39], v[12:15]
  buffer_load_dwordx4 v0, s[8:11], s43 offen offset:2048 sc1 lds
  v_mfma_f32_16x16x32_bf16 v[16:19], a[140:143], v[36:39], v[16:19]
  s_waitcnt vmcnt(13)
  ds_read2st64_b64 v[32:35], v44 offset0:58 offset1:59
  v_mfma_f32_16x16x32_bf16 v[20:23], a[144:147], v[36:39], v[20:23]
  s_waitcnt lgkmcnt(2)
  v_mfma_f32_16x16x32_bf16 v[12:15], a[148:151], v[40:43], v[12:15]
  buffer_load_dwordx4 v0, s[8:11], s43 offen offset:3072 sc1 lds
  v_mfma_f32_16x16x32_bf16 v[16:19], a[152:155], v[40:43], v[16:19]
  s_waitcnt vmcnt(13)
  ds_read2st64_b64 v[36:39], v44 offset0:60 offset1:61
  v_mfma_f32_16x16x32_bf16 v[20:23], a[156:159], v[40:43], v[20:23]
  s_waitcnt lgkmcnt(2)
  v_mfma_f32_16x16x32_bf16 v[12:15], a[160:163], v[28:31], v[12:15]
  s_add_u32 s43, s20, 8192
  s_add_u32 m0, s30, 8192
  s_nop 0
  buffer_load_dwordx4 v0, s[8:11], s43 offen offset:0 sc1 lds
  v_mfma_f32_16x16x32_bf16 v[16:19], a[164:167], v[28:31], v[16:19]
  s_waitcnt vmcnt(13)
  ds_read2st64_b64 v[40:43], v44 offset0:62 offset1:63
  v_mfma_f32_16x16x32_bf16 v[20:23], a[168:171], v[28:31], v[20:23]
  s_waitcnt lgkmcnt(2)
  v_mfma_f32_16x16x32_bf16 v[12:15], a[172:175], v[32:35], v[12:15]
  buffer_load_dwordx4 v0, s[8:11], s43 offen offset:1024 sc1 lds
  v_mfma_f32_16x16x32_bf16 v[16:19], a[176:179], v[32:35], v[16:19]
  s_waitcnt vmcnt(13)
  ds_read2st64_b64 v[28:31], v44 offset0:64 offset1:65
  v_mfma_f32_16x16x32_bf16 v[20:23], a[180:183], v[32:35], v[20:23]
  s_waitcnt lgkmcnt(2)
  v_mfma_f32_16x16x32_bf16 v[12:15], a[184:187], v[36:39], v[12:15]
  buffer_load_dwordx4 v0, s[8:11], s43 offen offset:2048 sc1 lds
  v_mfma_f32_16x16x32_bf16 v[16:19], a[188:191], v[36:39], v[16:19]
  s_waitcnt vmcnt(13)
  ds_read2st64_b64 v[32:35], v44 offset0:66 offset1:67
  v_mfma_f32_16x16x32_bf16 v[20:23], a[192:195], v[36:39], v[20:23]
  s_waitcnt lgkmcnt(2)
  v_mfma_f32_16x16x32_bf16 v[12:15], a[196:199], v[40:43], v[12:15]
  buffer_load_dwordx4 v0, s[8:11], s43 offen offset:3072 sc1 lds
  v_mfma_f32_16x16x32_bf16 v[16:19], a[200:203], v[40:43], v[16:19]
  s_waitcnt vmcnt(13)
  ds_read2st64_b64 v[36:39], v44 offset0:68 offset1:69
  v_mfma_f32_16x16x32_bf16 v[20:23], a[204:207], v[40:43], v[20:23]
  s_waitcnt lgkmcnt(2)
  v_mfma_f32_16x16x32_bf16 v[12:15], a[208:211], v[28:31], v[12:15]
  s_add_u32 s43, s20, 12288
  s_add_u32 m0, s30, 12288
  s_nop 0
  buffer_load_dwordx4 v0, s[8:11], s43 offen offset:0 sc1 lds
  v_mfma_f32_16x16x32_bf16 v[16:19], a[212:215], v[28:31], v[16:19]
  s_waitcnt vmcnt(13)
  ds_read2st64_b64 v[40:43], v44 offset0:70 offset1:71
  v_mfma_f32_16x16x32_bf16 v[20:23], a[216:219], v[28:31], v[20:23]
  s_waitcnt lgkmcnt(2)
  v_mfma_f32_16x16x32_bf16 v[12:15], a[220:223], v[32:35], v[12:15]
  buffer_load_dwordx4 v0, s[8:11], s43 offen offset:1024 sc1 lds
  v_mfma_f32_16x16x32_bf16 v[16:19], a[224:227], v[32:35], v[16:19]
  v_mfma_f32_16x16x32_bf16 v[20:23], a[228:231], v[32:35], v[20:23]
  s_waitcnt lgkmcnt(1)
  v_mfma_f32_16x16x32_bf16 v[12:15], a[232:235], v[36:39], v[12:15]
  buffer_load_dwordx4 v0, s[8:11], s43 offen offset:2048 sc1 lds
  v_mfma_f32_16x16x32_bf16 v[16:19], a[236:239], v[36:39], v[16:19]
  v_mfma_f32_16x16x32_bf16 v[20:23], a[240:243], v[36:39], v[20:23]
  s_waitcnt lgkmcnt(0)
  v_mfma_f32_16x16x32_bf16 v[12:15], a[244:247], v[40:43], v[12:15]
  buffer_load_dwordx4 v0, s[8:11], s43 offen offset:3072 sc1 lds
  v_mfma_f32_16x16x32_bf16 v[16:19], a[248:251], v[40:43], v[16:19]
  v_mfma_f32_16x16x32_bf16 v[20:23], a[252:255], v[40:43], v[20:23]
  s_branch Ldn_tj
Ldn_tn:
  v_mfma_f32_16x16x32_bf16 v[12:15], a[64:67], v[28:31], v[12:15]
  v_mfma_f32_16x16x32_bf16 v[16:19], a[68:71], v[28:31], v[16:19]
  s_waitcnt vmcnt(12)
  ds_read2st64_b64 v[40:43], v44 offset0:46 offset1:47
  v_mfma_f32_16x16x32_bf16 v[20:23], a[72:75], v[28:31], v[20:23]
  v_mfma_f32_16x16x32_bf16 v[12:15], a[76:79], v[32:35], v[12:15]
  v_mfma_f32_16x16x32_bf16 v[16:19], a[80:83], v[32:35], v[16:19]
  s_waitcnt vmcnt(11)
  ds_read2st64_b64 v[28:31], v44 offset0:48 offset1:49
  v_mfma_f32_16x16x32_bf16 v[20:23], a[84:87], v[32:35], v[20:23]
  v_mfma_f32_16x16x32_bf16 v[12:15], a[88:91], v[36:39], v[12:15]
  v_mfma_f32_16x16x32_bf16 v[16:19], a[92:95], v[36:39], v[16:19]
  s_waitcnt vmcnt(10)
  ds_read2st64_b64 v[32:35], v44 offset0:50 offset1:51
  v_mfma_f32_16x16x32_bf16 v[20:23], a[96:99], v[36:39], v[20:23]
  s_waitcnt lgkmcnt(2)
  v_mfma_f32_16x16x32_bf16 v[12:15], a[100:103], v[40:43], v[12:15]
  v_mfma_f32_16x16x32_bf16 v[16:19], a[104:107], v[40:43], v[16:19]
  s_waitcnt vmcnt(9)
  ds_read2st64_b64 v[36:39], v44 offset0:52 offset1:53
  v_mfma_f32_16x16x32_bf16 v[20:23], a[108:111], v[40:43], v[20:23]
  s_waitcnt lgkmcnt(2)
  v_mfma_f32_16x16x32_bf16 v[12:15], a[112:115], v[28:31], v[12:15]
  v_mfma_f32_16x16x32_bf16 v[16:19], a[116:119], v[28:31], v[16:19]
  s_waitcnt vmcnt(8)
  ds_read2st64_b64 v[40:43], v44 offset0:54 offset1:55
  v_mfma_f32_16x16x32_bf16 v[20:23], a[120:123], v[28:31], v[20:23]
  s_waitcnt lgkmcnt(2)
  v_mfma_f32_16x16x32_bf16 v[12:15], a[124:127], v[32:35], v[12:15]
  v_mfma_f32_16x16x32_bf16 v[16:19], a[128:131], v[32:35], v[16:19]
  s_waitcnt vmcnt(7)
  ds_read2st64_b64 v[28:31], v44 offset0:56 offset1:57
  v_mfma_f32_16x16x32_bf16 v[20:23], a[132:135], v[32:35], v[20:23]
  s_waitcnt lgkmcnt(2)
  v_mfma_f32_16x16x32_bf16 v[12:15], a[136:139], v[36:39], v[12:15]
  v_mfma_f32_16x16x32_bf16 v[16:19], a[140:143], v[36:39], v[16:19]
  s_waitcnt vmcnt(6)
  ds_read2st64_b64 v[32:35], v44 offset0:58 offset1:59
  v_mfma_f32_16x16x32_bf16 v[20:23], a[144:147], v[36:39], v[20:23]
  s_waitcnt lgkmcnt(2)
  v_mfma_f32_16x16x32_bf16 v[12:15], a[148:151], v[40:43], v[12:15]
  v_mfma_f32_16x16x32_bf16 v[16:19], a[152:155], v[40:43], v[16:19]
  s_lshr_b32 s45, s18, 1
  s_add_u32 s45, s45, 1
  s_mov_b32 s44, 28672
  buffer_load_dword v26, v4, s[8:11], s44 offen sc1
  buffer_load_dword v27, v7, s[8:11], s44 offen sc1
  s_waitcnt vmcnt(7)
  ds_read2st64_b64 v[36:39], v44 offset0:60 offset1:61
  v_mfma_f32_16x16x32_bf16 v[20:23], a[156:159], v[40:43], v[20:23]
  s_waitcnt lgkmcnt(2)
  v_mfma_f32_16x16x32_bf16 v[12:15], a[160:163], v[28:31], v[12:15]
  v_mfma_f32_16x16x32_bf16 v[16:19], a[164:167], v[28:31], v[16:19]
  s_waitcnt vmcnt(6)
  ds_read2st64_b64 v[40:43], v44 offset0:62 offset1:63
  v_mfma_f32_16x16x32_bf16 v[20:23], a[168:171], v[28:31], v[20:23]
  s_waitcnt lgkmcnt(2)
  v_mfma_f32_16x16x32_bf16 v[12:15], a[172:175], v[32:35], v[12:15]
  v_mfma_f32_16x16x32_bf16 v[16:19], a[176:179], v[32:35], v[16:19]
  s_waitcnt vmcnt(5)
  ds_read2st64_b64 v[28:31], v44 offset0:64 offset1:65
  v_mfma_f32_16x16x32_bf16 v[20:23], a[180:183], v[32:35], v[20:23]
  s_waitcnt lgkmcnt(2)
  v_mfma_f32_16x16x32_bf16 v[12:15], a[184:187], v[36:39], v[12:15]
  v_mfma_f32_16x16x32_bf16 v[16:19], a[188:191], v[36:39], v[16:19]
  s_waitcnt vmcnt(4)
  ds_read2st64_b64 v[32:35], v44 offset0:66 offset1:67
  v_mfma_f32_16x16x32_bf16 v[20:23], a[192:195], v[36:39], v[20:23]
  s_waitcnt lgkmcnt(2)
  v_mfma_f32_16x16x32_bf16 v[12:15], a[196:199], v[40:43], v[12:15]
  v_mfma_f32_16x16x32_bf16 v[16:19], a[200:203], v[40:43], v[16:19]
  s_waitcnt vmcnt(3)
  ds_read2st64_b64 v[36:39], v44 offset0:68 offset1:69
  v_mfma_f32_16x16x32_bf16 v[20:23], a[204:207], v[40:43], v[20:23]
  s_waitcnt lgkmcnt(2)
  v_mfma_f32_16x16x32_bf16 v[12:15], a[208:211], v[28:31], v[12:15]
  v_mfma_f32_16x16x32_bf16 v[16:19], a[212:215], v[28:31], v[16:19]
  s_waitcnt vmcnt(2)
  ds_read2st64_b64 v[40:43], v44 offset0:70 offset1:71
  v_mfma_f32_16x16x32_bf16 v[20:23], a[216:219], v[28:31], v[20:23]
  s_waitcnt lgkmcnt(2)
  v_mfma_f32_16x16x32_bf16 v[12:15], a[220:223], v[32:35], v[12:15]
  v_mfma_f32_16x16x32_bf16 v[16:19], a[224:227], v[32:35], v[16:19]
  v_mfma_f32_16x16x32_bf16 v[20:23], a[228:231], v[32:35], v[20:23]
  s_waitcnt lgkmcnt(1)
  v_mfma_f32_16x16x32_bf16 v[12:15], a[232:235], v[36:39], v[12:15]
  v_mfma_f32_16x16x32_bf16 v[16:19], a[236:239], v[36:39], v[16:19]
  v_mfma_f32_16x16x32_bf16 v[20:23], a[240:243], v[36:39], v[20:23]
  s_waitcnt lgkmcnt(0)
  v_mfma_f32_16x16x32_bf16 v[12:15], a[244:247], v[40:43], v[12:15]
  v_mfma_f32_16x16x32_bf16 v[16:19], a[248:251], v[40:43], v[16:19]
  v_mfma_f32_16x16x32_bf16 v[20:23], a[252:255], v[40:43], v[20:23]
  s_waitcnt vmcnt(0)
  s_cmp_eq_u32 s13, 3
  s_cbranch_scc0 Lw3_65
  v_min_u32 v26, v26, v27
  v_cmp_gt_u32 vcc, s35, v26
  s_cmp_eq_u64 vcc, 0
  s_cselect_b32 s42, 1, 0
  s_cmp_ge_u32 s18, 128
  s_cselect_b32 s42, 0, s42
  v_mov_b32 v26, 160004
  v_mov_b32 v27, s42
  ds_write_b32 v26, v27
  s_waitcnt lgkmcnt(0)
Lw3_65:
Ldn_tj:
  s_mul_i32 s42, s13, 3072
  s_add_u32 s42, s42, 147456
  v_add_u32 v5, s42, v0
  ds_write_b128 v5, v[12:15] offset:0
  ds_write_b128 v5, v[16:19] offset:1024
  s_nop 1
  ds_write_b128 v5, v[20:23] offset:2048
  s_waitcnt lgkmcnt(0)
  s_barrier
  v_mov_b32 v26, 160004
  ds_read_b32 v27, v26
  ds_read_b128 v[28:31], v1 offset:0
  ds_read_b128 v[32:35], v1 offset:3072
  ds_read_b128 v[36:39], v1 offset:6144
  ds_read_b128 v[40:43], v1 offset:9216
  v_lshlrev_b32 v12, 16, v24
  v_and_b32 v13, 0xffff0000, v24
  v_lshlrev_b32 v14, 16, v25
  v_and_b32 v15, 0xffff0000, v25
  s_waitcnt lgkmcnt(2)
  v_add_f32 v28, v28, v32
  s_waitcnt lgkmcnt(0)
  v_add_f32 v36, v36, v40
  v_add_f32 v29, v29, v33
  v_add_f32 v37, v37, v41
  v_add_f32 v30, v30, v34
  v_add_f32 v38, v38, v42
  v_add_f32 v31, v31, v35
  v_add_f32 v39, v39, v43
  v_add_f32 v28, v28, v36
  v_add_f32 v29, v29, v37
  v_add_f32 v30, v30, v38
  v_add_f32 v31, v31, v39
  v_fmac_f32 v12, v28, v8
  v_fmac_f32 v13, v29, v9
  v_fmac_f32 v14, v30, v10
  v_fmac_f32 v15, v31, v11
  v_cvt_pk_bf16_f32 v24, v12, v13
  v_cvt_pk_bf16_f32 v25, v14, v15
  s_mov_b64 exec, s[28:29]
  buffer_store_dwordx2 v[24:25], v3, s[4:7], s23 offen
  s_mov_b64 exec, -1
  s_cmp_eq_u32 s33, 1
  s_cbranch_scc1 Ldn_loop
  v_readfirstlane_b32 s33, v27
  s_lshl_b32 s33, s33, 1
  s_cbranch_scc1 Ldn_go
  s_cmp_ge_u32 s18, 128
  s_cbranch_scc1 Ldn_end
  s_cmp_eq_u32 s13, 3
  s_cbranch_scc0 Low_66
  s_lshr_b32 s45, s18, 1
  s_add_u32 s45, s45, 1
  s_mov_b32 s44, 28672
Lp_67:
  buffer_load_dword v26, v4, s[8:11], s44 offen sc1
  buffer_load_dword v27, v7, s[8:11], s44 offen sc1
  s_waitcnt vmcnt(0)
  v_min_u32 v26, v26, v27
  v_cmp_gt_u32 vcc, s45, v26
  s_cbranch_vccz Lpo_68
  s_sleep 2
  s_sub_u32 s15, s15, 1
  s_cbranch_scc0 Lp_67
  s_mov_b32 s15, 0
Lpo_68:
Low_66:
  s_barrier
Ldn_go:
  s_add_u32 s43, s20, 0
  s_add_u32 m0, s30, 0
  s_nop 0
  buffer_load_dwordx4 v0, s[8:11], s43 offen offset:0 sc1 lds
  buffer_load_dwordx4 v0, s[8:11], s43 offen offset:1024 sc1 lds
  buffer_load_dwordx4 v0, s[8:11], s43 offen offset:2048 sc1 lds
  buffer_load_dwordx4 v0, s[8:11], s43 offen offset:3072 sc1 lds
  s_add_u32 s43, s20, 4096
  s_add_u32 m0, s30, 4096
  s_nop 0
  buffer_load_dwordx4 v0, s[8:11], s43 offen offset:0 sc1 lds
  buffer_load_dwordx4 v0, s[8:11], s43 offen offset:1024 sc1 lds
  buffer_load_dwordx4 v0, s[8:11], s43 offen offset:2048 sc1 lds
  buffer_load_dwordx4 v0, s[8:11], s43 offen offset:3072 sc1 lds
  s_add_u32 s43, s20, 8192
  s_add_u32 m0, s30, 8192
  s_nop 0
  buffer_load_dwordx4 v0, s[8:11], s43 offen offset:0 sc1 lds
  buffer_load_dwordx4 v0, s[8:11], s43 offen offset:1024 sc1 lds
  buffer_load_dwordx4 v0, s[8:11], s43 offen offset:2048 sc1 lds
  buffer_load_dwordx4 v0, s[8:11], s43 offen offset:3072 sc1 lds
  s_add_u32 s43, s20, 12288
  s_add_u32 m0, s30, 12288
  s_nop 0
  buffer_load_dwordx4 v0, s[8:11], s43 offen offset:0 sc1 lds
  buffer_load_dwordx4 v0, s[8:11], s43 offen offset:1024 sc1 lds
  buffer_load_dwordx4 v0, s[8:11], s43 offen offset:2048 sc1 lds
  buffer_load_dwordx4 v0, s[8:11], s43 offen offset:3072 sc1 lds
  s_branch Ldn_loop
Ldn_end:
  s_branch Lend
Lqkva:
  s_getpc_b64 s[20:21]
Lpc_69:
  s_add_u32 s20, s20, Lpf1-Lpc_69
  s_addc_u32 s21, s21, 0
  v_and_b32 v251, 63, v0
  v_lshlrev_b32 v251, 6, v251
  s_lshl_b32 s22, s13, 12
  v_add_u32 v251, s22, v251
  global_load_dword v250, v251, s[20:21]
  v_add_u32 v251, 16384, v251
  global_load_dword v250, v251, s[20:21]
Lpf1:
  s_and_b32 s14, s12, 1
  s_lshr_b32 s12, s12, 1
  s_sub_u32 s42, s3, 1
  s_lshl_b32 s42, s42, 4
  s_add_u32 s12, s12, s42
  v_and_b32 v1, 63, v0
  v_lshlrev_b32 v72, 4, v1
  v_and_b32 v2, 31, v1
  v_lshrrev_b32 v3, 5, v1
  v_lshlrev_b32 v4, 8, v3
  s_lshl_b32 s42, s13, 10
  v_add_u32 v4, s42, v4
  v_bfe_u32 v5, v2, 3, 1
  v_lshl_add_u32 v6, v5, 12, v4
  v_lshrrev_b32 v7, 4, v2
  v_and_b32 v8, 7, v2
  v_lshl_add_u32 v8, v7, 3, v8
  v_lshl_add_u32 v73, v8, 4, v6
  v_lshl_add_u32 v6, v7, 12, v4
  v_and_b32 v8, 15, v2
  v_lshl_add_u32 v74, v8, 4, v6
  v_add_u32 v6, s42, v4
  v_lshl_add_u32 v6, v7, 10, v6
  v_lshl_add_u32 v75, v8, 4, v6
  v_lshrrev_b32 v5, 4, v1
  v_and_b32 v6, 7, v1
  v_lshlrev_b32 v6, 4, v6
  v_lshl_add_u32 v76, v5, 7, v6
  s_mov_b32 s20, 0x3e0293ee
  v_lshrrev_b32 v6, 1, v5
  v_lshlrev_b32 v6, 4, v6
  v_and_b32 v7, 1, v5
  v_lshl_add_u32 v6, v7, 2, v6
  v_and_b32 v7, 15, v1
  s_and_b32 s42, s13, 1
  s_lshl_b32 s42, s42, 4
  v_add_u32 v7, s42, v7
  v_sub_u32 v7, v7, v6
  s_lshl_b32 s42, s14, 5
  s_add_u32 s42, s42, s12
  s_lshl_b32 s24, s42, 7
  s_add_u32 s24, s24, 0
  s_lshl_b32 s42, s42, 7
  s_add_u32 s25, s42, 12288
  s_lshl_b32 s42, s12, 7
  s_add_u32 s26, s42, 8192
  v_cmp_le_i32 s[64:65], 0, v7
  v_cmp_le_i32 s[66:67], 1, v7
  v_cmp_le_i32 s[68:69], 2, v7
  v_cmp_le_i32 s[70:71], 3, v7
  v_cmp_le_i32 s[72:73], 8, v7
  v_cmp_le_i32 s[74:75], 9, v7
  v_cmp_le_i32 s[76:77], 10, v7
  v_cmp_le_i32 s[78:79], 11, v7
  s_mov_b32 s18, 0
  s_mov_b32 s19, 0
  s_mov_b32 s30, 0
  s_mov_b32 s31, 0
  s_mul_i32 s21, s14, 36864
  s_add_u32 s21, s21, 2097152
  s_lshl_b32 s42, s14, 5
  s_add_u32 s42, s42, s12
  s_lshl_b32 s22, s42, 13
  s_add_u32 s22, s22, 33554432
  s_lshl_b32 s28, s42, 12
  s_add_u32 s28, s28, 8388608
  s_mov_b32 s32, s28
  s_mov_b32 s33, 0
  s_mov_b32 s23, 73728
  s_mov_b32 s29, 73728
  s_lshl_b32 s27, s14, 1
  s_and_b32 s42, s13, 1
  s_add_u32 s27, s27, s42
  s_lshl_b32 s27, s27, 17
  s_lshl_b32 s42, s12, 12
  s_add_u32 s27, s27, s42
  s_lshr_b32 s42, s13, 1
  s_lshl_b32 s42, s42, 11
  s_add_u32 s27, s27, s42
  s_add_u32 s27, s27, 67108864
  v_and_b32 v13, 0x1f0, v72
  v_lshlrev_b32 v13, 4, v13
  v_mov_b32 v14, 0
  s_lshl_b32 s34, s14, 7
  s_add_u32 s34, s34, 47872
  v_lshrrev_b32 v1, 4, v72
  v_lshrrev_b32 v2, 4, v1
  v_and_b32 v3, 15, v1
  v_lshrrev_b32 v4, 2, v3
  v_xor_b32 v6, v4, v2
  v_lshlrev_b32 v6, 6, v6
  v_and_b32 v7, 3, v3
  v_lshl_add_u32 v6, v7, 4, v6
  v_lshl_add_u32 v8, v2, 13, v6
  v_lshrrev_b32 v5, 1, v2
  v_lshl_add_u32 v5, v5, 3, v4
  v_lshlrev_b32 v5, 8, v5
  v_xor_b32 v6, s13, v4
  v_lshl_add_u32 v5, v6, 6, v5
  v_and_b32 v6, 1, v2
  v_lshl_add_u32 v5, v6, 5, v5
  v_lshl_add_u32 v9, v7, 3, v5
  s_load_dwordx2 s[80:81], s[0:1], 16
  s_mov_b32 s82, 4718592
  s_mov_b32 s83, 0x20000
  s_load_dwordx2 s[84:85], s[0:1], 24
  s_mov_b32 s86, 4718592
  s_mov_b32 s87, 0x20000
  s_load_dwordx2 s[88:89], s[0:1], 32
  s_mov_b32 s90, 4718592
  s_mov_b32 s91, 0x20000
  s_lshl_b32 s92, s13, 17
  s_lshl_b32 s43, s12, 8
  s_add_u32 s92, s92, s43
  s_lshl_b32 s93, s13, 12
  s_waitcnt lgkmcnt(0)
Lq_w0:
  s_cmp_eq_u32 s14, 1
  s_cbranch_scc1 Lq_w1
  s_add_u32 m0, s93, 0
  s_add_u32 s42, s92, 0
  buffer_load_dwordx4 v8, s[84:87], s42 offen lds
  s_add_u32 m0, s93, 1024
  s_add_u32 s42, s92, 32768
  buffer_load_dwordx4 v8, s[84:87], s42 offen lds
  s_add_u32 m0, s93, 2048
  s_add_u32 s42, s92, 65536
  buffer_load_dwordx4 v8, s[84:87], s42 offen lds
  s_add_u32 m0, s93, 3072
  s_add_u32 s42, s92, 98304
  buffer_load_dwordx4 v8, s[84:87], s42 offen lds
  s_add_u32 m0, s93, 16384
  s_add_u32 s42, s92, 524288
  buffer_load_dwordx4 v8, s[84:87], s42 offen lds
  s_add_u32 m0, s93, 17408
  s_add_u32 s42, s92, 557056
  buffer_load_dwordx4 v8, s[84:87], s42 offen lds
  s_add_u32 m0, s93, 18432
  s_add_u32 s42, s92, 589824
  buffer_load_dwordx4 v8, s[84:87], s42 offen lds
  s_add_u32 m0, s93, 19456
  s_add_u32 s42, s92, 622592
  buffer_load_dwordx4 v8, s[84:87], s42 offen lds
  s_add_u32 m0, s93, 32768
  s_add_u32 s42, s92, 1048576
  buffer_load_dwordx4 v8, s[84:87], s42 offen lds
  s_add_u32 m0, s93, 33792
  s_add_u32 s42, s92, 1081344
  buffer_load_dwordx4 v8, s[84:87], s42 offen lds
  s_add_u32 m0, s93, 34816
  s_add_u32 s42, s92, 1114112
  buffer_load_dwordx4 v8, s[84:87], s42 offen lds
  s_add_u32 m0, s93, 35840
  s_add_u32 s42, s92, 1146880
  buffer_load_dwordx4 v8, s[84:87], s42 offen lds
  s_add_u32 m0, s93, 49152
  s_add_u32 s42, s92, 1572864
  buffer_load_dwordx4 v8, s[84:87], s42 offen lds
  s_add_u32 m0, s93, 50176
  s_add_u32 s42, s92, 1605632
  buffer_load_dwordx4 v8, s[84:87], s42 offen lds
  s_add_u32 m0, s93, 51200
  s_add_u32 s42, s92, 1638400
  buffer_load_dwordx4 v8, s[84:87], s42 offen lds
  s_add_u32 m0, s93, 52224
  s_add_u32 s42, s92, 1671168
  buffer_load_dwordx4 v8, s[84:87], s42 offen lds
  s_add_u32 m0, s93, 65536
  s_add_u32 s42, s92, 2097152
  buffer_load_dwordx4 v8, s[84:87], s42 offen lds
  s_add_u32 m0, s93, 66560
  s_add_u32 s42, s92, 2129920
  buffer_load_dwordx4 v8, s[84:87], s42 offen lds
  s_add_u32 m0, s93, 67584
  s_add_u32 s42, s92, 2162688
  buffer_load_dwordx4 v8, s[84:87], s42 offen lds
  s_add_u32 m0, s93, 68608
  s_add_u32 s42, s92, 2195456
  buffer_load_dwordx4 v8, s[84:87], s42 offen lds
  s_add_u32 m0, s93, 81920
  s_add_u32 s42, s92, 2621440
  buffer_load_dwordx4 v8, s[84:87], s42 offen lds
  s_add_u32 m0, s93, 82944
  s_add_u32 s42, s92, 2654208
  buffer_load_dwordx4 v8, s[84:87], s42 offen lds
  s_add_u32 m0, s93, 83968
  s_add_u32 s42, s92, 2686976
  buffer_load_dwordx4 v8, s[84:87], s42 offen lds
  s_add_u32 m0, s93, 84992
  s_add_u32 s42, s92, 2719744
  buffer_load_dwordx4 v8, s[84:87], s42 offen lds
  s_add_u32 m0, s93, 98304
  s_add_u32 s42, s92, 3145728
  buffer_load_dwordx4 v8, s[84:87], s42 offen lds
  s_add_u32 m0, s93, 99328
  s_add_u32 s42, s92, 3178496
  buffer_load_dwordx4 v8, s[84:87], s42 offen lds
  s_add_u32 m0, s93, 100352
  s_add_u32 s42, s92, 3211264
  buffer_load_dwordx4 v8, s[84:87], s42 offen lds
  s_add_u32 m0, s93, 101376
  s_add_u32 s42, s92, 3244032
  buffer_load_dwordx4 v8, s[84:87], s42 offen lds
  s_add_u32 m0, s93, 114688
  s_add_u32 s42, s92, 3670016
  buffer_load_dwordx4 v8, s[84:87], s42 offen lds
  s_add_u32 m0, s93, 115712
  s_add_u32 s42, s92, 3702784
  buffer_load_dwordx4 v8, s[84:87], s42 offen lds
  s_add_u32 m0, s93, 116736
  s_add_u32 s42, s92, 3735552
  buffer_load_dwordx4 v8, s[84:87], s42 offen lds
  s_add_u32 m0, s93, 117760
  s_add_u32 s42, s92, 3768320
  buffer_load_dwordx4 v8, s[84:87], s42 offen lds
  s_add_u32 m0, s93, 131072
  s_add_u32 s42, s92, 4194304
  buffer_load_dwordx4 v8, s[84:87], s42 offen lds
  s_add_u32 m0, s93, 132096
  s_add_u32 s42, s92, 4227072
  buffer_load_dwordx4 v8, s[84:87], s42 offen lds
  s_add_u32 m0, s93, 133120
  s_add_u32 s42, s92, 4259840
  buffer_load_dwordx4 v8, s[84:87], s42 offen lds
  s_add_u32 m0, s93, 134144
  s_add_u32 s42, s92, 4292608
  buffer_load_dwordx4 v8, s[84:87], s42 offen lds
  s_add_u32 m0, s93, 147456
  s_add_u32 s42, s92, 0
  buffer_load_dwordx4 v8, s[88:91], s42 offen lds
  s_add_u32 m0, s93, 148480
  s_add_u32 s42, s92, 32768
  buffer_load_dwordx4 v8, s[88:91], s42 offen lds
  s_add_u32 m0, s93, 149504
  s_add_u32 s42, s92, 65536
  buffer_load_dwordx4 v8, s[88:91], s42 offen lds
  s_add_u32 m0, s93, 150528
  s_add_u32 s42, s92, 98304
  buffer_load_dwordx4 v8, s[88:91], s42 offen lds
  s_waitcnt vmcnt(36) lgkmcnt(0)
  s_barrier
  v_add_u32 v10, 0, v9
  ds_read_b64_tr_b16 v[80:81], v10 offset:0
  ds_read_b64_tr_b16 v[82:83], v10 offset:1024
  ds_read_b64_tr_b16 v[84:85], v10 offset:4096
  ds_read_b64_tr_b16 v[86:87], v10 offset:5120
  ds_read_b64_tr_b16 v[88:89], v10 offset:8192
  ds_read_b64_tr_b16 v[90:91], v10 offset:9216
  ds_read_b64_tr_b16 v[92:93], v10 offset:12288
  ds_read_b64_tr_b16 v[94:95], v10 offset:13312
  s_waitcnt vmcnt(32) lgkmcnt(0)
  s_barrier
  s_add_u32 m0, s93, 0
  s_add_u32 s42, s92, 524288
  buffer_load_dwordx4 v8, s[88:91], s42 offen lds
  s_add_u32 m0, s93, 1024
  s_add_u32 s42, s92, 557056
  buffer_load_dwordx4 v8, s[88:91], s42 offen lds
  s_add_u32 m0, s93, 2048
  s_add_u32 s42, s92, 589824
  buffer_load_dwordx4 v8, s[88:91], s42 offen lds
  s_add_u32 m0, s93, 3072
  s_add_u32 s42, s92, 622592
  buffer_load_dwordx4 v8, s[88:91], s42 offen lds
  v_add_u32 v10, 16384, v9
  ds_read_b64_tr_b16 v[96:97], v10 offset:0
  ds_read_b64_tr_b16 v[98:99], v10 offset:1024
  ds_read_b64_tr_b16 v[100:101], v10 offset:4096
  ds_read_b64_tr_b16 v[102:103], v10 offset:5120
  ds_read_b64_tr_b16 v[104:105], v10 offset:8192
  ds_read_b64_tr_b16 v[106:107], v10 offset:9216
  ds_read_b64_tr_b16 v[108:109], v10 offset:12288
  ds_read_b64_tr_b16 v[110:111], v10 offset:13312
  s_waitcnt vmcnt(32) lgkmcnt(0)
  s_barrier
  s_add_u32 m0, s93, 16384
  s_add_u32 s42, s92, 1048576
  buffer_load_dwordx4 v8, s[88:91], s42 offen lds
  s_add_u32 m0, s93, 17408
  s_add_u32 s42, s92, 1081344
  buffer_load_dwordx4 v8, s[88:91], s42 offen lds
  s_add_u32 m0, s93, 18432
  s_add_u32 s42, s92, 1114112
  buffer_load_dwordx4 v8, s[88:91], s42 offen lds
  s_add_u32 m0, s93, 19456
  s_add_u32 s42, s92, 1146880
  buffer_load_dwordx4 v8, s[88:91], s42 offen lds
  v_add_u32 v10, 32768, v9
  ds_read_b64_tr_b16 v[112:113], v10 offset:0
  ds_read_b64_tr_b16 v[114:115], v10 offset:1024
  ds_read_b64_tr_b16 v[116:117], v10 offset:4096
  ds_read_b64_tr_b16 v[118:119], v10 offset:5120
  ds_read_b64_tr_b16 v[120:121], v10 offset:8192
  ds_read_b64_tr_b16 v[122:123], v10 offset:9216
  ds_read_b64_tr_b16 v[124:125], v10 offset:12288
  ds_read_b64_tr_b16 v[126:127], v10 offset:13312
  s_waitcnt vmcnt(32) lgkmcnt(0)
  s_barrier
  s_add_u32 m0, s93, 32768
  s_add_u32 s42, s92, 1572864
  buffer_load_dwordx4 v8, s[88:91], s42 offen lds
  s_add_u32 m0, s93, 33792
  s_add_u32 s42, s92, 1605632
  buffer_load_dwordx4 v8, s[88:91], s42 offen lds
  s_add_u32 m0, s93, 34816
  s_add_u32 s42, s92, 1638400
  buffer_load_dwordx4 v8, s[88:91], s42 offen lds
  s_add_u32 m0, s93, 35840
  s_add_u32 s42, s92, 1671168
  buffer_load_dwordx4 v8, s[88:91], s42 offen lds
  v_add_u32 v10, 49152, v9
  ds_read_b64_tr_b16 v[128:129], v10 offset:0
  ds_read_b64_tr_b16 v[130:131], v10 offset:1024
  ds_read_b64_tr_b16 v[132:133], v10 offset:4096
  ds_read_b64_tr_b16 v[134:135], v10 offset:5120
  ds_read_b64_tr_b16 v[136:137], v10 offset:8192
  ds_read_b64_tr_b16 v[138:139], v10 offset:9216
  ds_read_b64_tr_b16 v[140:141], v10 offset:12288
  ds_read_b64_tr_b16 v[142:143], v10 offset:13312
  s_waitcnt vmcnt(32) lgkmcnt(0)
  s_barrier
  s_add_u32 m0, s93, 49152
  s_add_u32 s42, s92, 2097152
  buffer_load_dwordx4 v8, s[88:91], s42 offen lds
  s_add_u32 m0, s93, 50176
  s_add_u32 s42, s92, 2129920
  buffer_load_dwordx4 v8, s[88:91], s42 offen lds
  s_add_u32 m0, s93, 51200
  s_add_u32 s42, s92, 2162688
  buffer_load_dwordx4 v8, s[88:91], s42 offen lds
  s_add_u32 m0, s93, 52224
  s_add_u32 s42, s92, 2195456
  buffer_load_dwordx4 v8, s[88:91], s42 offen lds
  v_add_u32 v10, 65536, v9
  ds_read_b64_tr_b16 v[144:145], v10 offset:0
  ds_read_b64_tr_b16 v[146:147], v10 offset:1024
  ds_read_b64_tr_b16 v[148:149], v10 offset:4096
  ds_read_b64_tr_b16 v[150:151], v10 offset:5120
  ds_read_b64_tr_b16 v[152:153], v10 offset:8192
  ds_read_b64_tr_b16 v[154:155], v10 offset:9216
  ds_read_b64_tr_b16 v[156:157], v10 offset:12288
  ds_read_b64_tr_b16 v[158:159], v10 offset:13312
  s_waitcnt vmcnt(32) lgkmcnt(0)
  s_barrier
  s_add_u32 m0, s93, 65536
  s_add_u32 s42, s92, 2621440
  buffer_load_dwordx4 v8, s[88:91], s42 offen lds
  s_add_u32 m0, s93, 66560
  s_add_u32 s42, s92, 2654208
  buffer_load_dwordx4 v8, s[88:91], s42 offen lds
  s_add_u32 m0, s93, 67584
  s_add_u32 s42, s92, 2686976
  buffer_load_dwordx4 v8, s[88:91], s42 offen lds
  s_add_u32 m0, s93, 68608
  s_add_u32 s42, s92, 2719744
  buffer_load_dwordx4 v8, s[88:91], s42 offen lds
  v_add_u32 v10, 81920, v9
  ds_read_b64_tr_b16 v[160:161], v10 offset:0
  ds_read_b64_tr_b16 v[162:163], v10 offset:1024
  ds_read_b64_tr_b16 v[164:165], v10 offset:4096
  ds_read_b64_tr_b16 v[166:167], v10 offset:5120
  ds_read_b64_tr_b16 v[168:169], v10 offset:8192
  ds_read_b64_tr_b16 v[170:171], v10 offset:9216
  ds_read_b64_tr_b16 v[172:173], v10 offset:12288
  ds_read_b64_tr_b16 v[174:175], v10 offset:13312
  s_waitcnt vmcnt(32) lgkmcnt(0)
  s_barrier
  s_add_u32 m0, s93, 81920
  s_add_u32 s42, s92, 3145728
  buffer_load_dwordx4 v8, s[88:91], s42 offen lds
  s_add_u32 m0, s93, 82944
  s_add_u32 s42, s92, 3178496
  buffer_load_dwordx4 v8, s[88:91], s42 offen lds
  s_add_u32 m0, s93, 83968
  s_add_u32 s42, s92, 3211264
  buffer_load_dwordx4 v8, s[88:91], s42 offen lds
  s_add_u32 m0, s93, 84992
  s_add_u32 s42, s92, 3244032
  buffer_load_dwordx4 v8, s[88:91], s42 offen lds
  v_add_u32 v10, 98304, v9
  ds_read_b64_tr_b16 v[176:177], v10 offset:0
  ds_read_b64_tr_b16 v[178:179], v10 offset:1024
  ds_read_b64_tr_b16 v[180:181], v10 offset:4096
  ds_read_b64_tr_b16 v[182:183], v10 offset:5120
  ds_read_b64_tr_b16 v[184:185], v10 offset:8192
  ds_read_b64_tr_b16 v[186:187], v10 offset:9216
  ds_read_b64_tr_b16 v[188:189], v10 offset:12288
  ds_read_b64_tr_b16 v[190:191], v10 offset:13312
  s_waitcnt vmcnt(32) lgkmcnt(0)
  s_barrier
  s_add_u32 m0, s93, 98304
  s_add_u32 s42, s92, 3670016
  buffer_load_dwordx4 v8, s[88:91], s42 offen lds
  s_add_u32 m0, s93, 99328
  s_add_u32 s42, s92, 3702784
  buffer_load_dwordx4 v8, s[88:91], s42 offen lds
  s_add_u32 m0, s93, 100352
  s_add_u32 s42, s92, 3735552
  buffer_load_dwordx4 v8, s[88:91], s42 offen lds
  s_add_u32 m0, s93, 101376
  s_add_u32 s42, s92, 3768320
  buffer_load_dwordx4 v8, s[88:91], s42 offen lds
  v_add_u32 v10, 114688, v9
  ds_read_b64_tr_b16 v[192:193], v10 offset:0
  ds_read_b64_tr_b16 v[194:195], v10 offset:1024
  ds_read_b64_tr_b16 v[196:197], v10 offset:4096
  ds_read_b64_tr_b16 v[198:199], v10 offset:5120
  ds_read_b64_tr_b16 v[200:201], v10 offset:8192
  ds_read_b64_tr_b16 v[202:203], v10 offset:9216
  ds_read_b64_tr_b16 v[204:205], v10 offset:12288
  ds_read_b64_tr_b16 v[206:207], v10 offset:13312
  s_waitcnt vmcnt(32) lgkmcnt(0)
  s_barrier
  s_add_u32 m0, s93, 114688
  s_add_u32 s42, s92, 4194304
  buffer_load_dwordx4 v8, s[88:91], s42 offen lds
  s_add_u32 m0, s93, 115712
  s_add_u32 s42, s92, 4227072
  buffer_load_dwordx4 v8, s[88:91], s42 offen lds
  s_add_u32 m0, s93, 116736
  s_add_u32 s42, s92, 4259840
  buffer_load_dwordx4 v8, s[88:91], s42 offen lds
  s_add_u32 m0, s93, 117760
  s_add_u32 s42, s92, 4292608
  buffer_load_dwordx4 v8, s[88:91], s42 offen lds
  v_add_u32 v10, 131072, v9
  ds_read_b64_tr_b16 v[208:209], v10 offset:0
  ds_read_b64_tr_b16 v[210:211], v10 offset:1024
  ds_read_b64_tr_b16 v[212:213], v10 offset:4096
  ds_read_b64_tr_b16 v[214:215], v10 offset:5120
  ds_read_b64_tr_b16 v[216:217], v10 offset:8192
  ds_read_b64_tr_b16 v[218:219], v10 offset:9216
  ds_read_b64_tr_b16 v[220:221], v10 offset:12288
  ds_read_b64_tr_b16 v[222:223], v10 offset:13312
  s_waitcnt vmcnt(32) lgkmcnt(0)
  s_barrier
  s_add_u32 m0, s93, 131072
  s_add_u32 s42, s92, 0
  buffer_load_dwordx4 v8, s[80:83], s42 offen lds
  s_add_u32 m0, s93, 132096
  s_add_u32 s42, s92, 32768
  buffer_load_dwordx4 v8, s[80:83], s42 offen lds
  s_add_u32 m0, s93, 133120
  s_add_u32 s42, s92, 65536
  buffer_load_dwordx4 v8, s[80:83], s42 offen lds
  s_add_u32 m0, s93, 134144
  s_add_u32 s42, s92, 98304
  buffer_load_dwordx4 v8, s[80:83], s42 offen lds
  v_add_u32 v10, 147456, v9
  ds_read_b64_tr_b16 v[224:225], v10 offset:0
  ds_read_b64_tr_b16 v[226:227], v10 offset:1024
  ds_read_b64_tr_b16 v[228:229], v10 offset:4096
  ds_read_b64_tr_b16 v[230:231], v10 offset:5120
  ds_read_b64_tr_b16 v[232:233], v10 offset:8192
  ds_read_b64_tr_b16 v[234:235], v10 offset:9216
  ds_read_b64_tr_b16 v[236:237], v10 offset:12288
  ds_read_b64_tr_b16 v[238:239], v10 offset:13312
  s_waitcnt vmcnt(32) lgkmcnt(0)
  s_barrier
  s_add_u32 m0, s93, 147456
  s_add_u32 s42, s92, 524288
  buffer_load_dwordx4 v8, s[80:83], s42 offen lds
  s_add_u32 m0, s93, 148480
  s_add_u32 s42, s92, 557056
  buffer_load_dwordx4 v8, s[80:83], s42 offen lds
  s_add_u32 m0, s93, 149504
  s_add_u32 s42, s92, 589824
  buffer_load_dwordx4 v8, s[80:83], s42 offen lds
  s_add_u32 m0, s93, 150528
  s_add_u32 s42, s92, 622592
  buffer_load_dwordx4 v8, s[80:83], s42 offen lds
  v_add_u32 v10, 0, v9
  ds_read_b64_tr_b16 v[240:241], v10 offset:0
  ds_read_b64_tr_b16 v[242:243], v10 offset:1024
  ds_read_b64_tr_b16 v[244:245], v10 offset:4096
  ds_read_b64_tr_b16 v[246:247], v10 offset:5120
  ds_read_b64_tr_b16 v[248:249], v10 offset:8192
  ds_read_b64_tr_b16 v[250:251], v10 offset:9216
  ds_read_b64_tr_b16 v[252:253], v10 offset:12288
  ds_read_b64_tr_b16 v[254:255], v10 offset:13312
  s_waitcnt vmcnt(32) lgkmcnt(0)
  s_barrier
  s_add_u32 m0, s93, 0
  s_add_u32 s42, s92, 1048576
  buffer_load_dwordx4 v8, s[80:83], s42 offen lds
  s_add_u32 m0, s93, 1024
  s_add_u32 s42, s92, 1081344
  buffer_load_dwordx4 v8, s[80:83], s42 offen lds
  s_add_u32 m0, s93, 2048
  s_add_u32 s42, s92, 1114112
  buffer_load_dwordx4 v8, s[80:83], s42 offen lds
  s_add_u32 m0, s93, 3072
  s_add_u32 s42, s92, 1146880
  buffer_load_dwordx4 v8, s[80:83], s42 offen lds
  v_add_u32 v10, 16384, v9
  ds_read_b64_tr_b16 a[0:1], v10 offset:0
  ds_read_b64_tr_b16 a[2:3], v10 offset:1024
  ds_read_b64_tr_b16 a[4:5], v10 offset:4096
  ds_read_b64_tr_b16 a[6:7], v10 offset:5120
  ds_read_b64_tr_b16 a[8:9], v10 offset:8192
  ds_read_b64_tr_b16 a[10:11], v10 offset:9216
  ds_read_b64_tr_b16 a[12:13], v10 offset:12288
  ds_read_b64_tr_b16 a[14:15], v10 offset:13312
  s_waitcnt vmcnt(32) lgkmcnt(0)
  s_barrier
  s_add_u32 m0, s93, 16384
  s_add_u32 s42, s92, 1572864
  buffer_load_dwordx4 v8, s[80:83], s42 offen lds
  s_add_u32 m0, s93, 17408
  s_add_u32 s42, s92, 1605632
  buffer_load_dwordx4 v8, s[80:83], s42 offen lds
  s_add_u32 m0, s93, 18432
  s_add_u32 s42, s92, 1638400
  buffer_load_dwordx4 v8, s[80:83], s42 offen lds
  s_add_u32 m0, s93, 19456
  s_add_u32 s42, s92, 1671168
  buffer_load_dwordx4 v8, s[80:83], s42 offen lds
  v_add_u32 v10, 32768, v9
  ds_read_b64_tr_b16 a[16:17], v10 offset:0
  ds_read_b64_tr_b16 a[18:19], v10 offset:1024
  ds_read_b64_tr_b16 a[20:21], v10 offset:4096
  ds_read_b64_tr_b16 a[22:23], v10 offset:5120
  ds_read_b64_tr_b16 a[24:25], v10 offset:8192
  ds_read_b64_tr_b16 a[26:27], v10 offset:9216
  ds_read_b64_tr_b16 a[28:29], v10 offset:12288
  ds_read_b64_tr_b16 a[30:31], v10 offset:13312
  s_waitcnt vmcnt(32) lgkmcnt(0)
  s_barrier
  s_add_u32 m0, s93, 32768
  s_add_u32 s42, s92, 2097152
  buffer_load_dwordx4 v8, s[80:83], s42 offen lds
  s_add_u32 m0, s93, 33792
  s_add_u32 s42, s92, 2129920
  buffer_load_dwordx4 v8, s[80:83], s42 offen lds
  s_add_u32 m0, s93, 34816
  s_add_u32 s42, s92, 2162688
  buffer_load_dwordx4 v8, s[80:83], s42 offen lds
  s_add_u32 m0, s93, 35840
  s_add_u32 s42, s92, 2195456
  buffer_load_dwordx4 v8, s[80:83], s42 offen lds
  v_add_u32 v10, 49152, v9
  ds_read_b64_tr_b16 a[32:33], v10 offset:0
  ds_read_b64_tr_b16 a[34:35], v10 offset:1024
  ds_read_b64_tr_b16 a[36:37], v10 offset:4096
  ds_read_b64_tr_b16 a[38:39], v10 offset:5120
  ds_read_b64_tr_b16 a[40:41], v10 offset:8192
  ds_read_b64_tr_b16 a[42:43], v10 offset:9216
  ds_read_b64_tr_b16 a[44:45], v10 offset:12288
  ds_read_b64_tr_b16 a[46:47], v10 offset:13312
  s_waitcnt vmcnt(32) lgkmcnt(0)
  s_barrier
  s_add_u32 m0, s93, 49152
  s_add_u32 s42, s92, 2621440
  buffer_load_dwordx4 v8, s[80:83], s42 offen lds
  s_add_u32 m0, s93, 50176
  s_add_u32 s42, s92, 2654208
  buffer_load_dwordx4 v8, s[80:83], s42 offen lds
  s_add_u32 m0, s93, 51200
  s_add_u32 s42, s92, 2686976
  buffer_load_dwordx4 v8, s[80:83], s42 offen lds
  s_add_u32 m0, s93, 52224
  s_add_u32 s42, s92, 2719744
  buffer_load_dwordx4 v8, s[80:83], s42 offen lds
  v_add_u32 v10, 65536, v9
  ds_read_b64_tr_b16 a[48:49], v10 offset:0
  ds_read_b64_tr_b16 a[50:51], v10 offset:1024
  ds_read_b64_tr_b16 a[52:53], v10 offset:4096
  ds_read_b64_tr_b16 a[54:55], v10 offset:5120
  ds_read_b64_tr_b16 a[56:57], v10 offset:8192
  ds_read_b64_tr_b16 a[58:59], v10 offset:9216
  ds_read_b64_tr_b16 a[60:61], v10 offset:12288
  ds_read_b64_tr_b16 a[62:63], v10 offset:13312
  s_waitcnt vmcnt(32) lgkmcnt(0)
  s_barrier
  s_add_u32 m0, s93, 65536
  s_add_u32 s42, s92, 3145728
  buffer_load_dwordx4 v8, s[80:83], s42 offen lds
  s_add_u32 m0, s93, 66560
  s_add_u32 s42, s92, 3178496
  buffer_load_dwordx4 v8, s[80:83], s42 offen lds
  s_add_u32 m0, s93, 67584
  s_add_u32 s42, s92, 3211264
  buffer_load_dwordx4 v8, s[80:83], s42 offen lds
  s_add_u32 m0, s93, 68608
  s_add_u32 s42, s92, 3244032
  buffer_load_dwordx4 v8, s[80:83], s42 offen lds
  v_add_u32 v10, 81920, v9
  ds_read_b64_tr_b16 a[64:65], v10 offset:0
  ds_read_b64_tr_b16 a[66:67], v10 offset:1024
  ds_read_b64_tr_b16 a[68:69], v10 offset:4096
  ds_read_b64_tr_b16 a[70:71], v10 offset:5120
  ds_read_b64_tr_b16 a[72:73], v10 offset:8192
  ds_read_b64_tr_b16 a[74:75], v10 offset:9216
  ds_read_b64_tr_b16 a[76:77], v10 offset:12288
  ds_read_b64_tr_b16 a[78:79], v10 offset:13312
  s_waitcnt vmcnt(32) lgkmcnt(0)
  s_barrier
  s_add_u32 m0, s93, 81920
  s_add_u32 s42, s92, 3670016
  buffer_load_dwordx4 v8, s[80:83], s42 offen lds
  s_add_u32 m0, s93, 82944
  s_add_u32 s42, s92, 3702784
  buffer_load_dwordx4 v8, s[80:83], s42 offen lds
  s_add_u32 m0, s93, 83968
  s_add_u32 s42, s92, 3735552
  buffer_load_dwordx4 v8, s[80:83], s42 offen lds
  s_add_u32 m0, s93, 84992
  s_add_u32 s42, s92, 3768320
  buffer_load_dwordx4 v8, s[80:83], s42 offen lds
  v_add_u32 v10, 98304, v9
  ds_read_b64_tr_b16 a[80:81], v10 offset:0
  ds_read_b64_tr_b16 a[82:83], v10 offset:1024
  ds_read_b64_tr_b16 a[84:85], v10 offset:4096
  ds_read_b64_tr_b16 a[86:87], v10 offset:5120
  ds_read_b64_tr_b16 a[88:89], v10 offset:8192
  ds_read_b64_tr_b16 a[90:91], v10 offset:9216
  ds_read_b64_tr_b16 a[92:93], v10 offset:12288
  ds_read_b64_tr_b16 a[94:95], v10 offset:13312
  s_waitcnt vmcnt(32) lgkmcnt(0)
  s_barrier
  s_add_u32 m0, s93, 98304
  s_add_u32 s42, s92, 4194304
  buffer_load_dwordx4 v8, s[80:83], s42 offen lds
  s_add_u32 m0, s93, 99328
  s_add_u32 s42, s92, 4227072
  buffer_load_dwordx4 v8, s[80:83], s42 offen lds
  s_add_u32 m0, s93, 100352
  s_add_u32 s42, s92, 4259840
  buffer_load_dwordx4 v8, s[80:83], s42 offen lds
  s_add_u32 m0, s93, 101376
  s_add_u32 s42, s92, 4292608
  buffer_load_dwordx4 v8, s[80:83], s42 offen lds
  v_add_u32 v10, 114688, v9
  ds_read_b64_tr_b16 a[96:97], v10 offset:0
  ds_read_b64_tr_b16 a[98:99], v10 offset:1024
  ds_read_b64_tr_b16 a[100:101], v10 offset:4096
  ds_read_b64_tr_b16 a[102:103], v10 offset:5120
  ds_read_b64_tr_b16 a[104:105], v10 offset:8192
  ds_read_b64_tr_b16 a[106:107], v10 offset:9216
  ds_read_b64_tr_b16 a[108:109], v10 offset:12288
  ds_read_b64_tr_b16 a[110:111], v10 offset:13312
  s_waitcnt vmcnt(32) lgkmcnt(0)
  s_barrier
  global_load_dword v11, v14, s[16:17] sc0 sc1
  buffer_load_dword v12, v13, s[8:11], s34 offen sc1
  v_add_u32 v10, 131072, v9
  ds_read_b64_tr_b16 a[112:113], v10 offset:0
  ds_read_b64_tr_b16 a[114:115], v10 offset:1024
  ds_read_b64_tr_b16 a[116:117], v10 offset:4096
  ds_read_b64_tr_b16 a[118:119], v10 offset:5120
  ds_read_b64_tr_b16 a[120:121], v10 offset:8192
  ds_read_b64_tr_b16 a[122:123], v10 offset:9216
  ds_read_b64_tr_b16 a[124:125], v10 offset:12288
  ds_read_b64_tr_b16 a[126:127], v10 offset:13312
  s_waitcnt vmcnt(30) lgkmcnt(0)
  s_barrier
  v_add_u32 v10, 147456, v9
  ds_read_b64_tr_b16 a[128:129], v10 offset:0
  ds_read_b64_tr_b16 a[130:131], v10 offset:1024
  ds_read_b64_tr_b16 a[132:133], v10 offset:4096
  ds_read_b64_tr_b16 a[134:135], v10 offset:5120
  ds_read_b64_tr_b16 a[136:137], v10 offset:8192
  ds_read_b64_tr_b16 a[138:139], v10 offset:9216
  ds_read_b64_tr_b16 a[140:141], v10 offset:12288
  ds_read_b64_tr_b16 a[142:143], v10 offset:13312
  s_waitcnt vmcnt(26) lgkmcnt(0)
  s_barrier
  v_add_u32 v10, 0, v9
  ds_read_b64_tr_b16 a[144:145], v10 offset:0
  ds_read_b64_tr_b16 a[146:147], v10 offset:1024
  ds_read_b64_tr_b16 a[148:149], v10 offset:4096
  ds_read_b64_tr_b16 a[150:151], v10 offset:5120
  ds_read_b64_tr_b16 a[152:153], v10 offset:8192
  ds_read_b64_tr_b16 a[154:155], v10 offset:9216
  ds_read_b64_tr_b16 a[156:157], v10 offset:12288
  ds_read_b64_tr_b16 a[158:159], v10 offset:13312
  s_waitcnt vmcnt(22) lgkmcnt(0)
  s_barrier
  v_add_u32 v10, 16384, v9
  ds_read_b64_tr_b16 a[160:161], v10 offset:0
  ds_read_b64_tr_b16 a[162:163], v10 offset:1024
  ds_read_b64_tr_b16 a[164:165], v10 offset:4096
  ds_read_b64_tr_b16 a[166:167], v10 offset:5120
  ds_read_b64_tr_b16 a[168:169], v10 offset:8192
  ds_read_b64_tr_b16 a[170:171], v10 offset:9216
  ds_read_b64_tr_b16 a[172:173], v10 offset:12288
  ds_read_b64_tr_b16 a[174:175], v10 offset:13312
  s_waitcnt vmcnt(18) lgkmcnt(0)
  s_barrier
  v_add_u32 v10, 32768, v9
  ds_read_b64_tr_b16 a[176:177], v10 offset:0
  ds_read_b64_tr_b16 a[178:179], v10 offset:1024
  ds_read_b64_tr_b16 a[180:181], v10 offset:4096
  ds_read_b64_tr_b16 a[182:183], v10 offset:5120
  ds_read_b64_tr_b16 a[184:185], v10 offset:8192
  ds_read_b64_tr_b16 a[186:187], v10 offset:9216
  ds_read_b64_tr_b16 a[188:189], v10 offset:12288
  ds_read_b64_tr_b16 a[190:191], v10 offset:13312
  s_waitcnt vmcnt(14) lgkmcnt(0)
  s_barrier
  s_waitcnt vmcnt(0)
  s_mov_b32 s42, 0x80808080
  v_cmp_ne_u32 vcc, s42, v11
  s_cbranch_vccnz Lq_slow0
  v_cmp_eq_u32 vcc, 0, v12
  s_cbranch_vccz Lq_go0
Lq_slow0:
  v_mov_b32 v18, 0
  s_mov_b32 s42, 0x80808080
Lcw_70:
  global_load_dword v16, v18, s[16:17] sc0 sc1
  s_waitcnt vmcnt(0)
  v_and_b32 v17, s42, v16
  v_cmp_ne_u32 vcc, s42, v17
  s_cbranch_vccz Lcwo_71
  s_sleep 4
  s_sub_u32 s15, s15, 1
  s_cbranch_scc0 Lcw_70
  s_mov_b32 s15, 0
Lcwo_71:
Lp_72:
  buffer_load_dword v16, v13, s[8:11], s34 offen sc1
  s_waitcnt vmcnt(0)
  v_cmp_gt_u32 vcc, 1, v16
  s_cbranch_vccz Lpo_73
  s_sleep 4
  s_sub_u32 s15, s15, 1
  s_cbranch_scc0 Lp_72
  s_mov_b32 s15, 0
Lpo_73:
Lq_go0:
  s_mul_i32 s42, s13, 9216
  s_add_u32 s43, s42, s21
  s_add_u32 s42, s42, s31
  s_add_u32 m0, s42, 0
  s_add_u32 s44, s43, 0
  buffer_load_dwordx4 v72, s[8:11], s44 offen offset:0 sc1 lds
  buffer_load_dwordx4 v72, s[8:11], s44 offen offset:1024 sc1 lds
  buffer_load_dwordx4 v72, s[8:11], s44 offen offset:2048 sc1 lds
  buffer_load_dwordx4 v72, s[8:11], s44 offen offset:3072 sc1 lds
  s_add_u32 m0, s42, 4096
  s_add_u32 s44, s43, 4096
  buffer_load_dwordx4 v72, s[8:11], s44 offen offset:0 sc1 lds
  buffer_load_dwordx4 v72, s[8:11], s44 offen offset:1024 sc1 lds
  buffer_load_dwordx4 v72, s[8:11], s44 offen offset:2048 sc1 lds
  buffer_load_dwordx4 v72, s[8:11], s44 offen offset:3072 sc1 lds
  s_add_u32 m0, s42, 8192
  s_add_u32 s44, s43, 8192
  buffer_load_dwordx4 v72, s[8:11], s44 offen offset:0 sc1 lds
  v_add_u32 v10, 49152, v9
  ds_read_b64_tr_b16 a[192:193], v10 offset:0
  ds_read_b64_tr_b16 a[194:195], v10 offset:1024
  ds_read_b64_tr_b16 a[196:197], v10 offset:4096
  ds_read_b64_tr_b16 a[198:199], v10 offset:5120
  ds_read_b64_tr_b16 a[200:201], v10 offset:8192
  ds_read_b64_tr_b16 a[202:203], v10 offset:9216
  ds_read_b64_tr_b16 a[204:205], v10 offset:12288
  ds_read_b64_tr_b16 a[206:207], v10 offset:13312
  s_waitcnt lgkmcnt(0)
  s_barrier
  v_add_u32 v10, 65536, v9
  ds_read_b64_tr_b16 a[208:209], v10 offset:0
  ds_read_b64_tr_b16 a[210:211], v10 offset:1024
  ds_read_b64_tr_b16 a[212:213], v10 offset:4096
  ds_read_b64_tr_b16 a[214:215], v10 offset:5120
  ds_read_b64_tr_b16 a[216:217], v10 offset:8192
  ds_read_b64_tr_b16 a[218:219], v10 offset:9216
  ds_read_b64_tr_b16 a[220:221], v10 offset:12288
  ds_read_b64_tr_b16 a[222:223], v10 offset:13312
  s_waitcnt lgkmcnt(0)
  s_barrier
  v_add_u32 v10, 81920, v9
  ds_read_b64_tr_b16 a[224:225], v10 offset:0
  ds_read_b64_tr_b16 a[226:227], v10 offset:1024
  ds_read_b64_tr_b16 a[228:229], v10 offset:4096
  ds_read_b64_tr_b16 a[230:231], v10 offset:5120
  ds_read_b64_tr_b16 a[232:233], v10 offset:8192
  ds_read_b64_tr_b16 a[234:235], v10 offset:9216
  ds_read_b64_tr_b16 a[236:237], v10 offset:12288
  ds_read_b64_tr_b16 a[238:239], v10 offset:13312
  s_waitcnt lgkmcnt(0)
  s_barrier
  v_add_u32 v10, 98304, v9
  ds_read_b64_tr_b16 a[240:241], v10 offset:0
  ds_read_b64_tr_b16 a[242:243], v10 offset:1024
  ds_read_b64_tr_b16 a[244:245], v10 offset:4096
  ds_read_b64_tr_b16 a[246:247], v10 offset:5120
  ds_read_b64_tr_b16 a[248:249], v10 offset:8192
  ds_read_b64_tr_b16 a[250:251], v10 offset:9216
  ds_read_b64_tr_b16 a[252:253], v10 offset:12288
  ds_read_b64_tr_b16 a[254:255], v10 offset:13312
  s_waitcnt lgkmcnt(0)
  s_barrier
  s_branch Lq_wd
Lq_w1:
  s_add_u32 m0, s93, 0
  s_add_u32 s42, s92, 0
  buffer_load_dwordx4 v8, s[84:87], s42 offen lds
  s_add_u32 m0, s93, 1024
  s_add_u32 s42, s92, 32768
  buffer_load_dwordx4 v8, s[84:87], s42 offen lds
  s_add_u32 m0, s93, 2048
  s_add_u32 s42, s92, 65536
  buffer_load_dwordx4 v8, s[84:87], s42 offen lds
  s_add_u32 m0, s93, 3072
  s_add_u32 s42, s92, 98304
  buffer_load_dwordx4 v8, s[84:87], s42 offen lds
  s_add_u32 m0, s93, 16384
  s_add_u32 s42, s92, 524288
  buffer_load_dwordx4 v8, s[84:87], s42 offen lds
  s_add_u32 m0, s93, 17408
  s_add_u32 s42, s92, 557056
  buffer_load_dwordx4 v8, s[84:87], s42 offen lds
  s_add_u32 m0, s93, 18432
  s_add_u32 s42, s92, 589824
  buffer_load_dwordx4 v8, s[84:87], s42 offen lds
  s_add_u32 m0, s93, 19456
  s_add_u32 s42, s92, 622592
  buffer_load_dwordx4 v8, s[84:87], s42 offen lds
  s_add_u32 m0, s93, 32768
  s_add_u32 s42, s92, 1048576
  buffer_load_dwordx4 v8, s[84:87], s42 offen lds
  s_add_u32 m0, s93, 33792
  s_add_u32 s42, s92, 1081344
  buffer_load_dwordx4 v8, s[84:87], s42 offen lds
  s_add_u32 m0, s93, 34816
  s_add_u32 s42, s92, 1114112
  buffer_load_dwordx4 v8, s[84:87], s42 offen lds
  s_add_u32 m0, s93, 35840
  s_add_u32 s42, s92, 1146880
  buffer_load_dwordx4 v8, s[84:87], s42 offen lds
  s_add_u32 m0, s93, 49152
  s_add_u32 s42, s92, 1572864
  buffer_load_dwordx4 v8, s[84:87], s42 offen lds
  s_add_u32 m0, s93, 50176
  s_add_u32 s42, s92, 1605632
  buffer_load_dwordx4 v8, s[84:87], s42 offen lds
  s_add_u32 m0, s93, 51200
  s_add_u32 s42, s92, 1638400
  buffer_load_dwordx4 v8, s[84:87], s42 offen lds
  s_add_u32 m0, s93, 52224
  s_add_u32 s42, s92, 1671168
  buffer_load_dwordx4 v8, s[84:87], s42 offen lds
  s_add_u32 m0, s93, 65536
  s_add_u32 s42, s92, 2097152
  buffer_load_dwordx4 v8, s[84:87], s42 offen lds
  s_add_u32 m0, s93, 66560
  s_add_u32 s42, s92, 2129920
  buffer_load_dwordx4 v8, s[84:87], s42 offen lds
  s_add_u32 m0, s93, 67584
  s_add_u32 s42, s92, 2162688
  buffer_load_dwordx4 v8, s[84:87], s42 offen lds
  s_add_u32 m0, s93, 68608
  s_add_u32 s42, s92, 2195456
  buffer_load_dwordx4 v8, s[84:87], s42 offen lds
  s_add_u32 m0, s93, 81920
  s_add_u32 s42, s92, 2621440
  buffer_load_dwordx4 v8, s[84:87], s42 offen lds
  s_add_u32 m0, s93, 82944
  s_add_u32 s42, s92, 2654208
  buffer_load_dwordx4 v8, s[84:87], s42 offen lds
  s_add_u32 m0, s93, 83968
  s_add_u32 s42, s92, 2686976
  buffer_load_dwordx4 v8, s[84:87], s42 offen lds
  s_add_u32 m0, s93, 84992
  s_add_u32 s42, s92, 2719744
  buffer_load_dwordx4 v8, s[84:87], s42 offen lds
  s_add_u32 m0, s93, 98304
  s_add_u32 s42, s92, 3145728
  buffer_load_dwordx4 v8, s[84:87], s42 offen lds
  s_add_u32 m0, s93, 99328
  s_add_u32 s42, s92, 3178496
  buffer_load_dwordx4 v8, s[84:87], s42 offen lds
  s_add_u32 m0, s93, 100352
  s_add_u32 s42, s92, 3211264
  buffer_load_dwordx4 v8, s[84:87], s42 offen lds
  s_add_u32 m0, s93, 101376
  s_add_u32 s42, s92, 3244032
  buffer_load_dwordx4 v8, s[84:87], s42 offen lds
  s_add_u32 m0, s93, 114688
  s_add_u32 s42, s92, 3670016
  buffer_load_dwordx4 v8, s[84:87], s42 offen lds
  s_add_u32 m0, s93, 115712
  s_add_u32 s42, s92, 3702784
  buffer_load_dwordx4 v8, s[84:87], s42 offen lds
  s_add_u32 m0, s93, 116736
  s_add_u32 s42, s92, 3735552
  buffer_load_dwordx4 v8, s[84:87], s42 offen lds
  s_add_u32 m0, s93, 117760
  s_add_u32 s42, s92, 3768320
  buffer_load_dwordx4 v8, s[84:87], s42 offen lds
  s_add_u32 m0, s93, 131072
  s_add_u32 s42, s92, 4194304
  buffer_load_dwordx4 v8, s[84:87], s42 offen lds
  s_add_u32 m0, s93, 132096
  s_add_u32 s42, s92, 4227072
  buffer_load_dwordx4 v8, s[84:87], s42 offen lds
  s_add_u32 m0, s93, 133120
  s_add_u32 s42, s92, 4259840
  buffer_load_dwordx4 v8, s[84:87], s42 offen lds
  s_add_u32 m0, s93, 134144
  s_add_u32 s42, s92, 4292608
  buffer_load_dwordx4 v8, s[84:87], s42 offen lds
  s_add_u32 m0, s93, 147456
  s_add_u32 s42, s92, 0
  buffer_load_dwordx4 v8, s[88:91], s42 offen lds
  s_add_u32 m0, s93, 148480
  s_add_u32 s42, s92, 32768
  buffer_load_dwordx4 v8, s[88:91], s42 offen lds
  s_add_u32 m0, s93, 149504
  s_add_u32 s42, s92, 65536
  buffer_load_dwordx4 v8, s[88:91], s42 offen lds
  s_add_u32 m0, s93, 150528
  s_add_u32 s42, s92, 98304
  buffer_load_dwordx4 v8, s[88:91], s42 offen lds
  s_waitcnt vmcnt(36) lgkmcnt(0)
  s_barrier
  v_add_u32 v10, 0, v9
  ds_read_b64_tr_b16 v[80:81], v10 offset:0
  ds_read_b64_tr_b16 v[82:83], v10 offset:1024
  ds_read_b64_tr_b16 v[84:85], v10 offset:4096
  ds_read_b64_tr_b16 v[86:87], v10 offset:5120
  ds_read_b64_tr_b16 v[88:89], v10 offset:8192
  ds_read_b64_tr_b16 v[90:91], v10 offset:9216
  ds_read_b64_tr_b16 v[92:93], v10 offset:12288
  ds_read_b64_tr_b16 v[94:95], v10 offset:13312
  s_waitcnt vmcnt(32) lgkmcnt(0)
  s_barrier
  s_add_u32 m0, s93, 0
  s_add_u32 s42, s92, 524288
  buffer_load_dwordx4 v8, s[88:91], s42 offen lds
  s_add_u32 m0, s93, 1024
  s_add_u32 s42, s92, 557056
  buffer_load_dwordx4 v8, s[88:91], s42 offen lds
  s_add_u32 m0, s93, 2048
  s_add_u32 s42, s92, 589824
  buffer_load_dwordx4 v8, s[88:91], s42 offen lds
  s_add_u32 m0, s93, 3072
  s_add_u32 s42, s92, 622592
  buffer_load_dwordx4 v8, s[88:91], s42 offen lds
  v_add_u32 v10, 16384, v9
  ds_read_b64_tr_b16 v[96:97], v10 offset:0
  ds_read_b64_tr_b16 v[98:99], v10 offset:1024
  ds_read_b64_tr_b16 v[100:101], v10 offset:4096
  ds_read_b64_tr_b16 v[102:103], v10 offset:5120
  ds_read_b64_tr_b16 v[104:105], v10 offset:8192
  ds_read_b64_tr_b16 v[106:107], v10 offset:9216
  ds_read_b64_tr_b16 v[108:109], v10 offset:12288
  ds_read_b64_tr_b16 v[110:111], v10 offset:13312
  s_waitcnt vmcnt(32) lgkmcnt(0)
  s_barrier
  s_add_u32 m0, s93, 16384
  s_add_u32 s42, s92, 1048576
  buffer_load_dwordx4 v8, s[88:91], s42 offen lds
  s_add_u32 m0, s93, 17408
  s_add_u32 s42, s92, 1081344
  buffer_load_dwordx4 v8, s[88:91], s42 offen lds
  s_add_u32 m0, s93, 18432
  s_add_u32 s42, s92, 1114112
  buffer_load_dwordx4 v8, s[88:91], s42 offen lds
  s_add_u32 m0, s93, 19456
  s_add_u32 s42, s92, 1146880
  buffer_load_dwordx4 v8, s[88:91], s42 offen lds
  v_add_u32 v10, 32768, v9
  ds_read_b64_tr_b16 v[112:113], v10 offset:0
  ds_read_b64_tr_b16 v[114:115], v10 offset:1024
  ds_read_b64_tr_b16 v[116:117], v10 offset:4096
  ds_read_b64_tr_b16 v[118:119], v10 offset:5120
  ds_read_b64_tr_b16 v[120:121], v10 offset:8192
  ds_read_b64_tr_b16 v[122:123], v10 offset:9216
  ds_read_b64_tr_b16 v[124:125], v10 offset:12288
  ds_read_b64_tr_b16 v[126:127], v10 offset:13312
  s_waitcnt vmcnt(32) lgkmcnt(0)
  s_barrier
  s_add_u32 m0, s93, 32768
  s_add_u32 s42, s92, 1572864
  buffer_load_dwordx4 v8, s[88:91], s42 offen lds
  s_add_u32 m0, s93, 33792
  s_add_u32 s42, s92, 1605632
  buffer_load_dwordx4 v8, s[88:91], s42 offen lds
  s_add_u32 m0, s93, 34816
  s_add_u32 s42, s92, 1638400
  buffer_load_dwordx4 v8, s[88:91], s42 offen lds
  s_add_u32 m0, s93, 35840
  s_add_u32 s42, s92, 1671168
  buffer_load_dwordx4 v8, s[88:91], s42 offen lds
  v_add_u32 v10, 49152, v9
  ds_read_b64_tr_b16 v[128:129], v10 offset:0
  ds_read_b64_tr_b16 v[130:131], v10 offset:1024
  ds_read_b64_tr_b16 v[132:133], v10 offset:4096
  ds_read_b64_tr_b16 v[134:135], v10 offset:5120
  ds_read_b64_tr_b16 v[136:137], v10 offset:8192
  ds_read_b64_tr_b16 v[138:139], v10 offset:9216
  ds_read_b64_tr_b16 v[140:141], v10 offset:12288
  ds_read_b64_tr_b16 v[142:143], v10 offset:13312
  s_waitcnt vmcnt(32) lgkmcnt(0)
  s_barrier
  s_add_u32 m0, s93, 49152
  s_add_u32 s42, s92, 2097152
  buffer_load_dwordx4 v8, s[88:91], s42 offen lds
  s_add_u32 m0, s93, 50176
  s_add_u32 s42, s92, 2129920
  buffer_load_dwordx4 v8, s[88:91], s42 offen lds
  s_add_u32 m0, s93, 51200
  s_add_u32 s42, s92, 2162688
  buffer_load_dwordx4 v8, s[88:91], s42 offen lds
  s_add_u32 m0, s93, 52224
  s_add_u32 s42, s92, 2195456
  buffer_load_dwordx4 v8, s[88:91], s42 offen lds
  v_add_u32 v10, 65536, v9
  ds_read_b64_tr_b16 v[144:145], v10 offset:0
  ds_read_b64_tr_b16 v[146:147], v10 offset:1024
  ds_read_b64_tr_b16 v[148:149], v10 offset:4096
  ds_read_b64_tr_b16 v[150:151], v10 offset:5120
  ds_read_b64_tr_b16 v[152:153], v10 offset:8192
  ds_read_b64_tr_b16 v[154:155], v10 offset:9216
  ds_read_b64_tr_b16 v[156:157], v10 offset:12288
  ds_read_b64_tr_b16 v[158:159], v10 offset:13312
  s_waitcnt vmcnt(32) lgkmcnt(0)
  s_barrier
  s_add_u32 m0, s93, 65536
  s_add_u32 s42, s92, 2621440
  buffer_load_dwordx4 v8, s[88:91], s42 offen lds
  s_add_u32 m0, s93, 66560
  s_add_u32 s42, s92, 2654208
  buffer_load_dwordx4 v8, s[88:91], s42 offen lds
  s_add_u32 m0, s93, 67584
  s_add_u32 s42, s92, 2686976
  buffer_load_dwordx4 v8, s[88:91], s42 offen lds
  s_add_u32 m0, s93, 68608
  s_add_u32 s42, s92, 2719744
  buffer_load_dwordx4 v8, s[88:91], s42 offen lds
  v_add_u32 v10, 81920, v9
  ds_read_b64_tr_b16 v[160:161], v10 offset:0
  ds_read_b64_tr_b16 v[162:163], v10 offset:1024
  ds_read_b64_tr_b16 v[164:165], v10 offset:4096
  ds_read_b64_tr_b16 v[166:167], v10 offset:5120
  ds_read_b64_tr_b16 v[168:169], v10 offset:8192
  ds_read_b64_tr_b16 v[170:171], v10 offset:9216
  ds_read_b64_tr_b16 v[172:173], v10 offset:12288
  ds_read_b64_tr_b16 v[174:175], v10 offset:13312
  s_waitcnt vmcnt(32) lgkmcnt(0)
  s_barrier
  s_add_u32 m0, s93, 81920
  s_add_u32 s42, s92, 3145728
  buffer_load_dwordx4 v8, s[88:91], s42 offen lds
  s_add_u32 m0, s93, 82944
  s_add_u32 s42, s92, 3178496
  buffer_load_dwordx4 v8, s[88:91], s42 offen lds
  s_add_u32 m0, s93, 83968
  s_add_u32 s42, s92, 3211264
  buffer_load_dwordx4 v8, s[88:91], s42 offen lds
  s_add_u32 m0, s93, 84992
  s_add_u32 s42, s92, 3244032
  buffer_load_dwordx4 v8, s[88:91], s42 offen lds
  v_add_u32 v10, 98304, v9
  ds_read_b64_tr_b16 v[176:177], v10 offset:0
  ds_read_b64_tr_b16 v[178:179], v10 offset:1024
  ds_read_b64_tr_b16 v[180:181], v10 offset:4096
  ds_read_b64_tr_b16 v[182:183], v10 offset:5120
  ds_read_b64_tr_b16 v[184:185], v10 offset:8192
  ds_read_b64_tr_b16 v[186:187], v10 offset:9216
  ds_read_b64_tr_b16 v[188:189], v10 offset:12288
  ds_read_b64_tr_b16 v[190:191], v10 offset:13312
  s_waitcnt vmcnt(32) lgkmcnt(0)
  s_barrier
  s_add_u32 m0, s93, 98304
  s_add_u32 s42, s92, 3670016
  buffer_load_dwordx4 v8, s[88:91], s42 offen lds
  s_add_u32 m0, s93, 99328
  s_add_u32 s42, s92, 3702784
  buffer_load_dwordx4 v8, s[88:91], s42 offen lds
  s_add_u32 m0, s93, 100352
  s_add_u32 s42, s92, 3735552
  buffer_load_dwordx4 v8, s[88:91], s42 offen lds
  s_add_u32 m0, s93, 101376
  s_add_u32 s42, s92, 3768320
  buffer_load_dwordx4 v8, s[88:91], s42 offen lds
  v_add_u32 v10, 114688, v9
  ds_read_b64_tr_b16 v[192:193], v10 offset:0
  ds_read_b64_tr_b16 v[194:195], v10 offset:1024
  ds_read_b64_tr_b16 v[196:197], v10 offset:4096
  ds_read_b64_tr_b16 v[198:199], v10 offset:5120
  ds_read_b64_tr_b16 v[200:201], v10 offset:8192
  ds_read_b64_tr_b16 v[202:203], v10 offset:9216
  ds_read_b64_tr_b16 v[204:205], v10 offset:12288
  ds_read_b64_tr_b16 v[206:207], v10 offset:13312
  s_waitcnt vmcnt(32) lgkmcnt(0)
  s_barrier
  s_add_u32 m0, s93, 114688
  s_add_u32 s42, s92, 4194304
  buffer_load_dwordx4 v8, s[88:91], s42 offen lds
  s_add_u32 m0, s93, 115712
  s_add_u32 s42, s92, 4227072
  buffer_load_dwordx4 v8, s[88:91], s42 offen lds
  s_add_u32 m0, s93, 116736
  s_add_u32 s42, s92, 4259840
  buffer_load_dwordx4 v8, s[88:91], s42 offen lds
  s_add_u32 m0, s93, 117760
  s_add_u32 s42, s92, 4292608
  buffer_load_dwordx4 v8, s[88:91], s42 offen lds
  v_add_u32 v10, 131072, v9
  ds_read_b64_tr_b16 v[208:209], v10 offset:0
  ds_read_b64_tr_b16 v[210:211], v10 offset:1024
  ds_read_b64_tr_b16 v[212:213], v10 offset:4096
  ds_read_b64_tr_b16 v[214:215], v10 offset:5120
  ds_read_b64_tr_b16 v[216:217], v10 offset:8192
  ds_read_b64_tr_b16 v[218:219], v10 offset:9216
  ds_read_b64_tr_b16 v[220:221], v10 offset:12288
  ds_read_b64_tr_b16 v[222:223], v10 offset:13312
  s_waitcnt vmcnt(32) lgkmcnt(0)
  s_barrier
  s_add_u32 m0, s93, 131072
  s_add_u32 s42, s92, 0
  buffer_load_dwordx4 v8, s[80:83], s42 offen lds
  s_add_u32 m0, s93, 132096
  s_add_u32 s42, s92, 32768
  buffer_load_dwordx4 v8, s[80:83], s42 offen lds
  s_add_u32 m0, s93, 133120
  s_add_u32 s42, s92, 65536
  buffer_load_dwordx4 v8, s[80:83], s42 offen lds
  s_add_u32 m0, s93, 134144
  s_add_u32 s42, s92, 98304
  buffer_load_dwordx4 v8, s[80:83], s42 offen lds
  v_add_u32 v10, 147456, v9
  ds_read_b64_tr_b16 v[224:225], v10 offset:0
  ds_read_b64_tr_b16 v[226:227], v10 offset:1024
  ds_read_b64_tr_b16 v[228:229], v10 offset:4096
  ds_read_b64_tr_b16 v[230:231], v10 offset:5120
  ds_read_b64_tr_b16 v[232:233], v10 offset:8192
  ds_read_b64_tr_b16 v[234:235], v10 offset:9216
  ds_read_b64_tr_b16 v[236:237], v10 offset:12288
  ds_read_b64_tr_b16 v[238:239], v10 offset:13312
  s_waitcnt vmcnt(32) lgkmcnt(0)
  s_barrier
  s_add_u32 m0, s93, 147456
  s_add_u32 s42, s92, 524288
  buffer_load_dwordx4 v8, s[80:83], s42 offen lds
  s_add_u32 m0, s93, 148480
  s_add_u32 s42, s92, 557056
  buffer_load_dwordx4 v8, s[80:83], s42 offen lds
  s_add_u32 m0, s93, 149504
  s_add_u32 s42, s92, 589824
  buffer_load_dwordx4 v8, s[80:83], s42 offen lds
  s_add_u32 m0, s93, 150528
  s_add_u32 s42, s92, 622592
  buffer_load_dwordx4 v8, s[80:83], s42 offen lds
  v_add_u32 v10, 0, v9
  ds_read_b64_tr_b16 v[240:241], v10 offset:0
  ds_read_b64_tr_b16 v[242:243], v10 offset:1024
  ds_read_b64_tr_b16 v[244:245], v10 offset:4096
  ds_read_b64_tr_b16 v[246:247], v10 offset:5120
  ds_read_b64_tr_b16 v[248:249], v10 offset:8192
  ds_read_b64_tr_b16 v[250:251], v10 offset:9216
  ds_read_b64_tr_b16 v[252:253], v10 offset:12288
  ds_read_b64_tr_b16 v[254:255], v10 offset:13312
  s_waitcnt vmcnt(32) lgkmcnt(0)
  s_barrier
  s_add_u32 m0, s93, 0
  s_add_u32 s42, s92, 1048576
  buffer_load_dwordx4 v8, s[80:83], s42 offen lds
  s_add_u32 m0, s93, 1024
  s_add_u32 s42, s92, 1081344
  buffer_load_dwordx4 v8, s[80:83], s42 offen lds
  s_add_u32 m0, s93, 2048
  s_add_u32 s42, s92, 1114112
  buffer_load_dwordx4 v8, s[80:83], s42 offen lds
  s_add_u32 m0, s93, 3072
  s_add_u32 s42, s92, 1146880
  buffer_load_dwordx4 v8, s[80:83], s42 offen lds
  v_add_u32 v10, 16384, v9
  ds_read_b64_tr_b16 a[0:1], v10 offset:0
  ds_read_b64_tr_b16 a[2:3], v10 offset:1024
  ds_read_b64_tr_b16 a[4:5], v10 offset:4096
  ds_read_b64_tr_b16 a[6:7], v10 offset:5120
  ds_read_b64_tr_b16 a[8:9], v10 offset:8192
  ds_read_b64_tr_b16 a[10:11], v10 offset:9216
  ds_read_b64_tr_b16 a[12:13], v10 offset:12288
  ds_read_b64_tr_b16 a[14:15], v10 offset:13312
  s_waitcnt vmcnt(32) lgkmcnt(0)
  s_barrier
  s_add_u32 m0, s93, 16384
  s_add_u32 s42, s92, 1572864
  buffer_load_dwordx4 v8, s[80:83], s42 offen lds
  s_add_u32 m0, s93, 17408
  s_add_u32 s42, s92, 1605632
  buffer_load_dwordx4 v8, s[80:83], s42 offen lds
  s_add_u32 m0, s93, 18432
  s_add_u32 s42, s92, 1638400
  buffer_load_dwordx4 v8, s[80:83], s42 offen lds
  s_add_u32 m0, s93, 19456
  s_add_u32 s42, s92, 1671168
  buffer_load_dwordx4 v8, s[80:83], s42 offen lds
  v_add_u32 v10, 32768, v9
  ds_read_b64_tr_b16 a[16:17], v10 offset:0
  ds_read_b64_tr_b16 a[18:19], v10 offset:1024
  ds_read_b64_tr_b16 a[20:21], v10 offset:4096
  ds_read_b64_tr_b16 a[22:23], v10 offset:5120
  ds_read_b64_tr_b16 a[24:25], v10 offset:8192
  ds_read_b64_tr_b16 a[26:27], v10 offset:9216
  ds_read_b64_tr_b16 a[28:29], v10 offset:12288
  ds_read_b64_tr_b16 a[30:31], v10 offset:13312
  s_waitcnt vmcnt(32) lgkmcnt(0)
  s_barrier
  s_add_u32 m0, s93, 32768
  s_add_u32 s42, s92, 2097152
  buffer_load_dwordx4 v8, s[80:83], s42 offen lds
  s_add_u32 m0, s93, 33792
  s_add_u32 s42, s92, 2129920
  buffer_load_dwordx4 v8, s[80:83], s42 offen lds
  s_add_u32 m0, s93, 34816
  s_add_u32 s42, s92, 2162688
  buffer_load_dwordx4 v8, s[80:83], s42 offen lds
  s_add_u32 m0, s93, 35840
  s_add_u32 s42, s92, 2195456
  buffer_load_dwordx4 v8, s[80:83], s42 offen lds
  v_add_u32 v10, 49152, v9
  ds_read_b64_tr_b16 a[32:33], v10 offset:0
  ds_read_b64_tr_b16 a[34:35], v10 offset:1024
  ds_read_b64_tr_b16 a[36:37], v10 offset:4096
  ds_read_b64_tr_b16 a[38:39], v10 offset:5120
  ds_read_b64_tr_b16 a[40:41], v10 offset:8192
  ds_read_b64_tr_b16 a[42:43], v10 offset:9216
  ds_read_b64_tr_b16 a[44:45], v10 offset:12288
  ds_read_b64_tr_b16 a[46:47], v10 offset:13312
  s_waitcnt vmcnt(32) lgkmcnt(0)
  s_barrier
  s_add_u32 m0, s93, 49152
  s_add_u32 s42, s92, 2621440
  buffer_load_dwordx4 v8, s[80:83], s42 offen lds
  s_add_u32 m0, s93, 50176
  s_add_u32 s42, s92, 2654208
  buffer_load_dwordx4 v8, s[80:83], s42 offen lds
  s_add_u32 m0, s93, 51200
  s_add_u32 s42, s92, 2686976
  buffer_load_dwordx4 v8, s[80:83], s42 offen lds
  s_add_u32 m0, s93, 52224
  s_add_u32 s42, s92, 2719744
  buffer_load_dwordx4 v8, s[80:83], s42 offen lds
  v_add_u32 v10, 65536, v9
  ds_read_b64_tr_b16 a[48:49], v10 offset:0
  ds_read_b64_tr_b16 a[50:51], v10 offset:1024
  ds_read_b64_tr_b16 a[52:53], v10 offset:4096
  ds_read_b64_tr_b16 a[54:55], v10 offset:5120
  ds_read_b64_tr_b16 a[56:57], v10 offset:8192
  ds_read_b64_tr_b16 a[58:59], v10 offset:9216
  ds_read_b64_tr_b16 a[60:61], v10 offset:12288
  ds_read_b64_tr_b16 a[62:63], v10 offset:13312
  s_waitcnt vmcnt(32) lgkmcnt(0)
  s_barrier
  s_add_u32 m0, s93, 65536
  s_add_u32 s42, s92, 3145728
  buffer_load_dwordx4 v8, s[80:83], s42 offen lds
  s_add_u32 m0, s93, 66560
  s_add_u32 s42, s92, 3178496
  buffer_load_dwordx4 v8, s[80:83], s42 offen lds
  s_add_u32 m0, s93, 67584
  s_add_u32 s42, s92, 3211264
  buffer_load_dwordx4 v8, s[80:83], s42 offen lds
  s_add_u32 m0, s93, 68608
  s_add_u32 s42, s92, 3244032
  buffer_load_dwordx4 v8, s[80:83], s42 offen lds
  v_add_u32 v10, 81920, v9
  ds_read_b64_tr_b16 a[64:65], v10 offset:0
  ds_read_b64_tr_b16 a[66:67], v10 offset:1024
  ds_read_b64_tr_b16 a[68:69], v10 offset:4096
  ds_read_b64_tr_b16 a[70:71], v10 offset:5120
  ds_read_b64_tr_b16 a[72:73], v10 offset:8192
  ds_read_b64_tr_b16 a[74:75], v10 offset:9216
  ds_read_b64_tr_b16 a[76:77], v10 offset:12288
  ds_read_b64_tr_b16 a[78:79], v10 offset:13312
  s_waitcnt vmcnt(32) lgkmcnt(0)
  s_barrier
  s_add_u32 m0, s93, 81920
  s_add_u32 s42, s92, 3670016
  buffer_load_dwordx4 v8, s[80:83], s42 offen lds
  s_add_u32 m0, s93, 82944
  s_add_u32 s42, s92, 3702784
  buffer_load_dwordx4 v8, s[80:83], s42 offen lds
  s_add_u32 m0, s93, 83968
  s_add_u32 s42, s92, 3735552
  buffer_load_dwordx4 v8, s[80:83], s42 offen lds
  s_add_u32 m0, s93, 84992
  s_add_u32 s42, s92, 3768320
  buffer_load_dwordx4 v8, s[80:83], s42 offen lds
  v_add_u32 v10, 98304, v9
  ds_read_b64_tr_b16 a[80:81], v10 offset:0
  ds_read_b64_tr_b16 a[82:83], v10 offset:1024
  ds_read_b64_tr_b16 a[84:85], v10 offset:4096
  ds_read_b64_tr_b16 a[86:87], v10 offset:5120
  ds_read_b64_tr_b16 a[88:89], v10 offset:8192
  ds_read_b64_tr_b16 a[90:91], v10 offset:9216
  ds_read_b64_tr_b16 a[92:93], v10 offset:12288
  ds_read_b64_tr_b16 a[94:95], v10 offset:13312
  s_waitcnt vmcnt(32) lgkmcnt(0)
  s_barrier
  s_add_u32 m0, s93, 98304
  s_add_u32 s42, s92, 4194304
  buffer_load_dwordx4 v8, s[80:83], s42 offen lds
  s_add_u32 m0, s93, 99328
  s_add_u32 s42, s92, 4227072
  buffer_load_dwordx4 v8, s[80:83], s42 offen lds
  s_add_u32 m0, s93, 100352
  s_add_u32 s42, s92, 4259840
  buffer_load_dwordx4 v8, s[80:83], s42 offen lds
  s_add_u32 m0, s93, 101376
  s_add_u32 s42, s92, 4292608
  buffer_load_dwordx4 v8, s[80:83], s42 offen lds
  v_add_u32 v10, 114688, v9
  ds_read_b64_tr_b16 a[96:97], v10 offset:0
  ds_read_b64_tr_b16 a[98:99], v10 offset:1024
  ds_read_b64_tr_b16 a[100:101], v10 offset:4096
  ds_read_b64_tr_b16 a[102:103], v10 offset:5120
  ds_read_b64_tr_b16 a[104:105], v10 offset:8192
  ds_read_b64_tr_b16 a[106:107], v10 offset:9216
  ds_read_b64_tr_b16 a[108:109], v10 offset:12288
  ds_read_b64_tr_b16 a[110:111], v10 offset:13312
  s_waitcnt vmcnt(32) lgkmcnt(0)
  s_barrier
  global_load_dword v11, v14, s[16:17] sc0 sc1
  buffer_load_dword v12, v13, s[8:11], s34 offen sc1
  v_add_u32 v10, 131072, v9
  ds_read_b64_tr_b16 a[112:113], v10 offset:0
  ds_read_b64_tr_b16 a[114:115], v10 offset:1024
  ds_read_b64_tr_b16 a[116:117], v10 offset:4096
  ds_read_b64_tr_b16 a[118:119], v10 offset:5120
  ds_read_b64_tr_b16 a[120:121], v10 offset:8192
  ds_read_b64_tr_b16 a[122:123], v10 offset:9216
  ds_read_b64_tr_b16 a[124:125], v10 offset:12288
  ds_read_b64_tr_b16 a[126:127], v10 offset:13312
  s_waitcnt vmcnt(30) lgkmcnt(0)
  s_barrier
  v_add_u32 v10, 147456, v9
  ds_read_b64_tr_b16 a[128:129], v10 offset:0
  ds_read_b64_tr_b16 a[130:131], v10 offset:1024
  ds_read_b64_tr_b16 a[132:133], v10 offset:4096
  ds_read_b64_tr_b16 a[134:135], v10 offset:5120
  ds_read_b64_tr_b16 a[136:137], v10 offset:8192
  ds_read_b64_tr_b16 a[138:139], v10 offset:9216
  ds_read_b64_tr_b16 a[140:141], v10 offset:12288
  ds_read_b64_tr_b16 a[142:143], v10 offset:13312
  s_waitcnt vmcnt(26) lgkmcnt(0)
  s_barrier
  v_add_u32 v10, 0, v9
  ds_read_b64_tr_b16 a[144:145], v10 offset:0
  ds_read_b64_tr_b16 a[146:147], v10 offset:1024
  ds_read_b64_tr_b16 a[148:149], v10 offset:4096
  ds_read_b64_tr_b16 a[150:151], v10 offset:5120
  ds_read_b64_tr_b16 a[152:153], v10 offset:8192
  ds_read_b64_tr_b16 a[154:155], v10 offset:9216
  ds_read_b64_tr_b16 a[156:157], v10 offset:12288
  ds_read_b64_tr_b16 a[158:159], v10 offset:13312
  s_waitcnt vmcnt(22) lgkmcnt(0)
  s_barrier
  v_add_u32 v10, 16384, v9
  ds_read_b64_tr_b16 a[160:161], v10 offset:0
  ds_read_b64_tr_b16 a[162:163], v10 offset:1024
  ds_read_b64_tr_b16 a[164:165], v10 offset:4096
  ds_read_b64_tr_b16 a[166:167], v10 offset:5120
  ds_read_b64_tr_b16 a[168:169], v10 offset:8192
  ds_read_b64_tr_b16 a[170:171], v10 offset:9216
  ds_read_b64_tr_b16 a[172:173], v10 offset:12288
  ds_read_b64_tr_b16 a[174:175], v10 offset:13312
  s_waitcnt vmcnt(18) lgkmcnt(0)
  s_barrier
  v_add_u32 v10, 32768, v9
  ds_read_b64_tr_b16 a[176:177], v10 offset:0
  ds_read_b64_tr_b16 a[178:179], v10 offset:1024
  ds_read_b64_tr_b16 a[180:181], v10 offset:4096
  ds_read_b64_tr_b16 a[182:183], v10 offset:5120
  ds_read_b64_tr_b16 a[184:185], v10 offset:8192
  ds_read_b64_tr_b16 a[186:187], v10 offset:9216
  ds_read_b64_tr_b16 a[188:189], v10 offset:12288
  ds_read_b64_tr_b16 a[190:191], v10 offset:13312
  s_waitcnt vmcnt(14) lgkmcnt(0)
  s_barrier
  s_waitcnt vmcnt(0)
  s_mov_b32 s42, 0x80808080
  v_cmp_ne_u32 vcc, s42, v11
  s_cbranch_vccnz Lq_slow1
  v_cmp_eq_u32 vcc, 0, v12
  s_cbranch_vccz Lq_go1
Lq_slow1:
  v_mov_b32 v18, 0
  s_mov_b32 s42, 0x80808080
Lcw_74:
  global_load_dword v16, v18, s[16:17] sc0 sc1
  s_waitcnt vmcnt(0)
  v_and_b32 v17, s42, v16
  v_cmp_ne_u32 vcc, s42, v17
  s_cbranch_vccz Lcwo_75
  s_sleep 4
  s_sub_u32 s15, s15, 1
  s_cbranch_scc0 Lcw_74
  s_mov_b32 s15, 0
Lcwo_75:
Lp_76:
  buffer_load_dword v16, v13, s[8:11], s34 offen sc1
  s_waitcnt vmcnt(0)
  v_cmp_gt_u32 vcc, 1, v16
  s_cbranch_vccz Lpo_77
  s_sleep 4
  s_sub_u32 s15, s15, 1
  s_cbranch_scc0 Lp_76
  s_mov_b32 s15, 0
Lpo_77:
Lq_go1:
  s_mul_i32 s42, s13, 9216
  s_add_u32 s43, s42, s21
  s_add_u32 s42, s42, s31
  s_add_u32 m0, s42, 0
  s_add_u32 s44, s43, 0
  buffer_load_dwordx4 v72, s[8:11], s44 offen offset:0 sc1 lds
  buffer_load_dwordx4 v72, s[8:11], s44 offen offset:1024 sc1 lds
  buffer_load_dwordx4 v72, s[8:11], s44 offen offset:2048 sc1 lds
  buffer_load_dwordx4 v72, s[8:11], s44 offen offset:3072 sc1 lds
  s_add_u32 m0, s42, 4096
  s_add_u32 s44, s43, 4096
  buffer_load_dwordx4 v72, s[8:11], s44 offen offset:0 sc1 lds
  buffer_load_dwordx4 v72, s[8:11], s44 offen offset:1024 sc1 lds
  buffer_load_dwordx4 v72, s[8:11], s44 offen offset:2048 sc1 lds
  buffer_load_dwordx4 v72, s[8:11], s44 offen offset:3072 sc1 lds
  s_add_u32 m0, s42, 8192
  s_add_u32 s44, s43, 8192
  buffer_load_dwordx4 v72, s[8:11], s44 offen offset:0 sc1 lds
  v_add_u32 v10, 49152, v9
  ds_read_b64_tr_b16 a[192:193], v10 offset:0
  ds_read_b64_tr_b16 a[194:195], v10 offset:1024
  ds_read_b64_tr_b16 a[196:197], v10 offset:4096
  ds_read_b64_tr_b16 a[198:199], v10 offset:5120
  ds_read_b64_tr_b16 a[200:201], v10 offset:8192
  ds_read_b64_tr_b16 a[202:203], v10 offset:9216
  ds_read_b64_tr_b16 a[204:205], v10 offset:12288
  ds_read_b64_tr_b16 a[206:207], v10 offset:13312
  s_waitcnt lgkmcnt(0)
  s_barrier
  v_add_u32 v10, 65536, v9
  ds_read_b64_tr_b16 a[208:209], v10 offset:0
  ds_read_b64_tr_b16 a[210:211], v10 offset:1024
  ds_read_b64_tr_b16 a[212:213], v10 offset:4096
  ds_read_b64_tr_b16 a[214:215], v10 offset:5120
  ds_read_b64_tr_b16 a[216:217], v10 offset:8192
  ds_read_b64_tr_b16 a[218:219], v10 offset:9216
  ds_read_b64_tr_b16 a[220:221], v10 offset:12288
  ds_read_b64_tr_b16 a[222:223], v10 offset:13312
  s_waitcnt lgkmcnt(0)
  s_barrier
  v_add_u32 v10, 81920, v9
  ds_read_b64_tr_b16 a[224:225], v10 offset:0
  ds_read_b64_tr_b16 a[226:227], v10 offset:1024
  ds_read_b64_tr_b16 a[228:229], v10 offset:4096
  ds_read_b64_tr_b16 a[230:231], v10 offset:5120
  ds_read_b64_tr_b16 a[232:233], v10 offset:8192
  ds_read_b64_tr_b16 a[234:235], v10 offset:9216
  ds_read_b64_tr_b16 a[236:237], v10 offset:12288
  ds_read_b64_tr_b16 a[238:239], v10 offset:13312
  s_waitcnt lgkmcnt(0)
  s_barrier
  v_add_u32 v10, 98304, v9
  ds_read_b64_tr_b16 a[240:241], v10 offset:0
  ds_read_b64_tr_b16 a[242:243], v10 offset:1024
  ds_read_b64_tr_b16 a[244:245], v10 offset:4096
  ds_read_b64_tr_b16 a[246:247], v10 offset:5120
  ds_read_b64_tr_b16 a[248:249], v10 offset:8192
  ds_read_b64_tr_b16 a[250:251], v10 offset:9216
  ds_read_b64_tr_b16 a[252:253], v10 offset:12288
  ds_read_b64_tr_b16 a[254:255], v10 offset:13312
  s_waitcnt lgkmcnt(0)
  s_barrier
Lq_wd:
  v_mov_b64 v[68:69], -1
  v_mov_b64 v[70:71], -1
  s_waitcnt vmcnt(0)
  s_barrier
  v_add_u32 v64, 0, v72
  ds_read_b128 v[48:51], v64 offset:0
  ds_read_b128 v[52:55], v64 offset:1024
  ds_read_b128 v[56:59], v64 offset:2048
  s_lshl_b32 s42, s13, 10
  s_add_u32 s42, s42, s32
  s_add_u32 s43, s42, 8388608
  buffer_store_dwordx4 v[68:71], v72, s[8:11], s42 offen sc1
  buffer_store_dwordx4 v[68:71], v72, s[8:11], s43 offen sc1
  s_add_u32 s32, s32, 262144
  s_mov_b32 s31, 36864
  s_add_u32 s21, s21, 73728
  s_mul_i32 s42, s13, 9216
  s_add_u32 s43, s42, s21
  s_add_u32 s42, s42, s31
  s_add_u32 m0, s42, 0
  s_add_u32 s44, s43, 0
  buffer_load_dwordx4 v72, s[8:11], s44 offen offset:0 sc1 lds
  buffer_load_dwordx4 v72, s[8:11], s44 offen offset:1024 sc1 lds
  buffer_load_dwordx4 v72, s[8:11], s44 offen offset:2048 sc1 lds
  buffer_load_dwordx4 v72, s[8:11], s44 offen offset:3072 sc1 lds
  s_add_u32 m0, s42, 4096
  s_add_u32 s44, s43, 4096
  buffer_load_dwordx4 v72, s[8:11], s44 offen offset:0 sc1 lds
  buffer_load_dwordx4 v72, s[8:11], s44 offen offset:1024 sc1 lds
  buffer_load_dwordx4 v72, s[8:11], s44 offen offset:2048 sc1 lds
  buffer_load_dwordx4 v72, s[8:11], s44 offen offset:3072 sc1 lds
  s_add_u32 m0, s42, 8192
  s_add_u32 s44, s43, 8192
  buffer_load_dwordx4 v72, s[8:11], s44 offen offset:0 sc1 lds
  s_waitcnt lgkmcnt(2)
  v_mfma_f32_32x32x16_bf16 v[16:31], v[80:83], v[48:51], 0
  ds_read_b128 v[60:63], v64 offset:3072
  v_mfma_f32_32x32x16_bf16 v[32:47], v[48:51], v[224:227], 0
  s_waitcnt lgkmcnt(2)
  v_mfma_f32_32x32x16_bf16 v[16:31], v[84:87], v[52:55], v[16:31]
  ds_read_b128 v[48:51], v64 offset:4096
  v_mfma_f32_32x32x16_bf16 v[32:47], v[52:55], v[228:231], v[32:47]
  s_waitcnt lgkmcnt(2)
  v_mfma_f32_32x32x16_bf16 v[16:31], v[88:91], v[56:59], v[16:31]
  ds_read_b128 v[52:55], v64 offset:5120
  v_mfma_f32_32x32x16_bf16 v[32:47], v[56:59], v[232:235], v[32:47]
  s_waitcnt lgkmcnt(2)
  v_mfma_f32_32x32x16_bf16 v[16:31], v[92:95], v[60:63], v[16:31]
  ds_read_b128 v[56:59], v64 offset:6144
  v_mfma_f32_32x32x16_bf16 v[32:47], v[60:63], v[236:239], v[32:47]
  s_waitcnt lgkmcnt(2)
  v_mfma_f32_32x32x16_bf16 v[16:31], v[96:99], v[48:51], v[16:31]
  ds_read_b128 v[60:63], v64 offset:7168
  v_mfma_f32_32x32x16_bf16 v[32:47], v[48:51], v[240:243], v[32:47]
  s_waitcnt lgkmcnt(2)
  v_mfma_f32_32x32x16_bf16 v[16:31], v[100:103], v[52:55], v[16:31]
  ds_read_b128 v[48:51], v64 offset:8192
  v_mfma_f32_32x32x16_bf16 v[32:47], v[52:55], v[244:247], v[32:47]
  s_waitcnt lgkmcnt(2)
  v_mfma_f32_32x32x16_bf16 v[16:31], v[104:107], v[56:59], v[16:31]
  ds_read_b128 v[52:55], v64 offset:9216
  v_mfma_f32_32x32x16_bf16 v[32:47], v[56:59], v[248:251], v[32:47]
  s_waitcnt lgkmcnt(2)
  v_mfma_f32_32x32x16_bf16 v[16:31], v[108:111], v[60:63], v[16:31]
  ds_read_b128 v[56:59], v64 offset:10240
  v_mfma_f32_32x32x16_bf16 v[32:47], v[60:63], v[252:255], v[32:47]
  s_waitcnt lgkmcnt(2)
  v_mfma_f32_32x32x16_bf16 v[16:31], v[112:115], v[48:51], v[16:31]
  ds_read_b128 v[60:63], v64 offset:11264
  v_mfma_f32_32x32x16_bf16 v[32:47], v[48:51], a[0:3], v[32:47]
  s_waitcnt lgkmcnt(2)
  v_mfma_f32_32x32x16_bf16 v[16:31], v[116:119], v[52:55], v[16:31]
  ds_read_b128 v[48:51], v64 offset:12288
  v_mfma_f32_32x32x16_bf16 v[32:47], v[52:55], a[4:7], v[32:47]
  s_waitcnt lgkmcnt(2)
  v_mfma_f32_32x32x16_bf16 v[16:31], v[120:123], v[56:59], v[16:31]
  ds_read_b128 v[52:55], v64 offset:13312
  v_mfma_f32_32x32x16_bf16 v[32:47], v[56:59], a[8:11], v[32:47]
  s_waitcnt lgkmcnt(2)
  v_mfma_f32_32x32x16_bf16 v[16:31], v[124:127], v[60:63], v[16:31]
  ds_read_b128 v[56:59], v64 offset:14336
  v_mfma_f32_32x32x16_bf16 v[32:47], v[60:63], a[12:15], v[32:47]
  s_waitcnt lgkmcnt(2)
  v_mfma_f32_32x32x16_bf16 v[16:31], v[128:131], v[48:51], v[16:31]
  ds_read_b128 v[60:63], v64 offset:15360
  v_mfma_f32_32x32x16_bf16 v[32:47], v[48:51], a[16:19], v[32:47]
  s_waitcnt lgkmcnt(2)
  v_mfma_f32_32x32x16_bf16 v[16:31], v[132:135], v[52:55], v[16:31]
  ds_read_b128 v[48:51], v64 offset:16384
  v_mfma_f32_32x32x16_bf16 v[32:47], v[52:55], a[20:23], v[32:47]
  s_waitcnt lgkmcnt(2)
  v_mfma_f32_32x32x16_bf16 v[16:31], v[136:139], v[56:59], v[16:31]
  ds_read_b128 v[52:55], v64 offset:17408
  v_mfma_f32_32x32x16_bf16 v[32:47], v[56:59], a[24:27], v[32:47]
  s_waitcnt lgkmcnt(2)
  v_mfma_f32_32x32x16_bf16 v[16:31], v[140:143], v[60:63], v[16:31]
  ds_read_b128 v[56:59], v64 offset:18432
  v_mfma_f32_32x32x16_bf16 v[32:47], v[60:63], a[28:31], v[32:47]
  s_waitcnt lgkmcnt(2)
  v_mfma_f32_32x32x16_bf16 v[16:31], v[144:147], v[48:51], v[16:31]
  ds_read_b128 v[60:63], v64 offset:19456
  v_mfma_f32_32x32x16_bf16 v[32:47], v[48:51], a[32:35], v[32:47]
  s_waitcnt lgkmcnt(2)
  v_mfma_f32_32x32x16_bf16 v[16:31], v[148:151], v[52:55], v[16:31]
  ds_read_b128 v[48:51], v64 offset:20480
  v_mfma_f32_32x32x16_bf16 v[32:47], v[52:55], a[36:39], v[32:47]
  s_waitcnt lgkmcnt(2)
  v_mfma_f32_32x32x16_bf16 v[16:31], v[152:155], v[56:59], v[16:31]
  ds_read_b128 v[52:55], v64 offset:21504
  v_mfma_f32_32x32x16_bf16 v[32:47], v[56:59], a[40:43], v[32:47]
  s_waitcnt lgkmcnt(2)
  v_mfma_f32_32x32x16_bf16 v[16:31], v[156:159], v[60:63], v[16:31]
  ds_read_b128 v[56:59], v64 offset:22528
  v_mfma_f32_32x32x16_bf16 v[32:47], v[60:63], a[44:47], v[32:47]
  s_waitcnt lgkmcnt(2)
  v_mfma_f32_32x32x16_bf16 v[16:31], v[160:163], v[48:51], v[16:31]
  ds_read_b128 v[60:63], v64 offset:23552
  v_mfma_f32_32x32x16_bf16 v[32:47], v[48:51], a[48:51], v[32:47]
  s_waitcnt lgkmcnt(2)
  v_mfma_f32_32x32x16_bf16 v[16:31], v[164:167], v[52:55], v[16:31]
  ds_read_b128 v[48:51], v64 offset:24576
  v_mfma_f32_32x32x16_bf16 v[32:47], v[52:55], a[52:55], v[32:47]
  s_waitcnt lgkmcnt(2)
  v_mfma_f32_32x32x16_bf16 v[16:31], v[168:171], v[56:59], v[16:31]
  ds_read_b128 v[52:55], v64 offset:25600
  v_mfma_f32_32x32x16_bf16 v[32:47], v[56:59], a[56:59], v[32:47]
  s_waitcnt lgkmcnt(2)
  v_mfma_f32_32x32x16_bf16 v[16:31], v[172:175], v[60:63], v[16:31]
  ds_read_b128 v[56:59], v64 offset:26624
  v_mfma_f32_32x32x16_bf16 v[32:47], v[60:63], a[60:63], v[32:47]
  s_waitcnt lgkmcnt(2)
  v_mfma_f32_32x32x16_bf16 v[16:31], v[176:179], v[48:51], v[16:31]
  ds_read_b128 v[60:63], v64 offset:27648
  v_mfma_f32_32x32x16_bf16 v[32:47], v[48:51], a[64:67], v[32:47]
  s_waitcnt lgkmcnt(2)
  v_mfma_f32_32x32x16_bf16 v[16:31], v[180:183], v[52:55], v[16:31]
  ds_read_b128 v[48:51], v64 offset:28672
  v_mfma_f32_32x32x16_bf16 v[32:47], v[52:55], a[68:71], v[32:47]
  s_waitcnt lgkmcnt(2)
  v_mfma_f32_32x32x16_bf16 v[16:31], v[184:187], v[56:59], v[16:31]
  ds_read_b128 v[52:55], v64 offset:29696
  v_mfma_f32_32x32x16_bf16 v[32:47], v[56:59], a[72:75], v[32:47]
  s_waitcnt lgkmcnt(2)
  v_mfma_f32_32x32x16_bf16 v[16:31], v[188:191], v[60:63], v[16:31]
  ds_read_b128 v[56:59], v64 offset:30720
  v_mfma_f32_32x32x16_bf16 v[32:47], v[60:63], a[76:79], v[32:47]
  s_waitcnt lgkmcnt(2)
  v_mfma_f32_32x32x16_bf16 v[16:31], v[192:195], v[48:51], v[16:31]
  ds_read_b128 v[60:63], v64 offset:31744
  v_mfma_f32_32x32x16_bf16 v[32:47], v[48:51], a[80:83], v[32:47]
  s_waitcnt lgkmcnt(2)
  v_mfma_f32_32x32x16_bf16 v[16:31], v[196:199], v[52:55], v[16:31]
  ds_read_b128 v[48:51], v64 offset:32768
  v_mfma_f32_32x32x16_bf16 v[32:47], v[52:55], a[84:87], v[32:47]
  s_waitcnt lgkmcnt(2)
  v_mfma_f32_32x32x16_bf16 v[16:31], v[200:203], v[56:59], v[16:31]
  ds_read_b128 v[52:55], v64 offset:33792
  v_mfma_f32_32x32x16_bf16 v[32:47], v[56:59], a[88:91], v[32:47]
  s_waitcnt lgkmcnt(2)
  v_mfma_f32_32x32x16_bf16 v[16:31], v[204:207], v[60:63], v[16:31]
  ds_read_b128 v[56:59], v64 offset:34816
  v_mfma_f32_32x32x16_bf16 v[32:47], v[60:63], a[92:95], v[32:47]
  s_waitcnt lgkmcnt(2)
  v_mfma_f32_32x32x16_bf16 v[16:31], v[208:211], v[48:51], v[16:31]
  ds_read_b128 v[60:63], v64 offset:35840
  v_mfma_f32_32x32x16_bf16 v[32:47], v[48:51], a[96:99], v[32:47]
  s_waitcnt lgkmcnt(2)
  v_mfma_f32_32x32x16_bf16 v[16:31], v[212:215], v[52:55], v[16:31]
  v_mfma_f32_32x32x16_bf16 v[32:47], v[52:55], a[100:103], v[32:47]
  s_waitcnt lgkmcnt(1)
  v_mfma_f32_32x32x16_bf16 v[16:31], v[216:219], v[56:59], v[16:31]
  v_mfma_f32_32x32x16_bf16 v[32:47], v[56:59], a[104:107], v[32:47]
  s_waitcnt lgkmcnt(0)
  v_mfma_f32_32x32x16_bf16 v[16:31], v[220:223], v[60:63], v[16:31]
  v_mfma_f32_32x32x16_bf16 v[32:47], v[60:63], a[108:111], v[32:47]
  v_add_u32 v64, 73728, v73
  v_add_u32 v65, 73728, v75
  v_add_u32 v66, 73728, v74
  s_add_u32 s42, s22, 16777216
  v_cvt_pk_bf16_f32 v16, v16, v17
  v_cvt_pk_bf16_f32 v17, v18, v19
  v_cvt_pk_bf16_f32 v18, v20, v21
  v_cvt_pk_bf16_f32 v19, v22, v23
  v_cvt_pk_bf16_f32 v20, v24, v25
  v_cvt_pk_bf16_f32 v21, v26, v27
  v_cvt_pk_bf16_f32 v22, v28, v29
  v_cvt_pk_bf16_f32 v23, v30, v31
  buffer_store_dwordx4 v[16:19], v73, s[8:11], s22 offen offset:0 sc1
  ds_write_b128 v64, v[16:19] offset:8192
  buffer_store_dwordx4 v[20:23], v73, s[8:11], s22 offen offset:512 sc1
  ds_write_b128 v64, v[20:23] offset:8704
  v_cvt_pk_bf16_f32 v32, v32, v33
  v_cvt_pk_bf16_f32 v33, v34, v35
  v_cvt_pk_bf16_f32 v34, v36, v37
  v_cvt_pk_bf16_f32 v35, v38, v39
  v_cvt_pk_bf16_f32 v36, v40, v41
  v_cvt_pk_bf16_f32 v37, v42, v43
  v_cvt_pk_bf16_f32 v38, v44, v45
  v_cvt_pk_bf16_f32 v39, v46, v47
  buffer_store_dwordx4 v[32:35], v75, s[8:11], s42 offen offset:0 sc1
  ds_write_b128 v65, v[32:35] offset:16384
  buffer_store_dwordx4 v[36:39], v75, s[8:11], s42 offen offset:512 sc1
  ds_write_b128 v65, v[36:39] offset:16896
  s_add_u32 s22, s22, 524288
  s_waitcnt vmcnt(4)
  s_barrier
  v_add_u32 v64, 36864, v72
  ds_read_b128 v[48:51], v64 offset:0
  ds_read_b128 v[52:55], v64 offset:1024
  ds_read_b128 v[56:59], v64 offset:2048
  s_lshl_b32 s42, s13, 10
  s_add_u32 s42, s42, s32
  s_add_u32 s43, s42, 8388608
  buffer_store_dwordx4 v[68:71], v72, s[8:11], s42 offen sc1
  buffer_store_dwordx4 v[68:71], v72, s[8:11], s43 offen sc1
  s_add_u32 s32, s32, 262144
  s_waitcnt lgkmcnt(2)
  v_mfma_f32_32x32x16_bf16 v[16:31], v[80:83], v[48:51], 0
  ds_read_b128 v[60:63], v64 offset:3072
  v_mfma_f32_32x32x16_bf16 v[32:47], v[48:51], v[224:227], 0
  s_waitcnt lgkmcnt(2)
  v_mfma_f32_32x32x16_bf16 v[16:31], v[84:87], v[52:55], v[16:31]
  ds_read_b128 v[48:51], v64 offset:4096
  v_mfma_f32_32x32x16_bf16 v[32:47], v[52:55], v[228:231], v[32:47]
  s_waitcnt lgkmcnt(2)
  v_mfma_f32_32x32x16_bf16 v[16:31], v[88:91], v[56:59], v[16:31]
  ds_read_b128 v[52:55], v64 offset:5120
  v_mfma_f32_32x32x16_bf16 v[32:47], v[56:59], v[232:235], v[32:47]
  s_waitcnt lgkmcnt(2)
  v_mfma_f32_32x32x16_bf16 v[16:31], v[92:95], v[60:63], v[16:31]
  ds_read_b128 v[56:59], v64 offset:6144
  v_mfma_f32_32x32x16_bf16 v[32:47], v[60:63], v[236:239], v[32:47]
  s_waitcnt lgkmcnt(2)
  v_mfma_f32_32x32x16_bf16 v[16:31], v[96:99], v[48:51], v[16:31]
  ds_read_b128 v[60:63], v64 offset:7168
  v_mfma_f32_32x32x16_bf16 v[32:47], v[48:51], v[240:243], v[32:47]
  s_waitcnt lgkmcnt(2)
  v_mfma_f32_32x32x16_bf16 v[16:31], v[100:103], v[52:55], v[16:31]
  ds_read_b128 v[48:51], v64 offset:8192
  v_mfma_f32_32x32x16_bf16 v[32:47], v[52:55], v[244:247], v[32:47]
  s_waitcnt lgkmcnt(2)
  v_mfma_f32_32x32x16_bf16 v[16:31], v[104:107], v[56:59], v[16:31]
  ds_read_b128 v[52:55], v64 offset:9216
  v_mfma_f32_32x32x16_bf16 v[32:47], v[56:59], v[248:251], v[32:47]
  s_waitcnt lgkmcnt(2)
  v_mfma_f32_32x32x16_bf16 v[16:31], v[108:111], v[60:63], v[16:31]
  ds_read_b128 v[56:59], v64 offset:10240
  v_mfma_f32_32x32x16_bf16 v[32:47], v[60:63], v[252:255], v[32:47]
  s_waitcnt lgkmcnt(2)
  v_mfma_f32_32x32x16_bf16 v[16:31], v[112:115], v[48:51], v[16:31]
  ds_read_b128 v[60:63], v64 offset:11264
  v_mfma_f32_32x32x16_bf16 v[32:47], v[48:51], a[0:3], v[32:47]
  s_waitcnt vmcnt(2)
  s_barrier
  s_cmp_eq_u32 s13, 1
  s_cbranch_scc0 Lfs_78
  v_mov_b32 v65, 1
  s_mov_b64 exec, 1
  buffer_store_dword v65, off, s[8:11], s24 sc1
  s_mov_b64 exec, -1
Lfs_78:
  s_waitcnt lgkmcnt(2)
  v_mfma_f32_32x32x16_bf16 v[16:31], v[116:119], v[52:55], v[16:31]
  ds_read_b128 v[48:51], v64 offset:12288
  v_mfma_f32_32x32x16_bf16 v[32:47], v[52:55], a[4:7], v[32:47]
  s_waitcnt lgkmcnt(2)
  v_mfma_f32_32x32x16_bf16 v[16:31], v[120:123], v[56:59], v[16:31]
  ds_read_b128 v[52:55], v64 offset:13312
  v_mfma_f32_32x32x16_bf16 v[32:47], v[56:59], a[8:11], v[32:47]
  s_waitcnt lgkmcnt(2)
  v_mfma_f32_32x32x16_bf16 v[16:31], v[124:127], v[60:63], v[16:31]
  ds_read_b128 v[56:59], v64 offset:14336
  v_mfma_f32_32x32x16_bf16 v[32:47], v[60:63], a[12:15], v[32:47]
  s_waitcnt lgkmcnt(2)
  v_mfma_f32_32x32x16_bf16 v[16:31], v[128:131], v[48:51], v[16:31]
  ds_read_b128 v[60:63], v64 offset:15360
  v_mfma_f32_32x32x16_bf16 v[32:47], v[48:51], a[16:19], v[32:47]
  s_waitcnt lgkmcnt(2)
  v_mfma_f32_32x32x16_bf16 v[16:31], v[132:135], v[52:55], v[16:31]
  ds_read_b128 v[48:51], v64 offset:16384
  v_mfma_f32_32x32x16_bf16 v[32:47], v[52:55], a[20:23], v[32:47]
  s_waitcnt lgkmcnt(2)
  v_mfma_f32_32x32x16_bf16 v[16:31], v[136:139], v[56:59], v[16:31]
  ds_read_b128 v[52:55], v64 offset:17408
  v_mfma_f32_32x32x16_bf16 v[32:47], v[56:59], a[24:27], v[32:47]
  s_waitcnt lgkmcnt(2)
  v_mfma_f32_32x32x16_bf16 v[16:31], v[140:143], v[60:63], v[16:31]
  ds_read_b128 v[56:59], v64 offset:18432
  v_mfma_f32_32x32x16_bf16 v[32:47], v[60:63], a[28:31], v[32:47]
  s_waitcnt lgkmcnt(2)
  v_mfma_f32_32x32x16_bf16 v[16:31], v[144:147], v[48:51], v[16:31]
  ds_read_b128 v[60:63], v64 offset:19456
  v_mfma_f32_32x32x16_bf16 v[32:47], v[48:51], a[32:35], v[32:47]
  s_waitcnt lgkmcnt(2)
  v_mfma_f32_32x32x16_bf16 v[16:31], v[148:151], v[52:55], v[16:31]
  ds_read_b128 v[48:51], v64 offset:20480
  v_mfma_f32_32x32x16_bf16 v[32:47], v[52:55], a[36:39], v[32:47]
  s_waitcnt lgkmcnt(2)
  v_mfma_f32_32x32x16_bf16 v[16:31], v[152:155], v[56:59], v[16:31]
  ds_read_b128 v[52:55], v64 offset:21504
  v_mfma_f32_32x32x16_bf16 v[32:47], v[56:59], a[40:43], v[32:47]
  s_waitcnt lgkmcnt(2)
  v_mfma_f32_32x32x16_bf16 v[16:31], v[156:159], v[60:63], v[16:31]
  ds_read_b128 v[56:59], v64 offset:22528
  v_mfma_f32_32x32x16_bf16 v[32:47], v[60:63], a[44:47], v[32:47]
  s_waitcnt lgkmcnt(2)
  v_mfma_f32_32x32x16_bf16 v[16:31], v[160:163], v[48:51], v[16:31]
  ds_read_b128 v[60:63], v64 offset:23552
  v_mfma_f32_32x32x16_bf16 v[32:47], v[48:51], a[48:51], v[32:47]
  s_waitcnt lgkmcnt(2)
  v_mfma_f32_32x32x16_bf16 v[16:31], v[164:167], v[52:55], v[16:31]
  ds_read_b128 v[48:51], v64 offset:24576
  v_mfma_f32_32x32x16_bf16 v[32:47], v[52:55], a[52:55], v[32:47]
  s_waitcnt lgkmcnt(2)
  v_mfma_f32_32x32x16_bf16 v[16:31], v[168:171], v[56:59], v[16:31]
  ds_read_b128 v[52:55], v64 offset:25600
  v_mfma_f32_32x32x16_bf16 v[32:47], v[56:59], a[56:59], v[32:47]
  s_waitcnt lgkmcnt(2)
  v_mfma_f32_32x32x16_bf16 v[16:31], v[172:175], v[60:63], v[16:31]
  ds_read_b128 v[56:59], v64 offset:26624
  v_mfma_f32_32x32x16_bf16 v[32:47], v[60:63], a[60:63], v[32:47]
  s_waitcnt lgkmcnt(2)
  v_mfma_f32_32x32x16_bf16 v[16:31], v[176:179], v[48:51], v[16:31]
  ds_read_b128 v[60:63], v64 offset:27648
  v_mfma_f32_32x32x16_bf16 v[32:47], v[48:51], a[64:67], v[32:47]
  s_waitcnt lgkmcnt(2)
  v_mfma_f32_32x32x16_bf16 v[16:31], v[180:183], v[52:55], v[16:31]
  ds_read_b128 v[48:51], v64 offset:28672
  v_mfma_f32_32x32x16_bf16 v[32:47], v[52:55], a[68:71], v[32:47]
  s_waitcnt lgkmcnt(2)
  v_mfma_f32_32x32x16_bf16 v[16:31], v[184:187], v[56:59], v[16:31]
  ds_read_b128 v[52:55], v64 offset:29696
  v_mfma_f32_32x32x16_bf16 v[32:47], v[56:59], a[72:75], v[32:47]
  s_waitcnt lgkmcnt(2)
  v_mfma_f32_32x32x16_bf16 v[16:31], v[188:191], v[60:63], v[16:31]
  ds_read_b128 v[56:59], v64 offset:30720
  v_mfma_f32_32x32x16_bf16 v[32:47], v[60:63], a[76:79], v[32:47]
  s_waitcnt lgkmcnt(2)
  v_mfma_f32_32x32x16_bf16 v[16:31], v[192:195], v[48:51], v[16:31]
  ds_read_b128 v[60:63], v64 offset:31744
  v_mfma_f32_32x32x16_bf16 v[32:47], v[48:51], a[80:83], v[32:47]
  s_waitcnt lgkmcnt(2)
  v_mfma_f32_32x32x16_bf16 v[16:31], v[196:199], v[52:55], v[16:31]
  ds_read_b128 v[48:51], v64 offset:32768
  v_mfma_f32_32x32x16_bf16 v[32:47], v[52:55], a[84:87], v[32:47]
  s_waitcnt lgkmcnt(2)
  v_mfma_f32_32x32x16_bf16 v[16:31], v[200:203], v[56:59], v[16:31]
  ds_read_b128 v[52:55], v64 offset:33792
  v_mfma_f32_32x32x16_bf16 v[32:47], v[56:59], a[88:91], v[32:47]
  s_waitcnt lgkmcnt(2)
  v_mfma_f32_32x32x16_bf16 v[16:31], v[204:207], v[60:63], v[16:31]
  ds_read_b128 v[56:59], v64 offset:34816
  v_mfma_f32_32x32x16_bf16 v[32:47], v[60:63], a[92:95], v[32:47]
  s_waitcnt lgkmcnt(2)
  v_mfma_f32_32x32x16_bf16 v[16:31], v[208:211], v[48:51], v[16:31]
  ds_read_b128 v[60:63], v64 offset:35840
  v_mfma_f32_32x32x16_bf16 v[32:47], v[48:51], a[96:99], v[32:47]
  s_waitcnt lgkmcnt(2)
  v_mfma_f32_32x32x16_bf16 v[16:31], v[212:215], v[52:55], v[16:31]
  v_mfma_f32_32x32x16_bf16 v[32:47], v[52:55], a[100:103], v[32:47]
  s_waitcnt lgkmcnt(1)
  v_mfma_f32_32x32x16_bf16 v[16:31], v[216:219], v[56:59], v[16:31]
  v_mfma_f32_32x32x16_bf16 v[32:47], v[56:59], a[104:107], v[32:47]
  s_waitcnt lgkmcnt(0)
  v_mfma_f32_32x32x16_bf16 v[16:31], v[220:223], v[60:63], v[16:31]
  v_mfma_f32_32x32x16_bf16 v[32:47], v[60:63], a[108:111], v[32:47]
  v_add_u32 v64, 98304, v73
  v_add_u32 v65, 98304, v75
  v_add_u32 v66, 98304, v74
  s_add_u32 s42, s22, 16777216
  v_cvt_pk_bf16_f32 v16, v16, v17
  v_cvt_pk_bf16_f32 v17, v18, v19
  v_cvt_pk_bf16_f32 v18, v20, v21
  v_cvt_pk_bf16_f32 v19, v22, v23
  v_cvt_pk_bf16_f32 v20, v24, v25
  v_cvt_pk_bf16_f32 v21, v26, v27
  v_cvt_pk_bf16_f32 v22, v28, v29
  v_cvt_pk_bf16_f32 v23, v30, v31
  buffer_store_dwordx4 v[16:19], v73, s[8:11], s22 offen offset:0 sc1
  ds_write_b128 v64, v[16:19] offset:8192
  buffer_store_dwordx4 v[20:23], v73, s[8:11], s22 offen offset:512 sc1
  ds_write_b128 v64, v[20:23] offset:8704
  v_cvt_pk_bf16_f32 v32, v32, v33
  v_cvt_pk_bf16_f32 v33, v34, v35
  v_cvt_pk_bf16_f32 v34, v36, v37
  v_cvt_pk_bf16_f32 v35, v38, v39
  v_cvt_pk_bf16_f32 v36, v40, v41
  v_cvt_pk_bf16_f32 v37, v42, v43
  v_cvt_pk_bf16_f32 v38, v44, v45
  v_cvt_pk_bf16_f32 v39, v46, v47
  buffer_store_dwordx4 v[32:35], v75, s[8:11], s42 offen offset:0 sc1
  ds_write_b128 v65, v[32:35] offset:16384
  buffer_store_dwordx4 v[36:39], v75, s[8:11], s42 offen offset:512 sc1
  ds_write_b128 v65, v[36:39] offset:16896
  s_add_u32 s22, s22, 524288
  v_add_u32 v64, 0, v72
  ds_read_b128 v[48:51], v64 offset:0
  ds_read_b128 v[52:55], v64 offset:1024
  ds_read_b128 v[56:59], v64 offset:2048
  s_waitcnt lgkmcnt(2)
  v_mfma_f32_32x32x16_bf16 v[0:15], a[112:115], v[48:51], 0
  ds_read_b128 v[60:63], v64 offset:3072
  s_waitcnt lgkmcnt(2)
  v_mfma_f32_32x32x16_bf16 v[0:15], a[116:119], v[52:55], v[0:15]
  ds_read_b128 v[48:51], v64 offset:4096
  s_waitcnt lgkmcnt(2)
  v_mfma_f32_32x32x16_bf16 v[0:15], a[120:123], v[56:59], v[0:15]
  ds_read_b128 v[52:55], v64 offset:5120
  s_waitcnt lgkmcnt(2)
  v_mfma_f32_32x32x16_bf16 v[0:15], a[124:127], v[60:63], v[0:15]
  ds_read_b128 v[56:59], v64 offset:6144
  s_waitcnt lgkmcnt(2)
  v_mfma_f32_32x32x16_bf16 v[0:15], a[128:131], v[48:51], v[0:15]
  ds_read_b128 v[60:63], v64 offset:7168
  s_waitcnt lgkmcnt(2)
  v_mfma_f32_32x32x16_bf16 v[0:15], a[132:135], v[52:55], v[0:15]
  ds_read_b128 v[48:51], v64 offset:8192
  s_waitcnt lgkmcnt(2)
  v_mfma_f32_32x32x16_bf16 v[0:15], a[136:139], v[56:59], v[0:15]
  ds_read_b128 v[52:55], v64 offset:9216
  s_waitcnt lgkmcnt(2)
  v_mfma_f32_32x32x16_bf16 v[0:15], a[140:143], v[60:63], v[0:15]
  ds_read_b128 v[56:59], v64 offset:10240
  s_waitcnt lgkmcnt(2)
  v_mfma_f32_32x32x16_bf16 v[0:15], a[144:147], v[48:51], v[0:15]
  ds_read_b128 v[60:63], v64 offset:11264
  s_waitcnt lgkmcnt(2)
  v_mfma_f32_32x32x16_bf16 v[0:15], a[148:151], v[52:55], v[0:15]
  ds_read_b128 v[48:51], v64 offset:12288
  s_waitcnt lgkmcnt(2)
  v_mfma_f32_32x32x16_bf16 v[0:15], a[152:155], v[56:59], v[0:15]
  ds_read_b128 v[52:55], v64 offset:13312
  s_waitcnt lgkmcnt(2)
  v_mfma_f32_32x32x16_bf16 v[0:15], a[156:159], v[60:63], v[0:15]
  ds_read_b128 v[56:59], v64 offset:14336
  s_waitcnt lgkmcnt(2)
  v_mfma_f32_32x32x16_bf16 v[0:15], a[160:163], v[48:51], v[0:15]
  ds_read_b128 v[60:63], v64 offset:15360
  s_waitcnt lgkmcnt(2)
  v_mfma_f32_32x32x16_bf16 v[0:15], a[164:167], v[52:55], v[0:15]
  ds_read_b128 v[48:51], v64 offset:16384
  s_waitcnt lgkmcnt(2)
  v_mfma_f32_32x32x16_bf16 v[0:15], a[168:171], v[56:59], v[0:15]
  ds_read_b128 v[52:55], v64 offset:17408
  s_waitcnt lgkmcnt(2)
  v_mfma_f32_32x32x16_bf16 v[0:15], a[172:175], v[60:63], v[0:15]
  ds_read_b128 v[56:59], v64 offset:18432
  s_waitcnt lgkmcnt(2)
  v_mfma_f32_32x32x16_bf16 v[0:15], a[176:179], v[48:51], v[0:15]
  ds_read_b128 v[60:63], v64 offset:19456
  s_waitcnt lgkmcnt(2)
  v_mfma_f32_32x32x16_bf16 v[0:15], a[180:183], v[52:55], v[0:15]
  ds_read_b128 v[48:51], v64 offset:20480
  s_waitcnt lgkmcnt(2)
  v_mfma_f32_32x32x16_bf16 v[0:15], a[184:187], v[56:59], v[0:15]
  ds_read_b128 v[52:55], v64 offset:21504
  s_waitcnt lgkmcnt(2)
  v_mfma_f32_32x32x16_bf16 v[0:15], a[188:191], v[60:63], v[0:15]
  ds_read_b128 v[56:59], v64 offset:22528
  s_waitcnt lgkmcnt(2)
  v_mfma_f32_32x32x16_bf16 v[0:15], a[192:195], v[48:51], v[0:15]
  ds_read_b128 v[60:63], v64 offset:23552
  s_waitcnt lgkmcnt(2)
  v_mfma_f32_32x32x16_bf16 v[0:15], a[196:199], v[52:55], v[0:15]
  ds_read_b128 v[48:51], v64 offset:24576
  s_waitcnt lgkmcnt(2)
  v_mfma_f32_32x32x16_bf16 v[0:15], a[200:203], v[56:59], v[0:15]
  ds_read_b128 v[52:55], v64 offset:25600
  s_waitcnt lgkmcnt(2)
  v_mfma_f32_32x32x16_bf16 v[0:15], a[204:207], v[60:63], v[0:15]
  ds_read_b128 v[56:59], v64 offset:26624
  s_waitcnt lgkmcnt(2)
  v_mfma_f32_32x32x16_bf16 v[0:15], a[208:211], v[48:51], v[0:15]
  ds_read_b128 v[60:63], v64 offset:27648
  s_waitcnt vmcnt(0)
  s_barrier
  s_cmp_eq_u32 s13, 1
  s_cbranch_scc0 Lfs_79
  v_mov_b32 v65, 2
  s_mov_b64 exec, 1
  buffer_store_dword v65, off, s[8:11], s24 sc1
  s_mov_b64 exec, -1
Lfs_79:
  s_waitcnt lgkmcnt(2)
  v_mfma_f32_32x32x16_bf16 v[0:15], a[212:215], v[52:55], v[0:15]
  ds_read_b128 v[48:51], v64 offset:28672
  s_waitcnt lgkmcnt(2)
  v_mfma_f32_32x32x16_bf16 v[0:15], a[216:219], v[56:59], v[0:15]
  ds_read_b128 v[52:55], v64 offset:29696
  s_waitcnt lgkmcnt(2)
  v_mfma_f32_32x32x16_bf16 v[0:15], a[220:223], v[60:63], v[0:15]
  ds_read_b128 v[56:59], v64 offset:30720
  s_waitcnt lgkmcnt(2)
  v_mfma_f32_32x32x16_bf16 v[0:15], a[224:227], v[48:51], v[0:15]
  ds_read_b128 v[60:63], v64 offset:31744
  s_waitcnt lgkmcnt(2)
  v_mfma_f32_32x32x16_bf16 v[0:15], a[228:231], v[52:55], v[0:15]
  ds_read_b128 v[48:51], v64 offset:32768
  s_waitcnt lgkmcnt(2)
  v_mfma_f32_32x32x16_bf16 v[0:15], a[232:235], v[56:59], v[0:15]
  ds_read_b128 v[52:55], v64 offset:33792
  s_waitcnt lgkmcnt(2)
  v_mfma_f32_32x32x16_bf16 v[0:15], a[236:239], v[60:63], v[0:15]
  ds_read_b128 v[56:59], v64 offset:34816
  s_waitcnt lgkmcnt(2)
  v_mfma_f32_32x32x16_bf16 v[0:15], a[240:243], v[48:51], v[0:15]
  ds_read_b128 v[60:63], v64 offset:35840
  s_waitcnt lgkmcnt(2)
  v_mfma_f32_32x32x16_bf16 v[0:15], a[244:247], v[52:55], v[0:15]
  s_waitcnt lgkmcnt(1)
  v_mfma_f32_32x32x16_bf16 v[0:15], a[248:251], v[56:59], v[0:15]
  s_waitcnt lgkmcnt(0)
  v_mfma_f32_32x32x16_bf16 v[0:15], a[252:255], v[60:63], v[0:15]
  v_add_u32 v64, 73728, v73
  v_add_u32 v65, 73728, v75
  v_add_u32 v66, 73728, v74
  s_add_u32 s42, s22, 16777216
  s_nop 7
  v_cvt_pk_bf16_f32 v0, v0, v1
  v_cvt_pk_bf16_f32 v1, v2, v3
  v_cvt_pk_bf16_f32 v2, v4, v5
  v_cvt_pk_bf16_f32 v3, v6, v7
  v_cvt_pk_bf16_f32 v4, v8, v9
  v_cvt_pk_bf16_f32 v5, v10, v11
  v_cvt_pk_bf16_f32 v6, v12, v13
  v_cvt_pk_bf16_f32 v7, v14, v15
  ds_write_b128 v66, v[0:3] offset:0
  ds_write_b128 v66, v[4:7] offset:512
  s_barrier
  s_mov_b32 s31, 0
  s_add_u32 s21, s21, 73728
  s_mul_i32 s42, s13, 9216
  s_add_u32 s43, s42, s21
  s_add_u32 s42, s42, s31
  s_add_u32 m0, s42, 0
  s_add_u32 s44, s43, 0
  buffer_load_dwordx4 v72, s[8:11], s44 offen offset:0 sc1 lds
  buffer_load_dwordx4 v72, s[8:11], s44 offen offset:1024 sc1 lds
  buffer_load_dwordx4 v72, s[8:11], s44 offen offset:2048 sc1 lds
  buffer_load_dwordx4 v72, s[8:11], s44 offen offset:3072 sc1 lds
  s_add_u32 m0, s42, 4096
  s_add_u32 s44, s43, 4096
  buffer_load_dwordx4 v72, s[8:11], s44 offen offset:0 sc1 lds
  buffer_load_dwordx4 v72, s[8:11], s44 offen offset:1024 sc1 lds
  buffer_load_dwordx4 v72, s[8:11], s44 offen offset:2048 sc1 lds
  buffer_load_dwordx4 v72, s[8:11], s44 offen offset:3072 sc1 lds
  s_add_u32 m0, s42, 8192
  s_add_u32 s44, s43, 8192
  buffer_load_dwordx4 v72, s[8:11], s44 offen offset:0 sc1 lds
  v_add_u32 v64, 36864, v72
  ds_read_b128 v[48:51], v64 offset:0
  ds_read_b128 v[52:55], v64 offset:1024
  ds_read_b128 v[56:59], v64 offset:2048
  s_waitcnt lgkmcnt(2)
  v_mfma_f32_32x32x16_bf16 v[0:15], a[112:115], v[48:51], 0
  ds_read_b128 v[60:63], v64 offset:3072
  s_waitcnt lgkmcnt(2)
  v_mfma_f32_32x32x16_bf16 v[0:15], a[116:119], v[52:55], v[0:15]
  ds_read_b128 v[48:51], v64 offset:4096
  s_waitcnt lgkmcnt(2)
  v_mfma_f32_32x32x16_bf16 v[0:15], a[120:123], v[56:59], v[0:15]
  ds_read_b128 v[52:55], v64 offset:5120
  s_waitcnt lgkmcnt(2)
  v_mfma_f32_32x32x16_bf16 v[0:15], a[124:127], v[60:63], v[0:15]
  ds_read_b128 v[56:59], v64 offset:6144
  s_waitcnt lgkmcnt(2)
  v_mfma_f32_32x32x16_bf16 v[0:15], a[128:131], v[48:51], v[0:15]
  ds_read_b128 v[60:63], v64 offset:7168
  s_waitcnt lgkmcnt(2)
  v_mfma_f32_32x32x16_bf16 v[0:15], a[132:135], v[52:55], v[0:15]
  ds_read_b128 v[48:51], v64 offset:8192
  s_waitcnt lgkmcnt(2)
  v_mfma_f32_32x32x16_bf16 v[0:15], a[136:139], v[56:59], v[0:15]
  ds_read_b128 v[52:55], v64 offset:9216
  s_waitcnt lgkmcnt(2)
  v_mfma_f32_32x32x16_bf16 v[0:15], a[140:143], v[60:63], v[0:15]
  ds_read_b128 v[56:59], v64 offset:10240
  s_waitcnt lgkmcnt(2)
  v_mfma_f32_32x32x16_bf16 v[0:15], a[144:147], v[48:51], v[0:15]
  ds_read_b128 v[60:63], v64 offset:11264
  s_waitcnt lgkmcnt(2)
  v_mfma_f32_32x32x16_bf16 v[0:15], a[148:151], v[52:55], v[0:15]
  ds_read_b128 v[48:51], v64 offset:12288
  s_waitcnt lgkmcnt(2)
  v_mfma_f32_32x32x16_bf16 v[0:15], a[152:155], v[56:59], v[0:15]
  ds_read_b128 v[52:55], v64 offset:13312
  s_waitcnt lgkmcnt(2)
  v_mfma_f32_32x32x16_bf16 v[0:15], a[156:159], v[60:63], v[0:15]
  ds_read_b128 v[56:59], v64 offset:14336
  s_waitcnt lgkmcnt(2)
  v_mfma_f32_32x32x16_bf16 v[0:15], a[160:163], v[48:51], v[0:15]
  ds_read_b128 v[60:63], v64 offset:15360
  s_waitcnt lgkmcnt(2)
  v_mfma_f32_32x32x16_bf16 v[0:15], a[164:167], v[52:55], v[0:15]
  ds_read_b128 v[48:51], v64 offset:16384
  s_waitcnt lgkmcnt(2)
  v_mfma_f32_32x32x16_bf16 v[0:15], a[168:171], v[56:59], v[0:15]
  ds_read_b128 v[52:55], v64 offset:17408
  s_waitcnt lgkmcnt(2)
  v_mfma_f32_32x32x16_bf16 v[0:15], a[172:175], v[60:63], v[0:15]
  ds_read_b128 v[56:59], v64 offset:18432
  s_waitcnt lgkmcnt(2)
  v_mfma_f32_32x32x16_bf16 v[0:15], a[176:179], v[48:51], v[0:15]
  ds_read_b128 v[60:63], v64 offset:19456
  s_waitcnt lgkmcnt(2)
  v_mfma_f32_32x32x16_bf16 v[0:15], a[180:183], v[52:55], v[0:15]
  ds_read_b128 v[48:51], v64 offset:20480
  s_waitcnt lgkmcnt(2)
  v_mfma_f32_32x32x16_bf16 v[0:15], a[184:187], v[56:59], v[0:15]
  ds_read_b128 v[52:55], v64 offset:21504
  s_waitcnt lgkmcnt(2)
  v_mfma_f32_32x32x16_bf16 v[0:15], a[188:191], v[60:63], v[0:15]
  ds_read_b128 v[56:59], v64 offset:22528
  s_waitcnt lgkmcnt(2)
  v_mfma_f32_32x32x16_bf16 v[0:15], a[192:195], v[48:51], v[0:15]
  ds_read_b128 v[60:63], v64 offset:23552
  s_waitcnt lgkmcnt(2)
  v_mfma_f32_32x32x16_bf16 v[0:15], a[196:199], v[52:55], v[0:15]
  ds_read_b128 v[48:51], v64 offset:24576
  s_waitcnt lgkmcnt(2)
  v_mfma_f32_32x32x16_bf16 v[0:15], a[200:203], v[56:59], v[0:15]
  ds_read_b128 v[52:55], v64 offset:25600
  s_waitcnt lgkmcnt(2)
  v_mfma_f32_32x32x16_bf16 v[0:15], a[204:207], v[60:63], v[0:15]
  ds_read_b128 v[56:59], v64 offset:26624
  s_waitcnt lgkmcnt(2)
  v_mfma_f32_32x32x16_bf16 v[0:15], a[208:211], v[48:51], v[0:15]
  ds_read_b128 v[60:63], v64 offset:27648
  s_waitcnt lgkmcnt(2)
  v_mfma_f32_32x32x16_bf16 v[0:15], a[212:215], v[52:55], v[0:15]
  ds_read_b128 v[48:51], v64 offset:28672
  s_waitcnt lgkmcnt(2)
  v_mfma_f32_32x32x16_bf16 v[0:15], a[216:219], v[56:59], v[0:15]
  ds_read_b128 v[52:55], v64 offset:29696
  s_waitcnt lgkmcnt(2)
  v_mfma_f32_32x32x16_bf16 v[0:15], a[220:223], v[60:63], v[0:15]
  ds_read_b128 v[56:59], v64 offset:30720
  s_waitcnt lgkmcnt(2)
  v_mfma_f32_32x32x16_bf16 v[0:15], a[224:227], v[48:51], v[0:15]
  ds_read_b128 v[60:63], v64 offset:31744
  s_waitcnt lgkmcnt(2)
  v_mfma_f32_32x32x16_bf16 v[0:15], a[228:231], v[52:55], v[0:15]
  ds_read_b128 v[48:51], v64 offset:32768
  s_waitcnt lgkmcnt(2)
  v_mfma_f32_32x32x16_bf16 v[0:15], a[232:235], v[56:59], v[0:15]
  ds_read_b128 v[52:55], v64 offset:33792
  s_waitcnt lgkmcnt(2)
  v_mfma_f32_32x32x16_bf16 v[0:15], a[236:239], v[60:63], v[0:15]
  ds_read_b128 v[56:59], v64 offset:34816
  s_waitcnt lgkmcnt(2)
  v_mfma_f32_32x32x16_bf16 v[0:15], a[240:243], v[48:51], v[0:15]
  ds_read_b128 v[60:63], v64 offset:35840
  s_waitcnt lgkmcnt(2)
  v_mfma_f32_32x32x16_bf16 v[0:15], a[244:247], v[52:55], v[0:15]
  s_waitcnt lgkmcnt(1)
  v_mfma_f32_32x32x16_bf16 v[0:15], a[248:251], v[56:59], v[0:15]
  s_waitcnt lgkmcnt(0)
  v_mfma_f32_32x32x16_bf16 v[0:15], a[252:255], v[60:63], v[0:15]
  v_add_u32 v64, 98304, v73
  v_add_u32 v65, 98304, v75
  v_add_u32 v66, 98304, v74
  s_add_u32 s42, s22, 16777216
  s_nop 7
  v_cvt_pk_bf16_f32 v0, v0, v1
  v_cvt_pk_bf16_f32 v1, v2, v3
  v_cvt_pk_bf16_f32 v2, v4, v5
  v_cvt_pk_bf16_f32 v3, v6, v7
  v_cvt_pk_bf16_f32 v4, v8, v9
  v_cvt_pk_bf16_f32 v5, v10, v11
  v_cvt_pk_bf16_f32 v6, v12, v13
  v_cvt_pk_bf16_f32 v7, v14, v15
  ds_write_b128 v66, v[0:3] offset:0
  ds_write_b128 v66, v[4:7] offset:512
  s_mov_b32 s18, 2
  s_mov_b32 s33, 2
  s_mov_b32 s23, 122880
  s_waitcnt vmcnt(0) lgkmcnt(0)
Lq_loop:
  s_cmp_ge_u32 s18, 32
  s_cbranch_scc1 Lq_noprod
  s_waitcnt vmcnt(2)
  s_barrier
  v_add_u32 v64, s31, v72
  ds_read_b128 v[48:51], v64 offset:0
  ds_read_b128 v[52:55], v64 offset:1024
  ds_read_b128 v[56:59], v64 offset:2048
  v_mov_b64 v[68:69], -1
  v_mov_b64 v[70:71], -1
  s_lshl_b32 s42, s13, 10
  s_add_u32 s42, s42, s32
  s_add_u32 s43, s42, 8388608
  buffer_store_dwordx4 v[68:71], v72, s[8:11], s42 offen sc1
  buffer_store_dwordx4 v[68:71], v72, s[8:11], s43 offen sc1
  s_add_u32 s32, s32, 262144
  s_xor_b32 s31, s31, 36864
  s_add_u32 s21, s21, 73728
  s_waitcnt lgkmcnt(2)
  v_mfma_f32_32x32x16_bf16 v[16:31], v[80:83], v[48:51], 0
  ds_read_b128 v[60:63], v64 offset:3072
  v_mfma_f32_32x32x16_bf16 v[32:47], v[48:51], v[224:227], 0
  v_mfma_f32_32x32x16_bf16 v[0:15], a[112:115], v[48:51], 0
  s_waitcnt lgkmcnt(2)
  v_mfma_f32_32x32x16_bf16 v[16:31], v[84:87], v[52:55], v[16:31]
  ds_read_b128 v[48:51], v64 offset:4096
  v_mfma_f32_32x32x16_bf16 v[32:47], v[52:55], v[228:231], v[32:47]
  v_mfma_f32_32x32x16_bf16 v[0:15], a[116:119], v[52:55], v[0:15]
  s_waitcnt lgkmcnt(2)
  v_mfma_f32_32x32x16_bf16 v[16:31], v[88:91], v[56:59], v[16:31]
  ds_read_b128 v[52:55], v64 offset:5120
  v_mfma_f32_32x32x16_bf16 v[32:47], v[56:59], v[232:235], v[32:47]
  v_mfma_f32_32x32x16_bf16 v[0:15], a[120:123], v[56:59], v[0:15]
  s_waitcnt lgkmcnt(2)
  v_mfma_f32_32x32x16_bf16 v[16:31], v[92:95], v[60:63], v[16:31]
  ds_read_b128 v[56:59], v64 offset:6144
  v_mfma_f32_32x32x16_bf16 v[32:47], v[60:63], v[236:239], v[32:47]
  v_mfma_f32_32x32x16_bf16 v[0:15], a[124:127], v[60:63], v[0:15]
  s_waitcnt lgkmcnt(2)
  v_mfma_f32_32x32x16_bf16 v[16:31], v[96:99], v[48:51], v[16:31]
  ds_read_b128 v[60:63], v64 offset:7168
  v_mfma_f32_32x32x16_bf16 v[32:47], v[48:51], v[240:243], v[32:47]
  v_mfma_f32_32x32x16_bf16 v[0:15], a[128:131], v[48:51], v[0:15]
  s_waitcnt lgkmcnt(2)
  v_mfma_f32_32x32x16_bf16 v[16:31], v[100:103], v[52:55], v[16:31]
  ds_read_b128 v[48:51], v64 offset:8192
  v_mfma_f32_32x32x16_bf16 v[32:47], v[52:55], v[244:247], v[32:47]
  v_mfma_f32_32x32x16_bf16 v[0:15], a[132:135], v[52:55], v[0:15]
  s_waitcnt lgkmcnt(2)
  v_mfma_f32_32x32x16_bf16 v[16:31], v[104:107], v[56:59], v[16:31]
  ds_read_b128 v[52:55], v64 offset:9216
  v_mfma_f32_32x32x16_bf16 v[32:47], v[56:59], v[248:251], v[32:47]
  v_mfma_f32_32x32x16_bf16 v[0:15], a[136:139], v[56:59], v[0:15]
  s_waitcnt vmcnt(2)
  s_barrier
  s_cmp_eq_u32 s30, 0
  s_cbranch_scc1 Lnof_81
  s_cmp_eq_u32 s13, 0
  s_cbranch_scc0 Lfs_82
  v_mov_b32 v65, s19
  s_mov_b64 exec, 1
  buffer_store_dword v65, off, s[8:11], s25 sc1
  s_mov_b64 exec, -1
Lfs_82:
  s_mov_b32 s30, 0
Lnof_81:
  s_waitcnt lgkmcnt(2)
  v_mfma_f32_32x32x16_bf16 v[16:31], v[108:111], v[60:63], v[16:31]
  ds_read_b128 v[56:59], v64 offset:10240
  v_mfma_f32_32x32x16_bf16 v[32:47], v[60:63], v[252:255], v[32:47]
  v_mfma_f32_32x32x16_bf16 v[0:15], a[140:143], v[60:63], v[0:15]
  s_waitcnt lgkmcnt(2)
  v_mfma_f32_32x32x16_bf16 v[16:31], v[112:115], v[48:51], v[16:31]
  ds_read_b128 v[60:63], v64 offset:11264
  v_mfma_f32_32x32x16_bf16 v[32:47], v[48:51], a[0:3], v[32:47]
  v_mfma_f32_32x32x16_bf16 v[0:15], a[144:147], v[48:51], v[0:15]
  s_cmp_ge_u32 s18, 31
  s_cbranch_scc1 Lnodma_80
  s_mul_i32 s42, s13, 9216
  s_add_u32 s43, s42, s21
  s_add_u32 s42, s42, s31
  s_add_u32 m0, s42, 0
  s_add_u32 s44, s43, 0
  buffer_load_dwordx4 v72, s[8:11], s44 offen offset:0 sc1 lds
  buffer_load_dwordx4 v72, s[8:11], s44 offen offset:1024 sc1 lds
  buffer_load_dwordx4 v72, s[8:11], s44 offen offset:2048 sc1 lds
  buffer_load_dwordx4 v72, s[8:11], s44 offen offset:3072 sc1 lds
  s_add_u32 m0, s42, 4096
  s_add_u32 s44, s43, 4096
  buffer_load_dwordx4 v72, s[8:11], s44 offen offset:0 sc1 lds
  buffer_load_dwordx4 v72, s[8:11], s44 offen offset:1024 sc1 lds
  buffer_load_dwordx4 v72, s[8:11], s44 offen offset:2048 sc1 lds
  buffer_load_dwordx4 v72, s[8:11], s44 offen offset:3072 sc1 lds
  s_add_u32 m0, s42, 8192
  s_add_u32 s44, s43, 8192
  buffer_load_dwordx4 v72, s[8:11], s44 offen offset:0 sc1 lds
Lnodma_80:
  s_waitcnt lgkmcnt(2)
  v_mfma_f32_32x32x16_bf16 v[16:31], v[116:119], v[52:55], v[16:31]
  ds_read_b128 v[48:51], v64 offset:12288
  v_mfma_f32_32x32x16_bf16 v[32:47], v[52:55], a[4:7], v[32:47]
  v_mfma_f32_32x32x16_bf16 v[0:15], a[148:151], v[52:55], v[0:15]
  s_waitcnt lgkmcnt(2)
  v_mfma_f32_32x32x16_bf16 v[16:31], v[120:123], v[56:59], v[16:31]
  ds_read_b128 v[52:55], v64 offset:13312
  v_mfma_f32_32x32x16_bf16 v[32:47], v[56:59], a[8:11], v[32:47]
  v_mfma_f32_32x32x16_bf16 v[0:15], a[152:155], v[56:59], v[0:15]
  s_waitcnt lgkmcnt(2)
  v_mfma_f32_32x32x16_bf16 v[16:31], v[124:127], v[60:63], v[16:31]
  ds_read_b128 v[56:59], v64 offset:14336
  v_mfma_f32_32x32x16_bf16 v[32:47], v[60:63], a[12:15], v[32:47]
  v_mfma_f32_32x32x16_bf16 v[0:15], a[156:159], v[60:63], v[0:15]
  s_waitcnt lgkmcnt(2)
  v_mfma_f32_32x32x16_bf16 v[16:31], v[128:131], v[48:51], v[16:31]
  ds_read_b128 v[60:63], v64 offset:15360
  v_mfma_f32_32x32x16_bf16 v[32:47], v[48:51], a[16:19], v[32:47]
  v_mfma_f32_32x32x16_bf16 v[0:15], a[160:163], v[48:51], v[0:15]
  s_waitcnt lgkmcnt(2)
  v_mfma_f32_32x32x16_bf16 v[16:31], v[132:135], v[52:55], v[16:31]
  ds_read_b128 v[48:51], v64 offset:16384
  v_mfma_f32_32x32x16_bf16 v[32:47], v[52:55], a[20:23], v[32:47]
  v_mfma_f32_32x32x16_bf16 v[0:15], a[164:167], v[52:55], v[0:15]
  s_waitcnt lgkmcnt(2)
  v_mfma_f32_32x32x16_bf16 v[16:31], v[136:139], v[56:59], v[16:31]
  ds_read_b128 v[52:55], v64 offset:17408
  v_mfma_f32_32x32x16_bf16 v[32:47], v[56:59], a[24:27], v[32:47]
  v_mfma_f32_32x32x16_bf16 v[0:15], a[168:171], v[56:59], v[0:15]
  s_waitcnt lgkmcnt(2)
  v_mfma_f32_32x32x16_bf16 v[16:31], v[140:143], v[60:63], v[16:31]
  ds_read_b128 v[56:59], v64 offset:18432
  v_mfma_f32_32x32x16_bf16 v[32:47], v[60:63], a[28:31], v[32:47]
  v_mfma_f32_32x32x16_bf16 v[0:15], a[172:175], v[60:63], v[0:15]
  s_waitcnt lgkmcnt(2)
  v_mfma_f32_32x32x16_bf16 v[16:31], v[144:147], v[48:51], v[16:31]
  ds_read_b128 v[60:63], v64 offset:19456
  v_mfma_f32_32x32x16_bf16 v[32:47], v[48:51], a[32:35], v[32:47]
  v_mfma_f32_32x32x16_bf16 v[0:15], a[176:179], v[48:51], v[0:15]
  s_waitcnt lgkmcnt(2)
  v_mfma_f32_32x32x16_bf16 v[16:31], v[148:151], v[52:55], v[16:31]
  ds_read_b128 v[48:51], v64 offset:20480
  v_mfma_f32_32x32x16_bf16 v[32:47], v[52:55], a[36:39], v[32:47]
  v_mfma_f32_32x32x16_bf16 v[0:15], a[180:183], v[52:55], v[0:15]
  s_waitcnt lgkmcnt(2)
  v_mfma_f32_32x32x16_bf16 v[16:31], v[152:155], v[56:59], v[16:31]
  ds_read_b128 v[52:55], v64 offset:21504
  v_mfma_f32_32x32x16_bf16 v[32:47], v[56:59], a[40:43], v[32:47]
  v_mfma_f32_32x32x16_bf16 v[0:15], a[184:187], v[56:59], v[0:15]
  s_waitcnt lgkmcnt(2)
  v_mfma_f32_32x32x16_bf16 v[16:31], v[156:159], v[60:63], v[16:31]
  ds_read_b128 v[56:59], v64 offset:22528
  v_mfma_f32_32x32x16_bf16 v[32:47], v[60:63], a[44:47], v[32:47]
  v_mfma_f32_32x32x16_bf16 v[0:15], a[188:191], v[60:63], v[0:15]
  s_waitcnt lgkmcnt(2)
  v_mfma_f32_32x32x16_bf16 v[16:31], v[160:163], v[48:51], v[16:31]
  ds_read_b128 v[60:63], v64 offset:23552
  v_mfma_f32_32x32x16_bf16 v[32:47], v[48:51], a[48:51], v[32:47]
  v_mfma_f32_32x32x16_bf16 v[0:15], a[192:195], v[48:51], v[0:15]
  s_waitcnt lgkmcnt(2)
  v_mfma_f32_32x32x16_bf16 v[16:31], v[164:167], v[52:55], v[16:31]
  ds_read_b128 v[48:51], v64 offset:24576
  v_mfma_f32_32x32x16_bf16 v[32:47], v[52:55], a[52:55], v[32:47]
  v_mfma_f32_32x32x16_bf16 v[0:15], a[196:199], v[52:55], v[0:15]
  s_waitcnt lgkmcnt(2)
  v_mfma_f32_32x32x16_bf16 v[16:31], v[168:171], v[56:59], v[16:31]
  ds_read_b128 v[52:55], v64 offset:25600
  v_mfma_f32_32x32x16_bf16 v[32:47], v[56:59], a[56:59], v[32:47]
  v_mfma_f32_32x32x16_bf16 v[0:15], a[200:203], v[56:59], v[0:15]
  s_waitcnt lgkmcnt(2)
  v_mfma_f32_32x32x16_bf16 v[16:31], v[172:175], v[60:63], v[16:31]
  ds_read_b128 v[56:59], v64 offset:26624
  v_mfma_f32_32x32x16_bf16 v[32:47], v[60:63], a[60:63], v[32:47]
  v_mfma_f32_32x32x16_bf16 v[0:15], a[204:207], v[60:63], v[0:15]
  s_waitcnt lgkmcnt(2)
  v_mfma_f32_32x32x16_bf16 v[16:31], v[176:179], v[48:51], v[16:31]
  ds_read_b128 v[60:63], v64 offset:27648
  v_mfma_f32_32x32x16_bf16 v[32:47], v[48:51], a[64:67], v[32:47]
  v_mfma_f32_32x32x16_bf16 v[0:15], a[208:211], v[48:51], v[0:15]
  s_waitcnt lgkmcnt(2)
  v_mfma_f32_32x32x16_bf16 v[16:31], v[180:183], v[52:55], v[16:31]
  ds_read_b128 v[48:51], v64 offset:28672
  v_mfma_f32_32x32x16_bf16 v[32:47], v[52:55], a[68:71], v[32:47]
  v_mfma_f32_32x32x16_bf16 v[0:15], a[212:215], v[52:55], v[0:15]
  s_waitcnt lgkmcnt(2)
  v_mfma_f32_32x32x16_bf16 v[16:31], v[184:187], v[56:59], v[16:31]
  ds_read_b128 v[52:55], v64 offset:29696
  v_mfma_f32_32x32x16_bf16 v[32:47], v[56:59], a[72:75], v[32:47]
  v_mfma_f32_32x32x16_bf16 v[0:15], a[216:219], v[56:59], v[0:15]
  s_waitcnt lgkmcnt(2)
  v_mfma_f32_32x32x16_bf16 v[16:31], v[188:191], v[60:63], v[16:31]
  ds_read_b128 v[56:59], v64 offset:30720
  v_mfma_f32_32x32x16_bf16 v[32:47], v[60:63], a[76:79], v[32:47]
  v_mfma_f32_32x32x16_bf16 v[0:15], a[220:223], v[60:63], v[0:15]
  s_waitcnt lgkmcnt(2)
  v_mfma_f32_32x32x16_bf16 v[16:31], v[192:195], v[48:51], v[16:31]
  ds_read_b128 v[60:63], v64 offset:31744
  v_mfma_f32_32x32x16_bf16 v[32:47], v[48:51], a[80:83], v[32:47]
  v_mfma_f32_32x32x16_bf16 v[0:15], a[224:227], v[48:51], v[0:15]
  s_waitcnt lgkmcnt(2)
  v_mfma_f32_32x32x16_bf16 v[16:31], v[196:199], v[52:55], v[16:31]
  ds_read_b128 v[48:51], v64 offset:32768
  v_mfma_f32_32x32x16_bf16 v[32:47], v[52:55], a[84:87], v[32:47]
  v_mfma_f32_32x32x16_bf16 v[0:15], a[228:231], v[52:55], v[0:15]
  s_waitcnt lgkmcnt(2)
  v_mfma_f32_32x32x16_bf16 v[16:31], v[200:203], v[56:59], v[16:31]
  ds_read_b128 v[52:55], v64 offset:33792
  v_mfma_f32_32x32x16_bf16 v[32:47], v[56:59], a[88:91], v[32:47]
  v_mfma_f32_32x32x16_bf16 v[0:15], a[232:235], v[56:59], v[0:15]
  s_waitcnt lgkmcnt(2)
  v_mfma_f32_32x32x16_bf16 v[16:31], v[204:207], v[60:63], v[16:31]
  ds_read_b128 v[56:59], v64 offset:34816
  v_mfma_f32_32x32x16_bf16 v[32:47], v[60:63], a[92:95], v[32:47]
  v_mfma_f32_32x32x16_bf16 v[0:15], a[236:239], v[60:63], v[0:15]
  s_waitcnt lgkmcnt(2)
  v_mfma_f32_32x32x16_bf16 v[16:31], v[208:211], v[48:51], v[16:31]
  ds_read_b128 v[60:63], v64 offset:35840
  v_mfma_f32_32x32x16_bf16 v[32:47], v[48:51], a[96:99], v[32:47]
  v_mfma_f32_32x32x16_bf16 v[0:15], a[240:243], v[48:51], v[0:15]
  s_waitcnt lgkmcnt(2)
  v_mfma_f32_32x32x16_bf16 v[16:31], v[212:215], v[52:55], v[16:31]
  v_mfma_f32_32x32x16_bf16 v[32:47], v[52:55], a[100:103], v[32:47]
  v_mfma_f32_32x32x16_bf16 v[0:15], a[244:247], v[52:55], v[0:15]
  s_waitcnt lgkmcnt(1)
  v_mfma_f32_32x32x16_bf16 v[16:31], v[216:219], v[56:59], v[16:31]
  v_mfma_f32_32x32x16_bf16 v[32:47], v[56:59], a[104:107], v[32:47]
  v_mfma_f32_32x32x16_bf16 v[0:15], a[248:251], v[56:59], v[0:15]
  s_waitcnt lgkmcnt(0)
  v_mfma_f32_32x32x16_bf16 v[16:31], v[220:223], v[60:63], v[16:31]
  v_mfma_f32_32x32x16_bf16 v[32:47], v[60:63], a[108:111], v[32:47]
  v_mfma_f32_32x32x16_bf16 v[0:15], a[252:255], v[60:63], v[0:15]
  v_add_u32 v64, s23, v73
  v_add_u32 v65, s23, v75
  v_add_u32 v66, s23, v74
  s_add_u32 s42, s22, 16777216
  v_cvt_pk_bf16_f32 v16, v16, v17
  v_cvt_pk_bf16_f32 v17, v18, v19
  v_cvt_pk_bf16_f32 v18, v20, v21
  v_cvt_pk_bf16_f32 v19, v22, v23
  v_cvt_pk_bf16_f32 v20, v24, v25
  v_cvt_pk_bf16_f32 v21, v26, v27
  v_cvt_pk_bf16_f32 v22, v28, v29
  v_cvt_pk_bf16_f32 v23, v30, v31
  buffer_store_dwordx4 v[16:19], v73, s[8:11], s22 offen offset:0 sc1
  ds_write_b128 v64, v[16:19] offset:8192
  buffer_store_dwordx4 v[20:23], v73, s[8:11], s22 offen offset:512 sc1
  ds_write_b128 v64, v[20:23] offset:8704
  v_cvt_pk_bf16_f32 v32, v32, v33
  v_cvt_pk_bf16_f32 v33, v34, v35
  v_cvt_pk_bf16_f32 v34, v36, v37
  v_cvt_pk_bf16_f32 v35, v38, v39
  v_cvt_pk_bf16_f32 v36, v40, v41
  v_cvt_pk_bf16_f32 v37, v42, v43
  v_cvt_pk_bf16_f32 v38, v44, v45
  v_cvt_pk_bf16_f32 v39, v46, v47
  buffer_store_dwordx4 v[32:35], v75, s[8:11], s42 offen offset:0 sc1
  ds_write_b128 v65, v[32:35] offset:16384
  buffer_store_dwordx4 v[36:39], v75, s[8:11], s42 offen offset:512 sc1
  ds_write_b128 v65, v[36:39] offset:16896
  v_cvt_pk_bf16_f32 v0, v0, v1
  v_cvt_pk_bf16_f32 v1, v2, v3
  v_cvt_pk_bf16_f32 v2, v4, v5
  v_cvt_pk_bf16_f32 v3, v6, v7
  v_cvt_pk_bf16_f32 v4, v8, v9
  v_cvt_pk_bf16_f32 v5, v10, v11
  v_cvt_pk_bf16_f32 v6, v12, v13
  v_cvt_pk_bf16_f32 v7, v14, v15
  ds_write_b128 v66, v[0:3] offset:0
  ds_write_b128 v66, v[4:7] offset:512
  s_add_u32 s18, s18, 1
  s_add_u32 s22, s22, 524288
  s_add_u32 s23, s23, 24576
  s_cmp_ge_u32 s23, 147456
  s_cselect_b32 s23, 73728, s23
  s_waitcnt lgkmcnt(0)
  s_branch Lq_att
Lq_noprod:
  s_waitcnt vmcnt(0)
  s_barrier
  s_cmp_eq_u32 s13, 0
  s_cbranch_scc0 Lfs_83
  v_mov_b32 v65, s19
  s_mov_b64 exec, 1
  buffer_store_dword v65, off, s[8:11], s25 sc1
  s_mov_b64 exec, -1
Lfs_83:
  s_cmp_ge_u32 s19, 32
  s_cbranch_scc1 Lq_end
Lq_att:
  s_and_b32 s42, s13, 1
  s_lshl_b32 s42, s42, 12
  s_add_u32 s42, s42, s29
  v_add_u32 v64, s42, v72
  v_add_u32 v65, s29, v72
  ds_read_b128 v[0:3], v64 offset:0
  ds_read_b128 v[4:7], v64 offset:1024
  ds_read_b128 v[8:11], v64 offset:2048
  ds_read_b128 v[12:15], v64 offset:3072
  ds_read_b128 v[16:19], v65 offset:8192
  ds_read_b128 v[20:23], v65 offset:9216
  ds_read_b128 v[24:27], v65 offset:10240
  ds_read_b128 v[28:31], v65 offset:11264
  ds_read_b128 v[32:35], v65 offset:12288
  ds_read_b128 v[36:39], v65 offset:13312
  s_waitcnt lgkmcnt(5)
  v_mfma_f32_16x16x32_bf16 v[68:71], v[16:19], v[0:3], 0
  s_waitcnt lgkmcnt(4)
  v_mfma_f32_16x16x32_bf16 v[68:71], v[20:23], v[4:7], v[68:71]
  s_waitcnt lgkmcnt(3)
  v_mfma_f32_16x16x32_bf16 v[68:71], v[24:27], v[8:11], v[68:71]
  s_waitcnt lgkmcnt(2)
  v_mfma_f32_16x16x32_bf16 v[68:71], v[28:31], v[12:15], v[68:71]
  ds_read_b128 v[16:19], v65 offset:14336
  ds_read_b128 v[20:23], v65 offset:15360
  s_waitcnt lgkmcnt(3)
  v_mfma_f32_16x16x32_bf16 v[44:47], v[32:35], v[0:3], 0
  s_waitcnt lgkmcnt(2)
  v_mfma_f32_16x16x32_bf16 v[44:47], v[36:39], v[4:7], v[44:47]
  s_waitcnt lgkmcnt(1)
  v_mfma_f32_16x16x32_bf16 v[44:47], v[16:19], v[8:11], v[44:47]
  s_waitcnt lgkmcnt(0)
  v_mfma_f32_16x16x32_bf16 v[44:47], v[20:23], v[12:15], v[44:47]
  s_cmp_eq_u32 s18, s33
  s_cbranch_scc1 Lkvf_84
  s_mov_b32 s33, s18
  s_waitcnt vmcnt(0)
  s_barrier
  s_cmp_eq_u32 s13, 1
  s_cbranch_scc0 Lfs_85
  v_mov_b32 v67, s18
  s_mov_b64 exec, 1
  buffer_store_dword v67, off, s[8:11], s24 sc1
  s_mov_b64 exec, -1
Lfs_85:
Lkvf_84:
  s_lshr_b32 s42, s13, 1
  s_lshl_b32 s45, s42, 11
  s_add_u32 s45, s45, s28
  s_add_u32 s45, s45, 8388608
  s_lshl_b32 s42, s42, 12
  v_add_u32 v65, s42, v65
  s_cmp_eq_u32 s13, 3
  s_cbranch_scc0 Low_86
Lkw_87:
  buffer_load_dword v66, off, s[8:11], s28 sc1
  s_waitcnt vmcnt(0)
  v_cmp_eq_u32 vcc, -1, v66
  s_cbranch_vccz Lkwo_88
  s_sleep 2
  s_sub_u32 s15, s15, 1
  s_cbranch_scc0 Lkw_87
  s_mov_b32 s15, 0
Lkwo_88:
Low_86:
  s_barrier
Lkm_89:
  buffer_load_dwordx4 v[48:51], v76, s[8:11], s28 offen offset:0 sc1
  buffer_load_dwordx4 v[52:55], v76, s[8:11], s28 offen offset:512 sc1
  buffer_load_dwordx4 v[56:59], v76, s[8:11], s28 offen offset:1024 sc1
  buffer_load_dwordx4 v[60:63], v76, s[8:11], s28 offen offset:1536 sc1
  buffer_load_dwordx4 v[32:35], v72, s[8:11], s45 offen sc1
  buffer_load_dwordx4 v[36:39], v72, s[8:11], s45 offen offset:1024 sc1
  s_waitcnt vmcnt(3)
  v_max3_u32 v66, v48, v52, v56
  s_waitcnt vmcnt(1)
  v_max3_u32 v66, v66, v60, v32
  s_waitcnt vmcnt(0)
  v_max_u32 v66, v66, v36
  v_cmp_eq_u32 vcc, -1, v66
  s_cbranch_vccz Lkmo_90
  s_sub_u32 s15, s15, 1
  s_cbranch_scc0 Lkm_89
  s_mov_b32 s15, 0
Lkmo_90:
  ds_read_b128 v[16:19], v65 offset:16384
  ds_read_b128 v[20:23], v65 offset:17408
  ds_read_b128 v[24:27], v65 offset:18432
  ds_read_b128 v[28:31], v65 offset:19456
  v_mov_b32 v66, 0xff800000
  v_cndmask_b32 v68, v66, v68, s[64:65]
  v_cndmask_b32 v69, v66, v69, s[66:67]
  v_cndmask_b32 v70, v66, v70, s[68:69]
  v_cndmask_b32 v71, v66, v71, s[70:71]
  v_cndmask_b32 v44, v66, v44, s[72:73]
  v_cndmask_b32 v45, v66, v45, s[74:75]
  v_cndmask_b32 v46, v66, v46, s[76:77]
  v_cndmask_b32 v47, v66, v47, s[78:79]
  v_max3_f32 v64, v68, v69, v70
  v_max3_f32 v64, v64, v71, v44
  v_max3_f32 v64, v64, v45, v46
  v_max_f32 v64, v64, v47
  v_mfma_f32_16x16x32_bf16 v[40:43], v[48:51], v[0:3], 0
  v_mfma_f32_16x16x32_bf16 v[40:43], v[52:55], v[4:7], v[40:43]
  v_mfma_f32_16x16x32_bf16 v[40:43], v[56:59], v[8:11], v[40:43]
  v_mfma_f32_16x16x32_bf16 v[40:43], v[60:63], v[12:15], v[40:43]
  s_nop 7
  v_max3_f32 v64, v64, v40, v41
  v_max3_f32 v64, v64, v42, v43
  v_mov_b32 v66, v64
  s_nop 1
  v_permlane16_swap_b32 v64, v66
  v_max_f32 v64, v64, v66
  v_mov_b32 v66, v64
  s_nop 1
  v_permlane32_swap_b32 v64, v66
  v_max_f32 v64, v64, v66
  v_mul_f32 v64, s20, v64
  v_fma_f32 v68, v68, s20, -v64
  v_fma_f32 v69, v69, s20, -v64
  v_fma_f32 v70, v70, s20, -v64
  v_fma_f32 v71, v71, s20, -v64
  v_fma_f32 v44, v44, s20, -v64
  v_fma_f32 v45, v45, s20, -v64
  v_fma_f32 v46, v46, s20, -v64
  v_fma_f32 v47, v47, s20, -v64
  v_fma_f32 v40, v40, s20, -v64
  v_fma_f32 v41, v41, s20, -v64
  v_fma_f32 v42, v42, s20, -v64
  v_fma_f32 v43, v43, s20, -v64
  v_exp_f32 v68, v68
  v_exp_f32 v69, v69
  v_exp_f32 v70, v70
  v_exp_f32 v71, v71
  v_exp_f32 v44, v44
  v_exp_f32 v45, v45
  v_exp_f32 v46, v46
  v_exp_f32 v47, v47
  v_exp_f32 v40, v40
  v_exp_f32 v41, v41
  v_exp_f32 v42, v42
  v_exp_f32 v43, v43
  v_cvt_pk_bf16_f32 v48, v68, v69
  v_cvt_pk_bf16_f32 v49, v70, v71
  v_cvt_pk_bf16_f32 v50, v44, v45
  v_cvt_pk_bf16_f32 v51, v46, v47
  v_cvt_pk_bf16_f32 v52, v40, v41
  v_cvt_pk_bf16_f32 v53, v42, v43
  s_waitcnt lgkmcnt(3)
  v_mfma_f32_16x16x32_bf16 v[0:3], v[16:19], v[48:51], 0
  s_waitcnt lgkmcnt(2)
  v_mfma_f32_16x16x32_bf16 v[4:7], v[20:23], v[48:51], 0
  s_waitcnt lgkmcnt(1)
  v_mfma_f32_16x16x32_bf16 v[8:11], v[24:27], v[48:51], 0
  s_waitcnt lgkmcnt(0)
  v_mfma_f32_16x16x32_bf16 v[12:15], v[28:31], v[48:51], 0
  v_mfma_f32_16x16x16_bf16 v[0:3], v[32:33], v[52:53], v[0:3]
  v_mfma_f32_16x16x16_bf16 v[4:7], v[34:35], v[52:53], v[4:7]
  v_mfma_f32_16x16x16_bf16 v[8:11], v[36:37], v[52:53], v[8:11]
  v_mfma_f32_16x16x16_bf16 v[12:15], v[38:39], v[52:53], v[12:15]
  v_add_f32 v64, v40, v41
  v_add_f32 v65, v42, v43
  v_add_f32 v64, v64, v65
  v_mul_f32 v64, 0.5, v64
  v_add_f32 v64, v64, v68
  v_add_f32 v64, v64, v69
  v_add_f32 v64, v64, v70
  v_add_f32 v64, v64, v71
  v_add_f32 v64, v64, v44
  v_add_f32 v64, v64, v45
  v_add_f32 v64, v64, v46
  v_add_f32 v64, v64, v47
  v_mov_b32 v66, v64
  s_nop 1
  v_permlane16_swap_b32 v64, v66
  v_add_f32 v64, v64, v66
  v_mov_b32 v66, v64
  s_nop 1
  v_permlane32_swap_b32 v64, v66
  v_add_f32 v64, v64, v66
  v_rcp_f32 v64, v64
  s_nop 0
  v_mul_f32 v0, v0, v64
  v_mul_f32 v1, v1, v64
  v_mul_f32 v2, v2, v64
  v_mul_f32 v3, v3, v64
  v_mul_f32 v4, v4, v64
  v_mul_f32 v5, v5, v64
  v_mul_f32 v6, v6, v64
  v_mul_f32 v7, v7, v64
  v_mul_f32 v8, v8, v64
  v_mul_f32 v9, v9, v64
  v_mul_f32 v10, v10, v64
  v_mul_f32 v11, v11, v64
  v_mul_f32 v12, v12, v64
  v_mul_f32 v13, v13, v64
  v_mul_f32 v14, v14, v64
  v_mul_f32 v15, v15, v64
  v_cvt_pk_bf16_f32 v0, v0, v1
  v_cvt_pk_bf16_f32 v1, v2, v3
  v_cvt_pk_bf16_f32 v2, v4, v5
  v_cvt_pk_bf16_f32 v3, v6, v7
  v_cvt_pk_bf16_f32 v4, v8, v9
  v_cvt_pk_bf16_f32 v5, v10, v11
  v_cvt_pk_bf16_f32 v6, v12, v13
  v_cvt_pk_bf16_f32 v7, v14, v15
  buffer_store_dwordx4 v[0:3], v72, s[8:11], s27 offen sc1
  buffer_store_dwordx4 v[4:7], v72, s[8:11], s27 offen offset:1024 sc1
  s_add_u32 s19, s19, 1
  s_add_u32 s27, s27, 524288
  s_add_u32 s28, s28, 262144
  s_add_u32 s29, s29, 24576
  s_cmp_ge_u32 s29, 147456
  s_cselect_b32 s29, 73728, s29
  s_mov_b32 s30, 1
  s_branch Lq_loop
Lq_end:
  s_branch Lend
Lchain:
  s_getpc_b64 s[20:21]
Lpc_91:
  s_add_u32 s20, s20, Lpf2-Lpc_91
  s_addc_u32 s21, s21, 0
  v_and_b32 v251, 63, v0
  v_lshlrev_b32 v251, 6, v251
  s_lshl_b32 s22, s13, 12
  v_add_u32 v251, s22, v251
  global_load_dword v250, v251, s[20:21]
  v_add_u32 v251, 16384, v251
  global_load_dword v250, v251, s[20:21]
  v_add_u32 v251, Lc_last0_top-Lpf2-28672, v251
  global_load_dword v250, v251, s[20:21]
Lpf2:
  v_and_b32 v1, 63, v0
  v_lshlrev_b32 v74, 4, v1
  v_and_b32 v2, 15, v1
  v_lshrrev_b32 v3, 4, v1
  v_mov_b32 v4, 0x4444
  v_mov_b32 v5, 0xeeee
  v_cmp_gt_u32 vcc, 8, v2
  s_nop 1
  v_cndmask_b32 v73, v5, v4, vcc
  s_mov_b32 s20, 0x00ff00ff
  s_mov_b32 s21, 0x00ff00ff
  v_and_b32 v4, 7, v1
  v_lshlrev_b32 v4, 4, v4
  v_lshl_add_u32 v4, v3, 7, v4
  v_add_u32 v75, 147456, v4
  v_lshrrev_b32 v5, 3, v2
  v_lshl_add_u32 v79, v5, 9, v75
  v_lshrrev_b32 v4, 1, v3
  v_lshl_add_u32 v4, v4, 4, v2
  v_lshlrev_b32 v4, 4, v4
  v_and_b32 v5, 1, v3
  v_lshl_add_u32 v77, v5, 3, v4
  v_lshrrev_b32 v4, 1, v3
  v_lshlrev_b32 v4, 4, v4
  v_lshl_add_u32 v4, v5, 2, v4
  v_lshrrev_b32 v6, 2, v2
  v_add_u32 v4, v4, v6
  v_lshlrev_b32 v4, 4, v4
  v_and_b32 v6, 1, v2
  v_lshl_add_u32 v4, v6, 3, v4
  v_add_u32 v76, 156672, v4
  s_lshl_b32 s42, s13, 11
  v_add_u32 v78, s42, v74
  s_mov_b32 s22, 0x3e0293ee
  s_lshl_b32 s42, s13, 9
  s_add_u32 s37, s42, 156672
  s_add_u32 s39, s42, 9216
  s_add_u32 s38, s42, 13312
  s_mov_b32 s46, 0x70
  s_cmp_eq_u32 s13, 3
  s_cselect_b32 s42, 1024, 0
  v_add_u32 v76, s42, v76
  s_mov_b32 s52, 82944
  s_mov_b32 s53, 165888
  s_mov_b32 s54, 248832
  s_cmp_eq_u32 s13, 1
  s_cselect_b32 s41, 40, 0
  s_cmp_eq_u32 s13, 2
  s_cselect_b32 s41, 32, s41
  s_add_u32 s41, s41, s12
  s_cmp_ge_u32 s12, 8
  s_cselect_b32 s42, -1, s41
  s_cmp_eq_u32 s13, 2
  s_cselect_b32 s41, s42, s41
  s_lshl_b32 s42, s12, 7
  s_add_u32 s56, s42, 8192
  s_mov_b32 s45, 0
  s_lshl_b32 s27, s41, 7
  s_mov_b32 s40, s27
  s_add_u32 s27, s27, 262144
  s_add_u32 s52, s52, s27
  s_add_u32 s53, s53, s27
  s_add_u32 s54, s54, s27
  s_mul_i32 s42, s45, 331776
  s_mul_i32 s43, s12, 10368
  s_add_u32 s42, s42, s43
  s_add_u32 s42, s42, 262144
  s_lshl_b32 s43, s13, 9
  s_add_u32 s23, s42, s43
  s_lshr_b32 s43, s13, 1
  s_lshl_b32 s43, s43, 9
  s_and_b32 s44, s13, 1
  s_mul_i32 s44, s44, 5120
  s_add_u32 s42, s42, s43
  s_add_u32 s42, s42, s44
  s_add_u32 s24, s42, 4096
  s_add_u32 s31, s23, 5120
  s_add_u32 s40, s40, 147456
  s_cmp_eq_u32 s13, 0
  s_cbranch_scc0 Lc_ann
  s_or_b32 s42, s47, 0x80
  s_add_u32 s43, s12, 128
  v_mov_b32 v1, s42
  v_mov_b32 v2, s43
  s_mov_b64 exec, 1
  global_store_byte v2, v1, s[16:17] sc0 sc1
  s_mov_b64 exec, -1
Lc_ann:
  s_load_dwordx2 s[4:5], s[0:1], 8
  s_mov_b32 s6, 9216
  s_mov_b32 s7, 0x20000
  s_waitcnt lgkmcnt(0)
  s_lshl_b32 s42, s13, 10
  v_add_u32 v32, s42, v74
  v_lshrrev_b32 v33, 7, v32
  v_bfe_u32 v34, v32, 4, 3
  v_mul_u32_u24 v34, 1152, v34
  v_lshl_add_u32 v33, v33, 4, v34
  buffer_load_dwordx4 v[52:55], v33, s[4:7], 0 offen
  buffer_load_dwordx4 v[56:59], v33, s[4:7], 0 offen offset:512
  buffer_load_dwordx4 v[64:67], v33, s[4:7], 0 offen offset:640
  v_lshrrev_b32 v35, 7, v74
  v_lshl_add_u32 v35, v35, 4, v34
  buffer_load_dwordx4 v[60:63], v35, s[4:7], 0 offen offset:1024
  s_add_u32 s42, s42, 152576
  v_add_u32 v72, s42, v74
  s_mul_i32 s58, s12, 9216
  s_add_u32 s58, s58, 1490944
  s_mov_b32 s14, 0
  s_mov_b32 s59, 0
  s_mov_b32 s25, 0
  s_mov_b32 s28, 1434624
  s_mov_b32 s29, 1443840
  s_mov_b32 s18, 1425408
  s_lshl_b32 s43, s12, 12
  s_cmp_eq_u32 s13, 3
  s_cselect_b32 s44, 1024, 0
  s_add_u32 s35, s43, s44
  s_add_u32 s35, s35, 8241152
  s_lshl_b32 s44, s13, 10
  s_add_u32 s36, s43, s44
  s_add_u32 s36, s36, 16777216
  s_lshl_b32 s43, s12, 13
  s_lshl_b32 s44, s13, 11
  s_add_u32 s34, s43, s44
  s_add_u32 s34, s34, 50331648
  s_add_u32 s33, s43, 33816576
  s_sub_u32 s44, s13, 1
  s_lshl_b32 s44, s44, 12
  s_add_u32 s32, s33, s44
  s_lshl_b32 s19, s12, 7
  s_add_u32 s19, s19, 0
  s_xor_b32 s55, s19, 4096
  v_bfe_u32 v47, v74, 4, 3
  v_lshlrev_b32 v47, 2, v47
  v_add_u32 v47, 128, v47
  v_mov_b32 v48, 0
  v_lshrrev_b32 v1, 4, v74
  v_lshrrev_b32 v2, 4, v1
  v_and_b32 v3, 15, v1
  v_lshrrev_b32 v4, 2, v3
  v_and_b32 v5, 1, v2
  v_xor_b32 v6, v4, v5
  v_lshlrev_b32 v6, 6, v6
  v_and_b32 v7, 3, v3
  v_lshl_add_u32 v6, v7, 4, v6
  v_lshl_add_u32 v32, v2, 13, v6
  v_xor_b32 v33, 128, v32
  v_lshrrev_b32 v8, 1, v2
  v_and_b32 v9, 1, v4
  v_lshrrev_b32 v10, 1, v4
  v_lshlrev_b32 v11, 3, v8
  v_lshl_add_u32 v11, v5, 2, v11
  v_add_u32 v11, v11, v9
  v_lshlrev_b32 v11, 8, v11
  v_lshl_add_u32 v12, v5, 1, v9
  v_xor_b32 v12, s13, v12
  v_lshl_add_u32 v11, v12, 6, v11
  v_lshl_add_u32 v11, v7, 3, v11
  v_lshl_add_u32 v34, v10, 5, v11
  v_lshl_add_u32 v35, v10, 13, v11
  v_lshlrev_b32 v11, 4, v5
  v_lshl_add_u32 v11, v8, 2, v11
  v_add_u32 v11, v11, v9
  v_mul_u32_u24 v11, 1152, v11
  v_lshl_add_u32 v11, v10, 5, v11
  v_lshl_add_u32 v11, v7, 3, v11
  s_lshl_b32 s42, s13, 6
  v_add_u32 v36, s42, v11
  s_lshr_b32 s42, s13, 1
  s_lshl_b32 s42, s42, 6
  s_add_u32 s42, s42, 512
  s_add_u32 s42, s42, 98304
  v_add_u32 v37, s42, v11
  v_add_u32 v36, 98304, v36
  s_load_dwordx2 s[60:61], s[0:1], 16
  s_load_dwordx2 s[64:65], s[0:1], 24
  s_load_dwordx2 s[68:69], s[0:1], 32
  s_load_dwordx2 s[4:5], s[0:1], 40
  s_mov_b32 s62, 4718592
  s_mov_b32 s63, 0x20000
  s_mov_b32 s66, 4718592
  s_mov_b32 s67, 0x20000
  s_mov_b32 s70, 4718592
  s_mov_b32 s71, 0x20000
  s_mov_b32 s6, 4718592
  s_mov_b32 s7, 0x20000
  s_mul_i32 s72, s12, 147456
  s_lshl_b32 s42, s13, 10
  s_add_u32 s72, s72, s42
  s_lshl_b32 s73, s13, 17
  s_lshl_b32 s43, s12, 8
  s_add_u32 s73, s73, s43
  s_lshl_b32 s74, s13, 12
  s_lshl_b32 s75, s13, 10
  s_mov_b32 s76, 13
  s_mov_b32 s78, s73
  v_mov_b32 v49, v32
  v_mov_b32 v50, v33
  s_waitcnt lgkmcnt(0)
  s_add_u32 m0, s75, 98304
  s_add_u32 s42, s72, 0
  buffer_load_dwordx4 v74, s[4:7], s42 offen lds
  s_add_u32 m0, s75, 102400
  s_add_u32 s42, s72, 4096
  buffer_load_dwordx4 v74, s[4:7], s42 offen lds
  s_add_u32 m0, s75, 106496
  s_add_u32 s42, s72, 8192
  buffer_load_dwordx4 v74, s[4:7], s42 offen lds
  s_add_u32 m0, s75, 110592
  s_add_u32 s42, s72, 12288
  buffer_load_dwordx4 v74, s[4:7], s42 offen lds
  s_add_u32 m0, s75, 114688
  s_add_u32 s42, s72, 16384
  buffer_load_dwordx4 v74, s[4:7], s42 offen lds
  s_add_u32 m0, s75, 118784
  s_add_u32 s42, s72, 20480
  buffer_load_dwordx4 v74, s[4:7], s42 offen lds
  s_add_u32 m0, s75, 122880
  s_add_u32 s42, s72, 24576
  buffer_load_dwordx4 v74, s[4:7], s42 offen lds
  s_add_u32 m0, s75, 126976
  s_add_u32 s42, s72, 28672
  buffer_load_dwordx4 v74, s[4:7], s42 offen lds
  s_add_u32 m0, s75, 131072
  s_add_u32 s42, s72, 32768
  buffer_load_dwordx4 v74, s[4:7], s42 offen lds
  s_add_u32 m0, s74, 16384
  s_add_u32 s42, s73, 524288
  buffer_load_dwordx4 v32, s[64:67], s42 offen sc1 lds
  s_add_u32 m0, s74, 17408
  s_add_u32 s42, s73, 557056
  buffer_load_dwordx4 v33, s[64:67], s42 offen sc1 lds
  s_add_u32 m0, s74, 18432
  s_add_u32 s42, s73, 589824
  buffer_load_dwordx4 v32, s[64:67], s42 offen sc1 lds
  s_add_u32 m0, s74, 19456
  s_add_u32 s42, s73, 622592
  buffer_load_dwordx4 v33, s[64:67], s42 offen sc1 lds
  s_add_u32 m0, s74, 49152
  s_add_u32 s42, s73, 2097152
  buffer_load_dwordx4 v32, s[64:67], s42 offen sc1 lds
  s_add_u32 m0, s74, 50176
  s_add_u32 s42, s73, 2129920
  buffer_load_dwordx4 v33, s[64:67], s42 offen sc1 lds
  s_add_u32 m0, s74, 51200
  s_add_u32 s42, s73, 2162688
  buffer_load_dwordx4 v32, s[64:67], s42 offen sc1 lds
  s_add_u32 m0, s74, 52224
  s_add_u32 s42, s73, 2195456
  buffer_load_dwordx4 v33, s[64:67], s42 offen sc1 lds
  s_add_u32 m0, s74, 81920
  s_add_u32 s42, s73, 3670016
  buffer_load_dwordx4 v32, s[64:67], s42 offen sc1 lds
  s_add_u32 m0, s74, 82944
  s_add_u32 s42, s73, 3702784
  buffer_load_dwordx4 v33, s[64:67], s42 offen sc1 lds
  s_add_u32 m0, s74, 83968
  s_add_u32 s42, s73, 3735552
  buffer_load_dwordx4 v32, s[64:67], s42 offen sc1 lds
  s_add_u32 m0, s74, 84992
  s_add_u32 s42, s73, 3768320
  buffer_load_dwordx4 v33, s[64:67], s42 offen sc1 lds
  s_add_u32 m0, s74, 0
  s_add_u32 s42, s73, 0
  buffer_load_dwordx4 v32, s[64:67], s42 offen sc1 lds
  s_add_u32 m0, s74, 1024
  s_add_u32 s42, s73, 32768
  buffer_load_dwordx4 v33, s[64:67], s42 offen sc1 lds
  s_add_u32 m0, s74, 2048
  s_add_u32 s42, s73, 65536
  buffer_load_dwordx4 v32, s[64:67], s42 offen sc1 lds
  s_add_u32 m0, s74, 3072
  s_add_u32 s42, s73, 98304
  buffer_load_dwordx4 v33, s[64:67], s42 offen sc1 lds
  s_add_u32 m0, s74, 32768
  s_add_u32 s42, s73, 1048576
  buffer_load_dwordx4 v32, s[64:67], s42 offen sc1 lds
  s_add_u32 m0, s74, 33792
  s_add_u32 s42, s73, 1081344
  buffer_load_dwordx4 v33, s[64:67], s42 offen sc1 lds
  s_add_u32 m0, s74, 34816
  s_add_u32 s42, s73, 1114112
  buffer_load_dwordx4 v32, s[64:67], s42 offen sc1 lds
  s_add_u32 m0, s74, 35840
  s_add_u32 s42, s73, 1146880
  buffer_load_dwordx4 v33, s[64:67], s42 offen sc1 lds
  s_add_u32 m0, s74, 65536
  s_add_u32 s42, s73, 1572864
  buffer_load_dwordx4 v32, s[64:67], s42 offen sc1 lds
  s_add_u32 m0, s74, 66560
  s_add_u32 s42, s73, 1605632
  buffer_load_dwordx4 v33, s[64:67], s42 offen sc1 lds
  s_add_u32 m0, s74, 67584
  s_add_u32 s42, s73, 1638400
  buffer_load_dwordx4 v32, s[64:67], s42 offen sc1 lds
  s_add_u32 m0, s74, 68608
  s_add_u32 s42, s73, 1671168
  buffer_load_dwordx4 v33, s[64:67], s42 offen sc1 lds
  s_add_u32 m0, s74, 147456
  s_add_u32 s42, s73, 2621440
  buffer_load_dwordx4 v32, s[64:67], s42 offen sc1 lds
  s_add_u32 m0, s74, 148480
  s_add_u32 s42, s73, 2654208
  buffer_load_dwordx4 v33, s[64:67], s42 offen sc1 lds
  s_add_u32 m0, s74, 149504
  s_add_u32 s42, s73, 2686976
  buffer_load_dwordx4 v32, s[64:67], s42 offen sc1 lds
  s_add_u32 m0, s74, 150528
  s_add_u32 s42, s73, 2719744
  buffer_load_dwordx4 v33, s[64:67], s42 offen sc1 lds
  s_mov_b32 s79, 0
  s_waitcnt vmcnt(28) lgkmcnt(0)
  s_barrier
  buffer_store_dwordx4 v[64:67], v72, s[8:11], s58 offen sc1
  ds_read_b64_tr_b16 a[144:145], v36 offset:0
  ds_read_b64_tr_b16 a[146:147], v36 offset:2304
  ds_read_b64_tr_b16 a[148:149], v36 offset:9216
  ds_read_b64_tr_b16 a[150:151], v36 offset:11520
  ds_read_b64_tr_b16 a[152:153], v36 offset:256
  ds_read_b64_tr_b16 a[154:155], v36 offset:2560
  ds_read_b64_tr_b16 a[156:157], v36 offset:9472
  ds_read_b64_tr_b16 a[158:159], v36 offset:11776
  ds_read_b64_tr_b16 a[160:161], v36 offset:640
  ds_read_b64_tr_b16 a[162:163], v36 offset:2944
  ds_read_b64_tr_b16 a[164:165], v36 offset:9856
  ds_read_b64_tr_b16 a[166:167], v36 offset:12160
  ds_read_b64_tr_b16 a[168:169], v36 offset:896
  ds_read_b64_tr_b16 a[170:171], v36 offset:3200
  ds_read_b64_tr_b16 a[172:173], v36 offset:10112
  ds_read_b64_tr_b16 a[174:175], v36 offset:12416
  s_bitcmp1_b32 s13, 0
  s_cbranch_scc1 Los_92
  ds_read_b64_tr_b16 a[240:241], v37 offset:0
  ds_read_b64_tr_b16 a[242:243], v37 offset:2304
  ds_read_b64_tr_b16 a[244:245], v37 offset:9216
  ds_read_b64_tr_b16 a[246:247], v37 offset:11520
Los_92:
  s_waitcnt vmcnt(25) lgkmcnt(0)
  s_barrier
  s_add_u32 m0, s75, 98304
  s_add_u32 s42, s72, 36864
  buffer_load_dwordx4 v74, s[4:7], s42 offen lds
  s_add_u32 m0, s75, 102400
  s_add_u32 s42, s72, 40960
  buffer_load_dwordx4 v74, s[4:7], s42 offen lds
  s_add_u32 m0, s75, 106496
  s_add_u32 s42, s72, 45056
  buffer_load_dwordx4 v74, s[4:7], s42 offen lds
  s_add_u32 m0, s75, 110592
  s_add_u32 s42, s72, 49152
  buffer_load_dwordx4 v74, s[4:7], s42 offen lds
  s_add_u32 m0, s75, 114688
  s_add_u32 s42, s72, 53248
  buffer_load_dwordx4 v74, s[4:7], s42 offen lds
  s_add_u32 m0, s75, 118784
  s_add_u32 s42, s72, 57344
  buffer_load_dwordx4 v74, s[4:7], s42 offen lds
  s_add_u32 m0, s75, 122880
  s_add_u32 s42, s72, 61440
  buffer_load_dwordx4 v74, s[4:7], s42 offen lds
  s_add_u32 m0, s75, 126976
  s_add_u32 s42, s72, 65536
  buffer_load_dwordx4 v74, s[4:7], s42 offen lds
  s_add_u32 m0, s75, 131072
  s_add_u32 s42, s72, 69632
  buffer_load_dwordx4 v74, s[4:7], s42 offen lds
  v_add_u32 v38, 16384, v34
  ds_read_b64_tr_b16 v[0:1], v38 offset:0
  ds_read_b64_tr_b16 v[2:3], v38 offset:512
  ds_read_b64_tr_b16 v[4:5], v38 offset:4096
  ds_read_b64_tr_b16 v[6:7], v38 offset:4608
  ds_read_b64_tr_b16 v[8:9], v38 offset:8192
  ds_read_b64_tr_b16 v[10:11], v38 offset:8704
  ds_read_b64_tr_b16 v[12:13], v38 offset:12288
  ds_read_b64_tr_b16 v[14:15], v38 offset:12800
  s_waitcnt vmcnt(30) lgkmcnt(0)
  s_barrier
  v_add_u32 v39, 16384, v78
  ds_write_b128 v39, v[0:3]
  ds_write_b128 v39, v[4:7] offset:1024
  v_add_u32 v39, 24576, v78
  ds_write_b128 v39, v[8:11]
  ds_write_b128 v39, v[12:15] offset:1024
  v_add_u32 v38, 49152, v34
  ds_read_b64_tr_b16 v[0:1], v38 offset:0
  ds_read_b64_tr_b16 v[2:3], v38 offset:512
  ds_read_b64_tr_b16 v[4:5], v38 offset:4096
  ds_read_b64_tr_b16 v[6:7], v38 offset:4608
  ds_read_b64_tr_b16 v[8:9], v38 offset:8192
  ds_read_b64_tr_b16 v[10:11], v38 offset:8704
  ds_read_b64_tr_b16 v[12:13], v38 offset:12288
  ds_read_b64_tr_b16 v[14:15], v38 offset:12800
  s_waitcnt vmcnt(26) lgkmcnt(0)
  s_barrier
  v_add_u32 v39, 49152, v78
  ds_write_b128 v39, v[0:3]
  ds_write_b128 v39, v[4:7] offset:1024
  v_add_u32 v39, 57344, v78
  ds_write_b128 v39, v[8:11]
  ds_write_b128 v39, v[12:15] offset:1024
  v_add_u32 v38, 81920, v34
  ds_read_b64_tr_b16 v[0:1], v38 offset:0
  ds_read_b64_tr_b16 v[2:3], v38 offset:512
  ds_read_b64_tr_b16 v[4:5], v38 offset:4096
  ds_read_b64_tr_b16 v[6:7], v38 offset:4608
  ds_read_b64_tr_b16 v[8:9], v38 offset:8192
  ds_read_b64_tr_b16 v[10:11], v38 offset:8704
  ds_read_b64_tr_b16 v[12:13], v38 offset:12288
  ds_read_b64_tr_b16 v[14:15], v38 offset:12800
  s_waitcnt vmcnt(22) lgkmcnt(0)
  s_barrier
  v_add_u32 v39, 81920, v78
  ds_write_b128 v39, v[0:3]
  ds_write_b128 v39, v[4:7] offset:1024
  v_add_u32 v39, 90112, v78
  ds_write_b128 v39, v[8:11]
  ds_write_b128 v39, v[12:15] offset:1024
  v_add_u32 v38, 0, v34
  ds_read_b64_tr_b16 v[80:81], v38 offset:0
  ds_read_b64_tr_b16 v[82:83], v38 offset:512
  ds_read_b64_tr_b16 v[84:85], v38 offset:4096
  ds_read_b64_tr_b16 v[86:87], v38 offset:4608
  ds_read_b64_tr_b16 v[88:89], v38 offset:8192
  ds_read_b64_tr_b16 v[90:91], v38 offset:8704
  ds_read_b64_tr_b16 v[92:93], v38 offset:12288
  ds_read_b64_tr_b16 v[94:95], v38 offset:12800
  s_waitcnt vmcnt(18) lgkmcnt(0)
  s_barrier
  s_add_u32 m0, s74, 0
  s_add_u32 s42, s73, 3145728
  buffer_load_dwordx4 v32, s[64:67], s42 offen sc1 lds
  s_add_u32 m0, s74, 1024
  s_add_u32 s42, s73, 3178496
  buffer_load_dwordx4 v33, s[64:67], s42 offen sc1 lds
  s_add_u32 m0, s74, 2048
  s_add_u32 s42, s73, 3211264
  buffer_load_dwordx4 v32, s[64:67], s42 offen sc1 lds
  s_add_u32 m0, s74, 3072
  s_add_u32 s42, s73, 3244032
  buffer_load_dwordx4 v33, s[64:67], s42 offen sc1 lds
  v_add_u32 v38, 32768, v34
  ds_read_b64_tr_b16 v[120:121], v38 offset:0
  ds_read_b64_tr_b16 v[122:123], v38 offset:512
  ds_read_b64_tr_b16 v[124:125], v38 offset:4096
  ds_read_b64_tr_b16 v[126:127], v38 offset:4608
  ds_read_b64_tr_b16 v[136:137], v38 offset:8192
  ds_read_b64_tr_b16 v[138:139], v38 offset:8704
  ds_read_b64_tr_b16 v[140:141], v38 offset:12288
  ds_read_b64_tr_b16 v[142:143], v38 offset:12800
  s_waitcnt vmcnt(18) lgkmcnt(0)
  s_barrier
  s_add_u32 m0, s74, 32768
  s_add_u32 s42, s73, 4194304
  buffer_load_dwordx4 v32, s[64:67], s42 offen sc1 lds
  s_add_u32 m0, s74, 33792
  s_add_u32 s42, s73, 4227072
  buffer_load_dwordx4 v33, s[64:67], s42 offen sc1 lds
  s_add_u32 m0, s74, 34816
  s_add_u32 s42, s73, 4259840
  buffer_load_dwordx4 v32, s[64:67], s42 offen sc1 lds
  s_add_u32 m0, s74, 35840
  s_add_u32 s42, s73, 4292608
  buffer_load_dwordx4 v33, s[64:67], s42 offen sc1 lds
  v_add_u32 v38, 65536, v34
  ds_read_b64_tr_b16 v[144:145], v38 offset:0
  ds_read_b64_tr_b16 v[146:147], v38 offset:512
  ds_read_b64_tr_b16 v[148:149], v38 offset:4096
  ds_read_b64_tr_b16 v[150:151], v38 offset:4608
  ds_read_b64_tr_b16 v[152:153], v38 offset:8192
  ds_read_b64_tr_b16 v[154:155], v38 offset:8704
  ds_read_b64_tr_b16 v[156:157], v38 offset:12288
  ds_read_b64_tr_b16 v[158:159], v38 offset:12800
  s_waitcnt vmcnt(18) lgkmcnt(0)
  s_barrier
  s_add_u32 m0, s74, 65536
  s_lshl_b32 s42, 64, s76
  s_add_u32 s42, s42, s78
  buffer_load_dwordx4 v49, s[60:63], s42 offen sc1 lds
  s_add_u32 m0, s74, 66560
  s_lshl_b32 s42, 68, s76
  s_add_u32 s42, s42, s78
  buffer_load_dwordx4 v50, s[60:63], s42 offen sc1 lds
  s_add_u32 m0, s74, 67584
  s_lshl_b32 s42, 72, s76
  s_add_u32 s42, s42, s78
  buffer_load_dwordx4 v49, s[60:63], s42 offen sc1 lds
  s_add_u32 m0, s74, 68608
  s_lshl_b32 s42, 76, s76
  s_add_u32 s42, s42, s78
  buffer_load_dwordx4 v50, s[60:63], s42 offen sc1 lds
  v_add_u32 v38, 147456, v34
  ds_read_b64_tr_b16 v[184:185], v38 offset:0
  ds_read_b64_tr_b16 v[186:187], v38 offset:512
  ds_read_b64_tr_b16 v[188:189], v38 offset:4096
  ds_read_b64_tr_b16 v[190:191], v38 offset:4608
  ds_read_b64_tr_b16 v[200:201], v38 offset:8192
  ds_read_b64_tr_b16 v[202:203], v38 offset:8704
  ds_read_b64_tr_b16 v[204:205], v38 offset:12288
  ds_read_b64_tr_b16 v[206:207], v38 offset:12800
  s_waitcnt vmcnt(12) lgkmcnt(0)
  s_barrier
  s_add_u32 m0, s74, 147456
  s_lshl_b32 s42, 128, s76
  s_add_u32 s42, s42, s78
  buffer_load_dwordx4 v49, s[60:63], s42 offen sc1 lds
  s_add_u32 m0, s74, 148480
  s_lshl_b32 s42, 132, s76
  s_add_u32 s42, s42, s78
  buffer_load_dwordx4 v50, s[60:63], s42 offen sc1 lds
  s_add_u32 m0, s74, 149504
  s_lshl_b32 s42, 136, s76
  s_add_u32 s42, s42, s78
  buffer_load_dwordx4 v49, s[60:63], s42 offen sc1 lds
  s_add_u32 m0, s74, 150528
  s_lshl_b32 s42, 140, s76
  s_add_u32 s42, s42, s78
  buffer_load_dwordx4 v50, s[60:63], s42 offen sc1 lds
  ds_read_b64_tr_b16 a[176:177], v36 offset:0
  ds_read_b64_tr_b16 a[178:179], v36 offset:2304
  ds_read_b64_tr_b16 a[180:181], v36 offset:9216
  ds_read_b64_tr_b16 a[182:183], v36 offset:11520
  ds_read_b64_tr_b16 a[184:185], v36 offset:256
  ds_read_b64_tr_b16 a[186:187], v36 offset:2560
  ds_read_b64_tr_b16 a[188:189], v36 offset:9472
  ds_read_b64_tr_b16 a[190:191], v36 offset:11776
  ds_read_b64_tr_b16 a[192:193], v36 offset:640
  ds_read_b64_tr_b16 a[194:195], v36 offset:2944
  ds_read_b64_tr_b16 a[196:197], v36 offset:9856
  ds_read_b64_tr_b16 a[198:199], v36 offset:12160
  ds_read_b64_tr_b16 a[200:201], v36 offset:896
  ds_read_b64_tr_b16 a[202:203], v36 offset:3200
  ds_read_b64_tr_b16 a[204:205], v36 offset:10112
  ds_read_b64_tr_b16 a[206:207], v36 offset:12416
  s_bitcmp0_b32 s13, 0
  s_cbranch_scc1 Los_93
  ds_read_b64_tr_b16 a[240:241], v37 offset:0
  ds_read_b64_tr_b16 a[242:243], v37 offset:2304
  ds_read_b64_tr_b16 a[244:245], v37 offset:9216
  ds_read_b64_tr_b16 a[246:247], v37 offset:11520
Los_93:
  s_waitcnt vmcnt(12) lgkmcnt(0)
  s_barrier
  s_add_u32 m0, s75, 98304
  s_add_u32 s42, s72, 73728
  buffer_load_dwordx4 v74, s[4:7], s42 offen lds
  s_add_u32 m0, s75, 102400
  s_add_u32 s42, s72, 77824
  buffer_load_dwordx4 v74, s[4:7], s42 offen lds
  s_add_u32 m0, s75, 106496
  s_add_u32 s42, s72, 81920
  buffer_load_dwordx4 v74, s[4:7], s42 offen lds
  s_add_u32 m0, s75, 110592
  s_add_u32 s42, s72, 86016
  buffer_load_dwordx4 v74, s[4:7], s42 offen lds
  s_add_u32 m0, s75, 114688
  s_add_u32 s42, s72, 90112
  buffer_load_dwordx4 v74, s[4:7], s42 offen lds
  s_add_u32 m0, s75, 118784
  s_add_u32 s42, s72, 94208
  buffer_load_dwordx4 v74, s[4:7], s42 offen lds
  s_add_u32 m0, s75, 122880
  s_add_u32 s42, s72, 98304
  buffer_load_dwordx4 v74, s[4:7], s42 offen lds
  s_add_u32 m0, s75, 126976
  s_add_u32 s42, s72, 102400
  buffer_load_dwordx4 v74, s[4:7], s42 offen lds
  s_add_u32 m0, s75, 131072
  s_add_u32 s42, s72, 106496
  buffer_load_dwordx4 v74, s[4:7], s42 offen lds
  v_add_u32 v38, 0, v34
  ds_read_b64_tr_b16 v[208:209], v38 offset:0
  ds_read_b64_tr_b16 v[210:211], v38 offset:512
  ds_read_b64_tr_b16 v[212:213], v38 offset:4096
  ds_read_b64_tr_b16 v[214:215], v38 offset:4608
  ds_read_b64_tr_b16 v[216:217], v38 offset:8192
  ds_read_b64_tr_b16 v[218:219], v38 offset:8704
  ds_read_b64_tr_b16 v[220:221], v38 offset:12288
  ds_read_b64_tr_b16 v[222:223], v38 offset:12800
  s_waitcnt vmcnt(17) lgkmcnt(0)
  s_barrier
  s_add_u32 m0, s74, 0
  s_lshl_b32 s42, 256, s76
  s_add_u32 s42, s42, s78
  buffer_load_dwordx4 v49, s[60:63], s42 offen sc1 lds
  s_add_u32 m0, s74, 1024
  s_lshl_b32 s42, 260, s76
  s_add_u32 s42, s42, s78
  buffer_load_dwordx4 v50, s[60:63], s42 offen sc1 lds
  s_add_u32 m0, s74, 2048
  s_lshl_b32 s42, 264, s76
  s_add_u32 s42, s42, s78
  buffer_load_dwordx4 v49, s[60:63], s42 offen sc1 lds
  s_add_u32 m0, s74, 3072
  s_lshl_b32 s42, 268, s76
  s_add_u32 s42, s42, s78
  buffer_load_dwordx4 v50, s[60:63], s42 offen sc1 lds
  v_add_u32 v38, 32768, v34
  ds_read_b64_tr_b16 v[248:249], v38 offset:0
  ds_read_b64_tr_b16 v[250:251], v38 offset:512
  ds_read_b64_tr_b16 v[252:253], v38 offset:4096
  ds_read_b64_tr_b16 v[254:255], v38 offset:4608
  ds_read_b64_tr_b16 a[8:9], v38 offset:8192
  ds_read_b64_tr_b16 a[10:11], v38 offset:8704
  ds_read_b64_tr_b16 a[12:13], v38 offset:12288
  ds_read_b64_tr_b16 a[14:15], v38 offset:12800
  s_waitcnt vmcnt(17) lgkmcnt(0)
  s_barrier
  s_add_u32 m0, s74, 32768
  s_lshl_b32 s42, 320, s76
  s_add_u32 s42, s42, s78
  buffer_load_dwordx4 v49, s[60:63], s42 offen sc1 lds
  s_add_u32 m0, s74, 33792
  s_lshl_b32 s42, 324, s76
  s_add_u32 s42, s42, s78
  buffer_load_dwordx4 v50, s[60:63], s42 offen sc1 lds
  s_add_u32 m0, s74, 34816
  s_lshl_b32 s42, 328, s76
  s_add_u32 s42, s42, s78
  buffer_load_dwordx4 v49, s[60:63], s42 offen sc1 lds
  s_add_u32 m0, s74, 35840
  s_lshl_b32 s42, 332, s76
  s_add_u32 s42, s42, s78
  buffer_load_dwordx4 v50, s[60:63], s42 offen sc1 lds
  v_add_u32 v38, 65536, v34
  ds_read_b64_tr_b16 v[96:97], v38 offset:0
  ds_read_b64_tr_b16 v[98:99], v38 offset:512
  ds_read_b64_tr_b16 v[100:101], v38 offset:4096
  ds_read_b64_tr_b16 v[102:103], v38 offset:4608
  ds_read_b64_tr_b16 v[104:105], v38 offset:8192
  ds_read_b64_tr_b16 v[106:107], v38 offset:8704
  ds_read_b64_tr_b16 v[108:109], v38 offset:12288
  ds_read_b64_tr_b16 v[110:111], v38 offset:12800
  s_waitcnt vmcnt(17) lgkmcnt(0)
  s_barrier
  s_add_u32 m0, s74, 65536
  s_lshl_b32 s42, 448, s76
  s_add_u32 s42, s42, s78
  buffer_load_dwordx4 v49, s[60:63], s42 offen sc1 lds
  s_add_u32 m0, s74, 66560
  s_lshl_b32 s42, 452, s76
  s_add_u32 s42, s42, s78
  buffer_load_dwordx4 v50, s[60:63], s42 offen sc1 lds
  s_add_u32 m0, s74, 67584
  s_lshl_b32 s42, 456, s76
  s_add_u32 s42, s42, s78
  buffer_load_dwordx4 v49, s[60:63], s42 offen sc1 lds
  s_add_u32 m0, s74, 68608
  s_lshl_b32 s42, 460, s76
  s_add_u32 s42, s42, s78
  buffer_load_dwordx4 v50, s[60:63], s42 offen sc1 lds
  v_add_u32 v38, 147456, v34
  ds_read_b64_tr_b16 v[112:113], v38 offset:0
  ds_read_b64_tr_b16 v[114:115], v38 offset:512
  ds_read_b64_tr_b16 v[116:117], v38 offset:4096
  ds_read_b64_tr_b16 v[118:119], v38 offset:4608
  ds_read_b64_tr_b16 v[128:129], v38 offset:8192
  ds_read_b64_tr_b16 v[130:131], v38 offset:8704
  ds_read_b64_tr_b16 v[132:133], v38 offset:12288
  ds_read_b64_tr_b16 v[134:135], v38 offset:12800
  s_waitcnt vmcnt(12) lgkmcnt(0)
  s_barrier
  s_add_u32 m0, s74, 147456
  s_lshl_b32 s42, 512, s76
  s_add_u32 s42, s42, s78
  buffer_load_dwordx4 v49, s[60:63], s42 offen sc1 lds
  s_add_u32 m0, s74, 148480
  s_lshl_b32 s42, 516, s76
  s_add_u32 s42, s42, s78
  buffer_load_dwordx4 v50, s[60:63], s42 offen sc1 lds
  s_add_u32 m0, s74, 149504
  s_lshl_b32 s42, 520, s76
  s_add_u32 s42, s42, s78
  buffer_load_dwordx4 v49, s[60:63], s42 offen sc1 lds
  s_add_u32 m0, s74, 150528
  s_lshl_b32 s42, 524, s76
  s_add_u32 s42, s42, s78
  buffer_load_dwordx4 v50, s[60:63], s42 offen sc1 lds
  ds_read_b64_tr_b16 a[208:209], v36 offset:0
  ds_read_b64_tr_b16 a[210:211], v36 offset:2304
  ds_read_b64_tr_b16 a[212:213], v36 offset:9216
  ds_read_b64_tr_b16 a[214:215], v36 offset:11520
  ds_read_b64_tr_b16 a[216:217], v36 offset:256
  ds_read_b64_tr_b16 a[218:219], v36 offset:2560
  ds_read_b64_tr_b16 a[220:221], v36 offset:9472
  ds_read_b64_tr_b16 a[222:223], v36 offset:11776
  ds_read_b64_tr_b16 a[224:225], v36 offset:640
  ds_read_b64_tr_b16 a[226:227], v36 offset:2944
  ds_read_b64_tr_b16 a[228:229], v36 offset:9856
  ds_read_b64_tr_b16 a[230:231], v36 offset:12160
  ds_read_b64_tr_b16 a[232:233], v36 offset:896
  ds_read_b64_tr_b16 a[234:235], v36 offset:3200
  ds_read_b64_tr_b16 a[236:237], v36 offset:10112
  ds_read_b64_tr_b16 a[238:239], v36 offset:12416
  s_bitcmp1_b32 s13, 0
  s_cbranch_scc1 Los_94
  ds_read_b64_tr_b16 a[248:249], v37 offset:0
  ds_read_b64_tr_b16 a[250:251], v37 offset:2304
  ds_read_b64_tr_b16 a[252:253], v37 offset:9216
  ds_read_b64_tr_b16 a[254:255], v37 offset:11520
Los_94:
  s_waitcnt vmcnt(12) lgkmcnt(0)
  s_barrier
  s_add_u32 m0, s75, 98304
  s_add_u32 s42, s72, 110592
  buffer_load_dwordx4 v74, s[4:7], s42 offen lds
  s_add_u32 m0, s75, 102400
  s_add_u32 s42, s72, 114688
  buffer_load_dwordx4 v74, s[4:7], s42 offen lds
  s_add_u32 m0, s75, 106496
  s_add_u32 s42, s72, 118784
  buffer_load_dwordx4 v74, s[4:7], s42 offen lds
  s_add_u32 m0, s75, 110592
  s_add_u32 s42, s72, 122880
  buffer_load_dwordx4 v74, s[4:7], s42 offen lds
  s_add_u32 m0, s75, 114688
  s_add_u32 s42, s72, 126976
  buffer_load_dwordx4 v74, s[4:7], s42 offen lds
  s_add_u32 m0, s75, 118784
  s_add_u32 s42, s72, 131072
  buffer_load_dwordx4 v74, s[4:7], s42 offen lds
  s_add_u32 m0, s75, 122880
  s_add_u32 s42, s72, 135168
  buffer_load_dwordx4 v74, s[4:7], s42 offen lds
  s_add_u32 m0, s75, 126976
  s_add_u32 s42, s72, 139264
  buffer_load_dwordx4 v74, s[4:7], s42 offen lds
  s_add_u32 m0, s75, 131072
  s_add_u32 s42, s72, 143360
  buffer_load_dwordx4 v74, s[4:7], s42 offen lds
  v_add_u32 v38, 0, v34
  ds_read_b64_tr_b16 v[160:161], v38 offset:0
  ds_read_b64_tr_b16 v[162:163], v38 offset:512
  ds_read_b64_tr_b16 v[164:165], v38 offset:4096
  ds_read_b64_tr_b16 v[166:167], v38 offset:4608
  ds_read_b64_tr_b16 v[168:169], v38 offset:8192
  ds_read_b64_tr_b16 v[170:171], v38 offset:8704
  ds_read_b64_tr_b16 v[172:173], v38 offset:12288
  ds_read_b64_tr_b16 v[174:175], v38 offset:12800
  s_waitcnt vmcnt(17) lgkmcnt(0)
  s_barrier
  s_add_u32 m0, s74, 0
  s_lshl_b32 s42, 0, s76
  s_add_u32 s42, s42, s78
  buffer_load_dwordx4 v49, s[68:71], s42 offen sc1 lds
  s_add_u32 m0, s74, 1024
  s_lshl_b32 s42, 4, s76
  s_add_u32 s42, s42, s78
  buffer_load_dwordx4 v50, s[68:71], s42 offen sc1 lds
  s_add_u32 m0, s74, 2048
  s_lshl_b32 s42, 8, s76
  s_add_u32 s42, s42, s78
  buffer_load_dwordx4 v49, s[68:71], s42 offen sc1 lds
  s_add_u32 m0, s74, 3072
  s_lshl_b32 s42, 12, s76
  s_add_u32 s42, s42, s78
  buffer_load_dwordx4 v50, s[68:71], s42 offen sc1 lds
  v_add_u32 v38, 32768, v34
  ds_read_b64_tr_b16 v[176:177], v38 offset:0
  ds_read_b64_tr_b16 v[178:179], v38 offset:512
  ds_read_b64_tr_b16 v[180:181], v38 offset:4096
  ds_read_b64_tr_b16 v[182:183], v38 offset:4608
  ds_read_b64_tr_b16 v[192:193], v38 offset:8192
  ds_read_b64_tr_b16 v[194:195], v38 offset:8704
  ds_read_b64_tr_b16 v[196:197], v38 offset:12288
  ds_read_b64_tr_b16 v[198:199], v38 offset:12800
  s_waitcnt vmcnt(17) lgkmcnt(0)
  s_barrier
  s_add_u32 m0, s74, 32768
  s_lshl_b32 s42, 64, s76
  s_add_u32 s42, s42, s78
  buffer_load_dwordx4 v49, s[68:71], s42 offen sc1 lds
  s_add_u32 m0, s74, 33792
  s_lshl_b32 s42, 68, s76
  s_add_u32 s42, s42, s78
  buffer_load_dwordx4 v50, s[68:71], s42 offen sc1 lds
  s_add_u32 m0, s74, 34816
  s_lshl_b32 s42, 72, s76
  s_add_u32 s42, s42, s78
  buffer_load_dwordx4 v49, s[68:71], s42 offen sc1 lds
  s_add_u32 m0, s74, 35840
  s_lshl_b32 s42, 76, s76
  s_add_u32 s42, s42, s78
  buffer_load_dwordx4 v50, s[68:71], s42 offen sc1 lds
  v_add_u32 v38, 65536, v34
  ds_read_b64_tr_b16 v[224:225], v38 offset:0
  ds_read_b64_tr_b16 v[226:227], v38 offset:512
  ds_read_b64_tr_b16 v[228:229], v38 offset:4096
  ds_read_b64_tr_b16 v[230:231], v38 offset:4608
  ds_read_b64_tr_b16 v[232:233], v38 offset:8192
  ds_read_b64_tr_b16 v[234:235], v38 offset:8704
  ds_read_b64_tr_b16 v[236:237], v38 offset:12288
  ds_read_b64_tr_b16 v[238:239], v38 offset:12800
  s_waitcnt vmcnt(17) lgkmcnt(0)
  s_barrier
  s_add_u32 m0, s74, 65536
  s_lshl_b32 s42, 128, s76
  s_add_u32 s42, s42, s78
  buffer_load_dwordx4 v49, s[68:71], s42 offen sc1 lds
  s_add_u32 m0, s74, 66560
  s_lshl_b32 s42, 132, s76
  s_add_u32 s42, s42, s78
  buffer_load_dwordx4 v50, s[68:71], s42 offen sc1 lds
  s_add_u32 m0, s74, 67584
  s_lshl_b32 s42, 136, s76
  s_add_u32 s42, s42, s78
  buffer_load_dwordx4 v49, s[68:71], s42 offen sc1 lds
  s_add_u32 m0, s74, 68608
  s_lshl_b32 s42, 140, s76
  s_add_u32 s42, s42, s78
  buffer_load_dwordx4 v50, s[68:71], s42 offen sc1 lds
  v_add_u32 v38, 147456, v34
  ds_read_b64_tr_b16 v[240:241], v38 offset:0
  ds_read_b64_tr_b16 v[242:243], v38 offset:512
  ds_read_b64_tr_b16 v[244:245], v38 offset:4096
  ds_read_b64_tr_b16 v[246:247], v38 offset:4608
  ds_read_b64_tr_b16 a[0:1], v38 offset:8192
  ds_read_b64_tr_b16 a[2:3], v38 offset:8704
  ds_read_b64_tr_b16 a[4:5], v38 offset:12288
  ds_read_b64_tr_b16 a[6:7], v38 offset:12800
  s_waitcnt vmcnt(12) lgkmcnt(0)
  s_barrier
  s_add_u32 m0, s74, 147456
  s_lshl_b32 s42, 192, s76
  s_add_u32 s42, s42, s78
  buffer_load_dwordx4 v49, s[68:71], s42 offen sc1 lds
  s_add_u32 m0, s74, 148480
  s_lshl_b32 s42, 196, s76
  s_add_u32 s42, s42, s78
  buffer_load_dwordx4 v50, s[68:71], s42 offen sc1 lds
  s_add_u32 m0, s74, 149504
  s_lshl_b32 s42, 200, s76
  s_add_u32 s42, s42, s78
  buffer_load_dwordx4 v49, s[68:71], s42 offen sc1 lds
  s_add_u32 m0, s74, 150528
  s_lshl_b32 s42, 204, s76
  s_add_u32 s42, s42, s78
  buffer_load_dwordx4 v50, s[68:71], s42 offen sc1 lds
  s_cmp_eq_u32 s13, 3
  s_cbranch_scc1 Lo3_95
  ds_read_b64_tr_b16 v[0:1], v36 offset:0
  ds_read_b64_tr_b16 v[2:3], v36 offset:2304
  ds_read_b64_tr_b16 v[4:5], v36 offset:9216
  ds_read_b64_tr_b16 v[6:7], v36 offset:11520
  ds_read_b64_tr_b16 v[8:9], v36 offset:256
  ds_read_b64_tr_b16 v[10:11], v36 offset:2560
  ds_read_b64_tr_b16 v[12:13], v36 offset:9472
  ds_read_b64_tr_b16 v[14:15], v36 offset:11776
  ds_read_b64_tr_b16 v[16:17], v36 offset:640
  ds_read_b64_tr_b16 v[18:19], v36 offset:2944
  ds_read_b64_tr_b16 v[20:21], v36 offset:9856
  ds_read_b64_tr_b16 v[22:23], v36 offset:12160
  ds_read_b64_tr_b16 v[24:25], v36 offset:896
  ds_read_b64_tr_b16 v[26:27], v36 offset:3200
  ds_read_b64_tr_b16 v[28:29], v36 offset:10112
  ds_read_b64_tr_b16 v[30:31], v36 offset:12416
  s_branch Lo3j_96
Lo3_95:
  s_waitcnt lgkmcnt(0)
  v_accvgpr_read_b32 v0, a208
  v_accvgpr_read_b32 v1, a209
  v_accvgpr_read_b32 v2, a210
  v_accvgpr_read_b32 v3, a211
  v_accvgpr_read_b32 v4, a212
  v_accvgpr_read_b32 v5, a213
  v_accvgpr_read_b32 v6, a214
  v_accvgpr_read_b32 v7, a215
  v_accvgpr_read_b32 v8, a216
  v_accvgpr_read_b32 v9, a217
  v_accvgpr_read_b32 v10, a218
  v_accvgpr_read_b32 v11, a219
  v_accvgpr_read_b32 v12, a220
  v_accvgpr_read_b32 v13, a221
  v_accvgpr_read_b32 v14, a222
  v_accvgpr_read_b32 v15, a223
  v_accvgpr_read_b32 v16, a224
  v_accvgpr_read_b32 v17, a225
  v_accvgpr_read_b32 v18, a226
  v_accvgpr_read_b32 v19, a227
  v_accvgpr_read_b32 v20, a228
  v_accvgpr_read_b32 v21, a229
  v_accvgpr_read_b32 v22, a230
  v_accvgpr_read_b32 v23, a231
  v_accvgpr_read_b32 v24, a232
  v_accvgpr_read_b32 v25, a233
  v_accvgpr_read_b32 v26, a234
  v_accvgpr_read_b32 v27, a235
  v_accvgpr_read_b32 v28, a236
  v_accvgpr_read_b32 v29, a237
  v_accvgpr_read_b32 v30, a238
  v_accvgpr_read_b32 v31, a239
  ds_read_b64_tr_b16 a[208:209], v36 offset:0
  ds_read_b64_tr_b16 a[210:211], v36 offset:2304
  ds_read_b64_tr_b16 a[212:213], v36 offset:9216
  ds_read_b64_tr_b16 a[214:215], v36 offset:11520
  ds_read_b64_tr_b16 a[216:217], v36 offset:256
  ds_read_b64_tr_b16 a[218:219], v36 offset:2560
  ds_read_b64_tr_b16 a[220:221], v36 offset:9472
  ds_read_b64_tr_b16 a[222:223], v36 offset:11776
  ds_read_b64_tr_b16 a[224:225], v36 offset:640
  ds_read_b64_tr_b16 a[226:227], v36 offset:2944
  ds_read_b64_tr_b16 a[228:229], v36 offset:9856
  ds_read_b64_tr_b16 a[230:231], v36 offset:12160
  ds_read_b64_tr_b16 a[232:233], v36 offset:896
  ds_read_b64_tr_b16 a[234:235], v36 offset:3200
  ds_read_b64_tr_b16 a[236:237], v36 offset:10112
  ds_read_b64_tr_b16 a[238:239], v36 offset:12416
Lo3j_96:
  s_bitcmp0_b32 s13, 0
  s_cbranch_scc1 Los_97
  ds_read_b64_tr_b16 a[248:249], v37 offset:0
  ds_read_b64_tr_b16 a[250:251], v37 offset:2304
  ds_read_b64_tr_b16 a[252:253], v37 offset:9216
  ds_read_b64_tr_b16 a[254:255], v37 offset:11520
Los_97:
  s_waitcnt vmcnt(12) lgkmcnt(0)
  s_barrier
  v_add_u32 v39, 98304, v78
  ds_write_b128 v39, v[0:3]
  ds_write_b128 v39, v[4:7] offset:1024
  v_add_u32 v39, 106496, v78
  ds_write_b128 v39, v[8:11]
  ds_write_b128 v39, v[12:15] offset:1024
  v_add_u32 v39, 114688, v78
  ds_write_b128 v39, v[16:19]
  ds_write_b128 v39, v[20:23] offset:1024
  v_add_u32 v39, 122880, v78
  ds_write_b128 v39, v[24:27]
  ds_write_b128 v39, v[28:31] offset:1024
  s_add_u32 m0, s74, 131072
  s_lshl_b32 s42, 256, s76
  s_add_u32 s42, s42, s78
  buffer_load_dwordx4 v49, s[68:71], s42 offen sc1 lds
  s_add_u32 m0, s74, 132096
  s_lshl_b32 s42, 260, s76
  s_add_u32 s42, s42, s78
  buffer_load_dwordx4 v50, s[68:71], s42 offen sc1 lds
  s_add_u32 m0, s74, 133120
  s_lshl_b32 s42, 264, s76
  s_add_u32 s42, s42, s78
  buffer_load_dwordx4 v49, s[68:71], s42 offen sc1 lds
  s_add_u32 m0, s74, 134144
  s_lshl_b32 s42, 268, s76
  s_add_u32 s42, s42, s78
  buffer_load_dwordx4 v50, s[68:71], s42 offen sc1 lds
  v_add_u32 v38, 0, v35
  ds_read_b64_tr_b16 a[16:17], v38 offset:0
  ds_read_b64_tr_b16 a[18:19], v38 offset:512
  ds_read_b64_tr_b16 a[20:21], v38 offset:4096
  ds_read_b64_tr_b16 a[22:23], v38 offset:4608
  ds_read_b64_tr_b16 a[24:25], v38 offset:32
  ds_read_b64_tr_b16 a[26:27], v38 offset:544
  ds_read_b64_tr_b16 a[28:29], v38 offset:4128
  ds_read_b64_tr_b16 a[30:31], v38 offset:4640
  s_waitcnt vmcnt(12) lgkmcnt(0)
  s_barrier
  s_add_u32 m0, s74, 0
  s_lshl_b32 s42, 320, s76
  s_add_u32 s42, s42, s78
  buffer_load_dwordx4 v49, s[68:71], s42 offen sc1 lds
  s_add_u32 m0, s74, 1024
  s_lshl_b32 s42, 324, s76
  s_add_u32 s42, s42, s78
  buffer_load_dwordx4 v50, s[68:71], s42 offen sc1 lds
  s_add_u32 m0, s74, 2048
  s_lshl_b32 s42, 328, s76
  s_add_u32 s42, s42, s78
  buffer_load_dwordx4 v49, s[68:71], s42 offen sc1 lds
  s_add_u32 m0, s74, 3072
  s_lshl_b32 s42, 332, s76
  s_add_u32 s42, s42, s78
  buffer_load_dwordx4 v50, s[68:71], s42 offen sc1 lds
  v_add_u32 v38, 32768, v35
  ds_read_b64_tr_b16 a[32:33], v38 offset:0
  ds_read_b64_tr_b16 a[34:35], v38 offset:512
  ds_read_b64_tr_b16 a[36:37], v38 offset:4096
  ds_read_b64_tr_b16 a[38:39], v38 offset:4608
  ds_read_b64_tr_b16 a[40:41], v38 offset:32
  ds_read_b64_tr_b16 a[42:43], v38 offset:544
  ds_read_b64_tr_b16 a[44:45], v38 offset:4128
  ds_read_b64_tr_b16 a[46:47], v38 offset:4640
  s_waitcnt vmcnt(12) lgkmcnt(0)
  s_barrier
  s_add_u32 m0, s74, 32768
  s_lshl_b32 s42, 384, s76
  s_add_u32 s42, s42, s78
  buffer_load_dwordx4 v49, s[68:71], s42 offen sc1 lds
  s_add_u32 m0, s74, 33792
  s_lshl_b32 s42, 388, s76
  s_add_u32 s42, s42, s78
  buffer_load_dwordx4 v50, s[68:71], s42 offen sc1 lds
  s_add_u32 m0, s74, 34816
  s_lshl_b32 s42, 392, s76
  s_add_u32 s42, s42, s78
  buffer_load_dwordx4 v49, s[68:71], s42 offen sc1 lds
  s_add_u32 m0, s74, 35840
  s_lshl_b32 s42, 396, s76
  s_add_u32 s42, s42, s78
  buffer_load_dwordx4 v50, s[68:71], s42 offen sc1 lds
  v_add_u32 v38, 65536, v35
  ds_read_b64_tr_b16 a[48:49], v38 offset:0
  ds_read_b64_tr_b16 a[50:51], v38 offset:512
  ds_read_b64_tr_b16 a[52:53], v38 offset:4096
  ds_read_b64_tr_b16 a[54:55], v38 offset:4608
  ds_read_b64_tr_b16 a[56:57], v38 offset:32
  ds_read_b64_tr_b16 a[58:59], v38 offset:544
  ds_read_b64_tr_b16 a[60:61], v38 offset:4128
  ds_read_b64_tr_b16 a[62:63], v38 offset:4640
  s_waitcnt vmcnt(12) lgkmcnt(0)
  s_barrier
  s_add_u32 m0, s74, 65536
  s_lshl_b32 s42, 448, s76
  s_add_u32 s42, s42, s78
  buffer_load_dwordx4 v49, s[68:71], s42 offen sc1 lds
  s_add_u32 m0, s74, 66560
  s_lshl_b32 s42, 452, s76
  s_add_u32 s42, s42, s78
  buffer_load_dwordx4 v50, s[68:71], s42 offen sc1 lds
  s_add_u32 m0, s74, 67584
  s_lshl_b32 s42, 456, s76
  s_add_u32 s42, s42, s78
  buffer_load_dwordx4 v49, s[68:71], s42 offen sc1 lds
  s_add_u32 m0, s74, 68608
  s_lshl_b32 s42, 460, s76
  s_add_u32 s42, s42, s78
  buffer_load_dwordx4 v50, s[68:71], s42 offen sc1 lds
  v_add_u32 v38, 147456, v35
  ds_read_b64_tr_b16 a[64:65], v38 offset:0
  ds_read_b64_tr_b16 a[66:67], v38 offset:512
  ds_read_b64_tr_b16 a[68:69], v38 offset:4096
  ds_read_b64_tr_b16 a[70:71], v38 offset:4608
  ds_read_b64_tr_b16 a[72:73], v38 offset:32
  ds_read_b64_tr_b16 a[74:75], v38 offset:544
  ds_read_b64_tr_b16 a[76:77], v38 offset:4128
  ds_read_b64_tr_b16 a[78:79], v38 offset:4640
  s_waitcnt vmcnt(12) lgkmcnt(0)
  s_barrier
  v_add_u32 v38, 131072, v35
  ds_read_b64_tr_b16 a[80:81], v38 offset:0
  ds_read_b64_tr_b16 a[82:83], v38 offset:512
  ds_read_b64_tr_b16 a[84:85], v38 offset:4096
  ds_read_b64_tr_b16 a[86:87], v38 offset:4608
  ds_read_b64_tr_b16 a[88:89], v38 offset:32
  ds_read_b64_tr_b16 a[90:91], v38 offset:544
  ds_read_b64_tr_b16 a[92:93], v38 offset:4128
  ds_read_b64_tr_b16 a[94:95], v38 offset:4640
  s_waitcnt vmcnt(8) lgkmcnt(0)
  s_barrier
  s_add_u32 m0, s74, 131072
  s_lshl_b32 s42, 512, s76
  s_add_u32 s42, s42, s78
  buffer_load_dwordx4 v49, s[68:71], s42 offen sc1 lds
  s_add_u32 m0, s74, 132096
  s_lshl_b32 s42, 516, s76
  s_add_u32 s42, s42, s78
  buffer_load_dwordx4 v50, s[68:71], s42 offen sc1 lds
  s_add_u32 m0, s74, 133120
  s_lshl_b32 s42, 520, s76
  s_add_u32 s42, s42, s78
  buffer_load_dwordx4 v49, s[68:71], s42 offen sc1 lds
  s_add_u32 m0, s74, 134144
  s_lshl_b32 s42, 524, s76
  s_add_u32 s42, s42, s78
  buffer_load_dwordx4 v50, s[68:71], s42 offen sc1 lds
  v_add_u32 v38, 0, v35
  ds_read_b64_tr_b16 a[96:97], v38 offset:0
  ds_read_b64_tr_b16 a[98:99], v38 offset:512
  ds_read_b64_tr_b16 a[100:101], v38 offset:4096
  ds_read_b64_tr_b16 a[102:103], v38 offset:4608
  ds_read_b64_tr_b16 a[104:105], v38 offset:32
  ds_read_b64_tr_b16 a[106:107], v38 offset:544
  ds_read_b64_tr_b16 a[108:109], v38 offset:4128
  ds_read_b64_tr_b16 a[110:111], v38 offset:4640
  s_waitcnt vmcnt(8) lgkmcnt(0)
  s_barrier
  s_add_u32 m0, s74, 0
  s_lshl_b32 s42, 0, s76
  s_add_u32 s42, s42, s78
  buffer_load_dwordx4 v49, s[60:63], s42 offen sc1 lds
  s_add_u32 m0, s74, 1024
  s_lshl_b32 s42, 4, s76
  s_add_u32 s42, s42, s78
  buffer_load_dwordx4 v50, s[60:63], s42 offen sc1 lds
  s_add_u32 m0, s74, 2048
  s_lshl_b32 s42, 8, s76
  s_add_u32 s42, s42, s78
  buffer_load_dwordx4 v49, s[60:63], s42 offen sc1 lds
  s_add_u32 m0, s74, 3072
  s_lshl_b32 s42, 12, s76
  s_add_u32 s42, s42, s78
  buffer_load_dwordx4 v50, s[60:63], s42 offen sc1 lds
  v_add_u32 v38, 32768, v35
  ds_read_b64_tr_b16 a[112:113], v38 offset:0
  ds_read_b64_tr_b16 a[114:115], v38 offset:512
  ds_read_b64_tr_b16 a[116:117], v38 offset:4096
  ds_read_b64_tr_b16 a[118:119], v38 offset:4608
  ds_read_b64_tr_b16 a[120:121], v38 offset:32
  ds_read_b64_tr_b16 a[122:123], v38 offset:544
  ds_read_b64_tr_b16 a[124:125], v38 offset:4128
  ds_read_b64_tr_b16 a[126:127], v38 offset:4640
  s_waitcnt vmcnt(8) lgkmcnt(0)
  s_barrier
  s_add_u32 m0, s74, 32768
  s_lshl_b32 s42, 192, s76
  s_add_u32 s42, s42, s78
  buffer_load_dwordx4 v49, s[60:63], s42 offen sc1 lds
  s_add_u32 m0, s74, 33792
  s_lshl_b32 s42, 196, s76
  s_add_u32 s42, s42, s78
  buffer_load_dwordx4 v50, s[60:63], s42 offen sc1 lds
  s_add_u32 m0, s74, 34816
  s_lshl_b32 s42, 200, s76
  s_add_u32 s42, s42, s78
  buffer_load_dwordx4 v49, s[60:63], s42 offen sc1 lds
  s_add_u32 m0, s74, 35840
  s_lshl_b32 s42, 204, s76
  s_add_u32 s42, s42, s78
  buffer_load_dwordx4 v50, s[60:63], s42 offen sc1 lds
  v_add_u32 v38, 65536, v35
  ds_read_b64_tr_b16 a[128:129], v38 offset:0
  ds_read_b64_tr_b16 a[130:131], v38 offset:512
  ds_read_b64_tr_b16 a[132:133], v38 offset:4096
  ds_read_b64_tr_b16 a[134:135], v38 offset:4608
  ds_read_b64_tr_b16 a[136:137], v38 offset:32
  ds_read_b64_tr_b16 a[138:139], v38 offset:544
  ds_read_b64_tr_b16 a[140:141], v38 offset:4128
  ds_read_b64_tr_b16 a[142:143], v38 offset:4640
  s_waitcnt vmcnt(8) lgkmcnt(0)
  s_barrier
  s_add_u32 m0, s74, 65536
  s_lshl_b32 s42, 384, s76
  s_add_u32 s42, s42, s78
  buffer_load_dwordx4 v49, s[60:63], s42 offen sc1 lds
  s_add_u32 m0, s74, 66560
  s_lshl_b32 s42, 388, s76
  s_add_u32 s42, s42, s78
  buffer_load_dwordx4 v50, s[60:63], s42 offen sc1 lds
  s_add_u32 m0, s74, 67584
  s_lshl_b32 s42, 392, s76
  s_add_u32 s42, s42, s78
  buffer_load_dwordx4 v49, s[60:63], s42 offen sc1 lds
  s_add_u32 m0, s74, 68608
  s_lshl_b32 s42, 396, s76
  s_add_u32 s42, s42, s78
  buffer_load_dwordx4 v50, s[60:63], s42 offen sc1 lds
  v_add_u32 v38, 131072, v35
  ds_read_b64_tr_b16 v[0:1], v38 offset:0
  ds_read_b64_tr_b16 v[2:3], v38 offset:512
  ds_read_b64_tr_b16 v[4:5], v38 offset:4096
  ds_read_b64_tr_b16 v[6:7], v38 offset:4608
  ds_read_b64_tr_b16 v[8:9], v38 offset:32
  ds_read_b64_tr_b16 v[10:11], v38 offset:544
  ds_read_b64_tr_b16 v[12:13], v38 offset:4128
  ds_read_b64_tr_b16 v[14:15], v38 offset:4640
  s_waitcnt vmcnt(8) lgkmcnt(0)
  s_barrier
  v_add_u32 v39, 131072, v78
  ds_write_b128 v39, v[0:3]
  ds_write_b128 v39, v[4:7] offset:1024
  v_add_u32 v39, 139264, v78
  ds_write_b128 v39, v[8:11]
  ds_write_b128 v39, v[12:15] offset:1024
  global_load_dword v44, v48, s[16:17] sc0 sc1
  global_load_dword v45, v47, s[16:17] sc0 sc1
  buffer_load_dword v46, off, s[8:11], s19 sc1
  v_add_u32 v38, 0, v34
  ds_read_b64_tr_b16 v[0:1], v38 offset:0
  ds_read_b64_tr_b16 v[2:3], v38 offset:512
  ds_read_b64_tr_b16 v[4:5], v38 offset:4096
  ds_read_b64_tr_b16 v[6:7], v38 offset:4608
  ds_read_b64_tr_b16 v[8:9], v38 offset:8192
  ds_read_b64_tr_b16 v[10:11], v38 offset:8704
  ds_read_b64_tr_b16 v[12:13], v38 offset:12288
  ds_read_b64_tr_b16 v[14:15], v38 offset:12800
  s_waitcnt vmcnt(7) lgkmcnt(0)
  s_barrier
  v_add_u32 v39, 0, v78
  ds_write_b128 v39, v[0:3]
  ds_write_b128 v39, v[4:7] offset:1024
  v_add_u32 v39, 8192, v78
  ds_write_b128 v39, v[8:11]
  ds_write_b128 v39, v[12:15] offset:1024
  v_add_u32 v38, 32768, v34
  ds_read_b64_tr_b16 v[0:1], v38 offset:0
  ds_read_b64_tr_b16 v[2:3], v38 offset:512
  ds_read_b64_tr_b16 v[4:5], v38 offset:4096
  ds_read_b64_tr_b16 v[6:7], v38 offset:4608
  ds_read_b64_tr_b16 v[8:9], v38 offset:8192
  ds_read_b64_tr_b16 v[10:11], v38 offset:8704
  ds_read_b64_tr_b16 v[12:13], v38 offset:12288
  ds_read_b64_tr_b16 v[14:15], v38 offset:12800
  s_waitcnt vmcnt(3) lgkmcnt(0)
  s_barrier
  v_add_u32 v39, 32768, v78
  ds_write_b128 v39, v[0:3]
  ds_write_b128 v39, v[4:7] offset:1024
  v_add_u32 v39, 40960, v78
  ds_write_b128 v39, v[8:11]
  ds_write_b128 v39, v[12:15] offset:1024
  v_add_u32 v38, 65536, v34
  ds_read_b64_tr_b16 v[0:1], v38 offset:0
  ds_read_b64_tr_b16 v[2:3], v38 offset:512
  ds_read_b64_tr_b16 v[4:5], v38 offset:4096
  ds_read_b64_tr_b16 v[6:7], v38 offset:4608
  ds_read_b64_tr_b16 v[8:9], v38 offset:8192
  ds_read_b64_tr_b16 v[10:11], v38 offset:8704
  ds_read_b64_tr_b16 v[12:13], v38 offset:12288
  ds_read_b64_tr_b16 v[14:15], v38 offset:12800
  s_waitcnt vmcnt(0) lgkmcnt(0)
  s_barrier
  v_add_u32 v39, 65536, v78
  ds_write_b128 v39, v[0:3]
  ds_write_b128 v39, v[4:7] offset:1024
  v_add_u32 v39, 73728, v78
  ds_write_b128 v39, v[8:11]
  ds_write_b128 v39, v[12:15] offset:1024
  v_and_b32 v32, v44, v45
  v_and_b32 v32, 0x80808080, v32
  s_mov_b32 s42, 0x80808080
  v_cmp_ne_u32 vcc, s42, v32
  v_mov_b32 v32, v45
  s_cbranch_vccz Lc_known
  v_mov_b32 v46, 0
  v_mov_b32 v34, 0
  s_mov_b32 s42, 0x80808080
Lcw_98:
  global_load_dword v32, v34, s[16:17] sc0 sc1
  s_waitcnt vmcnt(0)
  v_and_b32 v33, s42, v32
  v_cmp_ne_u32 vcc, s42, v33
  s_cbranch_vccz Lcwo_99
  s_sleep 4
  s_sub_u32 s15, s15, 1
  s_cbranch_scc0 Lcw_98
  s_mov_b32 s15, 0
Lcwo_99:
  s_mov_b32 s42, 0x80808080
Lcw_100:
  global_load_dword v32, v47, s[16:17] sc0 sc1
  s_waitcnt vmcnt(0)
  v_and_b32 v33, s42, v32
  v_cmp_ne_u32 vcc, s42, v33
  s_cbranch_vccz Lcwo_101
  s_sleep 4
  s_sub_u32 s15, s15, 1
  s_cbranch_scc0 Lcw_100
  s_mov_b32 s15, 0
Lcwo_101:
Lc_known:
  s_cmp_eq_u32 s12, 1
  s_cbranch_scc0 Lc_ncw
  s_mov_b32 s44, 65408
  s_cmp_eq_u32 s13, 3
  s_cbranch_scc0 Lfs_102
  v_mov_b32 v33, 1
  s_mov_b64 exec, 1
  buffer_store_dword v33, off, s[8:11], s44 sc1
  s_mov_b64 exec, -1
Lfs_102:
Lc_ncw:
  s_mul_i32 s42, s47, 0x01010101
  s_or_b32 s42, s42, 0x80808080
  v_cmp_ne_u32 vcc, s42, v32
  s_or_b32 s57, vcc_lo, vcc_hi
  s_lshl_b32 s42, s13, 10
  s_add_u32 s42, s42, 147456
  v_add_u32 v32, s42, v74
  v_add_u32 v34, 155648, v74
  ds_write_b128 v32, v[52:55]
  ds_write_b128 v32, v[56:59] offset:4096
  ds_write_b128 v34, v[60:63]
  s_mov_b32 s75, s58
  s_sub_u32 s32, s32, 262144
  s_sub_u32 s63, s33, 262144
  s_mov_b32 s26, s79
  s_mov_b32 s60, 0
  s_mov_b32 s61, 0
  s_mov_b32 s62, 0
  s_mov_b32 m0, 162816
  v_mov_b32 v69, 163832
  v_mov_b64 v[70:71], -1
  ds_write_b64 v69, v[70:71]
  s_mov_b32 s66, 0x3030303
  s_mov_b32 s67, 0x3030303
  s_mov_b32 s68, 0xc0c0c0c
  s_mov_b32 s69, 0xc0c0c0c
  s_mov_b32 s70, 0x30303030
  s_mov_b32 s71, 0x30303030
  s_mov_b32 s72, 0xc0c0c0c0
  s_mov_b32 s73, 0xc0c0c0c0
  v_cmp_eq_u32 vcc, 0, v46
  s_cbranch_vccz Lk0o_104
Lk0p_103:
  buffer_load_dword v33, off, s[8:11], s19 sc1
  s_waitcnt vmcnt(0)
  v_cmp_eq_u32 vcc, 0, v33
  s_cbranch_vccz Lk0o_104
  s_sleep 2
  s_sub_u32 s15, s15, 1
  s_cbranch_scc0 Lk0p_103
  s_mov_b32 s15, 0
Lk0o_104:
  ds_read_b128 v[0:3], v78 offset:0
  ds_read_b128 v[4:7], v78 offset:1024
  ds_read_b128 v[8:11], v78 offset:8192
  ds_read_b128 v[12:15], v78 offset:9216
  ds_read_b128 v[16:19], v78 offset:16384
  ds_read_b128 v[20:23], v78 offset:17408
  v_mov_b64 v[44:45], 0
  v_mov_b64 v[46:47], 0
  v_mov_b64 v[48:49], 0
  v_mov_b64 v[50:51], 0
  s_memrealtime s[84:85]
  s_waitcnt vmcnt(0) lgkmcnt(0)
  s_cmp_lg_u32 s57, 0
  s_cbranch_scc1 Lc_slow
Lc_fast:
  s_cmp_eq_u32 s13, 1
  s_cbranch_scc1 Lc_fast1_top
  s_cmp_eq_u32 s13, 2
  s_cbranch_scc1 Lc_fast2_top
  s_cmp_eq_u32 s13, 3
  s_cbranch_scc1 Lc_fast3_top
  s_branch Lc_fast0_top
Lc_fast0_top:
  s_barrier
  ds_read_b128 v[32:35], v75 offset:0
  ds_read_b128 v[36:39], v75 offset:512
  ds_read_b128 v[40:43], v75 offset:1024
  s_waitcnt lgkmcnt(2)
  v_smfmac_f32_16x16x64_bf16 v[44:47], v[32:35], v[0:7], v73
  ds_read_b128 v[68:71], v75 offset:1536
  buffer_load_dwordx4 v[24:27], v72, s[8:11], s75 offen sc1
  v_smfmac_f32_16x16x64_bf16 v[48:51], v[32:35], v[80:87], v73
  ds_read_b128 v[0:3], v78 offset:24576
  ds_read_b128 v[4:7], v78 offset:25600
  s_waitcnt lgkmcnt(4)
  v_smfmac_f32_16x16x64_bf16 v[44:47], v[36:39], v[8:15], v73
  ds_read_b128 v[32:35], v75 offset:2048
  v_smfmac_f32_16x16x64_bf16 v[48:51], v[36:39], v[88:95], v73
  ds_read_b128 v[8:11], v78 offset:32768
  s_waitcnt lgkmcnt(5)
  v_smfmac_f32_16x16x64_bf16 v[44:47], v[40:43], v[96:103], v73
  ds_read_b128 v[36:39], v75 offset:2560
  v_smfmac_f32_16x16x64_bf16 v[48:51], v[40:43], v[16:23], v73
  ds_read_b128 v[12:15], v78 offset:33792
  s_waitcnt lgkmcnt(6)
  v_smfmac_f32_16x16x64_bf16 v[44:47], v[68:71], v[104:111], v73
  ds_read_b128 v[40:43], v75 offset:3072
  s_waitcnt lgkmcnt(5)
  v_smfmac_f32_16x16x64_bf16 v[48:51], v[68:71], v[0:7], v73
  ds_read_b128 v[16:19], v78 offset:40960
  s_waitcnt lgkmcnt(5)
  v_smfmac_f32_16x16x64_bf16 v[44:47], v[32:35], v[112:119], v73
  ds_read_b128 v[68:71], v75 offset:3584
  v_smfmac_f32_16x16x64_bf16 v[48:51], v[32:35], v[120:127], v73
  ds_read_b128 v[20:23], v78 offset:41984
  s_waitcnt lgkmcnt(5)
  v_smfmac_f32_16x16x64_bf16 v[44:47], v[36:39], v[128:135], v73
  ds_read_b128 v[32:35], v75 offset:4096
  v_smfmac_f32_16x16x64_bf16 v[48:51], v[36:39], v[136:143], v73
  ds_read_b128 v[0:3], v78 offset:49152
  s_waitcnt lgkmcnt(5)
  v_smfmac_f32_16x16x64_bf16 v[44:47], v[40:43], v[8:15], v73
  ds_read_b128 v[36:39], v75 offset:4608
  v_smfmac_f32_16x16x64_bf16 v[48:51], v[40:43], v[144:151], v73
  ds_read_b128 v[4:7], v78 offset:50176
  ds_read_b128 v[8:11], v78 offset:57344
  s_waitcnt lgkmcnt(5)
  v_smfmac_f32_16x16x64_bf16 v[44:47], v[68:71], v[16:23], v73
  s_waitcnt vmcnt(0)
  ds_write_b128 v72, v[24:27]
  v_smfmac_f32_16x16x64_bf16 v[48:51], v[68:71], v[152:159], v73
  ds_read_b128 v[12:15], v78 offset:58368
  v_max3_u32 v28, v24, v25, v26
  v_max_u32 v28, v28, v27
  s_waitcnt lgkmcnt(6)
  v_smfmac_f32_16x16x64_bf16 v[44:47], v[32:35], v[160:167], v73
  v_add_u32 v78, 65536, v78
  v_cmp_eq_u32 vcc, -1, v28
  s_waitcnt lgkmcnt(3)
  v_smfmac_f32_16x16x64_bf16 v[48:51], v[32:35], v[0:7], v73
  ds_read_b128 v[16:19], v78 offset:0
  s_cbranch_vccnz Lc_fast0_pbr0
  s_waitcnt lgkmcnt(2)
Lc_fast0_pbok:
  s_barrier
  ds_read_b128 v[40:43], v75 offset:5120
  ds_read_b128 v[68:71], v75 offset:5632
  v_smfmac_f32_16x16x64_bf16 v[44:47], v[36:39], v[168:175], v73
  ds_read_b128 v[32:35], v75 offset:6144
  buffer_load_dwordx4 v[24:27], v74, s[8:11], s34 offen offset:0 sc1
  s_waitcnt lgkmcnt(4)
  v_smfmac_f32_16x16x64_bf16 v[48:51], v[36:39], v[8:15], v73
  ds_read_b128 v[20:23], v78 offset:1024
  ds_read_b128 v[0:3], v78 offset:8192
  s_waitcnt lgkmcnt(4)
  v_smfmac_f32_16x16x64_bf16 v[44:47], v[40:43], v[176:183], v73
  ds_read_b128 v[36:39], v75 offset:6656
  buffer_load_dwordx4 v[28:31], v74, s[8:11], s34 offen offset:1024 sc1
  v_smfmac_f32_16x16x64_bf16 v[48:51], v[40:43], v[184:191], v73
  ds_read_b128 v[4:7], v78 offset:9216
  s_waitcnt lgkmcnt(5)
  v_smfmac_f32_16x16x64_bf16 v[44:47], v[68:71], v[192:199], v73
  ds_read_b128 v[40:43], v75 offset:7168
  v_smfmac_f32_16x16x64_bf16 v[48:51], v[68:71], v[200:207], v73
  ds_read_b128 v[8:11], v78 offset:16384
  s_waitcnt lgkmcnt(5)
  v_smfmac_f32_16x16x64_bf16 v[44:47], v[32:35], v[16:23], v73
  ds_read_b128 v[68:71], v75 offset:7680
  v_smfmac_f32_16x16x64_bf16 v[48:51], v[32:35], v[208:215], v73
  ds_read_b128 v[12:15], v78 offset:17408
  ds_read_b128 v[16:19], v78 offset:24576
  s_waitcnt lgkmcnt(5)
  v_smfmac_f32_16x16x64_bf16 v[44:47], v[36:39], v[0:7], v73
  ds_read_b128 v[32:35], v75 offset:8192
  v_smfmac_f32_16x16x64_bf16 v[48:51], v[36:39], v[216:223], v73
  ds_read_b128 v[20:23], v78 offset:25600
  v_mov_b64 v[0:1], 0
  s_waitcnt lgkmcnt(6)
  v_smfmac_f32_16x16x64_bf16 v[44:47], v[40:43], v[224:231], v73
  ds_read_b128 v[36:39], v75 offset:8704
  s_waitcnt lgkmcnt(4)
  v_smfmac_f32_16x16x64_bf16 v[48:51], v[40:43], v[8:15], v73
  v_mov_b64 v[2:3], 0
  v_smfmac_f32_16x16x64_bf16 v[44:47], v[68:71], v[232:239], v73
  ds_read_b128 v[40:43], v79 offset:0
  s_waitcnt lgkmcnt(2)
  v_smfmac_f32_16x16x64_bf16 v[48:51], v[68:71], v[16:23], v73
  v_mov_b64 v[4:5], 0
  v_smfmac_f32_16x16x64_bf16 v[44:47], v[32:35], v[240:247], v73
  ds_read_b128 v[68:71], v79 offset:1024
  v_smfmac_f32_16x16x64_bf16 v[48:51], v[32:35], v[248:255], v73
  v_mov_b64 v[6:7], 0
  s_waitcnt lgkmcnt(2)
  v_smfmac_f32_16x16x64_bf16 v[44:47], v[36:39], a[0:7], v73
  ds_read_b128 v[32:35], v79 offset:2048
  v_smfmac_f32_16x16x64_bf16 v[48:51], v[36:39], a[8:15], v73
  v_add_u32 v8, s37, v77
  s_waitcnt lgkmcnt(2)
  v_smfmac_f32_16x16x64_bf16 v[0:3], v[40:43], a[16:23], v73
  v_cvt_pk_bf16_f32 v44, v44, v45
  v_cvt_pk_bf16_f32 v45, v46, v47
  ds_write_b64 v8, v[44:45]
  s_nop 0
  v_cvt_pk_bf16_f32 v48, v48, v49
  v_cvt_pk_bf16_f32 v49, v50, v51
  ds_write_b64 v8, v[48:49] offset:2048
  v_smfmac_f32_16x16x64_bf16 v[4:7], v[40:43], a[24:31], v73
  ds_read_b128 v[36:39], v79 offset:3072
  s_waitcnt lgkmcnt(4)
  v_smfmac_f32_16x16x64_bf16 v[0:3], v[68:71], a[32:39], v73
  v_smfmac_f32_16x16x64_bf16 v[4:7], v[68:71], a[40:47], v73
  ds_read_b128 v[40:43], v79 offset:4096
  v_add_u32_e64 v50, s38, v75
  s_waitcnt lgkmcnt(2)
  s_barrier
  ds_read_b64_tr_b16 v[8:9], v76 offset:0
  ds_read_b64_tr_b16 v[10:11], v76 offset:128
  ds_read_b64_tr_b16 v[52:53], v76 offset:2048
  ds_read_b64_tr_b16 v[54:55], v76 offset:2176
  ds_read_b64_tr_b16 v[12:13], v76 offset:512
  ds_read_b64_tr_b16 v[14:15], v76 offset:640
  ds_read_b64_tr_b16 v[56:57], v76 offset:2560
  ds_read_b64_tr_b16 v[58:59], v76 offset:2688
  v_add_u32 v51, 65536, v78
  v_smfmac_f32_16x16x64_bf16 v[0:3], v[32:35], a[48:55], v73
  v_smfmac_f32_16x16x64_bf16 v[4:7], v[32:35], a[56:63], v73
  ds_read_b128 v[68:71], v79 offset:5120
  s_waitcnt lgkmcnt(5)
  v_mfma_f32_16x16x32_bf16 v[44:47], v[52:55], v[8:11], 0
  s_waitcnt lgkmcnt(1)
  v_mfma_f32_16x16x32_bf16 v[44:47], v[56:59], v[12:15], v[44:47]
  v_smfmac_f32_16x16x64_bf16 v[0:3], v[36:39], a[64:71], v73
  ds_read_b128 v[8:11], v51 offset:0
  v_smfmac_f32_16x16x64_bf16 v[4:7], v[36:39], a[72:79], v73
  ds_read_b128 v[32:35], v79 offset:6144
  ds_write_b128 v50, v[44:47]
  ds_read_b128 v[12:15], v51 offset:1024
  ds_read_b128 v[16:19], v51 offset:8192
  ds_read_b128 v[20:23], v51 offset:9216
  v_bfe_u32 v50, v74, 7, 1
  v_smfmac_f32_16x16x64_bf16 v[0:3], v[40:43], a[80:87], v73
  v_smfmac_f32_16x16x64_bf16 v[4:7], v[40:43], a[88:95], v73
  ds_read_b128 v[36:39], v79 offset:7168
  v_lshl_add_u32 v50, v50, 3, v75
  s_waitcnt lgkmcnt(4)
  s_barrier
  ds_read_b128 v[44:47], v79 offset:13824
  ds_read_b64 v[48:49], v50 offset:13312
  ds_read_b64 v[62:63], v50 offset:14848
  v_smfmac_f32_16x16x64_bf16 v[0:3], v[68:71], a[96:103], v73
  v_smfmac_f32_16x16x64_bf16 v[4:7], v[68:71], a[104:111], v73
  ds_read_b128 v[40:43], v79 offset:8192
  v_smfmac_f32_16x16x64_bf16 v[0:3], v[32:35], a[112:119], v73
  v_smfmac_f32_16x16x64_bf16 v[4:7], v[32:35], a[120:127], v73
  s_waitcnt lgkmcnt(4)
  v_smfmac_f32_16x16x64_bf16 v[0:3], v[36:39], a[128:135], v73
  v_smfmac_f32_16x16x64_bf16 v[4:7], v[36:39], a[136:143], v73
  s_waitcnt lgkmcnt(0)
  v_smfmac_f32_16x16x64_bf16 v[0:3], v[40:43], v[8:15], v73
  v_smfmac_f32_16x16x64_bf16 v[4:7], v[40:43], v[16:23], v73
  s_mov_b64 exec, s[20:21]
  buffer_store_dwordx4 v[52:55], v75, s[8:11], s35 offen offset:0 sc1
  buffer_store_dwordx4 v[56:59], v75, s[8:11], s35 offen offset:512 sc1
  s_mov_b64 exec, -1
  v_max3_f32 v50, v44, v45, v46
  v_add_f32 v48, v48, v62
  v_add_f32 v49, v49, v63
  v_max3_f32 v51, v47, v48, v49
  v_max_f32 v50, v50, v51
  v_add_u32 v72, s39, v75
  ds_read_b128 v[8:11], v78 offset:49152
  v_max_f32_dpp v50, v50, v50 row_ror:8 row_mask:0xf bank_mask:0xf
  v_mov_b32_e64 v51, v50
  v_cvt_pk_bf16_f32 v36, v0, v1
  v_cvt_pk_bf16_f32 v37, v2, v3
  v_permlane16_swap_b32 v50, v51
  v_max_f32 v50, v50, v51
  v_mov_b32_e64 v51, v50
  v_cvt_pk_bf16_f32 v38, v4, v5
  v_cvt_pk_bf16_f32 v39, v6, v7
  v_permlane32_swap_b32 v50, v51
  v_max_f32 v50, v50, v51
  v_mul_f32_e64 v50, s22, v50
  v_fma_f32 v44, v44, s22, -v50
  v_fma_f32 v45, v45, s22, -v50
  v_fma_f32 v46, v46, s22, -v50
  v_fma_f32 v47, v47, s22, -v50
  v_fma_f32 v48, v48, s22, -v50
  v_fma_f32 v49, v49, s22, -v50
  v_exp_f32 v44, v44
  v_exp_f32 v45, v45
  v_exp_f32 v46, v46
  v_exp_f32 v47, v47
  v_exp_f32 v48, v48
  v_exp_f32 v49, v49
  v_cvt_pk_bf16_f32 v50, v44, v45
  v_cvt_pk_bf16_f32 v51, v46, v47
  v_cndmask_b32 v32, 0, v50, s[20:21]
  v_cndmask_b32 v33, 0, v51, s[20:21]
  v_cndmask_b32 v34, v50, 0, s[20:21]
  v_cndmask_b32 v35, v51, 0, s[20:21]
  v_cvt_pk_bf16_f32 v41, v48, v49
  v_add_f32 v50, v44, v45
  s_waitcnt vmcnt(3)
  v_mfma_f32_16x16x32_bf16 v[0:3], v[24:27], v[32:35], 0
  v_cndmask_b32 v40, 0, v41, s[20:21]
  v_cndmask_b32 v41, v41, 0, s[20:21]
  s_waitcnt vmcnt(2)
  v_mfma_f32_16x16x32_bf16 v[4:7], v[28:31], v[32:35], 0
  v_add_f32 v51, v46, v47
  v_add_f32_e64 v48, v48, v49
  v_mfma_f32_16x16x16_bf16 v[0:3], v[36:37], v[40:41], v[0:3]
  v_add_f32 v50, v50, v51
  v_fmac_f32 v50, 0.5, v48
  v_mfma_f32_16x16x16_bf16 v[4:7], v[38:39], v[40:41], v[4:7]
  buffer_store_dwordx4 v[36:39], v74, s[8:11], s36 offen sc1
  ds_read_b128 v[52:55], v78 offset:32768
  ds_read_b128 v[56:59], v78 offset:33792
  v_mov_b64_e64 v[24:25], 0
  v_add_f32_dpp v50, v50, v50 row_ror:8 row_mask:0xf bank_mask:0xf
  v_mov_b32 v51, v50
  v_mov_b64 v[26:27], 0
  v_mov_b64 v[28:29], 0
  v_permlane16_swap_b32 v50, v51
  v_add_f32 v50, v50, v51
  v_mov_b32 v51, v50
  v_add_f32_dpp v0, v0, v0 row_ror:8 row_mask:0xf bank_mask:0xf
  v_add_f32_dpp v1, v1, v1 row_ror:8 row_mask:0xf bank_mask:0xf
  v_permlane32_swap_b32 v50, v51
  v_add_f32 v50, v50, v51
  v_rcp_f32_e64 v50, v50
  v_add_f32_dpp v2, v2, v2 row_ror:8 row_mask:0xf bank_mask:0xf
  v_add_f32_dpp v3, v3, v3 row_ror:8 row_mask:0xf bank_mask:0xf
  v_add_f32_dpp v4, v4, v4 row_ror:8 row_mask:0xf bank_mask:0xf
  v_add_f32_dpp v5, v5, v5 row_ror:8 row_mask:0xf bank_mask:0xf
  v_add_f32_dpp v6, v6, v6 row_ror:8 row_mask:0xf bank_mask:0xf
  v_add_f32_dpp v7, v7, v7 row_ror:8 row_mask:0xf bank_mask:0xf
  v_mul_f32 v0, v0, v50
  v_mul_f32 v1, v1, v50
  v_mul_f32 v2, v2, v50
  v_mul_f32 v3, v3, v50
  v_mul_f32 v4, v4, v50
  v_mul_f32 v5, v5, v50
  v_mul_f32 v6, v6, v50
  v_mul_f32 v7, v7, v50
  v_cvt_pk_bf16_f32 v32, v0, v1
  v_cvt_pk_bf16_f32 v33, v2, v3
  v_cvt_pk_bf16_f32 v34, v4, v5
  v_cvt_pk_bf16_f32 v35, v6, v7
  ds_write_b128 v72, v[32:35]
  v_mov_b64_e64 v[30:31], 0
  v_smfmac_f32_16x16x64_bf16 v[24:27], v[32:35], a[152:159], v73
  v_mov_b64 v[0:1], 0
  v_mov_b64 v[2:3], 0
  v_smfmac_f32_16x16x64_bf16 v[28:31], v[32:35], a[160:167], v73
  v_mov_b64 v[4:5], 0
  v_mov_b64 v[6:7], 0
  v_smfmac_f32_16x16x64_bf16 v[0:3], v[32:35], a[240:247], v73
  v_mov_b64 v[44:45], 0
  v_mov_b64 v[46:47], 0
  s_waitcnt lgkmcnt(0)
  s_barrier
  ds_read_b128 v[40:43], v75 offset:10240
  ds_read_b128 v[36:39], v75 offset:9728
  ds_read_b128 v[68:71], v75 offset:10752
  v_smfmac_f32_16x16x64_bf16 v[4:7], v[32:35], a[144:151], v73
  v_bfe_u32 v48, v74, 7, 1
  v_smfmac_f32_16x16x64_bf16 v[44:47], v[32:35], a[168:175], v73
  v_lshrrev_b32_e64 v49, 8, v74
  v_lshl_add_u32 v48, v48, 2, v49
  v_mul_u32_u24 v48, 10368, v48
  v_and_or_b32 v72, v74, s46, v48
  ds_read_b128 v[60:63], v78 offset:40960
  ds_read_b128 v[64:67], v78 offset:41984
  s_waitcnt lgkmcnt(4)
  v_smfmac_f32_16x16x64_bf16 v[0:3], v[40:43], a[248:255], v73
  ds_read_b128 v[12:15], v78 offset:50176
  v_smfmac_f32_16x16x64_bf16 v[4:7], v[40:43], a[208:215], v73
  s_waitcnt lgkmcnt(4)
  v_smfmac_f32_16x16x64_bf16 v[4:7], v[36:39], a[176:183], v73
  v_cvt_pk_bf16_f32 v0, v0, v1
  v_cvt_pk_bf16_f32 v1, v2, v3
  s_waitcnt lgkmcnt(3)
  v_smfmac_f32_16x16x64_bf16 v[4:7], v[68:71], v[52:59], v73
  v_bfi_b32 v0, 1, s25, v0
  buffer_store_dwordx2 v[0:1], v77, s[8:11], s24 offen offset:0
  v_smfmac_f32_16x16x64_bf16 v[24:27], v[40:43], a[216:223], v73
  v_smfmac_f32_16x16x64_bf16 v[24:27], v[36:39], a[184:191], v73
  v_cvt_pk_bf16_f32 v4, v4, v5
  v_cvt_pk_bf16_f32 v5, v6, v7
  s_waitcnt lgkmcnt(1)
  v_smfmac_f32_16x16x64_bf16 v[24:27], v[68:71], v[60:67], v73
  v_bfi_b32 v4, 1, s25, v4
  buffer_store_dwordx2 v[4:5], v77, s[8:11], s23 offen offset:0
  v_smfmac_f32_16x16x64_bf16 v[28:31], v[40:43], a[224:231], v73
  v_smfmac_f32_16x16x64_bf16 v[28:31], v[36:39], a[192:199], v73
  v_cvt_pk_bf16_f32 v24, v24, v25
  v_cvt_pk_bf16_f32 v25, v26, v27
  s_waitcnt lgkmcnt(0)
  v_smfmac_f32_16x16x64_bf16 v[28:31], v[68:71], v[8:15], v73
  v_bfi_b32 v24, 1, s25, v24
  buffer_store_dwordx2 v[24:25], v77, s[8:11], s23 offen offset:2048
  v_smfmac_f32_16x16x64_bf16 v[44:47], v[40:43], a[232:239], v73
  ds_read_b128 v[16:19], v78 offset:57344
  ds_read_b128 v[20:23], v78 offset:58368
  v_smfmac_f32_16x16x64_bf16 v[44:47], v[36:39], a[200:207], v73
  v_cvt_pk_bf16_f32 v28, v28, v29
  v_cvt_pk_bf16_f32 v29, v30, v31
  s_waitcnt lgkmcnt(0)
  v_smfmac_f32_16x16x64_bf16 v[44:47], v[68:71], v[16:23], v73
  v_bfi_b32 v28, 1, s25, v28
  buffer_store_dwordx2 v[28:29], v77, s[8:11], s31 offen offset:0
  v_subrev_u32 v78, 65536, v78
  s_nop 4
  v_cvt_pk_bf16_f32 v44, v44, v45
  v_cvt_pk_bf16_f32 v45, v46, v47
  v_bfi_b32 v44, 1, s25, v44
  buffer_store_dwordx2 v[44:45], v77, s[8:11], s31 offen offset:2048
  s_waitcnt vmcnt(2)
  buffer_load_dwordx4 v[32:35], v72, s[8:11], s27 offen sc1
  buffer_load_dwordx4 v[36:39], v72, s[8:11], s52 offen sc1
  buffer_load_dwordx4 v[40:43], v72, s[8:11], s53 offen sc1
  buffer_load_dwordx4 v[24:27], v72, s[8:11], s54 offen sc1
  v_lshrrev_b32_e64 v69, 8, v74
  v_and_b32 v68, 0x70, v74
  v_and_b32_e64 v70, 1, v69
  v_lshl_add_u32 v68, v70, 3, v68
  v_lshrrev_b32_e64 v69, 1, v69
  v_lshl_add_u32 v68, v69, 2, v68
  v_add_u32 v68, s40, v68
  v_mov_b32 v71, -1
  v_bfe_u32 v69, v74, 4, 1
  v_lshlrev_b32_e64 v69, 4, v69
  v_mov_b32 v70, 0x3f80
  v_lshlrev_b32_e64 v70, v69, v70
  v_cndmask_b32 v48, 0, v70, s[66:67]
  v_cndmask_b32 v49, 0, v70, s[68:69]
  v_cndmask_b32 v50, 0, v70, s[70:71]
  v_cndmask_b32 v51, 0, v70, s[72:73]
  ds_read_b128 v[0:3], v78 offset:0
  ds_read_b128 v[4:7], v78 offset:1024
  ds_read_b128 v[8:11], v78 offset:8192
  ds_read_b128 v[12:15], v78 offset:9216
  ds_read_b128 v[16:19], v78 offset:16384
  ds_read_b128 v[20:23], v78 offset:17408
  buffer_load_dwordx4 v[52:55], v72, s[8:11], s27 offen sc1
  buffer_load_dwordx4 v[56:59], v72, s[8:11], s52 offen sc1
  buffer_load_dwordx4 v[60:63], v72, s[8:11], s53 offen sc1
  buffer_load_dwordx4 v[64:67], v72, s[8:11], s54 offen sc1
  s_waitcnt vmcnt(7)
  v_mfma_f32_16x16x32_bf16 v[44:47], v[32:35], v[48:51], 0
  v_xor_b32 v69, s25, v32
  v_bitop3_b32 v69, v69, v34, s25 bitop3:0xf6
  s_waitcnt vmcnt(6)
  v_mfma_f32_16x16x32_bf16 v[44:47], v[36:39], v[48:51], v[44:47]
  v_bitop3_b32 v69, v69, v36, s25 bitop3:0xf6
  v_bitop3_b32 v69, v69, v38, s25 bitop3:0xf6
  s_waitcnt vmcnt(5)
  v_mfma_f32_16x16x32_bf16 v[44:47], v[40:43], v[48:51], v[44:47]
  v_bitop3_b32 v69, v69, v40, s25 bitop3:0xf6
  v_bitop3_b32 v69, v69, v42, s25 bitop3:0xf6
  s_waitcnt vmcnt(4)
  v_mfma_f32_16x16x32_bf16 v[44:47], v[24:27], v[48:51], v[44:47]
  v_bitop3_b32 v69, v69, v24, s25 bitop3:0xf6
  v_bitop3_b32 v69, v69, v26, s25 bitop3:0xf6
  v_and_b32 v69, 1, v69
  v_cmp_ne_u32 vcc, 0, v69
  s_cbranch_vccnz Lc_fast0_redr
Lc_fast0_redok:
  s_nop 2
  v_permlane32_swap_b32 v44, v46
  v_permlane32_swap_b32 v45, v47
  v_add_f32 v44, v44, v46
  v_add_f32_e64 v45, v45, v47
  v_cvt_pk_bf16_f32 v44, v44, v45
  s_mov_b64 exec, s[20:21]
  buffer_store_dword v44, v68, s[8:11], s28 offen
  buffer_store_dword v71, v68, s[8:11], s18 offen
  s_mov_b64 exec, -1
  v_mov_b32 v69, 163832
  v_mov_b32_e64 v70, s14
  ds_write_b32 v69, v70
  v_mov_b64 v[44:45], 0
  v_mov_b64 v[46:47], 0
  v_mov_b64 v[48:49], 0
  v_mov_b64 v[50:51], 0
  s_mov_b32 s75, s28
  s_mov_b32 s44, s14
  v_add_u32 v68, 151552, v74
  buffer_load_dwordx4 v[52:55], v68, s[8:11], s75 offen offset:0 sc1
  s_add_u32 s14, s14, 1
  s_xor_b32 s25, s25, 1
  s_mov_b32 s45, s28
  s_mov_b32 s28, s29
  s_mov_b32 s29, s18
  s_mov_b32 s18, s45
  s_add_u32 s35, s35, 131072
  s_add_u32 s36, s36, 131072
  s_add_u32 s34, s34, 262144
  s_add_u32 s33, s33, 262144
  s_add_u32 s32, s32, 262144
  s_xor_b32 s55, s55, 4096
  s_xor_b32 s19, s19, 4096
  v_add_u32 v72, 152576, v74
  buffer_load_dwordx4 v[60:63], v68, s[8:11], s75 offen offset:0 sc1
  s_waitcnt vmcnt(1)
  ds_write_b128 v68, v[52:55] offset:0
  v_max3_u32 v69, v52, v53, v54
  v_max_u32 v69, v69, v55
  v_cmp_eq_u32 vcc, -1, v69
  s_cbranch_vccnz Lc_fast0_mpr
Lc_fast0_mpok:
  s_cmp_eq_u32 s14, 63
  s_waitcnt lgkmcnt(0)
  s_cbranch_scc0 Lc_fast0_top
  s_branch Lc_last0_top
Lc_fast0_end:
Lc_fast0_mpr:
  buffer_load_dwordx4 v[52:55], v68, s[8:11], s75 offen offset:0 sc1
  s_waitcnt vmcnt(1)
  ds_write_b128 v68, v[60:63] offset:0
  v_max3_u32 v69, v60, v61, v62
  v_max_u32 v69, v69, v63
  v_cmp_eq_u32 vcc, -1, v69
  s_cbranch_vccz Lc_fast0_mpok
  buffer_load_dwordx4 v[60:63], v68, s[8:11], s75 offen offset:0 sc1
  s_waitcnt vmcnt(1)
  ds_write_b128 v68, v[52:55] offset:0
  v_max3_u32 v69, v52, v53, v54
  v_max_u32 v69, v69, v55
  v_cmp_eq_u32 vcc, -1, v69
  s_cbranch_vccz Lc_fast0_mpok
  s_sub_u32 s15, s15, 1
  s_cbranch_scc0 Lc_fast0_mpr
  s_mov_b32 s15, 0
  s_branch Lc_fast0_mpok
Lc_fast0_pbr0:
  buffer_load_dwordx4 v[28:31], v72, s[8:11], s75 offen sc1
Lc_fast0_pbr:
  buffer_load_dwordx4 v[24:27], v72, s[8:11], s75 offen sc1
  s_waitcnt vmcnt(1)
  ds_write_b128 v72, v[28:31]
  s_waitcnt lgkmcnt(0)
  v_max3_u32 v28, v28, v29, v30
  v_max_u32 v28, v28, v31
  v_cmp_eq_u32 vcc, -1, v28
  s_cbranch_vccz Lc_fast0_pbd
  buffer_load_dwordx4 v[28:31], v72, s[8:11], s75 offen sc1
  s_waitcnt vmcnt(1)
  ds_write_b128 v72, v[24:27]
  s_waitcnt lgkmcnt(0)
  v_max3_u32 v24, v24, v25, v26
  v_max_u32 v24, v24, v27
  v_cmp_eq_u32 vcc, -1, v24
  s_cbranch_vccz Lc_fast0_pbd
  s_sub_u32 s15, s15, 1
  s_cbranch_scc0 Lc_fast0_pbr
  s_mov_b32 s15, 0
Lc_fast0_pbd:
  s_waitcnt lgkmcnt(0)
  s_branch Lc_fast0_pbok
Lc_fast0_redr:
  buffer_load_dwordx4 v[32:35], v72, s[8:11], s27 offen sc1
  buffer_load_dwordx4 v[36:39], v72, s[8:11], s52 offen sc1
  buffer_load_dwordx4 v[40:43], v72, s[8:11], s53 offen sc1
  buffer_load_dwordx4 v[24:27], v72, s[8:11], s54 offen sc1
  s_waitcnt vmcnt(7)
  v_mfma_f32_16x16x32_bf16 v[44:47], v[52:55], v[48:51], 0
  v_xor_b32 v69, s25, v52
  v_bitop3_b32 v69, v69, v54, s25 bitop3:0xf6
  s_waitcnt vmcnt(6)
  v_mfma_f32_16x16x32_bf16 v[44:47], v[56:59], v[48:51], v[44:47]
  v_bitop3_b32 v69, v69, v56, s25 bitop3:0xf6
  v_bitop3_b32 v69, v69, v58, s25 bitop3:0xf6
  s_waitcnt vmcnt(5)
  v_mfma_f32_16x16x32_bf16 v[44:47], v[60:63], v[48:51], v[44:47]
  v_bitop3_b32 v69, v69, v60, s25 bitop3:0xf6
  v_bitop3_b32 v69, v69, v62, s25 bitop3:0xf6
  s_waitcnt vmcnt(4)
  v_mfma_f32_16x16x32_bf16 v[44:47], v[64:67], v[48:51], v[44:47]
  v_bitop3_b32 v69, v69, v64, s25 bitop3:0xf6
  v_bitop3_b32 v69, v69, v66, s25 bitop3:0xf6
  v_and_b32 v69, 1, v69
  v_cmp_ne_u32 vcc, 0, v69
  s_cbranch_vccz Lc_fast0_redok
  buffer_load_dwordx4 v[52:55], v72, s[8:11], s27 offen sc1
  buffer_load_dwordx4 v[56:59], v72, s[8:11], s52 offen sc1
  buffer_load_dwordx4 v[60:63], v72, s[8:11], s53 offen sc1
  buffer_load_dwordx4 v[64:67], v72, s[8:11], s54 offen sc1
  s_waitcnt vmcnt(7)
  v_mfma_f32_16x16x32_bf16 v[44:47], v[32:35], v[48:51], 0
  v_xor_b32 v69, s25, v32
  v_bitop3_b32 v69, v69, v34, s25 bitop3:0xf6
  s_waitcnt vmcnt(6)
  v_mfma_f32_16x16x32_bf16 v[44:47], v[36:39], v[48:51], v[44:47]
  v_bitop3_b32 v69, v69, v36, s25 bitop3:0xf6
  v_bitop3_b32 v69, v69, v38, s25 bitop3:0xf6
  s_waitcnt vmcnt(5)
  v_mfma_f32_16x16x32_bf16 v[44:47], v[40:43], v[48:51], v[44:47]
  v_bitop3_b32 v69, v69, v40, s25 bitop3:0xf6
  v_bitop3_b32 v69, v69, v42, s25 bitop3:0xf6
  s_waitcnt vmcnt(4)
  v_mfma_f32_16x16x32_bf16 v[44:47], v[24:27], v[48:51], v[44:47]
  v_bitop3_b32 v69, v69, v24, s25 bitop3:0xf6
  v_bitop3_b32 v69, v69, v26, s25 bitop3:0xf6
  v_and_b32 v69, 1, v69
  v_cmp_ne_u32 vcc, 0, v69
  s_cbranch_vccz Lc_fast0_redok
  s_sub_u32 s15, s15, 1
  s_cbranch_scc0 Lc_fast0_redr
  s_mov_b32 s15, 0
  s_branch Lc_fast0_redok
Lc_fast1_top:
  s_barrier
  ds_read_b128 v[32:35], v75 offset:0
  ds_read_b128 v[36:39], v75 offset:512
  ds_read_b128 v[40:43], v75 offset:1024
  s_waitcnt lgkmcnt(2)
  v_smfmac_f32_16x16x64_bf16 v[44:47], v[32:35], v[0:7], v73
  ds_read_b128 v[68:71], v75 offset:1536
  buffer_load_dwordx4 v[24:27], v72, s[8:11], s75 offen sc1
  v_smfmac_f32_16x16x64_bf16 v[48:51], v[32:35], v[80:87], v73
  ds_read_b128 v[0:3], v78 offset:24576
  ds_read_b128 v[4:7], v78 offset:25600
  s_waitcnt lgkmcnt(4)
  v_smfmac_f32_16x16x64_bf16 v[44:47], v[36:39], v[8:15], v73
  ds_read_b128 v[32:35], v75 offset:2048
  v_smfmac_f32_16x16x64_bf16 v[48:51], v[36:39], v[88:95], v73
  ds_read_b128 v[8:11], v78 offset:32768
  s_waitcnt lgkmcnt(5)
  v_smfmac_f32_16x16x64_bf16 v[44:47], v[40:43], v[96:103], v73
  ds_read_b128 v[36:39], v75 offset:2560
  v_smfmac_f32_16x16x64_bf16 v[48:51], v[40:43], v[16:23], v73
  ds_read_b128 v[12:15], v78 offset:33792
  s_waitcnt lgkmcnt(6)
  v_smfmac_f32_16x16x64_bf16 v[44:47], v[68:71], v[104:111], v73
  ds_read_b128 v[40:43], v75 offset:3072
  s_waitcnt lgkmcnt(5)
  v_smfmac_f32_16x16x64_bf16 v[48:51], v[68:71], v[0:7], v73
  ds_read_b128 v[16:19], v78 offset:40960
  s_waitcnt lgkmcnt(5)
  v_smfmac_f32_16x16x64_bf16 v[44:47], v[32:35], v[112:119], v73
  ds_read_b128 v[68:71], v75 offset:3584
  v_smfmac_f32_16x16x64_bf16 v[48:51], v[32:35], v[120:127], v73
  ds_read_b128 v[20:23], v78 offset:41984
  s_waitcnt lgkmcnt(5)
  v_smfmac_f32_16x16x64_bf16 v[44:47], v[36:39], v[128:135], v73
  ds_read_b128 v[32:35], v75 offset:4096
  v_smfmac_f32_16x16x64_bf16 v[48:51], v[36:39], v[136:143], v73
  ds_read_b128 v[0:3], v78 offset:49152
  s_waitcnt lgkmcnt(5)
  v_smfmac_f32_16x16x64_bf16 v[44:47], v[40:43], v[8:15], v73
  ds_read_b128 v[36:39], v75 offset:4608
  v_smfmac_f32_16x16x64_bf16 v[48:51], v[40:43], v[144:151], v73
  ds_read_b128 v[4:7], v78 offset:50176
  ds_read_b128 v[8:11], v78 offset:57344
  s_waitcnt lgkmcnt(5)
  v_smfmac_f32_16x16x64_bf16 v[44:47], v[68:71], v[16:23], v73
  s_waitcnt vmcnt(0)
  ds_write_b128 v72, v[24:27]
  v_smfmac_f32_16x16x64_bf16 v[48:51], v[68:71], v[152:159], v73
  ds_read_b128 v[12:15], v78 offset:58368
  v_max3_u32 v28, v24, v25, v26
  v_max_u32 v28, v28, v27
  s_waitcnt lgkmcnt(6)
  v_smfmac_f32_16x16x64_bf16 v[44:47], v[32:35], v[160:167], v73
  v_add_u32 v78, 65536, v78
  v_cmp_eq_u32 vcc, -1, v28
  s_waitcnt lgkmcnt(3)
  v_smfmac_f32_16x16x64_bf16 v[48:51], v[32:35], v[0:7], v73
  ds_read_b128 v[16:19], v78 offset:0
  s_cbranch_vccnz Lc_fast1_pbr0
  s_waitcnt lgkmcnt(2)
Lc_fast1_pbok:
  s_barrier
  ds_read_b128 v[40:43], v75 offset:5120
  ds_read_b128 v[68:71], v75 offset:5632
  v_smfmac_f32_16x16x64_bf16 v[44:47], v[36:39], v[168:175], v73
  ds_read_b128 v[32:35], v75 offset:6144
  s_waitcnt lgkmcnt(4)
  v_smfmac_f32_16x16x64_bf16 v[48:51], v[36:39], v[8:15], v73
  ds_read_b128 v[20:23], v78 offset:1024
  ds_read_b128 v[0:3], v78 offset:8192
  buffer_load_dwordx4 v[52:55], v74, s[8:11], s32 offen offset:0 sc1
  s_waitcnt lgkmcnt(4)
  v_smfmac_f32_16x16x64_bf16 v[44:47], v[40:43], v[176:183], v73
  ds_read_b128 v[36:39], v75 offset:6656
  v_smfmac_f32_16x16x64_bf16 v[48:51], v[40:43], v[184:191], v73
  ds_read_b128 v[4:7], v78 offset:9216
  buffer_load_dwordx4 v[56:59], v74, s[8:11], s32 offen offset:1024 sc1
  s_waitcnt lgkmcnt(5)
  v_smfmac_f32_16x16x64_bf16 v[44:47], v[68:71], v[192:199], v73
  ds_read_b128 v[40:43], v75 offset:7168
  v_smfmac_f32_16x16x64_bf16 v[48:51], v[68:71], v[200:207], v73
  ds_read_b128 v[8:11], v78 offset:16384
  buffer_load_dwordx4 v[60:63], v74, s[8:11], s32 offen offset:2048 sc1
  s_waitcnt lgkmcnt(5)
  v_smfmac_f32_16x16x64_bf16 v[44:47], v[32:35], v[16:23], v73
  ds_read_b128 v[68:71], v75 offset:7680
  v_smfmac_f32_16x16x64_bf16 v[48:51], v[32:35], v[208:215], v73
  ds_read_b128 v[12:15], v78 offset:17408
  ds_read_b128 v[16:19], v78 offset:24576
  buffer_load_dwordx4 v[64:67], v74, s[8:11], s32 offen offset:3072 sc1
  s_waitcnt lgkmcnt(5)
  v_smfmac_f32_16x16x64_bf16 v[44:47], v[36:39], v[0:7], v73
  ds_read_b128 v[32:35], v75 offset:8192
  v_smfmac_f32_16x16x64_bf16 v[48:51], v[36:39], v[216:223], v73
  ds_read_b128 v[20:23], v78 offset:25600
  v_mov_b64_e64 v[0:1], 0
  buffer_load_dwordx4 v[24:27], v74, s[8:11], s34 offen offset:0 sc1
  s_waitcnt lgkmcnt(6)
  v_smfmac_f32_16x16x64_bf16 v[44:47], v[40:43], v[224:231], v73
  ds_read_b128 v[36:39], v75 offset:8704
  s_waitcnt lgkmcnt(4)
  v_smfmac_f32_16x16x64_bf16 v[48:51], v[40:43], v[8:15], v73
  v_mov_b64_e64 v[2:3], 0
  buffer_load_dwordx4 v[28:31], v74, s[8:11], s34 offen offset:1024 sc1
  v_smfmac_f32_16x16x64_bf16 v[44:47], v[68:71], v[232:239], v73
  ds_read_b128 v[40:43], v79 offset:0
  s_waitcnt lgkmcnt(2)
  v_smfmac_f32_16x16x64_bf16 v[48:51], v[68:71], v[16:23], v73
  v_mov_b64 v[4:5], 0
  v_smfmac_f32_16x16x64_bf16 v[44:47], v[32:35], v[240:247], v73
  ds_read_b128 v[68:71], v79 offset:1024
  v_smfmac_f32_16x16x64_bf16 v[48:51], v[32:35], v[248:255], v73
  v_mov_b64 v[6:7], 0
  s_waitcnt lgkmcnt(2)
  v_smfmac_f32_16x16x64_bf16 v[44:47], v[36:39], a[0:7], v73
  ds_read_b128 v[32:35], v79 offset:2048
  v_smfmac_f32_16x16x64_bf16 v[48:51], v[36:39], a[8:15], v73
  v_add_u32 v8, s37, v77
  s_waitcnt lgkmcnt(2)
  v_smfmac_f32_16x16x64_bf16 v[0:3], v[40:43], a[16:23], v73
  v_cvt_pk_bf16_f32 v44, v44, v45
  v_cvt_pk_bf16_f32 v45, v46, v47
  ds_write_b64 v8, v[44:45]
  s_nop 0
  v_cvt_pk_bf16_f32 v48, v48, v49
  v_cvt_pk_bf16_f32 v49, v50, v51
  ds_write_b64 v8, v[48:49] offset:2048
  v_smfmac_f32_16x16x64_bf16 v[4:7], v[40:43], a[24:31], v73
  ds_read_b128 v[36:39], v79 offset:3072
  s_waitcnt lgkmcnt(4)
  v_smfmac_f32_16x16x64_bf16 v[0:3], v[68:71], a[32:39], v73
  v_smfmac_f32_16x16x64_bf16 v[4:7], v[68:71], a[40:47], v73
  ds_read_b128 v[40:43], v79 offset:4096
  v_add_u32_e64 v50, s38, v75
  s_waitcnt lgkmcnt(2)
  s_barrier
  ds_read_b64_tr_b16 v[8:9], v76 offset:0
  ds_read_b64_tr_b16 v[10:11], v76 offset:128
  ds_read_b64_tr_b16 v[12:13], v76 offset:512
  ds_read_b64_tr_b16 v[14:15], v76 offset:640
  ds_read_b64_tr_b16 v[16:17], v76 offset:1024
  ds_read_b64_tr_b16 v[18:19], v76 offset:1152
  ds_read_b64_tr_b16 v[20:21], v76 offset:1536
  ds_read_b64_tr_b16 v[22:23], v76 offset:1664
  v_add_u32 v51, 65536, v78
  s_waitcnt vmcnt(5) lgkmcnt(6)
  v_mfma_f32_16x16x32_bf16 v[44:47], v[52:55], v[8:11], 0
  s_waitcnt vmcnt(4) lgkmcnt(4)
  v_mfma_f32_16x16x32_bf16 v[44:47], v[56:59], v[12:15], v[44:47]
  s_waitcnt vmcnt(3) lgkmcnt(2)
  v_mfma_f32_16x16x32_bf16 v[44:47], v[60:63], v[16:19], v[44:47]
  s_waitcnt vmcnt(2) lgkmcnt(0)
  v_mfma_f32_16x16x32_bf16 v[44:47], v[64:67], v[20:23], v[44:47]
  v_smfmac_f32_16x16x64_bf16 v[0:3], v[32:35], a[48:55], v73
  ds_read_b128 v[8:11], v51 offset:0
  v_smfmac_f32_16x16x64_bf16 v[4:7], v[32:35], a[56:63], v73
  ds_read_b128 v[68:71], v79 offset:5120
  ds_write_b128 v50, v[44:47]
  ds_read_b128 v[12:15], v51 offset:1024
  ds_read_b128 v[16:19], v51 offset:8192
  ds_read_b128 v[20:23], v51 offset:9216
  v_bfe_u32 v50, v74, 7, 1
  v_smfmac_f32_16x16x64_bf16 v[0:3], v[36:39], a[64:71], v73
  v_smfmac_f32_16x16x64_bf16 v[4:7], v[36:39], a[72:79], v73
  ds_read_b128 v[32:35], v79 offset:6144
  v_smfmac_f32_16x16x64_bf16 v[0:3], v[40:43], a[80:87], v73
  v_smfmac_f32_16x16x64_bf16 v[4:7], v[40:43], a[88:95], v73
  ds_read_b128 v[36:39], v79 offset:7168
  v_lshl_add_u32 v50, v50, 3, v75
  s_waitcnt lgkmcnt(5)
  s_barrier
  ds_read_b128 v[44:47], v79 offset:13824
  ds_read_b64 v[48:49], v50 offset:13312
  ds_read_b64 v[62:63], v50 offset:14848
  v_smfmac_f32_16x16x64_bf16 v[0:3], v[68:71], a[96:103], v73
  v_smfmac_f32_16x16x64_bf16 v[4:7], v[68:71], a[104:111], v73
  ds_read_b128 v[40:43], v79 offset:8192
  s_waitcnt lgkmcnt(5)
  v_smfmac_f32_16x16x64_bf16 v[0:3], v[32:35], a[112:119], v73
  v_smfmac_f32_16x16x64_bf16 v[4:7], v[32:35], a[120:127], v73
  s_waitcnt lgkmcnt(4)
  v_smfmac_f32_16x16x64_bf16 v[0:3], v[36:39], a[128:135], v73
  v_smfmac_f32_16x16x64_bf16 v[4:7], v[36:39], a[136:143], v73
  s_waitcnt lgkmcnt(0)
  v_smfmac_f32_16x16x64_bf16 v[0:3], v[40:43], v[8:15], v73
  v_smfmac_f32_16x16x64_bf16 v[4:7], v[40:43], v[16:23], v73
  v_max3_f32 v50, v44, v45, v46
  v_add_f32 v48, v48, v62
  v_add_f32_e64 v49, v49, v63
  v_max3_f32 v51, v47, v48, v49
  v_max_f32 v50, v50, v51
  v_add_u32 v72, s39, v75
  ds_read_b128 v[8:11], v78 offset:49152
  v_max_f32_dpp v50, v50, v50 row_ror:8 row_mask:0xf bank_mask:0xf
  v_mov_b32_e64 v51, v50
  v_cvt_pk_bf16_f32 v36, v0, v1
  v_cvt_pk_bf16_f32 v37, v2, v3
  v_permlane16_swap_b32 v50, v51
  v_max_f32 v50, v50, v51
  v_mov_b32_e64 v51, v50
  v_cvt_pk_bf16_f32 v38, v4, v5
  v_cvt_pk_bf16_f32 v39, v6, v7
  v_permlane32_swap_b32 v50, v51
  v_max_f32 v50, v50, v51
  v_mul_f32_e64 v50, s22, v50
  v_fma_f32 v44, v44, s22, -v50
  v_fma_f32 v45, v45, s22, -v50
  v_fma_f32 v46, v46, s22, -v50
  v_fma_f32 v47, v47, s22, -v50
  v_fma_f32 v48, v48, s22, -v50
  v_fma_f32 v49, v49, s22, -v50
  v_exp_f32 v44, v44
  v_exp_f32 v45, v45
  v_exp_f32 v46, v46
  v_exp_f32 v47, v47
  v_exp_f32 v48, v48
  v_exp_f32 v49, v49
  v_cvt_pk_bf16_f32 v50, v44, v45
  v_cvt_pk_bf16_f32 v51, v46, v47
  v_cndmask_b32 v32, 0, v50, s[20:21]
  v_cndmask_b32 v33, 0, v51, s[20:21]
  v_cndmask_b32 v34, v50, 0, s[20:21]
  v_cndmask_b32 v35, v51, 0, s[20:21]
  v_cvt_pk_bf16_f32 v41, v48, v49
  v_add_f32 v50, v44, v45
  s_waitcnt vmcnt(1)
  v_mfma_f32_16x16x32_bf16 v[0:3], v[24:27], v[32:35], 0
  v_cndmask_b32 v40, 0, v41, s[20:21]
  v_cndmask_b32 v41, v41, 0, s[20:21]
  s_waitcnt vmcnt(0)
  v_mfma_f32_16x16x32_bf16 v[4:7], v[28:31], v[32:35], 0
  v_add_f32 v51, v46, v47
  v_add_f32_e64 v48, v48, v49
  v_mfma_f32_16x16x16_bf16 v[0:3], v[36:37], v[40:41], v[0:3]
  v_add_f32 v50, v50, v51
  v_fmac_f32 v50, 0.5, v48
  v_mfma_f32_16x16x16_bf16 v[4:7], v[38:39], v[40:41], v[4:7]
  buffer_store_dwordx4 v[36:39], v74, s[8:11], s36 offen sc1
  ds_read_b128 v[52:55], v78 offset:32768
  ds_read_b128 v[56:59], v78 offset:33792
  v_mov_b64_e64 v[24:25], 0
  v_add_f32_dpp v50, v50, v50 row_ror:8 row_mask:0xf bank_mask:0xf
  v_mov_b32 v51, v50
  v_mov_b64 v[26:27], 0
  v_mov_b64 v[28:29], 0
  v_permlane16_swap_b32 v50, v51
  v_add_f32 v50, v50, v51
  v_mov_b32 v51, v50
  v_add_f32_dpp v0, v0, v0 row_ror:8 row_mask:0xf bank_mask:0xf
  v_add_f32_dpp v1, v1, v1 row_ror:8 row_mask:0xf bank_mask:0xf
  v_permlane32_swap_b32 v50, v51
  v_add_f32 v50, v50, v51
  v_rcp_f32_e64 v50, v50
  v_add_f32_dpp v2, v2, v2 row_ror:8 row_mask:0xf bank_mask:0xf
  v_add_f32_dpp v3, v3, v3 row_ror:8 row_mask:0xf bank_mask:0xf
  v_add_f32_dpp v4, v4, v4 row_ror:8 row_mask:0xf bank_mask:0xf
  v_add_f32_dpp v5, v5, v5 row_ror:8 row_mask:0xf bank_mask:0xf
  v_add_f32_dpp v6, v6, v6 row_ror:8 row_mask:0xf bank_mask:0xf
  v_add_f32_dpp v7, v7, v7 row_ror:8 row_mask:0xf bank_mask:0xf
  v_mul_f32 v0, v0, v50
  v_mul_f32 v1, v1, v50
  v_mul_f32 v2, v2, v50
  v_mul_f32 v3, v3, v50
  v_mul_f32 v4, v4, v50
  v_mul_f32 v5, v5, v50
  v_mul_f32 v6, v6, v50
  v_mul_f32 v7, v7, v50
  v_cvt_pk_bf16_f32 v36, v0, v1
  v_cvt_pk_bf16_f32 v37, v2, v3
  v_cvt_pk_bf16_f32 v38, v4, v5
  v_cvt_pk_bf16_f32 v39, v6, v7
  ds_write_b128 v72, v[36:39]
  v_mov_b64_e64 v[30:31], 0
  v_smfmac_f32_16x16x64_bf16 v[24:27], v[36:39], a[184:191], v73
  v_mov_b64 v[0:1], 0
  v_mov_b64 v[2:3], 0
  v_smfmac_f32_16x16x64_bf16 v[28:31], v[36:39], a[192:199], v73
  v_mov_b64 v[4:5], 0
  v_mov_b64 v[6:7], 0
  v_smfmac_f32_16x16x64_bf16 v[0:3], v[36:39], a[240:247], v73
  v_mov_b64 v[44:45], 0
  v_mov_b64 v[46:47], 0
  s_waitcnt lgkmcnt(0)
  s_barrier
  ds_read_b128 v[68:71], v75 offset:10752
  ds_read_b128 v[32:35], v75 offset:9216
  ds_read_b128 v[40:43], v75 offset:10240
  v_smfmac_f32_16x16x64_bf16 v[4:7], v[36:39], a[176:183], v73
  v_bfe_u32 v48, v74, 7, 1
  v_smfmac_f32_16x16x64_bf16 v[44:47], v[36:39], a[200:207], v73
  v_lshrrev_b32_e64 v49, 8, v74
  v_lshl_add_u32 v48, v48, 2, v49
  v_mul_u32_u24 v48, 10368, v48
  v_and_or_b32 v72, v74, s46, v48
  ds_read_b128 v[60:63], v78 offset:40960
  ds_read_b128 v[64:67], v78 offset:41984
  s_waitcnt lgkmcnt(4)
  v_smfmac_f32_16x16x64_bf16 v[0:3], v[68:71], a[248:255], v73
  ds_read_b128 v[12:15], v78 offset:50176
  s_waitcnt lgkmcnt(4)
  v_smfmac_f32_16x16x64_bf16 v[4:7], v[32:35], a[144:151], v73
  s_waitcnt lgkmcnt(3)
  v_smfmac_f32_16x16x64_bf16 v[4:7], v[40:43], a[208:215], v73
  v_cvt_pk_bf16_f32 v0, v0, v1
  v_cvt_pk_bf16_f32 v1, v2, v3
  v_smfmac_f32_16x16x64_bf16 v[4:7], v[68:71], v[52:59], v73
  v_bfi_b32 v0, 1, s25, v0
  buffer_store_dwordx2 v[0:1], v77, s[8:11], s24 offen offset:0
  v_smfmac_f32_16x16x64_bf16 v[24:27], v[32:35], a[152:159], v73
  v_smfmac_f32_16x16x64_bf16 v[24:27], v[40:43], a[216:223], v73
  v_cvt_pk_bf16_f32 v4, v4, v5
  v_cvt_pk_bf16_f32 v5, v6, v7
  s_waitcnt lgkmcnt(1)
  v_smfmac_f32_16x16x64_bf16 v[24:27], v[68:71], v[60:67], v73
  v_bfi_b32 v4, 1, s25, v4
  buffer_store_dwordx2 v[4:5], v77, s[8:11], s23 offen offset:0
  v_smfmac_f32_16x16x64_bf16 v[28:31], v[32:35], a[160:167], v73
  v_smfmac_f32_16x16x64_bf16 v[28:31], v[40:43], a[224:231], v73
  v_cvt_pk_bf16_f32 v24, v24, v25
  v_cvt_pk_bf16_f32 v25, v26, v27
  s_waitcnt lgkmcnt(0)
  v_smfmac_f32_16x16x64_bf16 v[28:31], v[68:71], v[8:15], v73
  v_bfi_b32 v24, 1, s25, v24
  buffer_store_dwordx2 v[24:25], v77, s[8:11], s23 offen offset:2048
  v_smfmac_f32_16x16x64_bf16 v[44:47], v[32:35], a[168:175], v73
  ds_read_b128 v[16:19], v78 offset:57344
  ds_read_b128 v[20:23], v78 offset:58368
  v_smfmac_f32_16x16x64_bf16 v[44:47], v[40:43], a[232:239], v73
  v_cvt_pk_bf16_f32 v28, v28, v29
  v_cvt_pk_bf16_f32 v29, v30, v31
  s_waitcnt lgkmcnt(0)
  v_smfmac_f32_16x16x64_bf16 v[44:47], v[68:71], v[16:23], v73
  v_bfi_b32 v28, 1, s25, v28
  buffer_store_dwordx2 v[28:29], v77, s[8:11], s31 offen offset:0
  v_subrev_u32 v78, 65536, v78
  s_nop 4
  v_cvt_pk_bf16_f32 v44, v44, v45
  v_cvt_pk_bf16_f32 v45, v46, v47
  v_bfi_b32 v44, 1, s25, v44
  buffer_store_dwordx2 v[44:45], v77, s[8:11], s31 offen offset:2048
  v_lshrrev_b32 v69, 8, v74
  v_and_b32 v68, 0x70, v74
  v_and_b32_e64 v70, 1, v69
  v_lshl_add_u32 v68, v70, 3, v68
  v_lshrrev_b32_e64 v69, 1, v69
  v_lshl_add_u32 v68, v69, 2, v68
  v_add_u32 v68, s40, v68
  v_mov_b32 v71, -1
  v_bfe_u32 v69, v74, 4, 1
  v_lshlrev_b32_e64 v69, 4, v69
  v_mov_b32 v70, 0x3f80
  v_lshlrev_b32_e64 v70, v69, v70
  v_cndmask_b32 v48, 0, v70, s[66:67]
  v_cndmask_b32 v49, 0, v70, s[68:69]
  v_cndmask_b32 v50, 0, v70, s[70:71]
  v_cndmask_b32 v51, 0, v70, s[72:73]
  ds_read_b128 v[0:3], v78 offset:0
  ds_read_b128 v[4:7], v78 offset:1024
  ds_read_b128 v[8:11], v78 offset:8192
  ds_read_b128 v[12:15], v78 offset:9216
  ds_read_b128 v[16:19], v78 offset:16384
  ds_read_b128 v[20:23], v78 offset:17408
  s_waitcnt vmcnt(0)
  buffer_load_dwordx4 v[32:35], v72, s[8:11], s27 offen sc1
  buffer_load_dwordx4 v[36:39], v72, s[8:11], s52 offen sc1
  buffer_load_dwordx4 v[40:43], v72, s[8:11], s53 offen sc1
  buffer_load_dwordx4 v[24:27], v72, s[8:11], s54 offen sc1
  s_waitcnt vmcnt(3)
  v_mfma_f32_16x16x32_bf16 v[44:47], v[32:35], v[48:51], 0
  v_xor_b32_e64 v69, s25, v32
  v_bitop3_b32 v69, v69, v34, s25 bitop3:0xf6
  s_waitcnt vmcnt(2)
  v_mfma_f32_16x16x32_bf16 v[44:47], v[36:39], v[48:51], v[44:47]
  v_bitop3_b32 v69, v69, v36, s25 bitop3:0xf6
  v_bitop3_b32 v69, v69, v38, s25 bitop3:0xf6
  s_waitcnt vmcnt(1)
  v_mfma_f32_16x16x32_bf16 v[44:47], v[40:43], v[48:51], v[44:47]
  v_bitop3_b32 v69, v69, v40, s25 bitop3:0xf6
  v_bitop3_b32 v69, v69, v42, s25 bitop3:0xf6
  s_waitcnt vmcnt(0)
  v_mfma_f32_16x16x32_bf16 v[44:47], v[24:27], v[48:51], v[44:47]
  v_bitop3_b32 v69, v69, v24, s25 bitop3:0xf6
  v_bitop3_b32 v69, v69, v26, s25 bitop3:0xf6
  v_and_b32 v69, 1, v69
  v_cmp_ne_u32 vcc, 0, v69
  s_cbranch_vccnz Lc_fast1_redr0
Lc_fast1_redok:
  s_nop 2
  v_permlane32_swap_b32 v44, v46
  v_permlane32_swap_b32 v45, v47
  v_add_f32 v44, v44, v46
  v_add_f32_e64 v45, v45, v47
  v_cvt_pk_bf16_f32 v44, v44, v45
  s_mov_b64 exec, s[20:21]
  buffer_store_dword v44, v68, s[8:11], s28 offen
  buffer_store_dword v71, v68, s[8:11], s18 offen
  s_mov_b64 exec, -1
  v_mov_b64 v[44:45], 0
  v_mov_b64 v[46:47], 0
  v_mov_b64 v[48:49], 0
  v_mov_b64 v[50:51], 0
  s_mov_b32 s75, s28
  s_mov_b32 s44, s14
  s_add_u32 s14, s14, 1
  s_xor_b32 s25, s25, 1
  s_mov_b32 s45, s28
  s_mov_b32 s28, s29
  s_mov_b32 s29, s18
  s_mov_b32 s18, s45
  s_add_u32 s35, s35, 131072
  s_add_u32 s36, s36, 131072
  s_add_u32 s34, s34, 262144
  s_add_u32 s33, s33, 262144
  s_add_u32 s32, s32, 262144
  s_xor_b32 s55, s55, 4096
  s_xor_b32 s19, s19, 4096
  v_add_u32 v72, 153600, v74
  v_add_u32 v68, 151552, v74
  s_waitcnt vmcnt(2)
Lc_fast1_mpok:
  s_cmp_eq_u32 s14, 63
  s_waitcnt lgkmcnt(0)
  s_cbranch_scc0 Lc_fast1_top
  s_branch Lc_last1_top
Lc_fast1_end:
Lc_fast1_pbr0:
  buffer_load_dwordx4 v[28:31], v72, s[8:11], s75 offen sc1
Lc_fast1_pbr:
  buffer_load_dwordx4 v[24:27], v72, s[8:11], s75 offen sc1
  s_waitcnt vmcnt(1)
  ds_write_b128 v72, v[28:31]
  s_waitcnt lgkmcnt(0)
  v_max3_u32 v28, v28, v29, v30
  v_max_u32 v28, v28, v31
  v_cmp_eq_u32 vcc, -1, v28
  s_cbranch_vccz Lc_fast1_pbd
  buffer_load_dwordx4 v[28:31], v72, s[8:11], s75 offen sc1
  s_waitcnt vmcnt(1)
  ds_write_b128 v72, v[24:27]
  s_waitcnt lgkmcnt(0)
  v_max3_u32 v24, v24, v25, v26
  v_max_u32 v24, v24, v27
  v_cmp_eq_u32 vcc, -1, v24
  s_cbranch_vccz Lc_fast1_pbd
  s_sub_u32 s15, s15, 1
  s_cbranch_scc0 Lc_fast1_pbr
  s_mov_b32 s15, 0
Lc_fast1_pbd:
  s_waitcnt lgkmcnt(0)
  s_branch Lc_fast1_pbok
Lc_fast1_redr0:
  buffer_load_dwordx4 v[52:55], v72, s[8:11], s27 offen sc1
  buffer_load_dwordx4 v[56:59], v72, s[8:11], s52 offen sc1
  buffer_load_dwordx4 v[60:63], v72, s[8:11], s53 offen sc1
  buffer_load_dwordx4 v[64:67], v72, s[8:11], s54 offen sc1
  s_branch Lc_fast1_redr
Lc_fast1_redr:
  buffer_load_dwordx4 v[32:35], v72, s[8:11], s27 offen sc1
  buffer_load_dwordx4 v[36:39], v72, s[8:11], s52 offen sc1
  buffer_load_dwordx4 v[40:43], v72, s[8:11], s53 offen sc1
  buffer_load_dwordx4 v[24:27], v72, s[8:11], s54 offen sc1
  s_waitcnt vmcnt(7)
  v_mfma_f32_16x16x32_bf16 v[44:47], v[52:55], v[48:51], 0
  v_xor_b32 v69, s25, v52
  v_bitop3_b32 v69, v69, v54, s25 bitop3:0xf6
  s_waitcnt vmcnt(6)
  v_mfma_f32_16x16x32_bf16 v[44:47], v[56:59], v[48:51], v[44:47]
  v_bitop3_b32 v69, v69, v56, s25 bitop3:0xf6
  v_bitop3_b32 v69, v69, v58, s25 bitop3:0xf6
  s_waitcnt vmcnt(5)
  v_mfma_f32_16x16x32_bf16 v[44:47], v[60:63], v[48:51], v[44:47]
  v_bitop3_b32 v69, v69, v60, s25 bitop3:0xf6
  v_bitop3_b32 v69, v69, v62, s25 bitop3:0xf6
  s_waitcnt vmcnt(4)
  v_mfma_f32_16x16x32_bf16 v[44:47], v[64:67], v[48:51], v[44:47]
  v_bitop3_b32 v69, v69, v64, s25 bitop3:0xf6
  v_bitop3_b32 v69, v69, v66, s25 bitop3:0xf6
  v_and_b32 v69, 1, v69
  v_cmp_ne_u32 vcc, 0, v69
  s_cbranch_vccz Lc_fast1_redok
  buffer_load_dwordx4 v[52:55], v72, s[8:11], s27 offen sc1
  buffer_load_dwordx4 v[56:59], v72, s[8:11], s52 offen sc1
  buffer_load_dwordx4 v[60:63], v72, s[8:11], s53 offen sc1
  buffer_load_dwordx4 v[64:67], v72, s[8:11], s54 offen sc1
  s_waitcnt vmcnt(7)
  v_mfma_f32_16x16x32_bf16 v[44:47], v[32:35], v[48:51], 0
  v_xor_b32 v69, s25, v32
  v_bitop3_b32 v69, v69, v34, s25 bitop3:0xf6
  s_waitcnt vmcnt(6)
  v_mfma_f32_16x16x32_bf16 v[44:47], v[36:39], v[48:51], v[44:47]
  v_bitop3_b32 v69, v69, v36, s25 bitop3:0xf6
  v_bitop3_b32 v69, v69, v38, s25 bitop3:0xf6
  s_waitcnt vmcnt(5)
  v_mfma_f32_16x16x32_bf16 v[44:47], v[40:43], v[48:51], v[44:47]
  v_bitop3_b32 v69, v69, v40, s25 bitop3:0xf6
  v_bitop3_b32 v69, v69, v42, s25 bitop3:0xf6
  s_waitcnt vmcnt(4)
  v_mfma_f32_16x16x32_bf16 v[44:47], v[24:27], v[48:51], v[44:47]
  v_bitop3_b32 v69, v69, v24, s25 bitop3:0xf6
  v_bitop3_b32 v69, v69, v26, s25 bitop3:0xf6
  v_and_b32 v69, 1, v69
  v_cmp_ne_u32 vcc, 0, v69
  s_cbranch_vccz Lc_fast1_redok
  s_sub_u32 s15, s15, 1
  s_cbranch_scc0 Lc_fast1_redr
  s_mov_b32 s15, 0
  s_branch Lc_fast1_redok
Lc_fast2_top:
  s_barrier
  ds_read_b128 v[32:35], v75 offset:0
  ds_read_b128 v[36:39], v75 offset:512
  ds_read_b128 v[40:43], v75 offset:1024
  s_waitcnt lgkmcnt(2)
  v_smfmac_f32_16x16x64_bf16 v[44:47], v[32:35], v[0:7], v73
  ds_read_b128 v[68:71], v75 offset:1536
  buffer_load_dwordx4 v[24:27], v72, s[8:11], s75 offen sc1
  v_smfmac_f32_16x16x64_bf16 v[48:51], v[32:35], v[80:87], v73
  ds_read_b128 v[0:3], v78 offset:24576
  ds_read_b128 v[4:7], v78 offset:25600
  s_waitcnt lgkmcnt(4)
  v_smfmac_f32_16x16x64_bf16 v[44:47], v[36:39], v[8:15], v73
  ds_read_b128 v[32:35], v75 offset:2048
  v_smfmac_f32_16x16x64_bf16 v[48:51], v[36:39], v[88:95], v73
  ds_read_b128 v[8:11], v78 offset:32768
  s_waitcnt lgkmcnt(5)
  v_smfmac_f32_16x16x64_bf16 v[44:47], v[40:43], v[96:103], v73
  ds_read_b128 v[36:39], v75 offset:2560
  v_smfmac_f32_16x16x64_bf16 v[48:51], v[40:43], v[16:23], v73
  ds_read_b128 v[12:15], v78 offset:33792
  s_waitcnt lgkmcnt(6)
  v_smfmac_f32_16x16x64_bf16 v[44:47], v[68:71], v[104:111], v73
  ds_read_b128 v[40:43], v75 offset:3072
  s_waitcnt lgkmcnt(5)
  v_smfmac_f32_16x16x64_bf16 v[48:51], v[68:71], v[0:7], v73
  ds_read_b128 v[16:19], v78 offset:40960
  s_waitcnt lgkmcnt(5)
  v_smfmac_f32_16x16x64_bf16 v[44:47], v[32:35], v[112:119], v73
  ds_read_b128 v[68:71], v75 offset:3584
  v_smfmac_f32_16x16x64_bf16 v[48:51], v[32:35], v[120:127], v73
  ds_read_b128 v[20:23], v78 offset:41984
  s_waitcnt lgkmcnt(5)
  v_smfmac_f32_16x16x64_bf16 v[44:47], v[36:39], v[128:135], v73
  ds_read_b128 v[32:35], v75 offset:4096
  v_smfmac_f32_16x16x64_bf16 v[48:51], v[36:39], v[136:143], v73
  ds_read_b128 v[0:3], v78 offset:49152
  s_waitcnt lgkmcnt(5)
  v_smfmac_f32_16x16x64_bf16 v[44:47], v[40:43], v[8:15], v73
  ds_read_b128 v[36:39], v75 offset:4608
  v_smfmac_f32_16x16x64_bf16 v[48:51], v[40:43], v[144:151], v73
  ds_read_b128 v[4:7], v78 offset:50176
  ds_read_b128 v[8:11], v78 offset:57344
  s_waitcnt lgkmcnt(5)
  v_smfmac_f32_16x16x64_bf16 v[44:47], v[68:71], v[16:23], v73
  s_waitcnt vmcnt(0)
  ds_write_b128 v72, v[24:27]
  v_smfmac_f32_16x16x64_bf16 v[48:51], v[68:71], v[152:159], v73
  ds_read_b128 v[12:15], v78 offset:58368
  v_max3_u32 v28, v24, v25, v26
  v_max_u32 v28, v28, v27
  s_waitcnt lgkmcnt(6)
  v_smfmac_f32_16x16x64_bf16 v[44:47], v[32:35], v[160:167], v73
  v_add_u32 v78, 65536, v78
  v_cmp_eq_u32 vcc, -1, v28
  s_waitcnt lgkmcnt(3)
  v_smfmac_f32_16x16x64_bf16 v[48:51], v[32:35], v[0:7], v73
  ds_read_b128 v[16:19], v78 offset:0
  s_cbranch_vccnz Lc_fast2_pbr0
  s_waitcnt lgkmcnt(2)
Lc_fast2_pbok:
  s_barrier
  ds_read_b128 v[40:43], v75 offset:5120
  ds_read_b128 v[68:71], v75 offset:5632
  v_smfmac_f32_16x16x64_bf16 v[44:47], v[36:39], v[168:175], v73
  ds_read_b128 v[32:35], v75 offset:6144
  buffer_load_dwordx4 v[52:55], v74, s[8:11], s32 offen offset:0 sc1
  s_waitcnt lgkmcnt(4)
  v_smfmac_f32_16x16x64_bf16 v[48:51], v[36:39], v[8:15], v73
  ds_read_b128 v[20:23], v78 offset:1024
  ds_read_b128 v[0:3], v78 offset:8192
  s_waitcnt lgkmcnt(4)
  v_smfmac_f32_16x16x64_bf16 v[44:47], v[40:43], v[176:183], v73
  ds_read_b128 v[36:39], v75 offset:6656
  buffer_load_dwordx4 v[56:59], v74, s[8:11], s32 offen offset:1024 sc1
  v_smfmac_f32_16x16x64_bf16 v[48:51], v[40:43], v[184:191], v73
  ds_read_b128 v[4:7], v78 offset:9216
  s_waitcnt lgkmcnt(5)
  v_smfmac_f32_16x16x64_bf16 v[44:47], v[68:71], v[192:199], v73
  ds_read_b128 v[40:43], v75 offset:7168
  buffer_load_dwordx4 v[60:63], v74, s[8:11], s32 offen offset:2048 sc1
  v_smfmac_f32_16x16x64_bf16 v[48:51], v[68:71], v[200:207], v73
  ds_read_b128 v[8:11], v78 offset:16384
  s_waitcnt lgkmcnt(5)
  v_smfmac_f32_16x16x64_bf16 v[44:47], v[32:35], v[16:23], v73
  ds_read_b128 v[68:71], v75 offset:7680
  buffer_load_dwordx4 v[64:67], v74, s[8:11], s32 offen offset:3072 sc1
  v_smfmac_f32_16x16x64_bf16 v[48:51], v[32:35], v[208:215], v73
  ds_read_b128 v[12:15], v78 offset:17408
  ds_read_b128 v[16:19], v78 offset:24576
  s_waitcnt lgkmcnt(5)
  v_smfmac_f32_16x16x64_bf16 v[44:47], v[36:39], v[0:7], v73
  ds_read_b128 v[32:35], v75 offset:8192
  buffer_load_dwordx4 v[24:27], v74, s[8:11], s34 offen offset:0 sc1
  v_smfmac_f32_16x16x64_bf16 v[48:51], v[36:39], v[216:223], v73
  ds_read_b128 v[20:23], v78 offset:25600
  v_mov_b64 v[0:1], 0
  s_waitcnt lgkmcnt(6)
  v_smfmac_f32_16x16x64_bf16 v[44:47], v[40:43], v[224:231], v73
  ds_read_b128 v[36:39], v75 offset:8704
  buffer_load_dwordx4 v[28:31], v74, s[8:11], s34 offen offset:1024 sc1
  s_waitcnt lgkmcnt(4)
  v_smfmac_f32_16x16x64_bf16 v[48:51], v[40:43], v[8:15], v73
  v_mov_b64 v[2:3], 0
  v_smfmac_f32_16x16x64_bf16 v[44:47], v[68:71], v[232:239], v73
  ds_read_b128 v[40:43], v79 offset:0
  s_waitcnt lgkmcnt(2)
  v_smfmac_f32_16x16x64_bf16 v[48:51], v[68:71], v[16:23], v73
  v_mov_b64 v[4:5], 0
  v_smfmac_f32_16x16x64_bf16 v[44:47], v[32:35], v[240:247], v73
  ds_read_b128 v[68:71], v79 offset:1024
  v_smfmac_f32_16x16x64_bf16 v[48:51], v[32:35], v[248:255], v73
  v_mov_b64 v[6:7], 0
  s_waitcnt lgkmcnt(2)
  v_smfmac_f32_16x16x64_bf16 v[44:47], v[36:39], a[0:7], v73
  ds_read_b128 v[32:35], v79 offset:2048
  v_smfmac_f32_16x16x64_bf16 v[48:51], v[36:39], a[8:15], v73
  v_add_u32 v8, s37, v77
  s_waitcnt lgkmcnt(2)
  v_smfmac_f32_16x16x64_bf16 v[0:3], v[40:43], a[16:23], v73
  v_cvt_pk_bf16_f32 v44, v44, v45
  v_cvt_pk_bf16_f32 v45, v46, v47
  ds_write_b64 v8, v[44:45]
  s_nop 0
  v_cvt_pk_bf16_f32 v48, v48, v49
  v_cvt_pk_bf16_f32 v49, v50, v51
  ds_write_b64 v8, v[48:49] offset:2048
  v_smfmac_f32_16x16x64_bf16 v[4:7], v[40:43], a[24:31], v73
  ds_read_b128 v[36:39], v79 offset:3072
  s_waitcnt lgkmcnt(4)
  v_smfmac_f32_16x16x64_bf16 v[0:3], v[68:71], a[32:39], v73
  v_smfmac_f32_16x16x64_bf16 v[4:7], v[68:71], a[40:47], v73
  ds_read_b128 v[40:43], v79 offset:4096
  v_add_u32_e64 v50, s38, v75
  s_waitcnt lgkmcnt(2)
  s_barrier
  ds_read_b64_tr_b16 v[8:9], v76 offset:0
  ds_read_b64_tr_b16 v[10:11], v76 offset:128
  ds_read_b64_tr_b16 v[12:13], v76 offset:512
  ds_read_b64_tr_b16 v[14:15], v76 offset:640
  ds_read_b64_tr_b16 v[16:17], v76 offset:1024
  ds_read_b64_tr_b16 v[18:19], v76 offset:1152
  ds_read_b64_tr_b16 v[20:21], v76 offset:1536
  ds_read_b64_tr_b16 v[22:23], v76 offset:1664
  v_add_u32 v51, 65536, v78
  s_waitcnt vmcnt(5) lgkmcnt(6)
  v_mfma_f32_16x16x32_bf16 v[44:47], v[52:55], v[8:11], 0
  s_waitcnt vmcnt(4) lgkmcnt(4)
  v_mfma_f32_16x16x32_bf16 v[44:47], v[56:59], v[12:15], v[44:47]
  s_waitcnt vmcnt(3) lgkmcnt(2)
  v_mfma_f32_16x16x32_bf16 v[44:47], v[60:63], v[16:19], v[44:47]
  s_waitcnt vmcnt(2) lgkmcnt(0)
  v_mfma_f32_16x16x32_bf16 v[44:47], v[64:67], v[20:23], v[44:47]
  v_smfmac_f32_16x16x64_bf16 v[0:3], v[32:35], a[48:55], v73
  ds_read_b128 v[8:11], v51 offset:0
  v_smfmac_f32_16x16x64_bf16 v[4:7], v[32:35], a[56:63], v73
  ds_read_b128 v[68:71], v79 offset:5120
  ds_write_b128 v50, v[44:47]
  ds_read_b128 v[12:15], v51 offset:1024
  ds_read_b128 v[16:19], v51 offset:8192
  ds_read_b128 v[20:23], v51 offset:9216
  v_bfe_u32 v50, v74, 7, 1
  v_smfmac_f32_16x16x64_bf16 v[0:3], v[36:39], a[64:71], v73
  v_smfmac_f32_16x16x64_bf16 v[4:7], v[36:39], a[72:79], v73
  ds_read_b128 v[32:35], v79 offset:6144
  v_smfmac_f32_16x16x64_bf16 v[0:3], v[40:43], a[80:87], v73
  v_smfmac_f32_16x16x64_bf16 v[4:7], v[40:43], a[88:95], v73
  ds_read_b128 v[36:39], v79 offset:7168
  v_lshl_add_u32 v50, v50, 3, v75
  s_waitcnt lgkmcnt(5)
  s_barrier
  ds_read_b128 v[44:47], v79 offset:13824
  ds_read_b64 v[48:49], v50 offset:13312
  ds_read_b64 v[62:63], v50 offset:14848
  v_smfmac_f32_16x16x64_bf16 v[0:3], v[68:71], a[96:103], v73
  v_smfmac_f32_16x16x64_bf16 v[4:7], v[68:71], a[104:111], v73
  ds_read_b128 v[40:43], v79 offset:8192
  s_waitcnt lgkmcnt(5)
  v_smfmac_f32_16x16x64_bf16 v[0:3], v[32:35], a[112:119], v73
  v_smfmac_f32_16x16x64_bf16 v[4:7], v[32:35], a[120:127], v73
  s_waitcnt lgkmcnt(4)
  v_smfmac_f32_16x16x64_bf16 v[0:3], v[36:39], a[128:135], v73
  v_smfmac_f32_16x16x64_bf16 v[4:7], v[36:39], a[136:143], v73
  s_waitcnt lgkmcnt(0)
  v_smfmac_f32_16x16x64_bf16 v[0:3], v[40:43], v[8:15], v73
  v_smfmac_f32_16x16x64_bf16 v[4:7], v[40:43], v[16:23], v73
  v_max3_f32 v50, v44, v45, v46
  v_add_f32 v48, v48, v62
  v_add_f32_e64 v49, v49, v63
  v_max3_f32 v51, v47, v48, v49
  v_max_f32 v50, v50, v51
  v_add_u32 v72, s39, v75
  ds_read_b128 v[8:11], v78 offset:49152
  v_max_f32_dpp v50, v50, v50 row_ror:8 row_mask:0xf bank_mask:0xf
  v_mov_b32_e64 v51, v50
  v_cvt_pk_bf16_f32 v36, v0, v1
  v_cvt_pk_bf16_f32 v37, v2, v3
  v_permlane16_swap_b32 v50, v51
  v_max_f32 v50, v50, v51
  v_mov_b32_e64 v51, v50
  v_cvt_pk_bf16_f32 v38, v4, v5
  v_cvt_pk_bf16_f32 v39, v6, v7
  v_permlane32_swap_b32 v50, v51
  v_max_f32 v50, v50, v51
  v_mul_f32_e64 v50, s22, v50
  v_fma_f32 v44, v44, s22, -v50
  v_fma_f32 v45, v45, s22, -v50
  v_fma_f32 v46, v46, s22, -v50
  v_fma_f32 v47, v47, s22, -v50
  v_fma_f32 v48, v48, s22, -v50
  v_fma_f32 v49, v49, s22, -v50
  v_exp_f32 v44, v44
  v_exp_f32 v45, v45
  v_exp_f32 v46, v46
  v_exp_f32 v47, v47
  v_exp_f32 v48, v48
  v_exp_f32 v49, v49
  v_cvt_pk_bf16_f32 v50, v44, v45
  v_cvt_pk_bf16_f32 v51, v46, v47
  v_cndmask_b32 v32, 0, v50, s[20:21]
  v_cndmask_b32 v33, 0, v51, s[20:21]
  v_cndmask_b32 v34, v50, 0, s[20:21]
  v_cndmask_b32 v35, v51, 0, s[20:21]
  v_cvt_pk_bf16_f32 v41, v48, v49
  v_add_f32 v50, v44, v45
  s_waitcnt vmcnt(1)
  v_mfma_f32_16x16x32_bf16 v[0:3], v[24:27], v[32:35], 0
  v_cndmask_b32 v40, 0, v41, s[20:21]
  v_cndmask_b32 v41, v41, 0, s[20:21]
  s_waitcnt vmcnt(0)
  v_mfma_f32_16x16x32_bf16 v[4:7], v[28:31], v[32:35], 0
  v_add_f32 v51, v46, v47
  v_add_f32_e64 v48, v48, v49
  v_mfma_f32_16x16x16_bf16 v[0:3], v[36:37], v[40:41], v[0:3]
  v_add_f32 v50, v50, v51
  v_fmac_f32 v50, 0.5, v48
  v_mfma_f32_16x16x16_bf16 v[4:7], v[38:39], v[40:41], v[4:7]
  buffer_store_dwordx4 v[36:39], v74, s[8:11], s36 offen sc1
  ds_read_b128 v[52:55], v78 offset:32768
  ds_read_b128 v[56:59], v78 offset:33792
  v_mov_b64_e64 v[24:25], 0
  v_add_f32_dpp v50, v50, v50 row_ror:8 row_mask:0xf bank_mask:0xf
  v_mov_b32 v51, v50
  v_mov_b64 v[26:27], 0
  v_mov_b64 v[28:29], 0
  v_permlane16_swap_b32 v50, v51
  v_add_f32 v50, v50, v51
  v_mov_b32 v51, v50
  v_add_f32_dpp v0, v0, v0 row_ror:8 row_mask:0xf bank_mask:0xf
  v_add_f32_dpp v1, v1, v1 row_ror:8 row_mask:0xf bank_mask:0xf
  v_permlane32_swap_b32 v50, v51
  v_add_f32 v50, v50, v51
  v_rcp_f32_e64 v50, v50
  v_add_f32_dpp v2, v2, v2 row_ror:8 row_mask:0xf bank_mask:0xf
  v_add_f32_dpp v3, v3, v3 row_ror:8 row_mask:0xf bank_mask:0xf
  v_add_f32_dpp v4, v4, v4 row_ror:8 row_mask:0xf bank_mask:0xf
  v_add_f32_dpp v5, v5, v5 row_ror:8 row_mask:0xf bank_mask:0xf
  v_add_f32_dpp v6, v6, v6 row_ror:8 row_mask:0xf bank_mask:0xf
  v_add_f32_dpp v7, v7, v7 row_ror:8 row_mask:0xf bank_mask:0xf
  v_mul_f32 v0, v0, v50
  v_mul_f32 v1, v1, v50
  v_mul_f32 v2, v2, v50
  v_mul_f32 v3, v3, v50
  v_mul_f32 v4, v4, v50
  v_mul_f32 v5, v5, v50
  v_mul_f32 v6, v6, v50
  v_mul_f32 v7, v7, v50
  v_cvt_pk_bf16_f32 v40, v0, v1
  v_cvt_pk_bf16_f32 v41, v2, v3
  v_cvt_pk_bf16_f32 v42, v4, v5
  v_cvt_pk_bf16_f32 v43, v6, v7
  ds_write_b128 v72, v[40:43]
  v_mov_b64_e64 v[30:31], 0
  v_smfmac_f32_16x16x64_bf16 v[24:27], v[40:43], a[216:223], v73
  v_mov_b64 v[0:1], 0
  v_mov_b64 v[2:3], 0
  v_smfmac_f32_16x16x64_bf16 v[28:31], v[40:43], a[224:231], v73
  v_mov_b64 v[4:5], 0
  v_mov_b64 v[6:7], 0
  v_smfmac_f32_16x16x64_bf16 v[0:3], v[40:43], a[248:255], v73
  v_mov_b64 v[44:45], 0
  v_mov_b64 v[46:47], 0
  s_waitcnt lgkmcnt(0)
  s_barrier
  ds_read_b128 v[32:35], v75 offset:9216
  ds_read_b128 v[36:39], v75 offset:9728
  ds_read_b128 v[68:71], v75 offset:10752
  v_smfmac_f32_16x16x64_bf16 v[4:7], v[40:43], a[208:215], v73
  v_bfe_u32 v48, v74, 7, 1
  v_smfmac_f32_16x16x64_bf16 v[44:47], v[40:43], a[232:239], v73
  v_lshrrev_b32_e64 v49, 8, v74
  v_lshl_add_u32 v48, v48, 2, v49
  v_mul_u32_u24 v48, 10368, v48
  v_and_or_b32 v72, v74, s46, v48
  ds_read_b128 v[60:63], v78 offset:40960
  ds_read_b128 v[64:67], v78 offset:41984
  s_waitcnt lgkmcnt(4)
  v_smfmac_f32_16x16x64_bf16 v[0:3], v[32:35], a[240:247], v73
  ds_read_b128 v[12:15], v78 offset:50176
  v_smfmac_f32_16x16x64_bf16 v[4:7], v[32:35], a[144:151], v73
  s_waitcnt lgkmcnt(4)
  v_smfmac_f32_16x16x64_bf16 v[4:7], v[36:39], a[176:183], v73
  v_cvt_pk_bf16_f32 v0, v0, v1
  v_cvt_pk_bf16_f32 v1, v2, v3
  s_waitcnt lgkmcnt(3)
  v_smfmac_f32_16x16x64_bf16 v[4:7], v[68:71], v[52:59], v73
  v_bfi_b32 v0, 1, s25, v0
  buffer_store_dwordx2 v[0:1], v77, s[8:11], s24 offen offset:0
  v_smfmac_f32_16x16x64_bf16 v[24:27], v[32:35], a[152:159], v73
  v_smfmac_f32_16x16x64_bf16 v[24:27], v[36:39], a[184:191], v73
  v_cvt_pk_bf16_f32 v4, v4, v5
  v_cvt_pk_bf16_f32 v5, v6, v7
  s_waitcnt lgkmcnt(1)
  v_smfmac_f32_16x16x64_bf16 v[24:27], v[68:71], v[60:67], v73
  v_bfi_b32 v4, 1, s25, v4
  buffer_store_dwordx2 v[4:5], v77, s[8:11], s23 offen offset:0
  v_smfmac_f32_16x16x64_bf16 v[28:31], v[32:35], a[160:167], v73
  v_smfmac_f32_16x16x64_bf16 v[28:31], v[36:39], a[192:199], v73
  v_cvt_pk_bf16_f32 v24, v24, v25
  v_cvt_pk_bf16_f32 v25, v26, v27
  s_waitcnt lgkmcnt(0)
  v_smfmac_f32_16x16x64_bf16 v[28:31], v[68:71], v[8:15], v73
  v_bfi_b32 v24, 1, s25, v24
  buffer_store_dwordx2 v[24:25], v77, s[8:11], s23 offen offset:2048
  v_smfmac_f32_16x16x64_bf16 v[44:47], v[32:35], a[168:175], v73
  ds_read_b128 v[16:19], v78 offset:57344
  ds_read_b128 v[20:23], v78 offset:58368
  v_smfmac_f32_16x16x64_bf16 v[44:47], v[36:39], a[200:207], v73
  v_cvt_pk_bf16_f32 v28, v28, v29
  v_cvt_pk_bf16_f32 v29, v30, v31
  s_waitcnt lgkmcnt(0)
  v_smfmac_f32_16x16x64_bf16 v[44:47], v[68:71], v[16:23], v73
  v_bfi_b32 v28, 1, s25, v28
  buffer_store_dwordx2 v[28:29], v77, s[8:11], s31 offen offset:0
  v_subrev_u32 v78, 65536, v78
  s_nop 4
  v_cvt_pk_bf16_f32 v44, v44, v45
  v_cvt_pk_bf16_f32 v45, v46, v47
  v_bfi_b32 v44, 1, s25, v44
  buffer_store_dwordx2 v[44:45], v77, s[8:11], s31 offen offset:2048
  s_cmp_eq_u32 s41, -1
  s_cbranch_scc0 Lc_fast2_spec
Lc_fast2_specd:
  s_mov_b32 s75, s28
  s_mov_b32 s44, s14
  v_add_u32 v68, 149504, v74
  v_mov_b32 v70, 163832
Lc_fast2_lw:
  ds_read_b32 v69, v70
  s_sub_u32 s15, s15, 1
  s_cbranch_scc1 Lc_fast2_lwto
  s_waitcnt lgkmcnt(0)
  v_cmp_ne_u32 vcc, s44, v69
  s_cbranch_vccnz Lc_fast2_lw
  s_add_u32 s15, s15, 1
Lc_fast2_lwok:
  buffer_load_dwordx4 v[52:55], v68, s[8:11], s75 offen offset:0 sc1
  buffer_load_dwordx4 v[56:59], v68, s[8:11], s75 offen offset:1024 sc1
  ds_read_b128 v[0:3], v78 offset:0
  ds_read_b128 v[4:7], v78 offset:1024
  ds_read_b128 v[8:11], v78 offset:8192
  ds_read_b128 v[12:15], v78 offset:9216
  ds_read_b128 v[16:19], v78 offset:16384
  ds_read_b128 v[20:23], v78 offset:17408
  v_mov_b64 v[44:45], 0
  v_mov_b64 v[46:47], 0
  v_mov_b64 v[48:49], 0
  v_mov_b64_e64 v[50:51], 0
  s_mov_b32 s75, s28
  s_mov_b32 s44, s14
  s_add_u32 s14, s14, 1
  s_xor_b32 s25, s25, 1
  s_mov_b32 s45, s28
  s_mov_b32 s28, s29
  s_mov_b32 s29, s18
  s_mov_b32 s18, s45
  s_add_u32 s35, s35, 131072
  s_add_u32 s36, s36, 131072
  s_add_u32 s34, s34, 262144
  s_add_u32 s33, s33, 262144
  s_add_u32 s32, s32, 262144
  s_xor_b32 s55, s55, 4096
  s_xor_b32 s19, s19, 4096
  v_add_u32 v72, 154624, v74
  buffer_load_dwordx4 v[60:63], v68, s[8:11], s75 offen offset:0 sc1
  buffer_load_dwordx4 v[64:67], v68, s[8:11], s75 offen offset:1024 sc1
  s_waitcnt vmcnt(3)
  ds_write_b128 v68, v[52:55] offset:0
  v_max3_u32 v69, v52, v53, v54
  v_max_u32_e64 v69, v69, v55
  s_waitcnt vmcnt(2)
  ds_write_b128 v68, v[56:59] offset:1024
  v_max3_u32 v69, v69, v56, v57
  v_max3_u32 v69, v69, v58, v59
  v_cmp_eq_u32 vcc, -1, v69
  s_cbranch_vccnz Lc_fast2_mpr
Lc_fast2_mpok:
  s_cmp_eq_u32 s14, 63
  s_waitcnt lgkmcnt(0)
  s_cbranch_scc0 Lc_fast2_top
  s_branch Lc_last2_top
Lc_fast2_end:
Lc_fast2_mpr:
  buffer_load_dwordx4 v[52:55], v68, s[8:11], s75 offen offset:0 sc1
  buffer_load_dwordx4 v[56:59], v68, s[8:11], s75 offen offset:1024 sc1
  s_waitcnt vmcnt(3)
  ds_write_b128 v68, v[60:63] offset:0
  v_max3_u32 v69, v60, v61, v62
  v_max_u32 v69, v69, v63
  s_waitcnt vmcnt(2)
  ds_write_b128 v68, v[64:67] offset:1024
  v_max3_u32 v69, v69, v64, v65
  v_max3_u32 v69, v69, v66, v67
  v_cmp_eq_u32 vcc, -1, v69
  s_cbranch_vccz Lc_fast2_mpok
  buffer_load_dwordx4 v[60:63], v68, s[8:11], s75 offen offset:0 sc1
  buffer_load_dwordx4 v[64:67], v68, s[8:11], s75 offen offset:1024 sc1
  s_waitcnt vmcnt(3)
  ds_write_b128 v68, v[52:55] offset:0
  v_max3_u32 v69, v52, v53, v54
  v_max_u32 v69, v69, v55
  s_waitcnt vmcnt(2)
  ds_write_b128 v68, v[56:59] offset:1024
  v_max3_u32 v69, v69, v56, v57
  v_max3_u32 v69, v69, v58, v59
  v_cmp_eq_u32 vcc, -1, v69
  s_cbranch_vccz Lc_fast2_mpok
  s_sub_u32 s15, s15, 1
  s_cbranch_scc0 Lc_fast2_mpr
  s_mov_b32 s15, 0
  s_branch Lc_fast2_mpok
Lc_fast2_pbr0:
  buffer_load_dwordx4 v[28:31], v72, s[8:11], s75 offen sc1
Lc_fast2_pbr:
  buffer_load_dwordx4 v[24:27], v72, s[8:11], s75 offen sc1
  s_waitcnt vmcnt(1)
  ds_write_b128 v72, v[28:31]
  s_waitcnt lgkmcnt(0)
  v_max3_u32 v28, v28, v29, v30
  v_max_u32 v28, v28, v31
  v_cmp_eq_u32 vcc, -1, v28
  s_cbranch_vccz Lc_fast2_pbd
  buffer_load_dwordx4 v[28:31], v72, s[8:11], s75 offen sc1
  s_waitcnt vmcnt(1)
  ds_write_b128 v72, v[24:27]
  s_waitcnt lgkmcnt(0)
  v_max3_u32 v24, v24, v25, v26
  v_max_u32 v24, v24, v27
  v_cmp_eq_u32 vcc, -1, v24
  s_cbranch_vccz Lc_fast2_pbd
  s_sub_u32 s15, s15, 1
  s_cbranch_scc0 Lc_fast2_pbr
  s_mov_b32 s15, 0
Lc_fast2_pbd:
  s_waitcnt lgkmcnt(0)
  s_branch Lc_fast2_pbok
Lc_fast2_spec:
  v_add_u32 v28, 5120, v72
  s_waitcnt vmcnt(4)
  buffer_load_dwordx4 v[32:35], v72, s[8:11], s27 offen sc1
  buffer_load_dwordx4 v[36:39], v72, s[8:11], s52 offen sc1
  buffer_load_dwordx4 v[40:43], v72, s[8:11], s53 offen sc1
  buffer_load_dwordx4 v[24:27], v72, s[8:11], s54 offen sc1
  buffer_load_dwordx4 v[52:55], v28, s[8:11], s27 offen sc1
  buffer_load_dwordx4 v[56:59], v28, s[8:11], s52 offen sc1
  buffer_load_dwordx4 v[60:63], v28, s[8:11], s53 offen sc1
  buffer_load_dwordx4 v[64:67], v28, s[8:11], s54 offen sc1
  v_lshrrev_b32 v69, 8, v74
  v_and_b32 v68, 0x70, v74
  v_and_b32 v70, 1, v69
  v_lshl_add_u32 v68, v70, 3, v68
  v_lshrrev_b32 v69, 1, v69
  v_lshl_add_u32 v68, v69, 2, v68
  v_add_u32 v68, s40, v68
  v_mov_b32 v71, -1
  v_bfe_u32 v69, v74, 4, 1
  v_lshlrev_b32 v69, 4, v69
  v_mov_b32 v70, 0x3f80
  v_lshlrev_b32 v70, v69, v70
  v_cndmask_b32 v48, 0, v70, s[66:67]
  v_cndmask_b32 v49, 0, v70, s[68:69]
  v_cndmask_b32 v50, 0, v70, s[70:71]
  v_cndmask_b32 v51, 0, v70, s[72:73]
  s_waitcnt vmcnt(7)
  s_nop 0
  v_mfma_f32_16x16x32_bf16 v[44:47], v[32:35], v[48:51], 0
  v_xor_b32 v69, s25, v32
  v_bitop3_b32 v69, v69, v34, s25 bitop3:0xf6
  s_waitcnt vmcnt(6)
  v_mfma_f32_16x16x32_bf16 v[44:47], v[36:39], v[48:51], v[44:47]
  v_bitop3_b32 v69, v69, v36, s25 bitop3:0xf6
  v_bitop3_b32 v69, v69, v38, s25 bitop3:0xf6
  s_waitcnt vmcnt(5)
  v_mfma_f32_16x16x32_bf16 v[44:47], v[40:43], v[48:51], v[44:47]
  v_bitop3_b32 v69, v69, v40, s25 bitop3:0xf6
  v_bitop3_b32 v69, v69, v42, s25 bitop3:0xf6
  s_waitcnt vmcnt(4)
  v_mfma_f32_16x16x32_bf16 v[44:47], v[24:27], v[48:51], v[44:47]
  v_bitop3_b32 v69, v69, v24, s25 bitop3:0xf6
  v_bitop3_b32 v69, v69, v26, s25 bitop3:0xf6
  s_waitcnt vmcnt(3)
  v_mfma_f32_16x16x32_bf16 v[44:47], v[52:55], v[48:51], v[44:47]
  v_bitop3_b32 v69, v69, v52, s25 bitop3:0xf6
  v_bitop3_b32 v69, v69, v54, s25 bitop3:0xf6
  s_waitcnt vmcnt(2)
  v_mfma_f32_16x16x32_bf16 v[44:47], v[56:59], v[48:51], v[44:47]
  v_bitop3_b32 v69, v69, v56, s25 bitop3:0xf6
  v_bitop3_b32 v69, v69, v58, s25 bitop3:0xf6
  s_waitcnt vmcnt(1)
  v_mfma_f32_16x16x32_bf16 v[44:47], v[60:63], v[48:51], v[44:47]
  v_bitop3_b32 v69, v69, v60, s25 bitop3:0xf6
  v_bitop3_b32 v69, v69, v62, s25 bitop3:0xf6
  s_waitcnt vmcnt(0)
  v_mfma_f32_16x16x32_bf16 v[44:47], v[64:67], v[48:51], v[44:47]
  v_bitop3_b32 v69, v69, v64, s25 bitop3:0xf6
  v_bitop3_b32 v69, v69, v66, s25 bitop3:0xf6
  v_and_b32 v69, 1, v69
  v_cmp_ne_u32 vcc, 0, v69
  s_cbranch_vccz Lc_fast2_redok
Lc_fast2_specl:
  buffer_load_dwordx4 v[32:35], v72, s[8:11], s27 offen sc1
  buffer_load_dwordx4 v[36:39], v72, s[8:11], s52 offen sc1
  buffer_load_dwordx4 v[40:43], v72, s[8:11], s53 offen sc1
  buffer_load_dwordx4 v[24:27], v72, s[8:11], s54 offen sc1
  buffer_load_dwordx4 v[52:55], v28, s[8:11], s27 offen sc1
  buffer_load_dwordx4 v[56:59], v28, s[8:11], s52 offen sc1
  buffer_load_dwordx4 v[60:63], v28, s[8:11], s53 offen sc1
  buffer_load_dwordx4 v[64:67], v28, s[8:11], s54 offen sc1
  s_waitcnt vmcnt(7)
  v_mfma_f32_16x16x32_bf16 v[44:47], v[32:35], v[48:51], 0
  v_xor_b32 v69, s25, v32
  v_bitop3_b32 v69, v69, v34, s25 bitop3:0xf6
  s_waitcnt vmcnt(6)
  v_mfma_f32_16x16x32_bf16 v[44:47], v[36:39], v[48:51], v[44:47]
  v_bitop3_b32 v69, v69, v36, s25 bitop3:0xf6
  v_bitop3_b32 v69, v69, v38, s25 bitop3:0xf6
  s_waitcnt vmcnt(5)
  v_mfma_f32_16x16x32_bf16 v[44:47], v[40:43], v[48:51], v[44:47]
  v_bitop3_b32 v69, v69, v40, s25 bitop3:0xf6
  v_bitop3_b32 v69, v69, v42, s25 bitop3:0xf6
  s_waitcnt vmcnt(4)
  v_mfma_f32_16x16x32_bf16 v[44:47], v[24:27], v[48:51], v[44:47]
  v_bitop3_b32 v69, v69, v24, s25 bitop3:0xf6
  v_bitop3_b32 v69, v69, v26, s25 bitop3:0xf6
  s_waitcnt vmcnt(3)
  v_mfma_f32_16x16x32_bf16 v[44:47], v[52:55], v[48:51], v[44:47]
  v_bitop3_b32 v69, v69, v52, s25 bitop3:0xf6
  v_bitop3_b32 v69, v69, v54, s25 bitop3:0xf6
  s_waitcnt vmcnt(2)
  v_mfma_f32_16x16x32_bf16 v[44:47], v[56:59], v[48:51], v[44:47]
  v_bitop3_b32 v69, v69, v56, s25 bitop3:0xf6
  v_bitop3_b32 v69, v69, v58, s25 bitop3:0xf6
  s_waitcnt vmcnt(1)
  v_mfma_f32_16x16x32_bf16 v[44:47], v[60:63], v[48:51], v[44:47]
  v_bitop3_b32 v69, v69, v60, s25 bitop3:0xf6
  v_bitop3_b32 v69, v69, v62, s25 bitop3:0xf6
  s_waitcnt vmcnt(0)
  v_mfma_f32_16x16x32_bf16 v[44:47], v[64:67], v[48:51], v[44:47]
  v_bitop3_b32 v69, v69, v64, s25 bitop3:0xf6
  v_bitop3_b32 v69, v69, v66, s25 bitop3:0xf6
  v_and_b32 v69, 1, v69
  v_cmp_ne_u32 vcc, 0, v69
  s_cbranch_vccz Lc_fast2_redok
  s_sub_u32 s15, s15, 1
  s_cbranch_scc0 Lc_fast2_specl
  s_mov_b32 s15, 0
Lc_fast2_redok:
  s_nop 2
  v_permlane32_swap_b32 v44, v46
  v_permlane32_swap_b32 v45, v47
  v_add_f32 v44, v44, v46
  v_add_f32 v45, v45, v47
  v_cvt_pk_bf16_f32 v44, v44, v45
  s_mov_b64 exec, s[20:21]
  buffer_store_dword v44, v68, s[8:11], s28 offen
  buffer_store_dword v71, v68, s[8:11], s18 offen
  s_mov_b64 exec, -1
  s_branch Lc_fast2_specd
Lc_fast2_lwto:
  s_mov_b32 s15, 0
  s_branch Lc_fast2_lwok
Lc_fast3_top:
  s_barrier
  ds_read_b128 v[32:35], v75 offset:0
  ds_read_b128 v[36:39], v75 offset:512
  ds_read_b128 v[40:43], v75 offset:1024
  s_waitcnt lgkmcnt(2)
  v_smfmac_f32_16x16x64_bf16 v[44:47], v[32:35], v[0:7], v73
  ds_read_b128 v[68:71], v75 offset:1536
  buffer_load_dwordx4 v[24:27], v72, s[8:11], s75 offen sc1
  v_smfmac_f32_16x16x64_bf16 v[48:51], v[32:35], v[80:87], v73
  ds_read_b128 v[0:3], v78 offset:24576
  ds_read_b128 v[4:7], v78 offset:25600
  s_waitcnt lgkmcnt(4)
  v_smfmac_f32_16x16x64_bf16 v[44:47], v[36:39], v[8:15], v73
  ds_read_b128 v[32:35], v75 offset:2048
  v_smfmac_f32_16x16x64_bf16 v[48:51], v[36:39], v[88:95], v73
  ds_read_b128 v[8:11], v78 offset:32768
  s_waitcnt lgkmcnt(5)
  v_smfmac_f32_16x16x64_bf16 v[44:47], v[40:43], v[96:103], v73
  ds_read_b128 v[36:39], v75 offset:2560
  v_smfmac_f32_16x16x64_bf16 v[48:51], v[40:43], v[16:23], v73
  ds_read_b128 v[12:15], v78 offset:33792
  s_waitcnt lgkmcnt(6)
  v_smfmac_f32_16x16x64_bf16 v[44:47], v[68:71], v[104:111], v73
  ds_read_b128 v[40:43], v75 offset:3072
  s_waitcnt lgkmcnt(5)
  v_smfmac_f32_16x16x64_bf16 v[48:51], v[68:71], v[0:7], v73
  ds_read_b128 v[16:19], v78 offset:40960
  s_waitcnt lgkmcnt(5)
  v_smfmac_f32_16x16x64_bf16 v[44:47], v[32:35], v[112:119], v73
  ds_read_b128 v[68:71], v75 offset:3584
  v_smfmac_f32_16x16x64_bf16 v[48:51], v[32:35], v[120:127], v73
  ds_read_b128 v[20:23], v78 offset:41984
  s_waitcnt lgkmcnt(5)
  v_smfmac_f32_16x16x64_bf16 v[44:47], v[36:39], v[128:135], v73
  ds_read_b128 v[32:35], v75 offset:4096
  v_smfmac_f32_16x16x64_bf16 v[48:51], v[36:39], v[136:143], v73
  ds_read_b128 v[0:3], v78 offset:49152
  s_waitcnt lgkmcnt(5)
  v_smfmac_f32_16x16x64_bf16 v[44:47], v[40:43], v[8:15], v73
  ds_read_b128 v[36:39], v75 offset:4608
  v_smfmac_f32_16x16x64_bf16 v[48:51], v[40:43], v[144:151], v73
  ds_read_b128 v[4:7], v78 offset:50176
  ds_read_b128 v[8:11], v78 offset:57344
  s_waitcnt lgkmcnt(5)
  v_smfmac_f32_16x16x64_bf16 v[44:47], v[68:71], v[16:23], v73
  s_waitcnt vmcnt(0)
  ds_write_b128 v72, v[24:27]
  v_smfmac_f32_16x16x64_bf16 v[48:51], v[68:71], v[152:159], v73
  ds_read_b128 v[12:15], v78 offset:58368
  v_max3_u32 v28, v24, v25, v26
  v_max_u32 v28, v28, v27
  s_waitcnt lgkmcnt(6)
  v_smfmac_f32_16x16x64_bf16 v[44:47], v[32:35], v[160:167], v73
  v_add_u32 v78, 65536, v78
  v_cmp_eq_u32 vcc, -1, v28
  s_waitcnt lgkmcnt(3)
  v_smfmac_f32_16x16x64_bf16 v[48:51], v[32:35], v[0:7], v73
  ds_read_b128 v[16:19], v78 offset:0
  s_cbranch_vccnz Lc_fast3_pbr0
  s_waitcnt lgkmcnt(2)
Lc_fast3_pbok:
  s_barrier
  ds_read_b128 v[40:43], v75 offset:5120
  ds_read_b128 v[68:71], v75 offset:5632
  v_smfmac_f32_16x16x64_bf16 v[44:47], v[36:39], v[168:175], v73
  ds_read_b128 v[32:35], v75 offset:6144
  s_waitcnt lgkmcnt(4)
  v_smfmac_f32_16x16x64_bf16 v[48:51], v[36:39], v[8:15], v73
  ds_read_b128 v[20:23], v78 offset:1024
  ds_read_b128 v[0:3], v78 offset:8192
  buffer_load_dwordx4 v[24:27], v74, s[8:11], s34 offen offset:0 sc1
  s_waitcnt lgkmcnt(4)
  v_smfmac_f32_16x16x64_bf16 v[44:47], v[40:43], v[176:183], v73
  ds_read_b128 v[36:39], v75 offset:6656
  v_smfmac_f32_16x16x64_bf16 v[48:51], v[40:43], v[184:191], v73
  ds_read_b128 v[4:7], v78 offset:9216
  buffer_load_dwordx4 v[28:31], v74, s[8:11], s34 offen offset:1024 sc1
  s_waitcnt lgkmcnt(5)
  v_smfmac_f32_16x16x64_bf16 v[44:47], v[68:71], v[192:199], v73
  ds_read_b128 v[40:43], v75 offset:7168
  v_smfmac_f32_16x16x64_bf16 v[48:51], v[68:71], v[200:207], v73
  ds_read_b128 v[8:11], v78 offset:16384
  s_waitcnt lgkmcnt(5)
  v_smfmac_f32_16x16x64_bf16 v[44:47], v[32:35], v[16:23], v73
  ds_read_b128 v[68:71], v75 offset:7680
  v_smfmac_f32_16x16x64_bf16 v[48:51], v[32:35], v[208:215], v73
  ds_read_b128 v[12:15], v78 offset:17408
  ds_read_b128 v[16:19], v78 offset:24576
  s_waitcnt lgkmcnt(5)
  v_smfmac_f32_16x16x64_bf16 v[44:47], v[36:39], v[0:7], v73
  ds_read_b128 v[32:35], v75 offset:8192
  v_smfmac_f32_16x16x64_bf16 v[48:51], v[36:39], v[216:223], v73
  ds_read_b128 v[20:23], v78 offset:25600
  v_mov_b64 v[0:1], 0
  s_waitcnt lgkmcnt(6)
  v_smfmac_f32_16x16x64_bf16 v[44:47], v[40:43], v[224:231], v73
  ds_read_b128 v[36:39], v75 offset:8704
  v_lshlrev_b32 v60, 2, v74
  s_waitcnt lgkmcnt(4)
  v_smfmac_f32_16x16x64_bf16 v[48:51], v[40:43], v[8:15], v73
  v_mov_b64_e64 v[2:3], 0
  v_smfmac_f32_16x16x64_bf16 v[44:47], v[68:71], v[232:239], v73
  ds_read_b128 v[40:43], v79 offset:0
  s_waitcnt lgkmcnt(2)
  v_smfmac_f32_16x16x64_bf16 v[48:51], v[68:71], v[16:23], v73
  v_mov_b64 v[4:5], 0
  buffer_load_dword v64, off, s[8:11], s19 sc1
  v_smfmac_f32_16x16x64_bf16 v[44:47], v[32:35], v[240:247], v73
  ds_read_b128 v[68:71], v79 offset:1024
  buffer_load_dword v60, s[8:11], s63 offen sc1 lds
  s_add_u32 s63, s63, 4096
  v_smfmac_f32_16x16x64_bf16 v[48:51], v[32:35], v[248:255], v73
  v_mov_b64_e64 v[6:7], 0
  buffer_load_dword v60, s[8:11], s63 offen sc1 lds
  s_add_u32 s63, s63, 16773120
  s_waitcnt lgkmcnt(2)
  v_smfmac_f32_16x16x64_bf16 v[44:47], v[36:39], a[0:7], v73
  ds_read_b128 v[32:35], v79 offset:2048
  buffer_load_dword v60, s[8:11], s63 offen sc1 lds
  s_add_u32 s63, s63, 4096
  v_smfmac_f32_16x16x64_bf16 v[48:51], v[36:39], a[8:15], v73
  v_add_u32 v8, s37, v77
  buffer_load_dword v60, s[8:11], s63 offen sc1 lds
  s_add_u32 s63, s63, 0
  s_waitcnt lgkmcnt(2)
  v_smfmac_f32_16x16x64_bf16 v[0:3], v[40:43], a[16:23], v73
  v_cvt_pk_bf16_f32 v44, v44, v45
  v_cvt_pk_bf16_f32 v45, v46, v47
  ds_write_b64 v8, v[44:45]
  v_cvt_pk_bf16_f32 v48, v48, v49
  v_cvt_pk_bf16_f32 v49, v50, v51
  ds_write_b64 v8, v[48:49] offset:2048
  v_smfmac_f32_16x16x64_bf16 v[4:7], v[40:43], a[24:31], v73
  ds_read_b128 v[36:39], v79 offset:3072
  s_waitcnt lgkmcnt(4)
  v_smfmac_f32_16x16x64_bf16 v[0:3], v[68:71], a[32:39], v73
  v_smfmac_f32_16x16x64_bf16 v[4:7], v[68:71], a[40:47], v73
  ds_read_b128 v[40:43], v79 offset:4096
  v_add_u32 v50, s38, v75
  s_waitcnt lgkmcnt(2)
  s_barrier
  ds_read_b64_tr_b16 v[8:9], v76 offset:0
  ds_read_b64_tr_b16 v[10:11], v76 offset:128
  ds_read_b64_tr_b16 v[52:53], v76 offset:2048
  ds_read_b64_tr_b16 v[54:55], v76 offset:2176
  ds_read_b64_tr_b16 v[12:13], v76 offset:512
  ds_read_b64_tr_b16 v[14:15], v76 offset:640
  ds_read_b64_tr_b16 v[56:57], v76 offset:2560
  ds_read_b64_tr_b16 v[58:59], v76 offset:2688
  v_add_u32 v51, 65536, v78
  v_smfmac_f32_16x16x64_bf16 v[0:3], v[32:35], a[48:55], v73
  v_smfmac_f32_16x16x64_bf16 v[4:7], v[32:35], a[56:63], v73
  ds_read_b128 v[68:71], v79 offset:5120
  s_waitcnt lgkmcnt(5)
  v_mfma_f32_16x16x32_bf16 v[44:47], v[52:55], v[8:11], 0
  s_waitcnt lgkmcnt(1)
  v_mfma_f32_16x16x32_bf16 v[44:47], v[56:59], v[12:15], v[44:47]
  v_smfmac_f32_16x16x64_bf16 v[0:3], v[36:39], a[64:71], v73
  ds_read_b128 v[8:11], v51 offset:0
  v_smfmac_f32_16x16x64_bf16 v[4:7], v[36:39], a[72:79], v73
  ds_read_b128 v[32:35], v79 offset:6144
  ds_write_b128 v50, v[44:47]
  ds_read_b128 v[12:15], v51 offset:1024
  ds_read_b128 v[16:19], v51 offset:8192
  ds_read_b128 v[20:23], v51 offset:9216
  v_bfe_u32 v50, v74, 7, 1
  v_smfmac_f32_16x16x64_bf16 v[0:3], v[40:43], a[80:87], v73
  v_smfmac_f32_16x16x64_bf16 v[4:7], v[40:43], a[88:95], v73
  ds_read_b128 v[36:39], v79 offset:7168
  v_lshl_add_u32 v50, v50, 3, v75
  s_waitcnt lgkmcnt(4)
  s_barrier
  ds_read_b128 v[44:47], v79 offset:13824
  ds_read_b64 v[48:49], v50 offset:13312
  ds_read_b64 v[62:63], v50 offset:14848
  v_smfmac_f32_16x16x64_bf16 v[0:3], v[68:71], a[96:103], v73
  v_smfmac_f32_16x16x64_bf16 v[4:7], v[68:71], a[104:111], v73
  ds_read_b128 v[40:43], v79 offset:8192
  v_smfmac_f32_16x16x64_bf16 v[0:3], v[32:35], a[112:119], v73
  v_smfmac_f32_16x16x64_bf16 v[4:7], v[32:35], a[120:127], v73
  s_waitcnt lgkmcnt(4)
  v_smfmac_f32_16x16x64_bf16 v[0:3], v[36:39], a[128:135], v73
  v_smfmac_f32_16x16x64_bf16 v[4:7], v[36:39], a[136:143], v73
  s_waitcnt lgkmcnt(0)
  v_smfmac_f32_16x16x64_bf16 v[0:3], v[40:43], v[8:15], v73
  v_smfmac_f32_16x16x64_bf16 v[4:7], v[40:43], v[16:23], v73
  s_mov_b64 exec, s[20:21]
  buffer_store_dwordx4 v[52:55], v75, s[8:11], s35 offen offset:0 sc1
  buffer_store_dwordx4 v[56:59], v75, s[8:11], s35 offen offset:512 sc1
  s_mov_b64 exec, -1
  v_max3_f32 v50, v44, v45, v46
  v_add_f32 v48, v48, v62
  v_add_f32 v49, v49, v63
  v_max3_f32 v51, v47, v48, v49
  v_max_f32 v50, v50, v51
  v_add_u32 v72, s39, v75
  ds_read_b128 v[8:11], v78 offset:49152
  v_max_f32_dpp v50, v50, v50 row_ror:8 row_mask:0xf bank_mask:0xf
  v_mov_b32_e64 v51, v50
  v_cvt_pk_bf16_f32 v36, v0, v1
  v_cvt_pk_bf16_f32 v37, v2, v3
  v_permlane16_swap_b32 v50, v51
  v_max_f32 v50, v50, v51
  v_mov_b32_e64 v51, v50
  v_cvt_pk_bf16_f32 v38, v4, v5
  v_cvt_pk_bf16_f32 v39, v6, v7
  v_permlane32_swap_b32 v50, v51
  v_max_f32 v50, v50, v51
  v_mul_f32_e64 v50, s22, v50
  v_fma_f32 v44, v44, s22, -v50
  v_fma_f32 v45, v45, s22, -v50
  v_fma_f32 v46, v46, s22, -v50
  v_fma_f32 v47, v47, s22, -v50
  v_fma_f32 v48, v48, s22, -v50
  v_fma_f32 v49, v49, s22, -v50
  v_exp_f32 v44, v44
  v_exp_f32 v45, v45
  v_exp_f32 v46, v46
  v_exp_f32 v47, v47
  v_exp_f32 v48, v48
  v_exp_f32 v49, v49
  v_cvt_pk_bf16_f32 v50, v44, v45
  v_cvt_pk_bf16_f32 v51, v46, v47
  v_cndmask_b32 v32, 0, v50, s[20:21]
  v_cndmask_b32 v33, 0, v51, s[20:21]
  v_cndmask_b32 v34, v50, 0, s[20:21]
  v_cndmask_b32 v35, v51, 0, s[20:21]
  v_cvt_pk_bf16_f32 v41, v48, v49
  v_add_f32 v50, v44, v45
  s_waitcnt vmcnt(8)
  v_mfma_f32_16x16x32_bf16 v[0:3], v[24:27], v[32:35], 0
  v_cndmask_b32 v40, 0, v41, s[20:21]
  v_cndmask_b32 v41, v41, 0, s[20:21]
  s_waitcnt vmcnt(7)
  v_mfma_f32_16x16x32_bf16 v[4:7], v[28:31], v[32:35], 0
  v_add_f32 v51, v46, v47
  v_add_f32_e64 v48, v48, v49
  v_mfma_f32_16x16x16_bf16 v[0:3], v[36:37], v[40:41], v[0:3]
  v_add_f32 v50, v50, v51
  v_fmac_f32 v50, 0.5, v48
  v_mfma_f32_16x16x16_bf16 v[4:7], v[38:39], v[40:41], v[4:7]
  buffer_store_dwordx4 v[36:39], v74, s[8:11], s36 offen sc1
  ds_read_b128 v[52:55], v78 offset:32768
  ds_read_b128 v[56:59], v78 offset:33792
  v_mov_b64_e64 v[24:25], 0
  v_add_f32_dpp v50, v50, v50 row_ror:8 row_mask:0xf bank_mask:0xf
  v_mov_b32 v51, v50
  v_mov_b64 v[26:27], 0
  v_mov_b64 v[28:29], 0
  v_permlane16_swap_b32 v50, v51
  v_add_f32 v50, v50, v51
  v_mov_b32 v51, v50
  v_add_f32_dpp v0, v0, v0 row_ror:8 row_mask:0xf bank_mask:0xf
  v_add_f32_dpp v1, v1, v1 row_ror:8 row_mask:0xf bank_mask:0xf
  v_permlane32_swap_b32 v50, v51
  v_add_f32 v50, v50, v51
  v_rcp_f32_e64 v50, v50
  v_add_f32_dpp v2, v2, v2 row_ror:8 row_mask:0xf bank_mask:0xf
  v_add_f32_dpp v3, v3, v3 row_ror:8 row_mask:0xf bank_mask:0xf
  v_add_f32_dpp v4, v4, v4 row_ror:8 row_mask:0xf bank_mask:0xf
  v_add_f32_dpp v5, v5, v5 row_ror:8 row_mask:0xf bank_mask:0xf
  v_add_f32_dpp v6, v6, v6 row_ror:8 row_mask:0xf bank_mask:0xf
  v_add_f32_dpp v7, v7, v7 row_ror:8 row_mask:0xf bank_mask:0xf
  v_mul_f32 v0, v0, v50
  v_mul_f32 v1, v1, v50
  v_mul_f32 v2, v2, v50
  v_mul_f32 v3, v3, v50
  v_mul_f32 v4, v4, v50
  v_mul_f32 v5, v5, v50
  v_mul_f32 v6, v6, v50
  v_mul_f32 v7, v7, v50
  v_cvt_pk_bf16_f32 v68, v0, v1
  v_cvt_pk_bf16_f32 v69, v2, v3
  v_cvt_pk_bf16_f32 v70, v4, v5
  v_cvt_pk_bf16_f32 v71, v6, v7
  ds_write_b128 v72, v[68:71]
  v_mov_b64_e64 v[30:31], 0
  v_smfmac_f32_16x16x64_bf16 v[24:27], v[68:71], a[216:223], v73
  v_mov_b64 v[0:1], 0
  v_mov_b64 v[2:3], 0
  v_smfmac_f32_16x16x64_bf16 v[28:31], v[68:71], a[224:231], v73
  v_mov_b64 v[4:5], 0
  v_mov_b64 v[6:7], 0
  v_smfmac_f32_16x16x64_bf16 v[0:3], v[68:71], a[248:255], v73
  v_mov_b64 v[44:45], 0
  v_mov_b64 v[46:47], 0
  s_waitcnt lgkmcnt(0)
  s_barrier
  ds_read_b128 v[36:39], v75 offset:9728
  ds_read_b128 v[32:35], v75 offset:9216
  ds_read_b128 v[40:43], v75 offset:10240
  v_smfmac_f32_16x16x64_bf16 v[4:7], v[68:71], a[208:215], v73
  s_waitcnt vmcnt(7)
  v_readfirstlane_b32 s59, v64
  v_smfmac_f32_16x16x64_bf16 v[44:47], v[68:71], a[232:239], v73
  ds_read_b128 v[60:63], v78 offset:40960
  ds_read_b128 v[64:67], v78 offset:41984
  s_waitcnt lgkmcnt(4)
  v_smfmac_f32_16x16x64_bf16 v[0:3], v[36:39], a[240:247], v73
  ds_read_b128 v[12:15], v78 offset:50176
  v_smfmac_f32_16x16x64_bf16 v[4:7], v[36:39], a[176:183], v73
  s_waitcnt lgkmcnt(4)
  v_smfmac_f32_16x16x64_bf16 v[4:7], v[32:35], a[144:151], v73
  v_cvt_pk_bf16_f32 v0, v0, v1
  v_cvt_pk_bf16_f32 v1, v2, v3
  s_waitcnt lgkmcnt(3)
  v_smfmac_f32_16x16x64_bf16 v[4:7], v[40:43], v[52:59], v73
  v_bfi_b32 v0, 1, s25, v0
  buffer_store_dwordx2 v[0:1], v77, s[8:11], s24 offen offset:0
  v_smfmac_f32_16x16x64_bf16 v[24:27], v[36:39], a[184:191], v73
  v_smfmac_f32_16x16x64_bf16 v[24:27], v[32:35], a[152:159], v73
  v_cvt_pk_bf16_f32 v4, v4, v5
  v_cvt_pk_bf16_f32 v5, v6, v7
  s_waitcnt lgkmcnt(1)
  v_smfmac_f32_16x16x64_bf16 v[24:27], v[40:43], v[60:67], v73
  v_bfi_b32 v4, 1, s25, v4
  buffer_store_dwordx2 v[4:5], v77, s[8:11], s23 offen offset:0
  v_smfmac_f32_16x16x64_bf16 v[28:31], v[36:39], a[192:199], v73
  v_smfmac_f32_16x16x64_bf16 v[28:31], v[32:35], a[160:167], v73
  v_cvt_pk_bf16_f32 v24, v24, v25
  v_cvt_pk_bf16_f32 v25, v26, v27
  s_waitcnt lgkmcnt(0)
  v_smfmac_f32_16x16x64_bf16 v[28:31], v[40:43], v[8:15], v73
  v_bfi_b32 v24, 1, s25, v24
  buffer_store_dwordx2 v[24:25], v77, s[8:11], s23 offen offset:2048
  v_smfmac_f32_16x16x64_bf16 v[44:47], v[36:39], a[200:207], v73
  ds_read_b128 v[16:19], v78 offset:57344
  ds_read_b128 v[20:23], v78 offset:58368
  v_smfmac_f32_16x16x64_bf16 v[44:47], v[32:35], a[168:175], v73
  v_cvt_pk_bf16_f32 v28, v28, v29
  v_cvt_pk_bf16_f32 v29, v30, v31
  s_waitcnt lgkmcnt(0)
  v_smfmac_f32_16x16x64_bf16 v[44:47], v[40:43], v[16:23], v73
  v_bfi_b32 v28, 1, s25, v28
  buffer_store_dwordx2 v[28:29], v77, s[8:11], s31 offen offset:0
  v_subrev_u32 v78, 65536, v78
  s_nop 4
  v_cvt_pk_bf16_f32 v44, v44, v45
  v_cvt_pk_bf16_f32 v45, v46, v47
  v_bfi_b32 v44, 1, s25, v44
  buffer_store_dwordx2 v[44:45], v77, s[8:11], s31 offen offset:2048
  s_cmp_eq_u32 s26, 1
  s_cbranch_scc0 Lc_fast3_kvspin
Lc_fast3_kvok:
  s_add_u32 s42, s14, 2
  s_lshr_b32 s42, s42, 1
  s_cmp_gt_u32 s59, s42
  s_cselect_b32 s26, 1, 0
  s_cselect_b32 s42, 262144, 0
  s_add_u32 s63, s33, s42
  s_mov_b32 s75, s28
  s_mov_b32 s44, s14
  v_add_u32 v68, 147456, v74
  v_mov_b32 v70, 163832
Lc_fast3_lw:
  ds_read_b32 v69, v70
  s_sub_u32 s15, s15, 1
  s_cbranch_scc1 Lc_fast3_lwto
  s_waitcnt lgkmcnt(0)
  v_cmp_ne_u32 vcc, s44, v69
  s_cbranch_vccnz Lc_fast3_lw
  s_add_u32 s15, s15, 1
Lc_fast3_lwok:
  buffer_load_dwordx4 v[52:55], v68, s[8:11], s75 offen offset:0 sc1
  buffer_load_dwordx4 v[56:59], v68, s[8:11], s75 offen offset:1024 sc1
  ds_read_b128 v[0:3], v78 offset:0
  ds_read_b128 v[4:7], v78 offset:1024
  ds_read_b128 v[8:11], v78 offset:8192
  ds_read_b128 v[12:15], v78 offset:9216
  ds_read_b128 v[16:19], v78 offset:16384
  ds_read_b128 v[20:23], v78 offset:17408
  v_mov_b64 v[44:45], 0
  v_mov_b64 v[46:47], 0
  v_mov_b64 v[48:49], 0
  v_mov_b64 v[50:51], 0
  s_mov_b32 s75, s28
  s_mov_b32 s44, s14
  s_add_u32 s14, s14, 1
  s_xor_b32 s25, s25, 1
  s_mov_b32 s45, s28
  s_mov_b32 s28, s29
  s_mov_b32 s29, s18
  s_mov_b32 s18, s45
  s_add_u32 s35, s35, 131072
  s_add_u32 s36, s36, 131072
  s_add_u32 s34, s34, 262144
  s_add_u32 s33, s33, 262144
  s_add_u32 s32, s32, 262144
  s_xor_b32 s55, s55, 4096
  s_xor_b32 s19, s19, 4096
  v_add_u32 v72, 155648, v74
  buffer_load_dwordx4 v[60:63], v68, s[8:11], s75 offen offset:0 sc1
  buffer_load_dwordx4 v[64:67], v68, s[8:11], s75 offen offset:1024 sc1
  s_waitcnt vmcnt(3)
  ds_write_b128 v68, v[52:55] offset:0
  v_max3_u32 v69, v52, v53, v54
  v_max_u32_e64 v69, v69, v55
  s_waitcnt vmcnt(2)
  ds_write_b128 v68, v[56:59] offset:1024
  v_max3_u32 v69, v69, v56, v57
  v_max3_u32 v69, v69, v58, v59
  v_cmp_eq_u32 vcc, -1, v69
  s_cbranch_vccnz Lc_fast3_mpr
Lc_fast3_mpok:
  s_cmp_eq_u32 s14, 63
  s_waitcnt lgkmcnt(0)
  s_cbranch_scc0 Lc_fast3_top
  s_branch Lc_last3_top
Lc_fast3_end:
Lc_fast3_mpr:
  buffer_load_dwordx4 v[52:55], v68, s[8:11], s75 offen offset:0 sc1
  buffer_load_dwordx4 v[56:59], v68, s[8:11], s75 offen offset:1024 sc1
  s_waitcnt vmcnt(3)
  ds_write_b128 v68, v[60:63] offset:0
  v_max3_u32 v69, v60, v61, v62
  v_max_u32 v69, v69, v63
  s_waitcnt vmcnt(2)
  ds_write_b128 v68, v[64:67] offset:1024
  v_max3_u32 v69, v69, v64, v65
  v_max3_u32 v69, v69, v66, v67
  v_cmp_eq_u32 vcc, -1, v69
  s_cbranch_vccz Lc_fast3_mpok
  buffer_load_dwordx4 v[60:63], v68, s[8:11], s75 offen offset:0 sc1
  buffer_load_dwordx4 v[64:67], v68, s[8:11], s75 offen offset:1024 sc1
  s_waitcnt vmcnt(3)
  ds_write_b128 v68, v[52:55] offset:0
  v_max3_u32 v69, v52, v53, v54
  v_max_u32 v69, v69, v55
  s_waitcnt vmcnt(2)
  ds_write_b128 v68, v[56:59] offset:1024
  v_max3_u32 v69, v69, v56, v57
  v_max3_u32 v69, v69, v58, v59
  v_cmp_eq_u32 vcc, -1, v69
  s_cbranch_vccz Lc_fast3_mpok
  s_sub_u32 s15, s15, 1
  s_cbranch_scc0 Lc_fast3_mpr
  s_mov_b32 s15, 0
  s_branch Lc_fast3_mpok
Lc_fast3_pbr0:
  buffer_load_dwordx4 v[28:31], v72, s[8:11], s75 offen sc1
Lc_fast3_pbr:
  buffer_load_dwordx4 v[24:27], v72, s[8:11], s75 offen sc1
  s_waitcnt vmcnt(1)
  ds_write_b128 v72, v[28:31]
  s_waitcnt lgkmcnt(0)
  v_max3_u32 v28, v28, v29, v30
  v_max_u32 v28, v28, v31
  v_cmp_eq_u32 vcc, -1, v28
  s_cbranch_vccz Lc_fast3_pbd
  buffer_load_dwordx4 v[28:31], v72, s[8:11], s75 offen sc1
  s_waitcnt vmcnt(1)
  ds_write_b128 v72, v[24:27]
  s_waitcnt lgkmcnt(0)
  v_max3_u32 v24, v24, v25, v26
  v_max_u32 v24, v24, v27
  v_cmp_eq_u32 vcc, -1, v24
  s_cbranch_vccz Lc_fast3_pbd
  s_sub_u32 s15, s15, 1
  s_cbranch_scc0 Lc_fast3_pbr
  s_mov_b32 s15, 0
Lc_fast3_pbd:
  s_waitcnt lgkmcnt(0)
  s_branch Lc_fast3_pbok
Lc_fast3_kvspin:
  s_add_u32 s42, s14, 1
  s_lshr_b32 s42, s42, 1
  buffer_load_dword v70, off, s[8:11], s55 sc1
  s_waitcnt vmcnt(0)
  v_cmp_ge_u32 vcc, s42, v70
  s_cbranch_vccz Lc_fast3_kvok
  s_sleep 2
  s_sub_u32 s15, s15, 1
  s_cbranch_scc0 Lc_fast3_kvspin
  s_mov_b32 s15, 0
  s_branch Lc_fast3_kvok
Lc_fast3_lwto:
  s_mov_b32 s15, 0
  s_branch Lc_fast3_lwok
Lc_slow:
  s_cmp_eq_u32 s13, 1
  s_cbranch_scc1 Lc_slow1_top
  s_cmp_eq_u32 s13, 2
  s_cbranch_scc1 Lc_slow2_top
  s_cmp_eq_u32 s13, 3
  s_cbranch_scc1 Lc_slow3_top
  s_branch Lc_slow0_top
Lc_slow0_top:
  s_barrier
  ds_read_b128 v[32:35], v75 offset:0
  ds_read_b128 v[36:39], v75 offset:512
  ds_read_b128 v[40:43], v75 offset:1024
  s_waitcnt lgkmcnt(2)
  v_smfmac_f32_16x16x64_bf16 v[44:47], v[32:35], v[0:7], v73
  ds_read_b128 v[68:71], v75 offset:1536
  buffer_load_dwordx4 v[24:27], v72, s[8:11], s75 offen sc1
  v_smfmac_f32_16x16x64_bf16 v[48:51], v[32:35], v[80:87], v73
  ds_read_b128 v[0:3], v78 offset:24576
  ds_read_b128 v[4:7], v78 offset:25600
  s_waitcnt lgkmcnt(4)
  v_smfmac_f32_16x16x64_bf16 v[44:47], v[36:39], v[8:15], v73
  ds_read_b128 v[32:35], v75 offset:2048
  v_smfmac_f32_16x16x64_bf16 v[48:51], v[36:39], v[88:95], v73
  ds_read_b128 v[8:11], v78 offset:32768
  s_waitcnt lgkmcnt(5)
  v_smfmac_f32_16x16x64_bf16 v[44:47], v[40:43], v[96:103], v73
  ds_read_b128 v[36:39], v75 offset:2560
  v_smfmac_f32_16x16x64_bf16 v[48:51], v[40:43], v[16:23], v73
  ds_read_b128 v[12:15], v78 offset:33792
  s_waitcnt lgkmcnt(6)
  v_smfmac_f32_16x16x64_bf16 v[44:47], v[68:71], v[104:111], v73
  ds_read_b128 v[40:43], v75 offset:3072
  s_waitcnt lgkmcnt(5)
  v_smfmac_f32_16x16x64_bf16 v[48:51], v[68:71], v[0:7], v73
  ds_read_b128 v[16:19], v78 offset:40960
  s_waitcnt lgkmcnt(5)
  v_smfmac_f32_16x16x64_bf16 v[44:47], v[32:35], v[112:119], v73
  ds_read_b128 v[68:71], v75 offset:3584
  v_smfmac_f32_16x16x64_bf16 v[48:51], v[32:35], v[120:127], v73
  ds_read_b128 v[20:23], v78 offset:41984
  s_waitcnt lgkmcnt(5)
  v_smfmac_f32_16x16x64_bf16 v[44:47], v[36:39], v[128:135], v73
  ds_read_b128 v[32:35], v75 offset:4096
  v_smfmac_f32_16x16x64_bf16 v[48:51], v[36:39], v[136:143], v73
  ds_read_b128 v[0:3], v78 offset:49152
  s_waitcnt lgkmcnt(5)
  v_smfmac_f32_16x16x64_bf16 v[44:47], v[40:43], v[8:15], v73
  ds_read_b128 v[36:39], v75 offset:4608
  v_smfmac_f32_16x16x64_bf16 v[48:51], v[40:43], v[144:151], v73
  ds_read_b128 v[4:7], v78 offset:50176
  ds_read_b128 v[8:11], v78 offset:57344
  s_waitcnt lgkmcnt(5)
  v_smfmac_f32_16x16x64_bf16 v[44:47], v[68:71], v[16:23], v73
  s_waitcnt vmcnt(0)
  ds_write_b128 v72, v[24:27]
  v_smfmac_f32_16x16x64_bf16 v[48:51], v[68:71], v[152:159], v73
  ds_read_b128 v[12:15], v78 offset:58368
  v_max3_u32 v28, v24, v25, v26
  v_max_u32_e64 v28, v28, v27
  s_waitcnt lgkmcnt(6)
  v_smfmac_f32_16x16x64_bf16 v[44:47], v[32:35], v[160:167], v73
  v_add_u32 v78, 65536, v78
  v_cmp_eq_u32 vcc, -1, v28
  s_waitcnt lgkmcnt(3)
  v_smfmac_f32_16x16x64_bf16 v[48:51], v[32:35], v[0:7], v73
  ds_read_b128 v[16:19], v78 offset:0
  s_cbranch_vccnz Lc_slow0_pbr0
  s_waitcnt lgkmcnt(2)
Lc_slow0_pbok:
  s_barrier
  ds_read_b128 v[40:43], v75 offset:5120
  ds_read_b128 v[68:71], v75 offset:5632
  v_smfmac_f32_16x16x64_bf16 v[44:47], v[36:39], v[168:175], v73
  ds_read_b128 v[32:35], v75 offset:6144
  buffer_load_dwordx4 v[24:27], v74, s[8:11], s34 offen offset:0 sc1
  s_waitcnt lgkmcnt(4)
  v_smfmac_f32_16x16x64_bf16 v[48:51], v[36:39], v[8:15], v73
  ds_read_b128 v[20:23], v78 offset:1024
  ds_read_b128 v[0:3], v78 offset:8192
  s_waitcnt lgkmcnt(4)
  v_smfmac_f32_16x16x64_bf16 v[44:47], v[40:43], v[176:183], v73
  ds_read_b128 v[36:39], v75 offset:6656
  buffer_load_dwordx4 v[28:31], v74, s[8:11], s34 offen offset:1024 sc1
  v_smfmac_f32_16x16x64_bf16 v[48:51], v[40:43], v[184:191], v73
  ds_read_b128 v[4:7], v78 offset:9216
  s_waitcnt lgkmcnt(5)
  v_smfmac_f32_16x16x64_bf16 v[44:47], v[68:71], v[192:199], v73
  ds_read_b128 v[40:43], v75 offset:7168
  v_smfmac_f32_16x16x64_bf16 v[48:51], v[68:71], v[200:207], v73
  ds_read_b128 v[8:11], v78 offset:16384
  s_waitcnt lgkmcnt(5)
  v_smfmac_f32_16x16x64_bf16 v[44:47], v[32:35], v[16:23], v73
  ds_read_b128 v[68:71], v75 offset:7680
  v_smfmac_f32_16x16x64_bf16 v[48:51], v[32:35], v[208:215], v73
  ds_read_b128 v[12:15], v78 offset:17408
  ds_read_b128 v[16:19], v78 offset:24576
  s_waitcnt lgkmcnt(5)
  v_smfmac_f32_16x16x64_bf16 v[44:47], v[36:39], v[0:7], v73
  ds_read_b128 v[32:35], v75 offset:8192
  v_smfmac_f32_16x16x64_bf16 v[48:51], v[36:39], v[216:223], v73
  ds_read_b128 v[20:23], v78 offset:25600
  v_mov_b64 v[0:1], 0
  s_waitcnt lgkmcnt(6)
  v_smfmac_f32_16x16x64_bf16 v[44:47], v[40:43], v[224:231], v73
  ds_read_b128 v[36:39], v75 offset:8704
  s_waitcnt lgkmcnt(4)
  v_smfmac_f32_16x16x64_bf16 v[48:51], v[40:43], v[8:15], v73
  v_mov_b64 v[2:3], 0
  v_smfmac_f32_16x16x64_bf16 v[44:47], v[68:71], v[232:239], v73
  ds_read_b128 v[40:43], v79 offset:0
  s_waitcnt lgkmcnt(2)
  v_smfmac_f32_16x16x64_bf16 v[48:51], v[68:71], v[16:23], v73
  v_mov_b64 v[4:5], 0
  v_smfmac_f32_16x16x64_bf16 v[44:47], v[32:35], v[240:247], v73
  ds_read_b128 v[68:71], v79 offset:1024
  v_smfmac_f32_16x16x64_bf16 v[48:51], v[32:35], v[248:255], v73
  v_mov_b64 v[6:7], 0
  s_waitcnt lgkmcnt(2)
  v_smfmac_f32_16x16x64_bf16 v[44:47], v[36:39], a[0:7], v73
  ds_read_b128 v[32:35], v79 offset:2048
  v_smfmac_f32_16x16x64_bf16 v[48:51], v[36:39], a[8:15], v73
  v_add_u32 v8, s37, v77
  s_waitcnt lgkmcnt(2)
  v_smfmac_f32_16x16x64_bf16 v[0:3], v[40:43], a[16:23], v73
  v_cvt_pk_bf16_f32 v44, v44, v45
  v_cvt_pk_bf16_f32 v45, v46, v47
  ds_write_b64 v8, v[44:45]
  s_nop 0
  v_cvt_pk_bf16_f32 v48, v48, v49
  v_cvt_pk_bf16_f32 v49, v50, v51
  ds_write_b64 v8, v[48:49] offset:2048
  v_smfmac_f32_16x16x64_bf16 v[4:7], v[40:43], a[24:31], v73
  ds_read_b128 v[36:39], v79 offset:3072
  s_waitcnt lgkmcnt(4)
  v_smfmac_f32_16x16x64_bf16 v[0:3], v[68:71], a[32:39], v73
  v_smfmac_f32_16x16x64_bf16 v[4:7], v[68:71], a[40:47], v73
  ds_read_b128 v[40:43], v79 offset:4096
  v_add_u32_e64 v50, s38, v75
  s_waitcnt lgkmcnt(2)
  s_barrier
  ds_read_b64_tr_b16 v[8:9], v76 offset:0
  ds_read_b64_tr_b16 v[10:11], v76 offset:128
  ds_read_b64_tr_b16 v[52:53], v76 offset:2048
  ds_read_b64_tr_b16 v[54:55], v76 offset:2176
  ds_read_b64_tr_b16 v[12:13], v76 offset:512
  ds_read_b64_tr_b16 v[14:15], v76 offset:640
  ds_read_b64_tr_b16 v[56:57], v76 offset:2560
  ds_read_b64_tr_b16 v[58:59], v76 offset:2688
  v_add_u32 v51, 65536, v78
  v_smfmac_f32_16x16x64_bf16 v[0:3], v[32:35], a[48:55], v73
  v_smfmac_f32_16x16x64_bf16 v[4:7], v[32:35], a[56:63], v73
  ds_read_b128 v[68:71], v79 offset:5120
  s_waitcnt lgkmcnt(5)
  v_mfma_f32_16x16x32_bf16 v[44:47], v[52:55], v[8:11], 0
  s_waitcnt lgkmcnt(1)
  v_mfma_f32_16x16x32_bf16 v[44:47], v[56:59], v[12:15], v[44:47]
  v_smfmac_f32_16x16x64_bf16 v[0:3], v[36:39], a[64:71], v73
  ds_read_b128 v[8:11], v51 offset:0
  v_smfmac_f32_16x16x64_bf16 v[4:7], v[36:39], a[72:79], v73
  ds_read_b128 v[32:35], v79 offset:6144
  ds_write_b128 v50, v[44:47]
  ds_read_b128 v[12:15], v51 offset:1024
  ds_read_b128 v[16:19], v51 offset:8192
  ds_read_b128 v[20:23], v51 offset:9216
  v_bfe_u32 v50, v74, 7, 1
  v_smfmac_f32_16x16x64_bf16 v[0:3], v[40:43], a[80:87], v73
  v_smfmac_f32_16x16x64_bf16 v[4:7], v[40:43], a[88:95], v73
  ds_read_b128 v[36:39], v79 offset:7168
  v_lshl_add_u32 v50, v50, 3, v75
  s_waitcnt lgkmcnt(4)
  s_barrier
  ds_read_b128 v[44:47], v79 offset:13824
  ds_read_b64 v[48:49], v50 offset:13312
  ds_read_b64 v[62:63], v50 offset:14848
  v_smfmac_f32_16x16x64_bf16 v[0:3], v[68:71], a[96:103], v73
  v_smfmac_f32_16x16x64_bf16 v[4:7], v[68:71], a[104:111], v73
  ds_read_b128 v[40:43], v79 offset:8192
  v_smfmac_f32_16x16x64_bf16 v[0:3], v[32:35], a[112:119], v73
  v_smfmac_f32_16x16x64_bf16 v[4:7], v[32:35], a[120:127], v73
  s_waitcnt lgkmcnt(4)
  v_smfmac_f32_16x16x64_bf16 v[0:3], v[36:39], a[128:135], v73
  v_smfmac_f32_16x16x64_bf16 v[4:7], v[36:39], a[136:143], v73
  s_waitcnt lgkmcnt(0)
  v_smfmac_f32_16x16x64_bf16 v[0:3], v[40:43], v[8:15], v73
  v_smfmac_f32_16x16x64_bf16 v[4:7], v[40:43], v[16:23], v73
  s_mov_b64 exec, s[20:21]
  buffer_store_dwordx4 v[52:55], v75, s[8:11], s35 offen offset:0 sc1
  buffer_store_dwordx4 v[56:59], v75, s[8:11], s35 offen offset:512 sc1
  s_mov_b64 exec, -1
  v_max3_f32 v50, v44, v45, v46
  v_add_f32 v48, v48, v62
  v_add_f32 v49, v49, v63
  v_max3_f32 v51, v47, v48, v49
  v_max_f32 v50, v50, v51
  v_add_u32 v72, s39, v75
  ds_read_b128 v[8:11], v78 offset:49152
  v_max_f32_dpp v50, v50, v50 row_ror:8 row_mask:0xf bank_mask:0xf
  v_mov_b32_e64 v51, v50
  v_cvt_pk_bf16_f32 v36, v0, v1
  v_cvt_pk_bf16_f32 v37, v2, v3
  v_permlane16_swap_b32 v50, v51
  v_max_f32 v50, v50, v51
  v_mov_b32_e64 v51, v50
  v_cvt_pk_bf16_f32 v38, v4, v5
  v_cvt_pk_bf16_f32 v39, v6, v7
  v_permlane32_swap_b32 v50, v51
  v_max_f32 v50, v50, v51
  v_mul_f32_e64 v50, s22, v50
  v_fma_f32 v44, v44, s22, -v50
  v_fma_f32 v45, v45, s22, -v50
  v_fma_f32 v46, v46, s22, -v50
  v_fma_f32 v47, v47, s22, -v50
  v_fma_f32 v48, v48, s22, -v50
  v_fma_f32 v49, v49, s22, -v50
  v_exp_f32 v44, v44
  v_exp_f32 v45, v45
  v_exp_f32 v46, v46
  v_exp_f32 v47, v47
  v_exp_f32 v48, v48
  v_exp_f32 v49, v49
  v_cvt_pk_bf16_f32 v50, v44, v45
  v_cvt_pk_bf16_f32 v51, v46, v47
  v_cndmask_b32 v32, 0, v50, s[20:21]
  v_cndmask_b32 v33, 0, v51, s[20:21]
  v_cndmask_b32 v34, v50, 0, s[20:21]
  v_cndmask_b32 v35, v51, 0, s[20:21]
  v_cvt_pk_bf16_f32 v41, v48, v49
  v_add_f32 v50, v44, v45
  s_waitcnt vmcnt(3)
  v_mfma_f32_16x16x32_bf16 v[0:3], v[24:27], v[32:35], 0
  v_cndmask_b32 v40, 0, v41, s[20:21]
  v_cndmask_b32 v41, v41, 0, s[20:21]
  s_waitcnt vmcnt(2)
  v_mfma_f32_16x16x32_bf16 v[4:7], v[28:31], v[32:35], 0
  v_add_f32 v51, v46, v47
  v_add_f32_e64 v48, v48, v49
  v_mfma_f32_16x16x16_bf16 v[0:3], v[36:37], v[40:41], v[0:3]
  v_add_f32 v50, v50, v51
  v_fmac_f32 v50, 0.5, v48
  v_mfma_f32_16x16x16_bf16 v[4:7], v[38:39], v[40:41], v[4:7]
  buffer_store_dwordx4 v[36:39], v74, s[8:11], s36 offen sc1
  ds_read_b128 v[52:55], v78 offset:32768
  ds_read_b128 v[56:59], v78 offset:33792
  v_mov_b64_e64 v[24:25], 0
  v_add_f32_dpp v50, v50, v50 row_ror:8 row_mask:0xf bank_mask:0xf
  v_mov_b32 v51, v50
  v_mov_b64 v[26:27], 0
  v_mov_b64 v[28:29], 0
  v_permlane16_swap_b32 v50, v51
  v_add_f32 v50, v50, v51
  v_mov_b32 v51, v50
  v_add_f32_dpp v0, v0, v0 row_ror:8 row_mask:0xf bank_mask:0xf
  v_add_f32_dpp v1, v1, v1 row_ror:8 row_mask:0xf bank_mask:0xf
  v_permlane32_swap_b32 v50, v51
  v_add_f32 v50, v50, v51
  v_rcp_f32_e64 v50, v50
  v_add_f32_dpp v2, v2, v2 row_ror:8 row_mask:0xf bank_mask:0xf
  v_add_f32_dpp v3, v3, v3 row_ror:8 row_mask:0xf bank_mask:0xf
  v_add_f32_dpp v4, v4, v4 row_ror:8 row_mask:0xf bank_mask:0xf
  v_add_f32_dpp v5, v5, v5 row_ror:8 row_mask:0xf bank_mask:0xf
  v_add_f32_dpp v6, v6, v6 row_ror:8 row_mask:0xf bank_mask:0xf
  v_add_f32_dpp v7, v7, v7 row_ror:8 row_mask:0xf bank_mask:0xf
  v_mul_f32 v0, v0, v50
  v_mul_f32 v1, v1, v50
  v_mul_f32 v2, v2, v50
  v_mul_f32 v3, v3, v50
  v_mul_f32 v4, v4, v50
  v_mul_f32 v5, v5, v50
  v_mul_f32 v6, v6, v50
  v_mul_f32 v7, v7, v50
  v_cvt_pk_bf16_f32 v32, v0, v1
  v_cvt_pk_bf16_f32 v33, v2, v3
  v_cvt_pk_bf16_f32 v34, v4, v5
  v_cvt_pk_bf16_f32 v35, v6, v7
  ds_write_b128 v72, v[32:35]
  v_mov_b64_e64 v[30:31], 0
  v_smfmac_f32_16x16x64_bf16 v[24:27], v[32:35], a[152:159], v73
  v_mov_b64 v[0:1], 0
  v_mov_b64 v[2:3], 0
  v_smfmac_f32_16x16x64_bf16 v[28:31], v[32:35], a[160:167], v73
  v_mov_b64 v[4:5], 0
  v_mov_b64 v[6:7], 0
  v_smfmac_f32_16x16x64_bf16 v[0:3], v[32:35], a[240:247], v73
  v_mov_b64 v[44:45], 0
  v_mov_b64 v[46:47], 0
  s_waitcnt lgkmcnt(0)
  s_barrier
  ds_read_b128 v[40:43], v75 offset:10240
  ds_read_b128 v[36:39], v75 offset:9728
  ds_read_b128 v[68:71], v75 offset:10752
  v_smfmac_f32_16x16x64_bf16 v[4:7], v[32:35], a[144:151], v73
  v_bfe_u32 v48, v74, 7, 1
  v_smfmac_f32_16x16x64_bf16 v[44:47], v[32:35], a[168:175], v73
  v_lshrrev_b32_e64 v49, 8, v74
  v_lshl_add_u32 v48, v48, 2, v49
  v_mul_u32_u24 v48, 10368, v48
  v_and_or_b32 v72, v74, s46, v48
  ds_read_b128 v[60:63], v78 offset:40960
  ds_read_b128 v[64:67], v78 offset:41984
  s_waitcnt lgkmcnt(4)
  v_smfmac_f32_16x16x64_bf16 v[0:3], v[40:43], a[248:255], v73
  ds_read_b128 v[12:15], v78 offset:50176
  v_smfmac_f32_16x16x64_bf16 v[4:7], v[40:43], a[208:215], v73
  s_waitcnt lgkmcnt(4)
  v_smfmac_f32_16x16x64_bf16 v[4:7], v[36:39], a[176:183], v73
  v_cvt_pk_bf16_f32 v0, v0, v1
  v_cvt_pk_bf16_f32 v1, v2, v3
  s_waitcnt lgkmcnt(3)
  v_smfmac_f32_16x16x64_bf16 v[4:7], v[68:71], v[52:59], v73
  v_bfi_b32 v0, 1, s25, v0
  buffer_store_dwordx2 v[0:1], v77, s[8:11], s24 offen offset:0 sc1
  v_smfmac_f32_16x16x64_bf16 v[24:27], v[40:43], a[216:223], v73
  v_smfmac_f32_16x16x64_bf16 v[24:27], v[36:39], a[184:191], v73
  v_cvt_pk_bf16_f32 v4, v4, v5
  v_cvt_pk_bf16_f32 v5, v6, v7
  s_waitcnt lgkmcnt(1)
  v_smfmac_f32_16x16x64_bf16 v[24:27], v[68:71], v[60:67], v73
  v_bfi_b32 v4, 1, s25, v4
  buffer_store_dwordx2 v[4:5], v77, s[8:11], s23 offen offset:0 sc1
  v_smfmac_f32_16x16x64_bf16 v[28:31], v[40:43], a[224:231], v73
  v_smfmac_f32_16x16x64_bf16 v[28:31], v[36:39], a[192:199], v73
  v_cvt_pk_bf16_f32 v24, v24, v25
  v_cvt_pk_bf16_f32 v25, v26, v27
  s_waitcnt lgkmcnt(0)
  v_smfmac_f32_16x16x64_bf16 v[28:31], v[68:71], v[8:15], v73
  v_bfi_b32 v24, 1, s25, v24
  buffer_store_dwordx2 v[24:25], v77, s[8:11], s23 offen offset:2048 sc1
  v_smfmac_f32_16x16x64_bf16 v[44:47], v[40:43], a[232:239], v73
  ds_read_b128 v[16:19], v78 offset:57344
  ds_read_b128 v[20:23], v78 offset:58368
  v_smfmac_f32_16x16x64_bf16 v[44:47], v[36:39], a[200:207], v73
  v_cvt_pk_bf16_f32 v28, v28, v29
  v_cvt_pk_bf16_f32 v29, v30, v31
  s_waitcnt lgkmcnt(0)
  v_smfmac_f32_16x16x64_bf16 v[44:47], v[68:71], v[16:23], v73
  v_bfi_b32 v28, 1, s25, v28
  buffer_store_dwordx2 v[28:29], v77, s[8:11], s31 offen offset:0 sc1
  v_subrev_u32 v78, 65536, v78
  s_nop 4
  v_cvt_pk_bf16_f32 v44, v44, v45
  v_cvt_pk_bf16_f32 v45, v46, v47
  v_bfi_b32 v44, 1, s25, v44
  buffer_store_dwordx2 v[44:45], v77, s[8:11], s31 offen offset:2048 sc1
  s_waitcnt vmcnt(2)
  buffer_load_dwordx4 v[32:35], v72, s[8:11], s27 offen sc1
  buffer_load_dwordx4 v[36:39], v72, s[8:11], s52 offen sc1
  buffer_load_dwordx4 v[40:43], v72, s[8:11], s53 offen sc1
  buffer_load_dwordx4 v[24:27], v72, s[8:11], s54 offen sc1
  v_lshrrev_b32_e64 v69, 8, v74
  v_and_b32 v68, 0x70, v74
  v_and_b32_e64 v70, 1, v69
  v_lshl_add_u32 v68, v70, 3, v68
  v_lshrrev_b32_e64 v69, 1, v69
  v_lshl_add_u32 v68, v69, 2, v68
  v_add_u32 v68, s40, v68
  v_mov_b32 v71, -1
  v_bfe_u32 v69, v74, 4, 1
  v_lshlrev_b32_e64 v69, 4, v69
  v_mov_b32 v70, 0x3f80
  v_lshlrev_b32_e64 v70, v69, v70
  v_cndmask_b32 v48, 0, v70, s[66:67]
  v_cndmask_b32 v49, 0, v70, s[68:69]
  v_cndmask_b32 v50, 0, v70, s[70:71]
  v_cndmask_b32 v51, 0, v70, s[72:73]
  ds_read_b128 v[0:3], v78 offset:0
  ds_read_b128 v[4:7], v78 offset:1024
  ds_read_b128 v[8:11], v78 offset:8192
  ds_read_b128 v[12:15], v78 offset:9216
  ds_read_b128 v[16:19], v78 offset:16384
  ds_read_b128 v[20:23], v78 offset:17408
  buffer_load_dwordx4 v[52:55], v72, s[8:11], s27 offen sc1
  buffer_load_dwordx4 v[56:59], v72, s[8:11], s52 offen sc1
  buffer_load_dwordx4 v[60:63], v72, s[8:11], s53 offen sc1
  buffer_load_dwordx4 v[64:67], v72, s[8:11], s54 offen sc1
  s_waitcnt vmcnt(7)
  v_mfma_f32_16x16x32_bf16 v[44:47], v[32:35], v[48:51], 0
  v_xor_b32 v69, s25, v32
  v_bitop3_b32 v69, v69, v34, s25 bitop3:0xf6
  s_waitcnt vmcnt(6)
  v_mfma_f32_16x16x32_bf16 v[44:47], v[36:39], v[48:51], v[44:47]
  v_bitop3_b32 v69, v69, v36, s25 bitop3:0xf6
  v_bitop3_b32 v69, v69, v38, s25 bitop3:0xf6
  s_waitcnt vmcnt(5)
  v_mfma_f32_16x16x32_bf16 v[44:47], v[40:43], v[48:51], v[44:47]
  v_bitop3_b32 v69, v69, v40, s25 bitop3:0xf6
  v_bitop3_b32 v69, v69, v42, s25 bitop3:0xf6
  s_waitcnt vmcnt(4)
  v_mfma_f32_16x16x32_bf16 v[44:47], v[24:27], v[48:51], v[44:47]
  v_bitop3_b32 v69, v69, v24, s25 bitop3:0xf6
  v_bitop3_b32 v69, v69, v26, s25 bitop3:0xf6
  v_and_b32 v69, 1, v69
  v_cmp_ne_u32 vcc, 0, v69
  s_cbranch_vccnz Lc_slow0_redr
Lc_slow0_redok:
  s_nop 2
  v_permlane32_swap_b32 v44, v46
  v_permlane32_swap_b32 v45, v47
  v_add_f32 v44, v44, v46
  v_add_f32_e64 v45, v45, v47
  v_cvt_pk_bf16_f32 v44, v44, v45
  s_mov_b64 exec, s[20:21]
  buffer_store_dword v44, v68, s[8:11], s28 offen sc1
  buffer_store_dword v71, v68, s[8:11], s18 offen sc1
  s_mov_b64 exec, -1
  v_mov_b32 v69, 163832
  v_mov_b32_e64 v70, s14
  ds_write_b32 v69, v70
  v_mov_b64 v[44:45], 0
  v_mov_b64 v[46:47], 0
  v_mov_b64 v[48:49], 0
  v_mov_b64 v[50:51], 0
  s_mov_b32 s75, s28
  s_mov_b32 s44, s14
  v_add_u32 v68, 151552, v74
  buffer_load_dwordx4 v[52:55], v68, s[8:11], s75 offen offset:0 sc1
  s_add_u32 s14, s14, 1
  s_xor_b32 s25, s25, 1
  s_mov_b32 s45, s28
  s_mov_b32 s28, s29
  s_mov_b32 s29, s18
  s_mov_b32 s18, s45
  s_add_u32 s35, s35, 131072
  s_add_u32 s36, s36, 131072
  s_add_u32 s34, s34, 262144
  s_add_u32 s33, s33, 262144
  s_add_u32 s32, s32, 262144
  s_xor_b32 s55, s55, 4096
  s_xor_b32 s19, s19, 4096
  v_add_u32 v72, 152576, v74
  buffer_load_dwordx4 v[60:63], v68, s[8:11], s75 offen offset:0 sc1
  s_waitcnt vmcnt(1)
  ds_write_b128 v68, v[52:55] offset:0
  v_max3_u32 v69, v52, v53, v54
  v_max_u32 v69, v69, v55
  v_cmp_eq_u32 vcc, -1, v69
  s_cbranch_vccnz Lc_slow0_mpr
Lc_slow0_mpok:
  s_cmp_eq_u32 s14, 63
  s_waitcnt lgkmcnt(0)
  s_cbranch_scc0 Lc_slow0_top
  s_branch Lc_last0_top
Lc_slow0_end:
Lc_slow0_mpr:
  buffer_load_dwordx4 v[52:55], v68, s[8:11], s75 offen offset:0 sc1
  s_waitcnt vmcnt(1)
  ds_write_b128 v68, v[60:63] offset:0
  v_max3_u32 v69, v60, v61, v62
  v_max_u32 v69, v69, v63
  v_cmp_eq_u32 vcc, -1, v69
  s_cbranch_vccz Lc_slow0_mpok
  buffer_load_dwordx4 v[60:63], v68, s[8:11], s75 offen offset:0 sc1
  s_waitcnt vmcnt(1)
  ds_write_b128 v68, v[52:55] offset:0
  v_max3_u32 v69, v52, v53, v54
  v_max_u32 v69, v69, v55
  v_cmp_eq_u32 vcc, -1, v69
  s_cbranch_vccz Lc_slow0_mpok
  s_sub_u32 s15, s15, 1
  s_cbranch_scc0 Lc_slow0_mpr
  s_mov_b32 s15, 0
  s_branch Lc_slow0_mpok
Lc_slow0_pbr0:
  buffer_load_dwordx4 v[28:31], v72, s[8:11], s75 offen sc1
Lc_slow0_pbr:
  buffer_load_dwordx4 v[24:27], v72, s[8:11], s75 offen sc1
  s_waitcnt vmcnt(1)
  ds_write_b128 v72, v[28:31]
  s_waitcnt lgkmcnt(0)
  v_max3_u32 v28, v28, v29, v30
  v_max_u32 v28, v28, v31
  v_cmp_eq_u32 vcc, -1, v28
  s_cbranch_vccz Lc_slow0_pbd
  buffer_load_dwordx4 v[28:31], v72, s[8:11], s75 offen sc1
  s_waitcnt vmcnt(1)
  ds_write_b128 v72, v[24:27]
  s_waitcnt lgkmcnt(0)
  v_max3_u32 v24, v24, v25, v26
  v_max_u32 v24, v24, v27
  v_cmp_eq_u32 vcc, -1, v24
  s_cbranch_vccz Lc_slow0_pbd
  s_sub_u32 s15, s15, 1
  s_cbranch_scc0 Lc_slow0_pbr
  s_mov_b32 s15, 0
Lc_slow0_pbd:
  s_waitcnt lgkmcnt(0)
  s_branch Lc_slow0_pbok
Lc_slow0_redr:
  buffer_load_dwordx4 v[32:35], v72, s[8:11], s27 offen sc1
  buffer_load_dwordx4 v[36:39], v72, s[8:11], s52 offen sc1
  buffer_load_dwordx4 v[40:43], v72, s[8:11], s53 offen sc1
  buffer_load_dwordx4 v[24:27], v72, s[8:11], s54 offen sc1
  s_waitcnt vmcnt(7)
  v_mfma_f32_16x16x32_bf16 v[44:47], v[52:55], v[48:51], 0
  v_xor_b32 v69, s25, v52
  v_bitop3_b32 v69, v69, v54, s25 bitop3:0xf6
  s_waitcnt vmcnt(6)
  v_mfma_f32_16x16x32_bf16 v[44:47], v[56:59], v[48:51], v[44:47]
  v_bitop3_b32 v69, v69, v56, s25 bitop3:0xf6
  v_bitop3_b32 v69, v69, v58, s25 bitop3:0xf6
  s_waitcnt vmcnt(5)
  v_mfma_f32_16x16x32_bf16 v[44:47], v[60:63], v[48:51], v[44:47]
  v_bitop3_b32 v69, v69, v60, s25 bitop3:0xf6
  v_bitop3_b32 v69, v69, v62, s25 bitop3:0xf6
  s_waitcnt vmcnt(4)
  v_mfma_f32_16x16x32_bf16 v[44:47], v[64:67], v[48:51], v[44:47]
  v_bitop3_b32 v69, v69, v64, s25 bitop3:0xf6
  v_bitop3_b32 v69, v69, v66, s25 bitop3:0xf6
  v_and_b32 v69, 1, v69
  v_cmp_ne_u32 vcc, 0, v69
  s_cbranch_vccz Lc_slow0_redok
  buffer_load_dwordx4 v[52:55], v72, s[8:11], s27 offen sc1
  buffer_load_dwordx4 v[56:59], v72, s[8:11], s52 offen sc1
  buffer_load_dwordx4 v[60:63], v72, s[8:11], s53 offen sc1
  buffer_load_dwordx4 v[64:67], v72, s[8:11], s54 offen sc1
  s_waitcnt vmcnt(7)
  v_mfma_f32_16x16x32_bf16 v[44:47], v[32:35], v[48:51], 0
  v_xor_b32 v69, s25, v32
  v_bitop3_b32 v69, v69, v34, s25 bitop3:0xf6
  s_waitcnt vmcnt(6)
  v_mfma_f32_16x16x32_bf16 v[44:47], v[36:39], v[48:51], v[44:47]
  v_bitop3_b32 v69, v69, v36, s25 bitop3:0xf6
  v_bitop3_b32 v69, v69, v38, s25 bitop3:0xf6
  s_waitcnt vmcnt(5)
  v_mfma_f32_16x16x32_bf16 v[44:47], v[40:43], v[48:51], v[44:47]
  v_bitop3_b32 v69, v69, v40, s25 bitop3:0xf6
  v_bitop3_b32 v69, v69, v42, s25 bitop3:0xf6
  s_waitcnt vmcnt(4)
  v_mfma_f32_16x16x32_bf16 v[44:47], v[24:27], v[48:51], v[44:47]
  v_bitop3_b32 v69, v69, v24, s25 bitop3:0xf6
  v_bitop3_b32 v69, v69, v26, s25 bitop3:0xf6
  v_and_b32 v69, 1, v69
  v_cmp_ne_u32 vcc, 0, v69
  s_cbranch_vccz Lc_slow0_redok
  s_sub_u32 s15, s15, 1
  s_cbranch_scc0 Lc_slow0_redr
  s_mov_b32 s15, 0
  s_branch Lc_slow0_redok
Lc_slow1_top:
  s_barrier
  ds_read_b128 v[32:35], v75 offset:0
  ds_read_b128 v[36:39], v75 offset:512
  ds_read_b128 v[40:43], v75 offset:1024
  s_waitcnt lgkmcnt(2)
  v_smfmac_f32_16x16x64_bf16 v[44:47], v[32:35], v[0:7], v73
  ds_read_b128 v[68:71], v75 offset:1536
  buffer_load_dwordx4 v[24:27], v72, s[8:11], s75 offen sc1
  v_smfmac_f32_16x16x64_bf16 v[48:51], v[32:35], v[80:87], v73
  ds_read_b128 v[0:3], v78 offset:24576
  ds_read_b128 v[4:7], v78 offset:25600
  s_waitcnt lgkmcnt(4)
  v_smfmac_f32_16x16x64_bf16 v[44:47], v[36:39], v[8:15], v73
  ds_read_b128 v[32:35], v75 offset:2048
  v_smfmac_f32_16x16x64_bf16 v[48:51], v[36:39], v[88:95], v73
  ds_read_b128 v[8:11], v78 offset:32768
  s_waitcnt lgkmcnt(5)
  v_smfmac_f32_16x16x64_bf16 v[44:47], v[40:43], v[96:103], v73
  ds_read_b128 v[36:39], v75 offset:2560
  v_smfmac_f32_16x16x64_bf16 v[48:51], v[40:43], v[16:23], v73
  ds_read_b128 v[12:15], v78 offset:33792
  s_waitcnt lgkmcnt(6)
  v_smfmac_f32_16x16x64_bf16 v[44:47], v[68:71], v[104:111], v73
  ds_read_b128 v[40:43], v75 offset:3072
  s_waitcnt lgkmcnt(5)
  v_smfmac_f32_16x16x64_bf16 v[48:51], v[68:71], v[0:7], v73
  ds_read_b128 v[16:19], v78 offset:40960
  s_waitcnt lgkmcnt(5)
  v_smfmac_f32_16x16x64_bf16 v[44:47], v[32:35], v[112:119], v73
  ds_read_b128 v[68:71], v75 offset:3584
  v_smfmac_f32_16x16x64_bf16 v[48:51], v[32:35], v[120:127], v73
  ds_read_b128 v[20:23], v78 offset:41984
  s_waitcnt lgkmcnt(5)
  v_smfmac_f32_16x16x64_bf16 v[44:47], v[36:39], v[128:135], v73
  ds_read_b128 v[32:35], v75 offset:4096
  v_smfmac_f32_16x16x64_bf16 v[48:51], v[36:39], v[136:143], v73
  ds_read_b128 v[0:3], v78 offset:49152
  s_waitcnt lgkmcnt(5)
  v_smfmac_f32_16x16x64_bf16 v[44:47], v[40:43], v[8:15], v73
  ds_read_b128 v[36:39], v75 offset:4608
  v_smfmac_f32_16x16x64_bf16 v[48:51], v[40:43], v[144:151], v73
  ds_read_b128 v[4:7], v78 offset:50176
  ds_read_b128 v[8:11], v78 offset:57344
  s_waitcnt lgkmcnt(5)
  v_smfmac_f32_16x16x64_bf16 v[44:47], v[68:71], v[16:23], v73
  s_waitcnt vmcnt(0)
  ds_write_b128 v72, v[24:27]
  v_smfmac_f32_16x16x64_bf16 v[48:51], v[68:71], v[152:159], v73
  ds_read_b128 v[12:15], v78 offset:58368
  v_max3_u32 v28, v24, v25, v26
  v_max_u32 v28, v28, v27
  s_waitcnt lgkmcnt(6)
  v_smfmac_f32_16x16x64_bf16 v[44:47], v[32:35], v[160:167], v73
  v_add_u32 v78, 65536, v78
  v_cmp_eq_u32 vcc, -1, v28
  s_waitcnt lgkmcnt(3)
  v_smfmac_f32_16x16x64_bf16 v[48:51], v[32:35], v[0:7], v73
  ds_read_b128 v[16:19], v78 offset:0
  s_cbranch_vccnz Lc_slow1_pbr0
  s_waitcnt lgkmcnt(2)
Lc_slow1_pbok:
  s_barrier
  ds_read_b128 v[40:43], v75 offset:5120
  ds_read_b128 v[68:71], v75 offset:5632
  v_smfmac_f32_16x16x64_bf16 v[44:47], v[36:39], v[168:175], v73
  ds_read_b128 v[32:35], v75 offset:6144
  s_waitcnt lgkmcnt(4)
  v_smfmac_f32_16x16x64_bf16 v[48:51], v[36:39], v[8:15], v73
  ds_read_b128 v[20:23], v78 offset:1024
  ds_read_b128 v[0:3], v78 offset:8192
  buffer_load_dwordx4 v[52:55], v74, s[8:11], s32 offen offset:0 sc1
  s_waitcnt lgkmcnt(4)
  v_smfmac_f32_16x16x64_bf16 v[44:47], v[40:43], v[176:183], v73
  ds_read_b128 v[36:39], v75 offset:6656
  v_smfmac_f32_16x16x64_bf16 v[48:51], v[40:43], v[184:191], v73
  ds_read_b128 v[4:7], v78 offset:9216
  buffer_load_dwordx4 v[56:59], v74, s[8:11], s32 offen offset:1024 sc1
  s_waitcnt lgkmcnt(5)
  v_smfmac_f32_16x16x64_bf16 v[44:47], v[68:71], v[192:199], v73
  ds_read_b128 v[40:43], v75 offset:7168
  v_smfmac_f32_16x16x64_bf16 v[48:51], v[68:71], v[200:207], v73
  ds_read_b128 v[8:11], v78 offset:16384
  buffer_load_dwordx4 v[60:63], v74, s[8:11], s32 offen offset:2048 sc1
  s_waitcnt lgkmcnt(5)
  v_smfmac_f32_16x16x64_bf16 v[44:47], v[32:35], v[16:23], v73
  ds_read_b128 v[68:71], v75 offset:7680
  v_smfmac_f32_16x16x64_bf16 v[48:51], v[32:35], v[208:215], v73
  ds_read_b128 v[12:15], v78 offset:17408
  ds_read_b128 v[16:19], v78 offset:24576
  buffer_load_dwordx4 v[64:67], v74, s[8:11], s32 offen offset:3072 sc1
  s_waitcnt lgkmcnt(5)
  v_smfmac_f32_16x16x64_bf16 v[44:47], v[36:39], v[0:7], v73
  ds_read_b128 v[32:35], v75 offset:8192
  v_smfmac_f32_16x16x64_bf16 v[48:51], v[36:39], v[216:223], v73
  ds_read_b128 v[20:23], v78 offset:25600
  v_mov_b64_e64 v[0:1], 0
  buffer_load_dwordx4 v[24:27], v74, s[8:11], s34 offen offset:0 sc1
  s_waitcnt lgkmcnt(6)
  v_smfmac_f32_16x16x64_bf16 v[44:47], v[40:43], v[224:231], v73
  ds_read_b128 v[36:39], v75 offset:8704
  s_waitcnt lgkmcnt(4)
  v_smfmac_f32_16x16x64_bf16 v[48:51], v[40:43], v[8:15], v73
  v_mov_b64_e64 v[2:3], 0
  buffer_load_dwordx4 v[28:31], v74, s[8:11], s34 offen offset:1024 sc1
  v_smfmac_f32_16x16x64_bf16 v[44:47], v[68:71], v[232:239], v73
  ds_read_b128 v[40:43], v79 offset:0
  s_waitcnt lgkmcnt(2)
  v_smfmac_f32_16x16x64_bf16 v[48:51], v[68:71], v[16:23], v73
  v_mov_b64 v[4:5], 0
  v_smfmac_f32_16x16x64_bf16 v[44:47], v[32:35], v[240:247], v73
  ds_read_b128 v[68:71], v79 offset:1024
  v_smfmac_f32_16x16x64_bf16 v[48:51], v[32:35], v[248:255], v73
  v_mov_b64 v[6:7], 0
  s_waitcnt lgkmcnt(2)
  v_smfmac_f32_16x16x64_bf16 v[44:47], v[36:39], a[0:7], v73
  ds_read_b128 v[32:35], v79 offset:2048
  v_smfmac_f32_16x16x64_bf16 v[48:51], v[36:39], a[8:15], v73
  v_add_u32 v8, s37, v77
  s_waitcnt lgkmcnt(2)
  v_smfmac_f32_16x16x64_bf16 v[0:3], v[40:43], a[16:23], v73
  v_cvt_pk_bf16_f32 v44, v44, v45
  v_cvt_pk_bf16_f32 v45, v46, v47
  ds_write_b64 v8, v[44:45]
  s_nop 0
  v_cvt_pk_bf16_f32 v48, v48, v49
  v_cvt_pk_bf16_f32 v49, v50, v51
  ds_write_b64 v8, v[48:49] offset:2048
  v_smfmac_f32_16x16x64_bf16 v[4:7], v[40:43], a[24:31], v73
  ds_read_b128 v[36:39], v79 offset:3072
  s_waitcnt lgkmcnt(4)
  v_smfmac_f32_16x16x64_bf16 v[0:3], v[68:71], a[32:39], v73
  v_smfmac_f32_16x16x64_bf16 v[4:7], v[68:71], a[40:47], v73
  ds_read_b128 v[40:43], v79 offset:4096
  v_add_u32_e64 v50, s38, v75
  s_waitcnt lgkmcnt(2)
  s_barrier
  ds_read_b64_tr_b16 v[8:9], v76 offset:0
  ds_read_b64_tr_b16 v[10:11], v76 offset:128
  ds_read_b64_tr_b16 v[12:13], v76 offset:512
  ds_read_b64_tr_b16 v[14:15], v76 offset:640
  ds_read_b64_tr_b16 v[16:17], v76 offset:1024
  ds_read_b64_tr_b16 v[18:19], v76 offset:1152
  ds_read_b64_tr_b16 v[20:21], v76 offset:1536
  ds_read_b64_tr_b16 v[22:23], v76 offset:1664
  v_add_u32 v51, 65536, v78
  s_waitcnt vmcnt(5) lgkmcnt(6)
  v_mfma_f32_16x16x32_bf16 v[44:47], v[52:55], v[8:11], 0
  s_waitcnt vmcnt(4) lgkmcnt(4)
  v_mfma_f32_16x16x32_bf16 v[44:47], v[56:59], v[12:15], v[44:47]
  s_waitcnt vmcnt(3) lgkmcnt(2)
  v_mfma_f32_16x16x32_bf16 v[44:47], v[60:63], v[16:19], v[44:47]
  s_waitcnt vmcnt(2) lgkmcnt(0)
  v_mfma_f32_16x16x32_bf16 v[44:47], v[64:67], v[20:23], v[44:47]
  v_smfmac_f32_16x16x64_bf16 v[0:3], v[32:35], a[48:55], v73
  ds_read_b128 v[8:11], v51 offset:0
  v_smfmac_f32_16x16x64_bf16 v[4:7], v[32:35], a[56:63], v73
  ds_read_b128 v[68:71], v79 offset:5120
  ds_write_b128 v50, v[44:47]
  ds_read_b128 v[12:15], v51 offset:1024
  ds_read_b128 v[16:19], v51 offset:8192
  ds_read_b128 v[20:23], v51 offset:9216
  v_bfe_u32 v50, v74, 7, 1
  v_smfmac_f32_16x16x64_bf16 v[0:3], v[36:39], a[64:71], v73
  v_smfmac_f32_16x16x64_bf16 v[4:7], v[36:39], a[72:79], v73
  ds_read_b128 v[32:35], v79 offset:6144
  v_smfmac_f32_16x16x64_bf16 v[0:3], v[40:43], a[80:87], v73
  v_smfmac_f32_16x16x64_bf16 v[4:7], v[40:43], a[88:95], v73
  ds_read_b128 v[36:39], v79 offset:7168
  v_lshl_add_u32 v50, v50, 3, v75
  s_waitcnt lgkmcnt(5)
  s_barrier
  ds_read_b128 v[44:47], v79 offset:13824
  ds_read_b64 v[48:49], v50 offset:13312
  ds_read_b64 v[62:63], v50 offset:14848
  v_smfmac_f32_16x16x64_bf16 v[0:3], v[68:71], a[96:103], v73
  v_smfmac_f32_16x16x64_bf16 v[4:7], v[68:71], a[104:111], v73
  ds_read_b128 v[40:43], v79 offset:8192
  s_waitcnt lgkmcnt(5)
  v_smfmac_f32_16x16x64_bf16 v[0:3], v[32:35], a[112:119], v73
  v_smfmac_f32_16x16x64_bf16 v[4:7], v[32:35], a[120:127], v73
  s_waitcnt lgkmcnt(4)
  v_smfmac_f32_16x16x64_bf16 v[0:3], v[36:39], a[128:135], v73
  v_smfmac_f32_16x16x64_bf16 v[4:7], v[36:39], a[136:143], v73
  s_waitcnt lgkmcnt(0)
  v_smfmac_f32_16x16x64_bf16 v[0:3], v[40:43], v[8:15], v73
  v_smfmac_f32_16x16x64_bf16 v[4:7], v[40:43], v[16:23], v73
  v_max3_f32 v50, v44, v45, v46
  v_add_f32 v48, v48, v62
  v_add_f32_e64 v49, v49, v63
  v_max3_f32 v51, v47, v48, v49
  v_max_f32 v50, v50, v51
  v_add_u32 v72, s39, v75
  ds_read_b128 v[8:11], v78 offset:49152
  v_max_f32_dpp v50, v50, v50 row_ror:8 row_mask:0xf bank_mask:0xf
  v_mov_b32_e64 v51, v50
  v_cvt_pk_bf16_f32 v36, v0, v1
  v_cvt_pk_bf16_f32 v37, v2, v3
  v_permlane16_swap_b32 v50, v51
  v_max_f32 v50, v50, v51
  v_mov_b32_e64 v51, v50
  v_cvt_pk_bf16_f32 v38, v4, v5
  v_cvt_pk_bf16_f32 v39, v6, v7
  v_permlane32_swap_b32 v50, v51
  v_max_f32 v50, v50, v51
  v_mul_f32_e64 v50, s22, v50
  v_fma_f32 v44, v44, s22, -v50
  v_fma_f32 v45, v45, s22, -v50
  v_fma_f32 v46, v46, s22, -v50
  v_fma_f32 v47, v47, s22, -v50
  v_fma_f32 v48, v48, s22, -v50
  v_fma_f32 v49, v49, s22, -v50
  v_exp_f32 v44, v44
  v_exp_f32 v45, v45
  v_exp_f32 v46, v46
  v_exp_f32 v47, v47
  v_exp_f32 v48, v48
  v_exp_f32 v49, v49
  v_cvt_pk_bf16_f32 v50, v44, v45
  v_cvt_pk_bf16_f32 v51, v46, v47
  v_cndmask_b32 v32, 0, v50, s[20:21]
  v_cndmask_b32 v33, 0, v51, s[20:21]
  v_cndmask_b32 v34, v50, 0, s[20:21]
  v_cndmask_b32 v35, v51, 0, s[20:21]
  v_cvt_pk_bf16_f32 v41, v48, v49
  v_add_f32 v50, v44, v45
  s_waitcnt vmcnt(1)
  v_mfma_f32_16x16x32_bf16 v[0:3], v[24:27], v[32:35], 0
  v_cndmask_b32 v40, 0, v41, s[20:21]
  v_cndmask_b32 v41, v41, 0, s[20:21]
  s_waitcnt vmcnt(0)
  v_mfma_f32_16x16x32_bf16 v[4:7], v[28:31], v[32:35], 0
  v_add_f32 v51, v46, v47
  v_add_f32_e64 v48, v48, v49
  v_mfma_f32_16x16x16_bf16 v[0:3], v[36:37], v[40:41], v[0:3]
  v_add_f32 v50, v50, v51
  v_fmac_f32 v50, 0.5, v48
  v_mfma_f32_16x16x16_bf16 v[4:7], v[38:39], v[40:41], v[4:7]
  buffer_store_dwordx4 v[36:39], v74, s[8:11], s36 offen sc1
  ds_read_b128 v[52:55], v78 offset:32768
  ds_read_b128 v[56:59], v78 offset:33792
  v_mov_b64_e64 v[24:25], 0
  v_add_f32_dpp v50, v50, v50 row_ror:8 row_mask:0xf bank_mask:0xf
  v_mov_b32 v51, v50
  v_mov_b64 v[26:27], 0
  v_mov_b64 v[28:29], 0
  v_permlane16_swap_b32 v50, v51
  v_add_f32 v50, v50, v51
  v_mov_b32 v51, v50
  v_add_f32_dpp v0, v0, v0 row_ror:8 row_mask:0xf bank_mask:0xf
  v_add_f32_dpp v1, v1, v1 row_ror:8 row_mask:0xf bank_mask:0xf
  v_permlane32_swap_b32 v50, v51
  v_add_f32 v50, v50, v51
  v_rcp_f32_e64 v50, v50
  v_add_f32_dpp v2, v2, v2 row_ror:8 row_mask:0xf bank_mask:0xf
  v_add_f32_dpp v3, v3, v3 row_ror:8 row_mask:0xf bank_mask:0xf
  v_add_f32_dpp v4, v4, v4 row_ror:8 row_mask:0xf bank_mask:0xf
  v_add_f32_dpp v5, v5, v5 row_ror:8 row_mask:0xf bank_mask:0xf
  v_add_f32_dpp v6, v6, v6 row_ror:8 row_mask:0xf bank_mask:0xf
  v_add_f32_dpp v7, v7, v7 row_ror:8 row_mask:0xf bank_mask:0xf
  v_mul_f32 v0, v0, v50
  v_mul_f32 v1, v1, v50
  v_mul_f32 v2, v2, v50
  v_mul_f32 v3, v3, v50
  v_mul_f32 v4, v4, v50
  v_mul_f32 v5, v5, v50
  v_mul_f32 v6, v6, v50
  v_mul_f32 v7, v7, v50
  v_cvt_pk_bf16_f32 v36, v0, v1
  v_cvt_pk_bf16_f32 v37, v2, v3
  v_cvt_pk_bf16_f32 v38, v4, v5
  v_cvt_pk_bf16_f32 v39, v6, v7
  ds_write_b128 v72, v[36:39]
  v_mov_b64_e64 v[30:31], 0
  v_smfmac_f32_16x16x64_bf16 v[24:27], v[36:39], a[184:191], v73
  v_mov_b64 v[0:1], 0
  v_mov_b64 v[2:3], 0
  v_smfmac_f32_16x16x64_bf16 v[28:31], v[36:39], a[192:199], v73
  v_mov_b64 v[4:5], 0
  v_mov_b64 v[6:7], 0
  v_smfmac_f32_16x16x64_bf16 v[0:3], v[36:39], a[240:247], v73
  v_mov_b64 v[44:45], 0
  v_mov_b64 v[46:47], 0
  s_waitcnt lgkmcnt(0)
  s_barrier
  ds_read_b128 v[68:71], v75 offset:10752
  ds_read_b128 v[32:35], v75 offset:9216
  ds_read_b128 v[40:43], v75 offset:10240
  v_smfmac_f32_16x16x64_bf16 v[4:7], v[36:39], a[176:183], v73
  v_bfe_u32 v48, v74, 7, 1
  v_smfmac_f32_16x16x64_bf16 v[44:47], v[36:39], a[200:207], v73
  v_lshrrev_b32_e64 v49, 8, v74
  v_lshl_add_u32 v48, v48, 2, v49
  v_mul_u32_u24 v48, 10368, v48
  v_and_or_b32 v72, v74, s46, v48
  ds_read_b128 v[60:63], v78 offset:40960
  ds_read_b128 v[64:67], v78 offset:41984
  s_waitcnt lgkmcnt(4)
  v_smfmac_f32_16x16x64_bf16 v[0:3], v[68:71], a[248:255], v73
  ds_read_b128 v[12:15], v78 offset:50176
  s_waitcnt lgkmcnt(4)
  v_smfmac_f32_16x16x64_bf16 v[4:7], v[32:35], a[144:151], v73
  s_waitcnt lgkmcnt(3)
  v_smfmac_f32_16x16x64_bf16 v[4:7], v[40:43], a[208:215], v73
  v_cvt_pk_bf16_f32 v0, v0, v1
  v_cvt_pk_bf16_f32 v1, v2, v3
  v_smfmac_f32_16x16x64_bf16 v[4:7], v[68:71], v[52:59], v73
  v_bfi_b32 v0, 1, s25, v0
  buffer_store_dwordx2 v[0:1], v77, s[8:11], s24 offen offset:0 sc1
  v_smfmac_f32_16x16x64_bf16 v[24:27], v[32:35], a[152:159], v73
  v_smfmac_f32_16x16x64_bf16 v[24:27], v[40:43], a[216:223], v73
  v_cvt_pk_bf16_f32 v4, v4, v5
  v_cvt_pk_bf16_f32 v5, v6, v7
  s_waitcnt lgkmcnt(1)
  v_smfmac_f32_16x16x64_bf16 v[24:27], v[68:71], v[60:67], v73
  v_bfi_b32 v4, 1, s25, v4
  buffer_store_dwordx2 v[4:5], v77, s[8:11], s23 offen offset:0 sc1
  v_smfmac_f32_16x16x64_bf16 v[28:31], v[32:35], a[160:167], v73
  v_smfmac_f32_16x16x64_bf16 v[28:31], v[40:43], a[224:231], v73
  v_cvt_pk_bf16_f32 v24, v24, v25
  v_cvt_pk_bf16_f32 v25, v26, v27
  s_waitcnt lgkmcnt(0)
  v_smfmac_f32_16x16x64_bf16 v[28:31], v[68:71], v[8:15], v73
  v_bfi_b32 v24, 1, s25, v24
  buffer_store_dwordx2 v[24:25], v77, s[8:11], s23 offen offset:2048 sc1
  v_smfmac_f32_16x16x64_bf16 v[44:47], v[32:35], a[168:175], v73
  ds_read_b128 v[16:19], v78 offset:57344
  ds_read_b128 v[20:23], v78 offset:58368
  v_smfmac_f32_16x16x64_bf16 v[44:47], v[40:43], a[232:239], v73
  v_cvt_pk_bf16_f32 v28, v28, v29
  v_cvt_pk_bf16_f32 v29, v30, v31
  s_waitcnt lgkmcnt(0)
  v_smfmac_f32_16x16x64_bf16 v[44:47], v[68:71], v[16:23], v73
  v_bfi_b32 v28, 1, s25, v28
  buffer_store_dwordx2 v[28:29], v77, s[8:11], s31 offen offset:0 sc1
  v_subrev_u32 v78, 65536, v78
  s_nop 4
  v_cvt_pk_bf16_f32 v44, v44, v45
  v_cvt_pk_bf16_f32 v45, v46, v47
  v_bfi_b32 v44, 1, s25, v44
  buffer_store_dwordx2 v[44:45], v77, s[8:11], s31 offen offset:2048 sc1
  v_lshrrev_b32 v69, 8, v74
  v_and_b32 v68, 0x70, v74
  v_and_b32_e64 v70, 1, v69
  v_lshl_add_u32 v68, v70, 3, v68
  v_lshrrev_b32_e64 v69, 1, v69
  v_lshl_add_u32 v68, v69, 2, v68
  v_add_u32 v68, s40, v68
  v_mov_b32 v71, -1
  v_bfe_u32 v69, v74, 4, 1
  v_lshlrev_b32_e64 v69, 4, v69
  v_mov_b32 v70, 0x3f80
  v_lshlrev_b32_e64 v70, v69, v70
  v_cndmask_b32 v48, 0, v70, s[66:67]
  v_cndmask_b32 v49, 0, v70, s[68:69]
  v_cndmask_b32 v50, 0, v70, s[70:71]
  v_cndmask_b32 v51, 0, v70, s[72:73]
  ds_read_b128 v[0:3], v78 offset:0
  ds_read_b128 v[4:7], v78 offset:1024
  ds_read_b128 v[8:11], v78 offset:8192
  ds_read_b128 v[12:15], v78 offset:9216
  ds_read_b128 v[16:19], v78 offset:16384
  ds_read_b128 v[20:23], v78 offset:17408
  s_waitcnt vmcnt(0)
  buffer_load_dwordx4 v[32:35], v72, s[8:11], s27 offen sc1
  buffer_load_dwordx4 v[36:39], v72, s[8:11], s52 offen sc1
  buffer_load_dwordx4 v[40:43], v72, s[8:11], s53 offen sc1
  buffer_load_dwordx4 v[24:27], v72, s[8:11], s54 offen sc1
  s_waitcnt vmcnt(3)
  v_mfma_f32_16x16x32_bf16 v[44:47], v[32:35], v[48:51], 0
  v_xor_b32_e64 v69, s25, v32
  v_bitop3_b32 v69, v69, v34, s25 bitop3:0xf6
  s_waitcnt vmcnt(2)
  v_mfma_f32_16x16x32_bf16 v[44:47], v[36:39], v[48:51], v[44:47]
  v_bitop3_b32 v69, v69, v36, s25 bitop3:0xf6
  v_bitop3_b32 v69, v69, v38, s25 bitop3:0xf6
  s_waitcnt vmcnt(1)
  v_mfma_f32_16x16x32_bf16 v[44:47], v[40:43], v[48:51], v[44:47]
  v_bitop3_b32 v69, v69, v40, s25 bitop3:0xf6
  v_bitop3_b32 v69, v69, v42, s25 bitop3:0xf6
  s_waitcnt vmcnt(0)
  v_mfma_f32_16x16x32_bf16 v[44:47], v[24:27], v[48:51], v[44:47]
  v_bitop3_b32 v69, v69, v24, s25 bitop3:0xf6
  v_bitop3_b32 v69, v69, v26, s25 bitop3:0xf6
  v_and_b32 v69, 1, v69
  v_cmp_ne_u32 vcc, 0, v69
  s_cbranch_vccnz Lc_slow1_redr0
Lc_slow1_redok:
  s_nop 2
  v_permlane32_swap_b32 v44, v46
  v_permlane32_swap_b32 v45, v47
  v_add_f32 v44, v44, v46
  v_add_f32_e64 v45, v45, v47
  v_cvt_pk_bf16_f32 v44, v44, v45
  s_mov_b64 exec, s[20:21]
  buffer_store_dword v44, v68, s[8:11], s28 offen sc1
  buffer_store_dword v71, v68, s[8:11], s18 offen sc1
  s_mov_b64 exec, -1
  v_mov_b64 v[44:45], 0
  v_mov_b64 v[46:47], 0
  v_mov_b64 v[48:49], 0
  v_mov_b64 v[50:51], 0
  s_mov_b32 s75, s28
  s_mov_b32 s44, s14
  s_add_u32 s14, s14, 1
  s_xor_b32 s25, s25, 1
  s_mov_b32 s45, s28
  s_mov_b32 s28, s29
  s_mov_b32 s29, s18
  s_mov_b32 s18, s45
  s_add_u32 s35, s35, 131072
  s_add_u32 s36, s36, 131072
  s_add_u32 s34, s34, 262144
  s_add_u32 s33, s33, 262144
  s_add_u32 s32, s32, 262144
  s_xor_b32 s55, s55, 4096
  s_xor_b32 s19, s19, 4096
  v_add_u32 v72, 153600, v74
  v_add_u32 v68, 151552, v74
  s_waitcnt vmcnt(2)
Lc_slow1_mpok:
  s_cmp_eq_u32 s14, 63
  s_waitcnt lgkmcnt(0)
  s_cbranch_scc0 Lc_slow1_top
  s_branch Lc_last1_top
Lc_slow1_end:
Lc_slow1_pbr0:
  buffer_load_dwordx4 v[28:31], v72, s[8:11], s75 offen sc1
Lc_slow1_pbr:
  buffer_load_dwordx4 v[24:27], v72, s[8:11], s75 offen sc1
  s_waitcnt vmcnt(1)
  ds_write_b128 v72, v[28:31]
  s_waitcnt lgkmcnt(0)
  v_max3_u32 v28, v28, v29, v30
  v_max_u32 v28, v28, v31
  v_cmp_eq_u32 vcc, -1, v28
  s_cbranch_vccz Lc_slow1_pbd
  buffer_load_dwordx4 v[28:31], v72, s[8:11], s75 offen sc1
  s_waitcnt vmcnt(1)
  ds_write_b128 v72, v[24:27]
  s_waitcnt lgkmcnt(0)
  v_max3_u32 v24, v24, v25, v26
  v_max_u32 v24, v24, v27
  v_cmp_eq_u32 vcc, -1, v24
  s_cbranch_vccz Lc_slow1_pbd
  s_sub_u32 s15, s15, 1
  s_cbranch_scc0 Lc_slow1_pbr
  s_mov_b32 s15, 0
Lc_slow1_pbd:
  s_waitcnt lgkmcnt(0)
  s_branch Lc_slow1_pbok
Lc_slow1_redr0:
  buffer_load_dwordx4 v[52:55], v72, s[8:11], s27 offen sc1
  buffer_load_dwordx4 v[56:59], v72, s[8:11], s52 offen sc1
  buffer_load_dwordx4 v[60:63], v72, s[8:11], s53 offen sc1
  buffer_load_dwordx4 v[64:67], v72, s[8:11], s54 offen sc1
  s_branch Lc_slow1_redr
Lc_slow1_redr:
  buffer_load_dwordx4 v[32:35], v72, s[8:11], s27 offen sc1
  buffer_load_dwordx4 v[36:39], v72, s[8:11], s52 offen sc1
  buffer_load_dwordx4 v[40:43], v72, s[8:11], s53 offen sc1
  buffer_load_dwordx4 v[24:27], v72, s[8:11], s54 offen sc1
  s_waitcnt vmcnt(7)
  v_mfma_f32_16x16x32_bf16 v[44:47], v[52:55], v[48:51], 0
  v_xor_b32 v69, s25, v52
  v_bitop3_b32 v69, v69, v54, s25 bitop3:0xf6
  s_waitcnt vmcnt(6)
  v_mfma_f32_16x16x32_bf16 v[44:47], v[56:59], v[48:51], v[44:47]
  v_bitop3_b32 v69, v69, v56, s25 bitop3:0xf6
  v_bitop3_b32 v69, v69, v58, s25 bitop3:0xf6
  s_waitcnt vmcnt(5)
  v_mfma_f32_16x16x32_bf16 v[44:47], v[60:63], v[48:51], v[44:47]
  v_bitop3_b32 v69, v69, v60, s25 bitop3:0xf6
  v_bitop3_b32 v69, v69, v62, s25 bitop3:0xf6
  s_waitcnt vmcnt(4)
  v_mfma_f32_16x16x32_bf16 v[44:47], v[64:67], v[48:51], v[44:47]
  v_bitop3_b32 v69, v69, v64, s25 bitop3:0xf6
  v_bitop3_b32 v69, v69, v66, s25 bitop3:0xf6
  v_and_b32 v69, 1, v69
  v_cmp_ne_u32 vcc, 0, v69
  s_cbranch_vccz Lc_slow1_redok
  buffer_load_dwordx4 v[52:55], v72, s[8:11], s27 offen sc1
  buffer_load_dwordx4 v[56:59], v72, s[8:11], s52 offen sc1
  buffer_load_dwordx4 v[60:63], v72, s[8:11], s53 offen sc1
  buffer_load_dwordx4 v[64:67], v72, s[8:11], s54 offen sc1
  s_waitcnt vmcnt(7)
  v_mfma_f32_16x16x32_bf16 v[44:47], v[32:35], v[48:51], 0
  v_xor_b32 v69, s25, v32
  v_bitop3_b32 v69, v69, v34, s25 bitop3:0xf6
  s_waitcnt vmcnt(6)
  v_mfma_f32_16x16x32_bf16 v[44:47], v[36:39], v[48:51], v[44:47]
  v_bitop3_b32 v69, v69, v36, s25 bitop3:0xf6
  v_bitop3_b32 v69, v69, v38, s25 bitop3:0xf6
  s_waitcnt vmcnt(5)
  v_mfma_f32_16x16x32_bf16 v[44:47], v[40:43], v[48:51], v[44:47]
  v_bitop3_b32 v69, v69, v40, s25 bitop3:0xf6
  v_bitop3_b32 v69, v69, v42, s25 bitop3:0xf6
  s_waitcnt vmcnt(4)
  v_mfma_f32_16x16x32_bf16 v[44:47], v[24:27], v[48:51], v[44:47]
  v_bitop3_b32 v69, v69, v24, s25 bitop3:0xf6
  v_bitop3_b32 v69, v69, v26, s25 bitop3:0xf6
  v_and_b32 v69, 1, v69
  v_cmp_ne_u32 vcc, 0, v69
  s_cbranch_vccz Lc_slow1_redok
  s_sub_u32 s15, s15, 1
  s_cbranch_scc0 Lc_slow1_redr
  s_mov_b32 s15, 0
  s_branch Lc_slow1_redok
Lc_slow2_top:
  s_barrier
  ds_read_b128 v[32:35], v75 offset:0
  ds_read_b128 v[36:39], v75 offset:512
  ds_read_b128 v[40:43], v75 offset:1024
  s_waitcnt lgkmcnt(2)
  v_smfmac_f32_16x16x64_bf16 v[44:47], v[32:35], v[0:7], v73
  ds_read_b128 v[68:71], v75 offset:1536
  buffer_load_dwordx4 v[24:27], v72, s[8:11], s75 offen sc1
  v_smfmac_f32_16x16x64_bf16 v[48:51], v[32:35], v[80:87], v73
  ds_read_b128 v[0:3], v78 offset:24576
  ds_read_b128 v[4:7], v78 offset:25600
  s_waitcnt lgkmcnt(4)
  v_smfmac_f32_16x16x64_bf16 v[44:47], v[36:39], v[8:15], v73
  ds_read_b128 v[32:35], v75 offset:2048
  v_smfmac_f32_16x16x64_bf16 v[48:51], v[36:39], v[88:95], v73
  ds_read_b128 v[8:11], v78 offset:32768
  s_waitcnt lgkmcnt(5)
  v_smfmac_f32_16x16x64_bf16 v[44:47], v[40:43], v[96:103], v73
  ds_read_b128 v[36:39], v75 offset:2560
  v_smfmac_f32_16x16x64_bf16 v[48:51], v[40:43], v[16:23], v73
  ds_read_b128 v[12:15], v78 offset:33792
  s_waitcnt lgkmcnt(6)
  v_smfmac_f32_16x16x64_bf16 v[44:47], v[68:71], v[104:111], v73
  ds_read_b128 v[40:43], v75 offset:3072
  s_waitcnt lgkmcnt(5)
  v_smfmac_f32_16x16x64_bf16 v[48:51], v[68:71], v[0:7], v73
  ds_read_b128 v[16:19], v78 offset:40960
  s_waitcnt lgkmcnt(5)
  v_smfmac_f32_16x16x64_bf16 v[44:47], v[32:35], v[112:119], v73
  ds_read_b128 v[68:71], v75 offset:3584
  v_smfmac_f32_16x16x64_bf16 v[48:51], v[32:35], v[120:127], v73
  ds_read_b128 v[20:23], v78 offset:41984
  s_waitcnt lgkmcnt(5)
  v_smfmac_f32_16x16x64_bf16 v[44:47], v[36:39], v[128:135], v73
  ds_read_b128 v[32:35], v75 offset:4096
  v_smfmac_f32_16x16x64_bf16 v[48:51], v[36:39], v[136:143], v73
  ds_read_b128 v[0:3], v78 offset:49152
  s_waitcnt lgkmcnt(5)
  v_smfmac_f32_16x16x64_bf16 v[44:47], v[40:43], v[8:15], v73
  ds_read_b128 v[36:39], v75 offset:4608
  v_smfmac_f32_16x16x64_bf16 v[48:51], v[40:43], v[144:151], v73
  ds_read_b128 v[4:7], v78 offset:50176
  ds_read_b128 v[8:11], v78 offset:57344
  s_waitcnt lgkmcnt(5)
  v_smfmac_f32_16x16x64_bf16 v[44:47], v[68:71], v[16:23], v73
  s_waitcnt vmcnt(0)
  ds_write_b128 v72, v[24:27]
  v_smfmac_f32_16x16x64_bf16 v[48:51], v[68:71], v[152:159], v73
  ds_read_b128 v[12:15], v78 offset:58368
  v_max3_u32 v28, v24, v25, v26
  v_max_u32 v28, v28, v27
  s_waitcnt lgkmcnt(6)
  v_smfmac_f32_16x16x64_bf16 v[44:47], v[32:35], v[160:167], v73
  v_add_u32 v78, 65536, v78
  v_cmp_eq_u32 vcc, -1, v28
  s_waitcnt lgkmcnt(3)
  v_smfmac_f32_16x16x64_bf16 v[48:51], v[32:35], v[0:7], v73
  ds_read_b128 v[16:19], v78 offset:0
  s_cbranch_vccnz Lc_slow2_pbr0
  s_waitcnt lgkmcnt(2)
Lc_slow2_pbok:
  s_barrier
  ds_read_b128 v[40:43], v75 offset:5120
  ds_read_b128 v[68:71], v75 offset:5632
  v_smfmac_f32_16x16x64_bf16 v[44:47], v[36:39], v[168:175], v73
  ds_read_b128 v[32:35], v75 offset:6144
  buffer_load_dwordx4 v[52:55], v74, s[8:11], s32 offen offset:0 sc1
  s_waitcnt lgkmcnt(4)
  v_smfmac_f32_16x16x64_bf16 v[48:51], v[36:39], v[8:15], v73
  ds_read_b128 v[20:23], v78 offset:1024
  ds_read_b128 v[0:3], v78 offset:8192
  s_waitcnt lgkmcnt(4)
  v_smfmac_f32_16x16x64_bf16 v[44:47], v[40:43], v[176:183], v73
  ds_read_b128 v[36:39], v75 offset:6656
  buffer_load_dwordx4 v[56:59], v74, s[8:11], s32 offen offset:1024 sc1
  v_smfmac_f32_16x16x64_bf16 v[48:51], v[40:43], v[184:191], v73
  ds_read_b128 v[4:7], v78 offset:9216
  s_waitcnt lgkmcnt(5)
  v_smfmac_f32_16x16x64_bf16 v[44:47], v[68:71], v[192:199], v73
  ds_read_b128 v[40:43], v75 offset:7168
  buffer_load_dwordx4 v[60:63], v74, s[8:11], s32 offen offset:2048 sc1
  v_smfmac_f32_16x16x64_bf16 v[48:51], v[68:71], v[200:207], v73
  ds_read_b128 v[8:11], v78 offset:16384
  s_waitcnt lgkmcnt(5)
  v_smfmac_f32_16x16x64_bf16 v[44:47], v[32:35], v[16:23], v73
  ds_read_b128 v[68:71], v75 offset:7680
  buffer_load_dwordx4 v[64:67], v74, s[8:11], s32 offen offset:3072 sc1
  v_smfmac_f32_16x16x64_bf16 v[48:51], v[32:35], v[208:215], v73
  ds_read_b128 v[12:15], v78 offset:17408
  ds_read_b128 v[16:19], v78 offset:24576
  s_waitcnt lgkmcnt(5)
  v_smfmac_f32_16x16x64_bf16 v[44:47], v[36:39], v[0:7], v73
  ds_read_b128 v[32:35], v75 offset:8192
  buffer_load_dwordx4 v[24:27], v74, s[8:11], s34 offen offset:0 sc1
  v_smfmac_f32_16x16x64_bf16 v[48:51], v[36:39], v[216:223], v73
  ds_read_b128 v[20:23], v78 offset:25600
  v_mov_b64 v[0:1], 0
  s_waitcnt lgkmcnt(6)
  v_smfmac_f32_16x16x64_bf16 v[44:47], v[40:43], v[224:231], v73
  ds_read_b128 v[36:39], v75 offset:8704
  buffer_load_dwordx4 v[28:31], v74, s[8:11], s34 offen offset:1024 sc1
  s_waitcnt lgkmcnt(4)
  v_smfmac_f32_16x16x64_bf16 v[48:51], v[40:43], v[8:15], v73
  v_mov_b64 v[2:3], 0
  v_smfmac_f32_16x16x64_bf16 v[44:47], v[68:71], v[232:239], v73
  ds_read_b128 v[40:43], v79 offset:0
  s_waitcnt lgkmcnt(2)
  v_smfmac_f32_16x16x64_bf16 v[48:51], v[68:71], v[16:23], v73
  v_mov_b64 v[4:5], 0
  v_smfmac_f32_16x16x64_bf16 v[44:47], v[32:35], v[240:247], v73
  ds_read_b128 v[68:71], v79 offset:1024
  v_smfmac_f32_16x16x64_bf16 v[48:51], v[32:35], v[248:255], v73
  v_mov_b64 v[6:7], 0
  s_waitcnt lgkmcnt(2)
  v_smfmac_f32_16x16x64_bf16 v[44:47], v[36:39], a[0:7], v73
  ds_read_b128 v[32:35], v79 offset:2048
  v_smfmac_f32_16x16x64_bf16 v[48:51], v[36:39], a[8:15], v73
  v_add_u32 v8, s37, v77
  s_waitcnt lgkmcnt(2)
  v_smfmac_f32_16x16x64_bf16 v[0:3], v[40:43], a[16:23], v73
  v_cvt_pk_bf16_f32 v44, v44, v45
  v_cvt_pk_bf16_f32 v45, v46, v47
  ds_write_b64 v8, v[44:45]
  s_nop 0
  v_cvt_pk_bf16_f32 v48, v48, v49
  v_cvt_pk_bf16_f32 v49, v50, v51
  ds_write_b64 v8, v[48:49] offset:2048
  v_smfmac_f32_16x16x64_bf16 v[4:7], v[40:43], a[24:31], v73
  ds_read_b128 v[36:39], v79 offset:3072
  s_waitcnt lgkmcnt(4)
  v_smfmac_f32_16x16x64_bf16 v[0:3], v[68:71], a[32:39], v73
  v_smfmac_f32_16x16x64_bf16 v[4:7], v[68:71], a[40:47], v73
  ds_read_b128 v[40:43], v79 offset:4096
  v_add_u32_e64 v50, s38, v75
  s_waitcnt lgkmcnt(2)
  s_barrier
  ds_read_b64_tr_b16 v[8:9], v76 offset:0
  ds_read_b64_tr_b16 v[10:11], v76 offset:128
  ds_read_b64_tr_b16 v[12:13], v76 offset:512
  ds_read_b64_tr_b16 v[14:15], v76 offset:640
  ds_read_b64_tr_b16 v[16:17], v76 offset:1024
  ds_read_b64_tr_b16 v[18:19], v76 offset:1152
  ds_read_b64_tr_b16 v[20:21], v76 offset:1536
  ds_read_b64_tr_b16 v[22:23], v76 offset:1664
  v_add_u32 v51, 65536, v78
  s_waitcnt vmcnt(5) lgkmcnt(6)
  v_mfma_f32_16x16x32_bf16 v[44:47], v[52:55], v[8:11], 0
  s_waitcnt vmcnt(4) lgkmcnt(4)
  v_mfma_f32_16x16x32_bf16 v[44:47], v[56:59], v[12:15], v[44:47]
  s_waitcnt vmcnt(3) lgkmcnt(2)
  v_mfma_f32_16x16x32_bf16 v[44:47], v[60:63], v[16:19], v[44:47]
  s_waitcnt vmcnt(2) lgkmcnt(0)
  v_mfma_f32_16x16x32_bf16 v[44:47], v[64:67], v[20:23], v[44:47]
  v_smfmac_f32_16x16x64_bf16 v[0:3], v[32:35], a[48:55], v73
  ds_read_b128 v[8:11], v51 offset:0
  v_smfmac_f32_16x16x64_bf16 v[4:7], v[32:35], a[56:63], v73
  ds_read_b128 v[68:71], v79 offset:5120
  ds_write_b128 v50, v[44:47]
  ds_read_b128 v[12:15], v51 offset:1024
  ds_read_b128 v[16:19], v51 offset:8192
  ds_read_b128 v[20:23], v51 offset:9216
  v_bfe_u32 v50, v74, 7, 1
  v_smfmac_f32_16x16x64_bf16 v[0:3], v[36:39], a[64:71], v73
  v_smfmac_f32_16x16x64_bf16 v[4:7], v[36:39], a[72:79], v73
  ds_read_b128 v[32:35], v79 offset:6144
  v_smfmac_f32_16x16x64_bf16 v[0:3], v[40:43], a[80:87], v73
  v_smfmac_f32_16x16x64_bf16 v[4:7], v[40:43], a[88:95], v73
  ds_read_b128 v[36:39], v79 offset:7168
  v_lshl_add_u32 v50, v50, 3, v75
  s_waitcnt lgkmcnt(5)
  s_barrier
  ds_read_b128 v[44:47], v79 offset:13824
  ds_read_b64 v[48:49], v50 offset:13312
  ds_read_b64 v[62:63], v50 offset:14848
  v_smfmac_f32_16x16x64_bf16 v[0:3], v[68:71], a[96:103], v73
  v_smfmac_f32_16x16x64_bf16 v[4:7], v[68:71], a[104:111], v73
  ds_read_b128 v[40:43], v79 offset:8192
  s_waitcnt lgkmcnt(5)
  v_smfmac_f32_16x16x64_bf16 v[0:3], v[32:35], a[112:119], v73
  v_smfmac_f32_16x16x64_bf16 v[4:7], v[32:35], a[120:127], v73
  s_waitcnt lgkmcnt(4)
  v_smfmac_f32_16x16x64_bf16 v[0:3], v[36:39], a[128:135], v73
  v_smfmac_f32_16x16x64_bf16 v[4:7], v[36:39], a[136:143], v73
  s_waitcnt lgkmcnt(0)
  v_smfmac_f32_16x16x64_bf16 v[0:3], v[40:43], v[8:15], v73
  v_smfmac_f32_16x16x64_bf16 v[4:7], v[40:43], v[16:23], v73
  v_max3_f32 v50, v44, v45, v46
  v_add_f32 v48, v48, v62
  v_add_f32_e64 v49, v49, v63
  v_max3_f32 v51, v47, v48, v49
  v_max_f32 v50, v50, v51
  v_add_u32 v72, s39, v75
  ds_read_b128 v[8:11], v78 offset:49152
  v_max_f32_dpp v50, v50, v50 row_ror:8 row_mask:0xf bank_mask:0xf
  v_mov_b32_e64 v51, v50
  v_cvt_pk_bf16_f32 v36, v0, v1
  v_cvt_pk_bf16_f32 v37, v2, v3
  v_permlane16_swap_b32 v50, v51
  v_max_f32 v50, v50, v51
  v_mov_b32_e64 v51, v50
  v_cvt_pk_bf16_f32 v38, v4, v5
  v_cvt_pk_bf16_f32 v39, v6, v7
  v_permlane32_swap_b32 v50, v51
  v_max_f32 v50, v50, v51
  v_mul_f32_e64 v50, s22, v50
  v_fma_f32 v44, v44, s22, -v50
  v_fma_f32 v45, v45, s22, -v50
  v_fma_f32 v46, v46, s22, -v50
  v_fma_f32 v47, v47, s22, -v50
  v_fma_f32 v48, v48, s22, -v50
  v_fma_f32 v49, v49, s22, -v50
  v_exp_f32 v44, v44
  v_exp_f32 v45, v45
  v_exp_f32 v46, v46
  v_exp_f32 v47, v47
  v_exp_f32 v48, v48
  v_exp_f32 v49, v49
  v_cvt_pk_bf16_f32 v50, v44, v45
  v_cvt_pk_bf16_f32 v51, v46, v47
  v_cndmask_b32 v32, 0, v50, s[20:21]
  v_cndmask_b32 v33, 0, v51, s[20:21]
  v_cndmask_b32 v34, v50, 0, s[20:21]
  v_cndmask_b32 v35, v51, 0, s[20:21]
  v_cvt_pk_bf16_f32 v41, v48, v49
  v_add_f32 v50, v44, v45
  s_waitcnt vmcnt(1)
  v_mfma_f32_16x16x32_bf16 v[0:3], v[24:27], v[32:35], 0
  v_cndmask_b32 v40, 0, v41, s[20:21]
  v_cndmask_b32 v41, v41, 0, s[20:21]
  s_waitcnt vmcnt(0)
  v_mfma_f32_16x16x32_bf16 v[4:7], v[28:31], v[32:35], 0
  v_add_f32 v51, v46, v47
  v_add_f32_e64 v48, v48, v49
  v_mfma_f32_16x16x16_bf16 v[0:3], v[36:37], v[40:41], v[0:3]
  v_add_f32 v50, v50, v51
  v_fmac_f32 v50, 0.5, v48
  v_mfma_f32_16x16x16_bf16 v[4:7], v[38:39], v[40:41], v[4:7]
  buffer_store_dwordx4 v[36:39], v74, s[8:11], s36 offen sc1
  ds_read_b128 v[52:55], v78 offset:32768
  ds_read_b128 v[56:59], v78 offset:33792
  v_mov_b64_e64 v[24:25], 0
  v_add_f32_dpp v50, v50, v50 row_ror:8 row_mask:0xf bank_mask:0xf
  v_mov_b32 v51, v50
  v_mov_b64 v[26:27], 0
  v_mov_b64 v[28:29], 0
  v_permlane16_swap_b32 v50, v51
  v_add_f32 v50, v50, v51
  v_mov_b32 v51, v50
  v_add_f32_dpp v0, v0, v0 row_ror:8 row_mask:0xf bank_mask:0xf
  v_add_f32_dpp v1, v1, v1 row_ror:8 row_mask:0xf bank_mask:0xf
  v_permlane32_swap_b32 v50, v51
  v_add_f32 v50, v50, v51
  v_rcp_f32_e64 v50, v50
  v_add_f32_dpp v2, v2, v2 row_ror:8 row_mask:0xf bank_mask:0xf
  v_add_f32_dpp v3, v3, v3 row_ror:8 row_mask:0xf bank_mask:0xf
  v_add_f32_dpp v4, v4, v4 row_ror:8 row_mask:0xf bank_mask:0xf
  v_add_f32_dpp v5, v5, v5 row_ror:8 row_mask:0xf bank_mask:0xf
  v_add_f32_dpp v6, v6, v6 row_ror:8 row_mask:0xf bank_mask:0xf
  v_add_f32_dpp v7, v7, v7 row_ror:8 row_mask:0xf bank_mask:0xf
  v_mul_f32 v0, v0, v50
  v_mul_f32 v1, v1, v50
  v_mul_f32 v2, v2, v50
  v_mul_f32 v3, v3, v50
  v_mul_f32 v4, v4, v50
  v_mul_f32 v5, v5, v50
  v_mul_f32 v6, v6, v50
  v_mul_f32 v7, v7, v50
  v_cvt_pk_bf16_f32 v40, v0, v1
  v_cvt_pk_bf16_f32 v41, v2, v3
  v_cvt_pk_bf16_f32 v42, v4, v5
  v_cvt_pk_bf16_f32 v43, v6, v7
  ds_write_b128 v72, v[40:43]
  v_mov_b64_e64 v[30:31], 0
  v_smfmac_f32_16x16x64_bf16 v[24:27], v[40:43], a[216:223], v73
  v_mov_b64 v[0:1], 0
  v_mov_b64 v[2:3], 0
  v_smfmac_f32_16x16x64_bf16 v[28:31], v[40:43], a[224:231], v73
  v_mov_b64 v[4:5], 0
  v_mov_b64 v[6:7], 0
  v_smfmac_f32_16x16x64_bf16 v[0:3], v[40:43], a[248:255], v73
  v_mov_b64 v[44:45], 0
  v_mov_b64 v[46:47], 0
  s_waitcnt lgkmcnt(0)
  s_barrier
  ds_read_b128 v[32:35], v75 offset:9216
  ds_read_b128 v[36:39], v75 offset:9728
  ds_read_b128 v[68:71], v75 offset:10752
  v_smfmac_f32_16x16x64_bf16 v[4:7], v[40:43], a[208:215], v73
  v_bfe_u32 v48, v74, 7, 1
  v_smfmac_f32_16x16x64_bf16 v[44:47], v[40:43], a[232:239], v73
  v_lshrrev_b32_e64 v49, 8, v74
  v_lshl_add_u32 v48, v48, 2, v49
  v_mul_u32_u24 v48, 10368, v48
  v_and_or_b32 v72, v74, s46, v48
  ds_read_b128 v[60:63], v78 offset:40960
  ds_read_b128 v[64:67], v78 offset:41984
  s_waitcnt lgkmcnt(4)
  v_smfmac_f32_16x16x64_bf16 v[0:3], v[32:35], a[240:247], v73
  ds_read_b128 v[12:15], v78 offset:50176
  v_smfmac_f32_16x16x64_bf16 v[4:7], v[32:35], a[144:151], v73
  s_waitcnt lgkmcnt(4)
  v_smfmac_f32_16x16x64_bf16 v[4:7], v[36:39], a[176:183], v73
  v_cvt_pk_bf16_f32 v0, v0, v1
  v_cvt_pk_bf16_f32 v1, v2, v3
  s_waitcnt lgkmcnt(3)
  v_smfmac_f32_16x16x64_bf16 v[4:7], v[68:71], v[52:59], v73
  v_bfi_b32 v0, 1, s25, v0
  buffer_store_dwordx2 v[0:1], v77, s[8:11], s24 offen offset:0 sc1
  v_smfmac_f32_16x16x64_bf16 v[24:27], v[32:35], a[152:159], v73
  v_smfmac_f32_16x16x64_bf16 v[24:27], v[36:39], a[184:191], v73
  v_cvt_pk_bf16_f32 v4, v4, v5
  v_cvt_pk_bf16_f32 v5, v6, v7
  s_waitcnt lgkmcnt(1)
  v_smfmac_f32_16x16x64_bf16 v[24:27], v[68:71], v[60:67], v73
  v_bfi_b32 v4, 1, s25, v4
  buffer_store_dwordx2 v[4:5], v77, s[8:11], s23 offen offset:0 sc1
  v_smfmac_f32_16x16x64_bf16 v[28:31], v[32:35], a[160:167], v73
  v_smfmac_f32_16x16x64_bf16 v[28:31], v[36:39], a[192:199], v73
  v_cvt_pk_bf16_f32 v24, v24, v25
  v_cvt_pk_bf16_f32 v25, v26, v27
  s_waitcnt lgkmcnt(0)
  v_smfmac_f32_16x16x64_bf16 v[28:31], v[68:71], v[8:15], v73
  v_bfi_b32 v24, 1, s25, v24
  buffer_store_dwordx2 v[24:25], v77, s[8:11], s23 offen offset:2048 sc1
  v_smfmac_f32_16x16x64_bf16 v[44:47], v[32:35], a[168:175], v73
  ds_read_b128 v[16:19], v78 offset:57344
  ds_read_b128 v[20:23], v78 offset:58368
  v_smfmac_f32_16x16x64_bf16 v[44:47], v[36:39], a[200:207], v73
  v_cvt_pk_bf16_f32 v28, v28, v29
  v_cvt_pk_bf16_f32 v29, v30, v31
  s_waitcnt lgkmcnt(0)
  v_smfmac_f32_16x16x64_bf16 v[44:47], v[68:71], v[16:23], v73
  v_bfi_b32 v28, 1, s25, v28
  buffer_store_dwordx2 v[28:29], v77, s[8:11], s31 offen offset:0 sc1
  v_subrev_u32 v78, 65536, v78
  s_nop 4
  v_cvt_pk_bf16_f32 v44, v44, v45
  v_cvt_pk_bf16_f32 v45, v46, v47
  v_bfi_b32 v44, 1, s25, v44
  buffer_store_dwordx2 v[44:45], v77, s[8:11], s31 offen offset:2048 sc1
  s_cmp_eq_u32 s41, -1
  s_cbranch_scc0 Lc_slow2_spec
Lc_slow2_specd:
  s_mov_b32 s75, s28
  s_mov_b32 s44, s14
  v_add_u32 v68, 149504, v74
  v_mov_b32 v70, 163832
Lc_slow2_lw:
  ds_read_b32 v69, v70
  s_sub_u32 s15, s15, 1
  s_cbranch_scc1 Lc_slow2_lwto
  s_waitcnt lgkmcnt(0)
  v_cmp_ne_u32 vcc, s44, v69
  s_cbranch_vccnz Lc_slow2_lw
  s_add_u32 s15, s15, 1
Lc_slow2_lwok:
  buffer_load_dwordx4 v[52:55], v68, s[8:11], s75 offen offset:0 sc1
  buffer_load_dwordx4 v[56:59], v68, s[8:11], s75 offen offset:1024 sc1
  ds_read_b128 v[0:3], v78 offset:0
  ds_read_b128 v[4:7], v78 offset:1024
  ds_read_b128 v[8:11], v78 offset:8192
  ds_read_b128 v[12:15], v78 offset:9216
  ds_read_b128 v[16:19], v78 offset:16384
  ds_read_b128 v[20:23], v78 offset:17408
  v_mov_b64 v[44:45], 0
  v_mov_b64 v[46:47], 0
  v_mov_b64 v[48:49], 0
  v_mov_b64_e64 v[50:51], 0
  s_mov_b32 s75, s28
  s_mov_b32 s44, s14
  s_add_u32 s14, s14, 1
  s_xor_b32 s25, s25, 1
  s_mov_b32 s45, s28
  s_mov_b32 s28, s29
  s_mov_b32 s29, s18
  s_mov_b32 s18, s45
  s_add_u32 s35, s35, 131072
  s_add_u32 s36, s36, 131072
  s_add_u32 s34, s34, 262144
  s_add_u32 s33, s33, 262144
  s_add_u32 s32, s32, 262144
  s_xor_b32 s55, s55, 4096
  s_xor_b32 s19, s19, 4096
  v_add_u32 v72, 154624, v74
  buffer_load_dwordx4 v[60:63], v68, s[8:11], s75 offen offset:0 sc1
  buffer_load_dwordx4 v[64:67], v68, s[8:11], s75 offen offset:1024 sc1
  s_waitcnt vmcnt(3)
  ds_write_b128 v68, v[52:55] offset:0
  v_max3_u32 v69, v52, v53, v54
  v_max_u32_e64 v69, v69, v55
  s_waitcnt vmcnt(2)
  ds_write_b128 v68, v[56:59] offset:1024
  v_max3_u32 v69, v69, v56, v57
  v_max3_u32 v69, v69, v58, v59
  v_cmp_eq_u32 vcc, -1, v69
  s_cbranch_vccnz Lc_slow2_mpr
Lc_slow2_mpok:
  s_cmp_eq_u32 s14, 63
  s_waitcnt lgkmcnt(0)
  s_cbranch_scc0 Lc_slow2_top
  s_branch Lc_last2_top
Lc_slow2_end:
Lc_slow2_mpr:
  buffer_load_dwordx4 v[52:55], v68, s[8:11], s75 offen offset:0 sc1
  buffer_load_dwordx4 v[56:59], v68, s[8:11], s75 offen offset:1024 sc1
  s_waitcnt vmcnt(3)
  ds_write_b128 v68, v[60:63] offset:0
  v_max3_u32 v69, v60, v61, v62
  v_max_u32 v69, v69, v63
  s_waitcnt vmcnt(2)
  ds_write_b128 v68, v[64:67] offset:1024
  v_max3_u32 v69, v69, v64, v65
  v_max3_u32 v69, v69, v66, v67
  v_cmp_eq_u32 vcc, -1, v69
  s_cbranch_vccz Lc_slow2_mpok
  buffer_load_dwordx4 v[60:63], v68, s[8:11], s75 offen offset:0 sc1
  buffer_load_dwordx4 v[64:67], v68, s[8:11], s75 offen offset:1024 sc1
  s_waitcnt vmcnt(3)
  ds_write_b128 v68, v[52:55] offset:0
  v_max3_u32 v69, v52, v53, v54
  v_max_u32 v69, v69, v55
  s_waitcnt vmcnt(2)
  ds_write_b128 v68, v[56:59] offset:1024
  v_max3_u32 v69, v69, v56, v57
  v_max3_u32 v69, v69, v58, v59
  v_cmp_eq_u32 vcc, -1, v69
  s_cbranch_vccz Lc_slow2_mpok
  s_sub_u32 s15, s15, 1
  s_cbranch_scc0 Lc_slow2_mpr
  s_mov_b32 s15, 0
  s_branch Lc_slow2_mpok
Lc_slow2_pbr0:
  buffer_load_dwordx4 v[28:31], v72, s[8:11], s75 offen sc1
Lc_slow2_pbr:
  buffer_load_dwordx4 v[24:27], v72, s[8:11], s75 offen sc1
  s_waitcnt vmcnt(1)
  ds_write_b128 v72, v[28:31]
  s_waitcnt lgkmcnt(0)
  v_max3_u32 v28, v28, v29, v30
  v_max_u32 v28, v28, v31
  v_cmp_eq_u32 vcc, -1, v28
  s_cbranch_vccz Lc_slow2_pbd
  buffer_load_dwordx4 v[28:31], v72, s[8:11], s75 offen sc1
  s_waitcnt vmcnt(1)
  ds_write_b128 v72, v[24:27]
  s_waitcnt lgkmcnt(0)
  v_max3_u32 v24, v24, v25, v26
  v_max_u32 v24, v24, v27
  v_cmp_eq_u32 vcc, -1, v24
  s_cbranch_vccz Lc_slow2_pbd
  s_sub_u32 s15, s15, 1
  s_cbranch_scc0 Lc_slow2_pbr
  s_mov_b32 s15, 0
Lc_slow2_pbd:
  s_waitcnt lgkmcnt(0)
  s_branch Lc_slow2_pbok
Lc_slow2_spec:
  v_add_u32 v28, 5120, v72
  s_waitcnt vmcnt(4)
  buffer_load_dwordx4 v[32:35], v72, s[8:11], s27 offen sc1
  buffer_load_dwordx4 v[36:39], v72, s[8:11], s52 offen sc1
  buffer_load_dwordx4 v[40:43], v72, s[8:11], s53 offen sc1
  buffer_load_dwordx4 v[24:27], v72, s[8:11], s54 offen sc1
  buffer_load_dwordx4 v[52:55], v28, s[8:11], s27 offen sc1
  buffer_load_dwordx4 v[56:59], v28, s[8:11], s52 offen sc1
  buffer_load_dwordx4 v[60:63], v28, s[8:11], s53 offen sc1
  buffer_load_dwordx4 v[64:67], v28, s[8:11], s54 offen sc1
  v_lshrrev_b32 v69, 8, v74
  v_and_b32 v68, 0x70, v74
  v_and_b32 v70, 1, v69
  v_lshl_add_u32 v68, v70, 3, v68
  v_lshrrev_b32 v69, 1, v69
  v_lshl_add_u32 v68, v69, 2, v68
  v_add_u32 v68, s40, v68
  v_mov_b32 v71, -1
  v_bfe_u32 v69, v74, 4, 1
  v_lshlrev_b32 v69, 4, v69
  v_mov_b32 v70, 0x3f80
  v_lshlrev_b32 v70, v69, v70
  v_cndmask_b32 v48, 0, v70, s[66:67]
  v_cndmask_b32 v49, 0, v70, s[68:69]
  v_cndmask_b32 v50, 0, v70, s[70:71]
  v_cndmask_b32 v51, 0, v70, s[72:73]
  s_waitcnt vmcnt(7)
  s_nop 0
  v_mfma_f32_16x16x32_bf16 v[44:47], v[32:35], v[48:51], 0
  v_xor_b32 v69, s25, v32
  v_bitop3_b32 v69, v69, v34, s25 bitop3:0xf6
  s_waitcnt vmcnt(6)
  v_mfma_f32_16x16x32_bf16 v[44:47], v[36:39], v[48:51], v[44:47]
  v_bitop3_b32 v69, v69, v36, s25 bitop3:0xf6
  v_bitop3_b32 v69, v69, v38, s25 bitop3:0xf6
  s_waitcnt vmcnt(5)
  v_mfma_f32_16x16x32_bf16 v[44:47], v[40:43], v[48:51], v[44:47]
  v_bitop3_b32 v69, v69, v40, s25 bitop3:0xf6
  v_bitop3_b32 v69, v69, v42, s25 bitop3:0xf6
  s_waitcnt vmcnt(4)
  v_mfma_f32_16x16x32_bf16 v[44:47], v[24:27], v[48:51], v[44:47]
  v_bitop3_b32 v69, v69, v24, s25 bitop3:0xf6
  v_bitop3_b32 v69, v69, v26, s25 bitop3:0xf6
  s_waitcnt vmcnt(3)
  v_mfma_f32_16x16x32_bf16 v[44:47], v[52:55], v[48:51], v[44:47]
  v_bitop3_b32 v69, v69, v52, s25 bitop3:0xf6
  v_bitop3_b32 v69, v69, v54, s25 bitop3:0xf6
  s_waitcnt vmcnt(2)
  v_mfma_f32_16x16x32_bf16 v[44:47], v[56:59], v[48:51], v[44:47]
  v_bitop3_b32 v69, v69, v56, s25 bitop3:0xf6
  v_bitop3_b32 v69, v69, v58, s25 bitop3:0xf6
  s_waitcnt vmcnt(1)
  v_mfma_f32_16x16x32_bf16 v[44:47], v[60:63], v[48:51], v[44:47]
  v_bitop3_b32 v69, v69, v60, s25 bitop3:0xf6
  v_bitop3_b32 v69, v69, v62, s25 bitop3:0xf6
  s_waitcnt vmcnt(0)
  v_mfma_f32_16x16x32_bf16 v[44:47], v[64:67], v[48:51], v[44:47]
  v_bitop3_b32 v69, v69, v64, s25 bitop3:0xf6
  v_bitop3_b32 v69, v69, v66, s25 bitop3:0xf6
  v_and_b32 v69, 1, v69
  v_cmp_ne_u32 vcc, 0, v69
  s_cbranch_vccz Lc_slow2_redok
Lc_slow2_specl:
  buffer_load_dwordx4 v[32:35], v72, s[8:11], s27 offen sc1
  buffer_load_dwordx4 v[36:39], v72, s[8:11], s52 offen sc1
  buffer_load_dwordx4 v[40:43], v72, s[8:11], s53 offen sc1
  buffer_load_dwordx4 v[24:27], v72, s[8:11], s54 offen sc1
  buffer_load_dwordx4 v[52:55], v28, s[8:11], s27 offen sc1
  buffer_load_dwordx4 v[56:59], v28, s[8:11], s52 offen sc1
  buffer_load_dwordx4 v[60:63], v28, s[8:11], s53 offen sc1
  buffer_load_dwordx4 v[64:67], v28, s[8:11], s54 offen sc1
  s_waitcnt vmcnt(7)
  v_mfma_f32_16x16x32_bf16 v[44:47], v[32:35], v[48:51], 0
  v_xor_b32 v69, s25, v32
  v_bitop3_b32 v69, v69, v34, s25 bitop3:0xf6
  s_waitcnt vmcnt(6)
  v_mfma_f32_16x16x32_bf16 v[44:47], v[36:39], v[48:51], v[44:47]
  v_bitop3_b32 v69, v69, v36, s25 bitop3:0xf6
  v_bitop3_b32 v69, v69, v38, s25 bitop3:0xf6
  s_waitcnt vmcnt(5)
  v_mfma_f32_16x16x32_bf16 v[44:47], v[40:43], v[48:51], v[44:47]
  v_bitop3_b32 v69, v69, v40, s25 bitop3:0xf6
  v_bitop3_b32 v69, v69, v42, s25 bitop3:0xf6
  s_waitcnt vmcnt(4)
  v_mfma_f32_16x16x32_bf16 v[44:47], v[24:27], v[48:51], v[44:47]
  v_bitop3_b32 v69, v69, v24, s25 bitop3:0xf6
  v_bitop3_b32 v69, v69, v26, s25 bitop3:0xf6
  s_waitcnt vmcnt(3)
  v_mfma_f32_16x16x32_bf16 v[44:47], v[52:55], v[48:51], v[44:47]
  v_bitop3_b32 v69, v69, v52, s25 bitop3:0xf6
  v_bitop3_b32 v69, v69, v54, s25 bitop3:0xf6
  s_waitcnt vmcnt(2)
  v_mfma_f32_16x16x32_bf16 v[44:47], v[56:59], v[48:51], v[44:47]
  v_bitop3_b32 v69, v69, v56, s25 bitop3:0xf6
  v_bitop3_b32 v69, v69, v58, s25 bitop3:0xf6
  s_waitcnt vmcnt(1)
  v_mfma_f32_16x16x32_bf16 v[44:47], v[60:63], v[48:51], v[44:47]
  v_bitop3_b32 v69, v69, v60, s25 bitop3:0xf6
  v_bitop3_b32 v69, v69, v62, s25 bitop3:0xf6
  s_waitcnt vmcnt(0)
  v_mfma_f32_16x16x32_bf16 v[44:47], v[64:67], v[48:51], v[44:47]
  v_bitop3_b32 v69, v69, v64, s25 bitop3:0xf6
  v_bitop3_b32 v69, v69, v66, s25 bitop3:0xf6
  v_and_b32 v69, 1, v69
  v_cmp_ne_u32 vcc, 0, v69
  s_cbranch_vccz Lc_slow2_redok
  s_sub_u32 s15, s15, 1
  s_cbranch_scc0 Lc_slow2_specl
  s_mov_b32 s15, 0
Lc_slow2_redok:
  s_nop 2
  v_permlane32_swap_b32 v44, v46
  v_permlane32_swap_b32 v45, v47
  v_add_f32 v44, v44, v46
  v_add_f32 v45, v45, v47
  v_cvt_pk_bf16_f32 v44, v44, v45
  s_mov_b64 exec, s[20:21]
  buffer_store_dword v44, v68, s[8:11], s28 offen sc1
  buffer_store_dword v71, v68, s[8:11], s18 offen sc1
  s_mov_b64 exec, -1
  s_branch Lc_slow2_specd
Lc_slow2_lwto:
  s_mov_b32 s15, 0
  s_branch Lc_slow2_lwok
Lc_slow3_top:
  s_barrier
  ds_read_b128 v[32:35], v75 offset:0
  ds_read_b128 v[36:39], v75 offset:512
  ds_read_b128 v[40:43], v75 offset:1024
  s_waitcnt lgkmcnt(2)
  v_smfmac_f32_16x16x64_bf16 v[44:47], v[32:35], v[0:7], v73
  ds_read_b128 v[68:71], v75 offset:1536
  buffer_load_dwordx4 v[24:27], v72, s[8:11], s75 offen sc1
  v_smfmac_f32_16x16x64_bf16 v[48:51], v[32:35], v[80:87], v73
  ds_read_b128 v[0:3], v78 offset:24576
  ds_read_b128 v[4:7], v78 offset:25600
  s_waitcnt lgkmcnt(4)
  v_smfmac_f32_16x16x64_bf16 v[44:47], v[36:39], v[8:15], v73
  ds_read_b128 v[32:35], v75 offset:2048
  v_smfmac_f32_16x16x64_bf16 v[48:51], v[36:39], v[88:95], v73
  ds_read_b128 v[8:11], v78 offset:32768
  s_waitcnt lgkmcnt(5)
  v_smfmac_f32_16x16x64_bf16 v[44:47], v[40:43], v[96:103], v73
  ds_read_b128 v[36:39], v75 offset:2560
  v_smfmac_f32_16x16x64_bf16 v[48:51], v[40:43], v[16:23], v73
  ds_read_b128 v[12:15], v78 offset:33792
  s_waitcnt lgkmcnt(6)
  v_smfmac_f32_16x16x64_bf16 v[44:47], v[68:71], v[104:111], v73
  ds_read_b128 v[40:43], v75 offset:3072
  s_waitcnt lgkmcnt(5)
  v_smfmac_f32_16x16x64_bf16 v[48:51], v[68:71], v[0:7], v73
  ds_read_b128 v[16:19], v78 offset:40960
  s_waitcnt lgkmcnt(5)
  v_smfmac_f32_16x16x64_bf16 v[44:47], v[32:35], v[112:119], v73
  ds_read_b128 v[68:71], v75 offset:3584
  v_smfmac_f32_16x16x64_bf16 v[48:51], v[32:35], v[120:127], v73
  ds_read_b128 v[20:23], v78 offset:41984
  s_waitcnt lgkmcnt(5)
  v_smfmac_f32_16x16x64_bf16 v[44:47], v[36:39], v[128:135], v73
  ds_read_b128 v[32:35], v75 offset:4096
  v_smfmac_f32_16x16x64_bf16 v[48:51], v[36:39], v[136:143], v73
  ds_read_b128 v[0:3], v78 offset:49152
  s_waitcnt lgkmcnt(5)
  v_smfmac_f32_16x16x64_bf16 v[44:47], v[40:43], v[8:15], v73
  ds_read_b128 v[36:39], v75 offset:4608
  v_smfmac_f32_16x16x64_bf16 v[48:51], v[40:43], v[144:151], v73
  ds_read_b128 v[4:7], v78 offset:50176
  ds_read_b128 v[8:11], v78 offset:57344
  s_waitcnt lgkmcnt(5)
  v_smfmac_f32_16x16x64_bf16 v[44:47], v[68:71], v[16:23], v73
  s_waitcnt vmcnt(0)
  ds_write_b128 v72, v[24:27]
  v_smfmac_f32_16x16x64_bf16 v[48:51], v[68:71], v[152:159], v73
  ds_read_b128 v[12:15], v78 offset:58368
  v_max3_u32 v28, v24, v25, v26
  v_max_u32 v28, v28, v27
  s_waitcnt lgkmcnt(6)
  v_smfmac_f32_16x16x64_bf16 v[44:47], v[32:35], v[160:167], v73
  v_add_u32 v78, 65536, v78
  v_cmp_eq_u32 vcc, -1, v28
  s_waitcnt lgkmcnt(3)
  v_smfmac_f32_16x16x64_bf16 v[48:51], v[32:35], v[0:7], v73
  ds_read_b128 v[16:19], v78 offset:0
  s_cbranch_vccnz Lc_slow3_pbr0
  s_waitcnt lgkmcnt(2)
Lc_slow3_pbok:
  s_barrier
  ds_read_b128 v[40:43], v75 offset:5120
  ds_read_b128 v[68:71], v75 offset:5632
  v_smfmac_f32_16x16x64_bf16 v[44:47], v[36:39], v[168:175], v73
  ds_read_b128 v[32:35], v75 offset:6144
  s_waitcnt lgkmcnt(4)
  v_smfmac_f32_16x16x64_bf16 v[48:51], v[36:39], v[8:15], v73
  ds_read_b128 v[20:23], v78 offset:1024
  ds_read_b128 v[0:3], v78 offset:8192
  buffer_load_dwordx4 v[24:27], v74, s[8:11], s34 offen offset:0 sc1
  s_waitcnt lgkmcnt(4)
  v_smfmac_f32_16x16x64_bf16 v[44:47], v[40:43], v[176:183], v73
  ds_read_b128 v[36:39], v75 offset:6656
  v_smfmac_f32_16x16x64_bf16 v[48:51], v[40:43], v[184:191], v73
  ds_read_b128 v[4:7], v78 offset:9216
  buffer_load_dwordx4 v[28:31], v74, s[8:11], s34 offen offset:1024 sc1
  s_waitcnt lgkmcnt(5)
  v_smfmac_f32_16x16x64_bf16 v[44:47], v[68:71], v[192:199], v73
  ds_read_b128 v[40:43], v75 offset:7168
  v_smfmac_f32_16x16x64_bf16 v[48:51], v[68:71], v[200:207], v73
  ds_read_b128 v[8:11], v78 offset:16384
  s_waitcnt lgkmcnt(5)
  v_smfmac_f32_16x16x64_bf16 v[44:47], v[32:35], v[16:23], v73
  ds_read_b128 v[68:71], v75 offset:7680
  v_smfmac_f32_16x16x64_bf16 v[48:51], v[32:35], v[208:215], v73
  ds_read_b128 v[12:15], v78 offset:17408
  ds_read_b128 v[16:19], v78 offset:24576
  s_waitcnt lgkmcnt(5)
  v_smfmac_f32_16x16x64_bf16 v[44:47], v[36:39], v[0:7], v73
  ds_read_b128 v[32:35], v75 offset:8192
  v_smfmac_f32_16x16x64_bf16 v[48:51], v[36:39], v[216:223], v73
  ds_read_b128 v[20:23], v78 offset:25600
  v_mov_b64 v[0:1], 0
  s_waitcnt lgkmcnt(6)
  v_smfmac_f32_16x16x64_bf16 v[44:47], v[40:43], v[224:231], v73
  ds_read_b128 v[36:39], v75 offset:8704
  v_lshlrev_b32 v60, 2, v74
  s_waitcnt lgkmcnt(4)
  v_smfmac_f32_16x16x64_bf16 v[48:51], v[40:43], v[8:15], v73
  v_mov_b64_e64 v[2:3], 0
  v_smfmac_f32_16x16x64_bf16 v[44:47], v[68:71], v[232:239], v73
  ds_read_b128 v[40:43], v79 offset:0
  s_waitcnt lgkmcnt(2)
  v_smfmac_f32_16x16x64_bf16 v[48:51], v[68:71], v[16:23], v73
  v_mov_b64 v[4:5], 0
  buffer_load_dword v64, off, s[8:11], s19 sc1
  v_smfmac_f32_16x16x64_bf16 v[44:47], v[32:35], v[240:247], v73
  ds_read_b128 v[68:71], v79 offset:1024
  buffer_load_dword v60, s[8:11], s63 offen sc1 lds
  s_add_u32 s63, s63, 4096
  v_smfmac_f32_16x16x64_bf16 v[48:51], v[32:35], v[248:255], v73
  v_mov_b64_e64 v[6:7], 0
  buffer_load_dword v60, s[8:11], s63 offen sc1 lds
  s_add_u32 s63, s63, 16773120
  s_waitcnt lgkmcnt(2)
  v_smfmac_f32_16x16x64_bf16 v[44:47], v[36:39], a[0:7], v73
  ds_read_b128 v[32:35], v79 offset:2048
  buffer_load_dword v60, s[8:11], s63 offen sc1 lds
  s_add_u32 s63, s63, 4096
  v_smfmac_f32_16x16x64_bf16 v[48:51], v[36:39], a[8:15], v73
  v_add_u32 v8, s37, v77
  buffer_load_dword v60, s[8:11], s63 offen sc1 lds
  s_add_u32 s63, s63, 0
  s_waitcnt lgkmcnt(2)
  v_smfmac_f32_16x16x64_bf16 v[0:3], v[40:43], a[16:23], v73
  v_cvt_pk_bf16_f32 v44, v44, v45
  v_cvt_pk_bf16_f32 v45, v46, v47
  ds_write_b64 v8, v[44:45]
  v_cvt_pk_bf16_f32 v48, v48, v49
  v_cvt_pk_bf16_f32 v49, v50, v51
  ds_write_b64 v8, v[48:49] offset:2048
  v_smfmac_f32_16x16x64_bf16 v[4:7], v[40:43], a[24:31], v73
  ds_read_b128 v[36:39], v79 offset:3072
  s_waitcnt lgkmcnt(4)
  v_smfmac_f32_16x16x64_bf16 v[0:3], v[68:71], a[32:39], v73
  v_smfmac_f32_16x16x64_bf16 v[4:7], v[68:71], a[40:47], v73
  ds_read_b128 v[40:43], v79 offset:4096
  v_add_u32 v50, s38, v75
  s_waitcnt lgkmcnt(2)
  s_barrier
  ds_read_b64_tr_b16 v[8:9], v76 offset:0
  ds_read_b64_tr_b16 v[10:11], v76 offset:128
  ds_read_b64_tr_b16 v[52:53], v76 offset:2048
  ds_read_b64_tr_b16 v[54:55], v76 offset:2176
  ds_read_b64_tr_b16 v[12:13], v76 offset:512
  ds_read_b64_tr_b16 v[14:15], v76 offset:640
  ds_read_b64_tr_b16 v[56:57], v76 offset:2560
  ds_read_b64_tr_b16 v[58:59], v76 offset:2688
  v_add_u32 v51, 65536, v78
  v_smfmac_f32_16x16x64_bf16 v[0:3], v[32:35], a[48:55], v73
  v_smfmac_f32_16x16x64_bf16 v[4:7], v[32:35], a[56:63], v73
  ds_read_b128 v[68:71], v79 offset:5120
  s_waitcnt lgkmcnt(5)
  v_mfma_f32_16x16x32_bf16 v[44:47], v[52:55], v[8:11], 0
  s_waitcnt lgkmcnt(1)
  v_mfma_f32_16x16x32_bf16 v[44:47], v[56:59], v[12:15], v[44:47]
  v_smfmac_f32_16x16x64_bf16 v[0:3], v[36:39], a[64:71], v73
  ds_read_b128 v[8:11], v51 offset:0
  v_smfmac_f32_16x16x64_bf16 v[4:7], v[36:39], a[72:79], v73
  ds_read_b128 v[32:35], v79 offset:6144
  ds_write_b128 v50, v[44:47]
  ds_read_b128 v[12:15], v51 offset:1024
  ds_read_b128 v[16:19], v51 offset:8192
  ds_read_b128 v[20:23], v51 offset:9216
  v_bfe_u32 v50, v74, 7, 1
  v_smfmac_f32_16x16x64_bf16 v[0:3], v[40:43], a[80:87], v73
  v_smfmac_f32_16x16x64_bf16 v[4:7], v[40:43], a[88:95], v73
  ds_read_b128 v[36:39], v79 offset:7168
  v_lshl_add_u32 v50, v50, 3, v75
  s_waitcnt lgkmcnt(4)
  s_barrier
  ds_read_b128 v[44:47], v79 offset:13824
  ds_read_b64 v[48:49], v50 offset:13312
  ds_read_b64 v[62:63], v50 offset:14848
  v_smfmac_f32_16x16x64_bf16 v[0:3], v[68:71], a[96:103], v73
  v_smfmac_f32_16x16x64_bf16 v[4:7], v[68:71], a[104:111], v73
  ds_read_b128 v[40:43], v79 offset:8192
  v_smfmac_f32_16x16x64_bf16 v[0:3], v[32:35], a[112:119], v73
  v_smfmac_f32_16x16x64_bf16 v[4:7], v[32:35], a[120:127], v73
  s_waitcnt lgkmcnt(4)
  v_smfmac_f32_16x16x64_bf16 v[0:3], v[36:39], a[128:135], v73
  v_smfmac_f32_16x16x64_bf16 v[4:7], v[36:39], a[136:143], v73
  s_waitcnt lgkmcnt(0)
  v_smfmac_f32_16x16x64_bf16 v[0:3], v[40:43], v[8:15], v73
  v_smfmac_f32_16x16x64_bf16 v[4:7], v[40:43], v[16:23], v73
  s_mov_b64 exec, s[20:21]
  buffer_store_dwordx4 v[52:55], v75, s[8:11], s35 offen offset:0 sc1
  buffer_store_dwordx4 v[56:59], v75, s[8:11], s35 offen offset:512 sc1
  s_mov_b64 exec, -1
  v_max3_f32 v50, v44, v45, v46
  v_add_f32 v48, v48, v62
  v_add_f32 v49, v49, v63
  v_max3_f32 v51, v47, v48, v49
  v_max_f32 v50, v50, v51
  v_add_u32 v72, s39, v75
  ds_read_b128 v[8:11], v78 offset:49152
  v_max_f32_dpp v50, v50, v50 row_ror:8 row_mask:0xf bank_mask:0xf
  v_mov_b32_e64 v51, v50
  v_cvt_pk_bf16_f32 v36, v0, v1
  v_cvt_pk_bf16_f32 v37, v2, v3
  v_permlane16_swap_b32 v50, v51
  v_max_f32 v50, v50, v51
  v_mov_b32_e64 v51, v50
  v_cvt_pk_bf16_f32 v38, v4, v5
  v_cvt_pk_bf16_f32 v39, v6, v7
  v_permlane32_swap_b32 v50, v51
  v_max_f32 v50, v50, v51
  v_mul_f32_e64 v50, s22, v50
  v_fma_f32 v44, v44, s22, -v50
  v_fma_f32 v45, v45, s22, -v50
  v_fma_f32 v46, v46, s22, -v50
  v_fma_f32 v47, v47, s22, -v50
  v_fma_f32 v48, v48, s22, -v50
  v_fma_f32 v49, v49, s22, -v50
  v_exp_f32 v44, v44
  v_exp_f32 v45, v45
  v_exp_f32 v46, v46
  v_exp_f32 v47, v47
  v_exp_f32 v48, v48
  v_exp_f32 v49, v49
  v_cvt_pk_bf16_f32 v50, v44, v45
  v_cvt_pk_bf16_f32 v51, v46, v47
  v_cndmask_b32 v32, 0, v50, s[20:21]
  v_cndmask_b32 v33, 0, v51, s[20:21]
  v_cndmask_b32 v34, v50, 0, s[20:21]
  v_cndmask_b32 v35, v51, 0, s[20:21]
  v_cvt_pk_bf16_f32 v41, v48, v49
  v_add_f32 v50, v44, v45
  s_waitcnt vmcnt(8)
  v_mfma_f32_16x16x32_bf16 v[0:3], v[24:27], v[32:35], 0
  v_cndmask_b32 v40, 0, v41, s[20:21]
  v_cndmask_b32 v41, v41, 0, s[20:21]
  s_waitcnt vmcnt(7)
  v_mfma_f32_16x16x32_bf16 v[4:7], v[28:31], v[32:35], 0
  v_add_f32 v51, v46, v47
  v_add_f32_e64 v48, v48, v49
  v_mfma_f32_16x16x16_bf16 v[0:3], v[36:37], v[40:41], v[0:3]
  v_add_f32 v50, v50, v51
  v_fmac_f32 v50, 0.5, v48
  v_mfma_f32_16x16x16_bf16 v[4:7], v[38:39], v[40:41], v[4:7]
  buffer_store_dwordx4 v[36:39], v74, s[8:11], s36 offen sc1
  ds_read_b128 v[52:55], v78 offset:32768
  ds_read_b128 v[56:59], v78 offset:33792
  v_mov_b64_e64 v[24:25], 0
  v_add_f32_dpp v50, v50, v50 row_ror:8 row_mask:0xf bank_mask:0xf
  v_mov_b32 v51, v50
  v_mov_b64 v[26:27], 0
  v_mov_b64 v[28:29], 0
  v_permlane16_swap_b32 v50, v51
  v_add_f32 v50, v50, v51
  v_mov_b32 v51, v50
  v_add_f32_dpp v0, v0, v0 row_ror:8 row_mask:0xf bank_mask:0xf
  v_add_f32_dpp v1, v1, v1 row_ror:8 row_mask:0xf bank_mask:0xf
  v_permlane32_swap_b32 v50, v51
  v_add_f32 v50, v50, v51
  v_rcp_f32_e64 v50, v50
  v_add_f32_dpp v2, v2, v2 row_ror:8 row_mask:0xf bank_mask:0xf
  v_add_f32_dpp v3, v3, v3 row_ror:8 row_mask:0xf bank_mask:0xf
  v_add_f32_dpp v4, v4, v4 row_ror:8 row_mask:0xf bank_mask:0xf
  v_add_f32_dpp v5, v5, v5 row_ror:8 row_mask:0xf bank_mask:0xf
  v_add_f32_dpp v6, v6, v6 row_ror:8 row_mask:0xf bank_mask:0xf
  v_add_f32_dpp v7, v7, v7 row_ror:8 row_mask:0xf bank_mask:0xf
  v_mul_f32 v0, v0, v50
  v_mul_f32 v1, v1, v50
  v_mul_f32 v2, v2, v50
  v_mul_f32 v3, v3, v50
  v_mul_f32 v4, v4, v50
  v_mul_f32 v5, v5, v50
  v_mul_f32 v6, v6, v50
  v_mul_f32 v7, v7, v50
  v_cvt_pk_bf16_f32 v68, v0, v1
  v_cvt_pk_bf16_f32 v69, v2, v3
  v_cvt_pk_bf16_f32 v70, v4, v5
  v_cvt_pk_bf16_f32 v71, v6, v7
  ds_write_b128 v72, v[68:71]
  v_mov_b64_e64 v[30:31], 0
  v_smfmac_f32_16x16x64_bf16 v[24:27], v[68:71], a[216:223], v73
  v_mov_b64 v[0:1], 0
  v_mov_b64 v[2:3], 0
  v_smfmac_f32_16x16x64_bf16 v[28:31], v[68:71], a[224:231], v73
  v_mov_b64 v[4:5], 0
  v_mov_b64 v[6:7], 0
  v_smfmac_f32_16x16x64_bf16 v[0:3], v[68:71], a[248:255], v73
  v_mov_b64 v[44:45], 0
  v_mov_b64 v[46:47], 0
  s_waitcnt lgkmcnt(0)
  s_barrier
  ds_read_b128 v[36:39], v75 offset:9728
  ds_read_b128 v[32:35], v75 offset:9216
  ds_read_b128 v[40:43], v75 offset:10240
  v_smfmac_f32_16x16x64_bf16 v[4:7], v[68:71], a[208:215], v73
  s_waitcnt vmcnt(7)
  v_readfirstlane_b32 s59, v64
  v_smfmac_f32_16x16x64_bf16 v[44:47], v[68:71], a[232:239], v73
  ds_read_b128 v[60:63], v78 offset:40960
  ds_read_b128 v[64:67], v78 offset:41984
  s_waitcnt lgkmcnt(4)
  v_smfmac_f32_16x16x64_bf16 v[0:3], v[36:39], a[240:247], v73
  ds_read_b128 v[12:15], v78 offset:50176
  v_smfmac_f32_16x16x64_bf16 v[4:7], v[36:39], a[176:183], v73
  s_waitcnt lgkmcnt(4)
  v_smfmac_f32_16x16x64_bf16 v[4:7], v[32:35], a[144:151], v73
  v_cvt_pk_bf16_f32 v0, v0, v1
  v_cvt_pk_bf16_f32 v1, v2, v3
  s_waitcnt lgkmcnt(3)
  v_smfmac_f32_16x16x64_bf16 v[4:7], v[40:43], v[52:59], v73
  v_bfi_b32 v0, 1, s25, v0
  buffer_store_dwordx2 v[0:1], v77, s[8:11], s24 offen offset:0 sc1
  v_smfmac_f32_16x16x64_bf16 v[24:27], v[36:39], a[184:191], v73
  v_smfmac_f32_16x16x64_bf16 v[24:27], v[32:35], a[152:159], v73
  v_cvt_pk_bf16_f32 v4, v4, v5
  v_cvt_pk_bf16_f32 v5, v6, v7
  s_waitcnt lgkmcnt(1)
  v_smfmac_f32_16x16x64_bf16 v[24:27], v[40:43], v[60:67], v73
  v_bfi_b32 v4, 1, s25, v4
  buffer_store_dwordx2 v[4:5], v77, s[8:11], s23 offen offset:0 sc1
  v_smfmac_f32_16x16x64_bf16 v[28:31], v[36:39], a[192:199], v73
  v_smfmac_f32_16x16x64_bf16 v[28:31], v[32:35], a[160:167], v73
  v_cvt_pk_bf16_f32 v24, v24, v25
  v_cvt_pk_bf16_f32 v25, v26, v27
  s_waitcnt lgkmcnt(0)
  v_smfmac_f32_16x16x64_bf16 v[28:31], v[40:43], v[8:15], v73
  v_bfi_b32 v24, 1, s25, v24
  buffer_store_dwordx2 v[24:25], v77, s[8:11], s23 offen offset:2048 sc1
  v_smfmac_f32_16x16x64_bf16 v[44:47], v[36:39], a[200:207], v73
  ds_read_b128 v[16:19], v78 offset:57344
  ds_read_b128 v[20:23], v78 offset:58368
  v_smfmac_f32_16x16x64_bf16 v[44:47], v[32:35], a[168:175], v73
  v_cvt_pk_bf16_f32 v28, v28, v29
  v_cvt_pk_bf16_f32 v29, v30, v31
  s_waitcnt lgkmcnt(0)
  v_smfmac_f32_16x16x64_bf16 v[44:47], v[40:43], v[16:23], v73
  v_bfi_b32 v28, 1, s25, v28
  buffer_store_dwordx2 v[28:29], v77, s[8:11], s31 offen offset:0 sc1
  v_subrev_u32 v78, 65536, v78
  s_nop 4
  v_cvt_pk_bf16_f32 v44, v44, v45
  v_cvt_pk_bf16_f32 v45, v46, v47
  v_bfi_b32 v44, 1, s25, v44
  buffer_store_dwordx2 v[44:45], v77, s[8:11], s31 offen offset:2048 sc1
  s_cmp_eq_u32 s26, 1
  s_cbranch_scc0 Lc_slow3_kvspin
Lc_slow3_kvok:
  s_add_u32 s42, s14, 2
  s_lshr_b32 s42, s42, 1
  s_cmp_gt_u32 s59, s42
  s_cselect_b32 s26, 1, 0
  s_cselect_b32 s42, 262144, 0
  s_add_u32 s63, s33, s42
  s_mov_b32 s75, s28
  s_mov_b32 s44, s14
  v_add_u32 v68, 147456, v74
  v_mov_b32 v70, 163832
Lc_slow3_lw:
  ds_read_b32 v69, v70
  s_sub_u32 s15, s15, 1
  s_cbranch_scc1 Lc_slow3_lwto
  s_waitcnt lgkmcnt(0)
  v_cmp_ne_u32 vcc, s44, v69
  s_cbranch_vccnz Lc_slow3_lw
  s_add_u32 s15, s15, 1
Lc_slow3_lwok:
  buffer_load_dwordx4 v[52:55], v68, s[8:11], s75 offen offset:0 sc1
  buffer_load_dwordx4 v[56:59], v68, s[8:11], s75 offen offset:1024 sc1
  ds_read_b128 v[0:3], v78 offset:0
  ds_read_b128 v[4:7], v78 offset:1024
  ds_read_b128 v[8:11], v78 offset:8192
  ds_read_b128 v[12:15], v78 offset:9216
  ds_read_b128 v[16:19], v78 offset:16384
  ds_read_b128 v[20:23], v78 offset:17408
  v_mov_b64 v[44:45], 0
  v_mov_b64 v[46:47], 0
  v_mov_b64 v[48:49], 0
  v_mov_b64 v[50:51], 0
  s_mov_b32 s75, s28
  s_mov_b32 s44, s14
  s_add_u32 s14, s14, 1
  s_xor_b32 s25, s25, 1
  s_mov_b32 s45, s28
  s_mov_b32 s28, s29
  s_mov_b32 s29, s18
  s_mov_b32 s18, s45
  s_add_u32 s35, s35, 131072
  s_add_u32 s36, s36, 131072
  s_add_u32 s34, s34, 262144
  s_add_u32 s33, s33, 262144
  s_add_u32 s32, s32, 262144
  s_xor_b32 s55, s55, 4096
  s_xor_b32 s19, s19, 4096
  v_add_u32 v72, 155648, v74
  buffer_load_dwordx4 v[60:63], v68, s[8:11], s75 offen offset:0 sc1
  buffer_load_dwordx4 v[64:67], v68, s[8:11], s75 offen offset:1024 sc1
  s_waitcnt vmcnt(3)
  ds_write_b128 v68, v[52:55] offset:0
  v_max3_u32 v69, v52, v53, v54
  v_max_u32_e64 v69, v69, v55
  s_waitcnt vmcnt(2)
  ds_write_b128 v68, v[56:59] offset:1024
  v_max3_u32 v69, v69, v56, v57
  v_max3_u32 v69, v69, v58, v59
  v_cmp_eq_u32 vcc, -1, v69
  s_cbranch_vccnz Lc_slow3_mpr
Lc_slow3_mpok:
  s_cmp_eq_u32 s14, 63
  s_waitcnt lgkmcnt(0)
  s_cbranch_scc0 Lc_slow3_top
  s_branch Lc_last3_top
Lc_slow3_end:
Lc_slow3_mpr:
  buffer_load_dwordx4 v[52:55], v68, s[8:11], s75 offen offset:0 sc1
  buffer_load_dwordx4 v[56:59], v68, s[8:11], s75 offen offset:1024 sc1
  s_waitcnt vmcnt(3)
  ds_write_b128 v68, v[60:63] offset:0
  v_max3_u32 v69, v60, v61, v62
  v_max_u32 v69, v69, v63
  s_waitcnt vmcnt(2)
  ds_write_b128 v68, v[64:67] offset:1024
  v_max3_u32 v69, v69, v64, v65
  v_max3_u32 v69, v69, v66, v67
  v_cmp_eq_u32 vcc, -1, v69
  s_cbranch_vccz Lc_slow3_mpok
  buffer_load_dwordx4 v[60:63], v68, s[8:11], s75 offen offset:0 sc1
  buffer_load_dwordx4 v[64:67], v68, s[8:11], s75 offen offset:1024 sc1
  s_waitcnt vmcnt(3)
  ds_write_b128 v68, v[52:55] offset:0
  v_max3_u32 v69, v52, v53, v54
  v_max_u32 v69, v69, v55
  s_waitcnt vmcnt(2)
  ds_write_b128 v68, v[56:59] offset:1024
  v_max3_u32 v69, v69, v56, v57
  v_max3_u32 v69, v69, v58, v59
  v_cmp_eq_u32 vcc, -1, v69
  s_cbranch_vccz Lc_slow3_mpok
  s_sub_u32 s15, s15, 1
  s_cbranch_scc0 Lc_slow3_mpr
  s_mov_b32 s15, 0
  s_branch Lc_slow3_mpok
Lc_slow3_pbr0:
  buffer_load_dwordx4 v[28:31], v72, s[8:11], s75 offen sc1
Lc_slow3_pbr:
  buffer_load_dwordx4 v[24:27], v72, s[8:11], s75 offen sc1
  s_waitcnt vmcnt(1)
  ds_write_b128 v72, v[28:31]
  s_waitcnt lgkmcnt(0)
  v_max3_u32 v28, v28, v29, v30
  v_max_u32 v28, v28, v31
  v_cmp_eq_u32 vcc, -1, v28
  s_cbranch_vccz Lc_slow3_pbd
  buffer_load_dwordx4 v[28:31], v72, s[8:11], s75 offen sc1
  s_waitcnt vmcnt(1)
  ds_write_b128 v72, v[24:27]
  s_waitcnt lgkmcnt(0)
  v_max3_u32 v24, v24, v25, v26
  v_max_u32 v24, v24, v27
  v_cmp_eq_u32 vcc, -1, v24
  s_cbranch_vccz Lc_slow3_pbd
  s_sub_u32 s15, s15, 1
  s_cbranch_scc0 Lc_slow3_pbr
  s_mov_b32 s15, 0
Lc_slow3_pbd:
  s_waitcnt lgkmcnt(0)
  s_branch Lc_slow3_pbok
Lc_slow3_kvspin:
  s_add_u32 s42, s14, 1
  s_lshr_b32 s42, s42, 1
  buffer_load_dword v70, off, s[8:11], s55 sc1
  s_waitcnt vmcnt(0)
  v_cmp_ge_u32 vcc, s42, v70
  s_cbranch_vccz Lc_slow3_kvok
  s_sleep 2
  s_sub_u32 s15, s15, 1
  s_cbranch_scc0 Lc_slow3_kvspin
  s_mov_b32 s15, 0
  s_branch Lc_slow3_kvok
Lc_slow3_lwto:
  s_mov_b32 s15, 0
  s_branch Lc_slow3_lwok
Lc_last0_top:
  s_barrier
  ds_read_b128 v[32:35], v75 offset:0
  ds_read_b128 v[36:39], v75 offset:512
  ds_read_b128 v[40:43], v75 offset:1024
  ds_read_b128 v[68:71], v75 offset:1536
  buffer_load_dwordx4 v[24:27], v72, s[8:11], s75 offen sc1
  s_waitcnt lgkmcnt(3)
  v_smfmac_f32_16x16x64_bf16 v[48:51], v[32:35], v[80:87], v73
  ds_read_b128 v[0:3], v78 offset:24576
  ds_read_b128 v[4:7], v78 offset:25600
  ds_read_b128 v[32:35], v75 offset:2048
  s_waitcnt lgkmcnt(5)
  v_smfmac_f32_16x16x64_bf16 v[48:51], v[36:39], v[88:95], v73
  ds_read_b128 v[8:11], v78 offset:32768
  ds_read_b128 v[36:39], v75 offset:2560
  s_waitcnt lgkmcnt(6)
  v_smfmac_f32_16x16x64_bf16 v[48:51], v[40:43], v[16:23], v73
  ds_read_b128 v[12:15], v78 offset:33792
  ds_read_b128 v[40:43], v75 offset:3072
  s_waitcnt lgkmcnt(5)
  v_smfmac_f32_16x16x64_bf16 v[48:51], v[68:71], v[0:7], v73
  ds_read_b128 v[16:19], v78 offset:40960
  ds_read_b128 v[68:71], v75 offset:3584
  s_waitcnt lgkmcnt(6)
  v_smfmac_f32_16x16x64_bf16 v[48:51], v[32:35], v[120:127], v73
  ds_read_b128 v[20:23], v78 offset:41984
  ds_read_b128 v[32:35], v75 offset:4096
  s_waitcnt lgkmcnt(6)
  v_smfmac_f32_16x16x64_bf16 v[48:51], v[36:39], v[136:143], v73
  ds_read_b128 v[0:3], v78 offset:49152
  ds_read_b128 v[36:39], v75 offset:4608
  s_waitcnt lgkmcnt(6)
  v_smfmac_f32_16x16x64_bf16 v[48:51], v[40:43], v[144:151], v73
  ds_read_b128 v[4:7], v78 offset:50176
  ds_read_b128 v[8:11], v78 offset:57344
  s_waitcnt vmcnt(0)
  ds_write_b128 v72, v[24:27]
  s_waitcnt lgkmcnt(7)
  v_smfmac_f32_16x16x64_bf16 v[48:51], v[68:71], v[152:159], v73
  ds_read_b128 v[12:15], v78 offset:58368
  v_max3_u32 v28, v24, v25, v26
  v_max_u32 v28, v28, v27
  v_add_u32 v78, 65536, v78
  v_cmp_eq_u32 vcc, -1, v28
  s_waitcnt lgkmcnt(3)
  v_smfmac_f32_16x16x64_bf16 v[48:51], v[32:35], v[0:7], v73
  ds_read_b128 v[16:19], v78 offset:0
  s_cbranch_vccnz Lc_last0_pbr0
  s_waitcnt lgkmcnt(2)
Lc_last0_pbok:
  s_barrier
  ds_read_b128 v[40:43], v75 offset:5120
  ds_read_b128 v[68:71], v75 offset:5632
  ds_read_b128 v[32:35], v75 offset:6144
  s_waitcnt lgkmcnt(4)
  v_smfmac_f32_16x16x64_bf16 v[48:51], v[36:39], v[8:15], v73
  ds_read_b128 v[20:23], v78 offset:1024
  ds_read_b128 v[0:3], v78 offset:8192
  ds_read_b128 v[36:39], v75 offset:6656
  s_waitcnt lgkmcnt(5)
  v_smfmac_f32_16x16x64_bf16 v[48:51], v[40:43], v[184:191], v73
  ds_read_b128 v[4:7], v78 offset:9216
  ds_read_b128 v[40:43], v75 offset:7168
  s_waitcnt lgkmcnt(6)
  v_smfmac_f32_16x16x64_bf16 v[48:51], v[68:71], v[200:207], v73
  ds_read_b128 v[8:11], v78 offset:16384
  ds_read_b128 v[68:71], v75 offset:7680
  s_waitcnt lgkmcnt(7)
  v_smfmac_f32_16x16x64_bf16 v[48:51], v[32:35], v[208:215], v73
  ds_read_b128 v[12:15], v78 offset:17408
  ds_read_b128 v[16:19], v78 offset:24576
  ds_read_b128 v[32:35], v75 offset:8192
  s_waitcnt lgkmcnt(7)
  v_smfmac_f32_16x16x64_bf16 v[48:51], v[36:39], v[216:223], v73
  ds_read_b128 v[20:23], v78 offset:25600
  v_mov_b64_e64 v[0:1], 0
  ds_read_b128 v[36:39], v75 offset:8704
  s_waitcnt lgkmcnt(4)
  v_smfmac_f32_16x16x64_bf16 v[48:51], v[40:43], v[8:15], v73
  v_mov_b64 v[2:3], 0
  ds_read_b128 v[40:43], v79 offset:0
  s_waitcnt lgkmcnt(2)
  v_smfmac_f32_16x16x64_bf16 v[48:51], v[68:71], v[16:23], v73
  v_mov_b64 v[4:5], 0
  ds_read_b128 v[68:71], v79 offset:1024
  v_smfmac_f32_16x16x64_bf16 v[48:51], v[32:35], v[248:255], v73
  v_mov_b64_e64 v[6:7], 0
  ds_read_b128 v[32:35], v79 offset:2048
  s_waitcnt lgkmcnt(3)
  v_smfmac_f32_16x16x64_bf16 v[48:51], v[36:39], a[8:15], v73
  v_add_u32_e64 v8, s37, v77
  s_waitcnt lgkmcnt(2)
  v_smfmac_f32_16x16x64_bf16 v[0:3], v[40:43], a[16:23], v73
  v_smfmac_f32_16x16x64_bf16 v[4:7], v[40:43], a[24:31], v73
  ds_read_b128 v[36:39], v79 offset:3072
  v_cvt_pk_bf16_f32 v48, v48, v49
  v_cvt_pk_bf16_f32 v49, v50, v51
  ds_write_b64 v8, v[48:49] offset:2048
  v_add_u32 v51, 65536, v78
  ds_read_b128 v[8:11], v51 offset:0
  ds_read_b128 v[12:15], v51 offset:1024
  ds_read_b128 v[16:19], v51 offset:8192
  ds_read_b128 v[20:23], v51 offset:9216
  s_waitcnt lgkmcnt(7)
  v_smfmac_f32_16x16x64_bf16 v[0:3], v[68:71], a[32:39], v73
  v_smfmac_f32_16x16x64_bf16 v[4:7], v[68:71], a[40:47], v73
  ds_read_b128 v[40:43], v79 offset:4096
  s_waitcnt lgkmcnt(7)
  v_smfmac_f32_16x16x64_bf16 v[0:3], v[32:35], a[48:55], v73
  v_smfmac_f32_16x16x64_bf16 v[4:7], v[32:35], a[56:63], v73
  ds_read_b128 v[68:71], v79 offset:5120
  s_waitcnt lgkmcnt(0)
  s_barrier
  ds_read_b64_tr_b16 v[52:53], v76 offset:2048
  ds_read_b64_tr_b16 v[54:55], v76 offset:2176
  ds_read_b64_tr_b16 v[56:57], v76 offset:2560
  ds_read_b64_tr_b16 v[58:59], v76 offset:2688
  v_smfmac_f32_16x16x64_bf16 v[0:3], v[36:39], a[64:71], v73
  v_smfmac_f32_16x16x64_bf16 v[4:7], v[36:39], a[72:79], v73
  ds_read_b128 v[32:35], v79 offset:6144
  v_smfmac_f32_16x16x64_bf16 v[0:3], v[40:43], a[80:87], v73
  v_smfmac_f32_16x16x64_bf16 v[4:7], v[40:43], a[88:95], v73
  ds_read_b128 v[36:39], v79 offset:7168
  s_waitcnt lgkmcnt(2)
  s_mov_b64 exec, s[20:21]
  buffer_store_dwordx4 v[52:55], v75, s[8:11], s35 offen offset:0 sc1
  buffer_store_dwordx4 v[56:59], v75, s[8:11], s35 offen offset:512 sc1
  s_mov_b64 exec, -1
  v_smfmac_f32_16x16x64_bf16 v[0:3], v[68:71], a[96:103], v73
  v_smfmac_f32_16x16x64_bf16 v[4:7], v[68:71], a[104:111], v73
  ds_read_b128 v[40:43], v79 offset:8192
  s_waitcnt lgkmcnt(2)
  v_smfmac_f32_16x16x64_bf16 v[0:3], v[32:35], a[112:119], v73
  v_smfmac_f32_16x16x64_bf16 v[4:7], v[32:35], a[120:127], v73
  s_waitcnt lgkmcnt(1)
  v_smfmac_f32_16x16x64_bf16 v[0:3], v[36:39], a[128:135], v73
  v_smfmac_f32_16x16x64_bf16 v[4:7], v[36:39], a[136:143], v73
  s_waitcnt lgkmcnt(0)
  v_smfmac_f32_16x16x64_bf16 v[0:3], v[40:43], v[8:15], v73
  v_smfmac_f32_16x16x64_bf16 v[4:7], v[40:43], v[16:23], v73
  s_nop 3
  v_cvt_pk_bf16_f32 v36, v0, v1
  v_cvt_pk_bf16_f32 v37, v2, v3
  s_nop 1
  v_cvt_pk_bf16_f32 v38, v4, v5
  v_cvt_pk_bf16_f32 v39, v6, v7
  buffer_store_dwordx4 v[36:39], v74, s[8:11], s36 offen sc1
  s_branch Lc_fin
Lc_last0_pbr0:
  buffer_load_dwordx4 v[28:31], v72, s[8:11], s75 offen sc1
Lc_last0_pbr:
  buffer_load_dwordx4 v[24:27], v72, s[8:11], s75 offen sc1
  s_waitcnt vmcnt(1)
  ds_write_b128 v72, v[28:31]
  s_waitcnt lgkmcnt(0)
  v_max3_u32 v28, v28, v29, v30
  v_max_u32 v28, v28, v31
  v_cmp_eq_u32 vcc, -1, v28
  s_cbranch_vccz Lc_last0_pbd
  buffer_load_dwordx4 v[28:31], v72, s[8:11], s75 offen sc1
  s_waitcnt vmcnt(1)
  ds_write_b128 v72, v[24:27]
  s_waitcnt lgkmcnt(0)
  v_max3_u32 v24, v24, v25, v26
  v_max_u32 v24, v24, v27
  v_cmp_eq_u32 vcc, -1, v24
  s_cbranch_vccz Lc_last0_pbd
  s_sub_u32 s15, s15, 1
  s_cbranch_scc0 Lc_last0_pbr
  s_mov_b32 s15, 0
Lc_last0_pbd:
  s_waitcnt lgkmcnt(0)
  s_branch Lc_last0_pbok
Lc_last1_top:
  s_barrier
  ds_read_b128 v[32:35], v75 offset:0
  ds_read_b128 v[36:39], v75 offset:512
  ds_read_b128 v[40:43], v75 offset:1024
  ds_read_b128 v[68:71], v75 offset:1536
  buffer_load_dwordx4 v[24:27], v72, s[8:11], s75 offen sc1
  s_waitcnt lgkmcnt(3)
  v_smfmac_f32_16x16x64_bf16 v[48:51], v[32:35], v[80:87], v73
  ds_read_b128 v[0:3], v78 offset:24576
  ds_read_b128 v[4:7], v78 offset:25600
  ds_read_b128 v[32:35], v75 offset:2048
  s_waitcnt lgkmcnt(5)
  v_smfmac_f32_16x16x64_bf16 v[48:51], v[36:39], v[88:95], v73
  ds_read_b128 v[8:11], v78 offset:32768
  ds_read_b128 v[36:39], v75 offset:2560
  s_waitcnt lgkmcnt(6)
  v_smfmac_f32_16x16x64_bf16 v[48:51], v[40:43], v[16:23], v73
  ds_read_b128 v[12:15], v78 offset:33792
  ds_read_b128 v[40:43], v75 offset:3072
  s_waitcnt lgkmcnt(5)
  v_smfmac_f32_16x16x64_bf16 v[48:51], v[68:71], v[0:7], v73
  ds_read_b128 v[16:19], v78 offset:40960
  ds_read_b128 v[68:71], v75 offset:3584
  s_waitcnt lgkmcnt(6)
  v_smfmac_f32_16x16x64_bf16 v[48:51], v[32:35], v[120:127], v73
  ds_read_b128 v[20:23], v78 offset:41984
  ds_read_b128 v[32:35], v75 offset:4096
  s_waitcnt lgkmcnt(6)
  v_smfmac_f32_16x16x64_bf16 v[48:51], v[36:39], v[136:143], v73
  ds_read_b128 v[0:3], v78 offset:49152
  ds_read_b128 v[36:39], v75 offset:4608
  s_waitcnt lgkmcnt(6)
  v_smfmac_f32_16x16x64_bf16 v[48:51], v[40:43], v[144:151], v73
  ds_read_b128 v[4:7], v78 offset:50176
  ds_read_b128 v[8:11], v78 offset:57344
  s_waitcnt vmcnt(0)
  ds_write_b128 v72, v[24:27]
  s_waitcnt lgkmcnt(7)
  v_smfmac_f32_16x16x64_bf16 v[48:51], v[68:71], v[152:159], v73
  ds_read_b128 v[12:15], v78 offset:58368
  v_max3_u32 v28, v24, v25, v26
  v_max_u32_e64 v28, v28, v27
  v_add_u32 v78, 65536, v78
  v_cmp_eq_u32 vcc, -1, v28
  s_waitcnt lgkmcnt(3)
  v_smfmac_f32_16x16x64_bf16 v[48:51], v[32:35], v[0:7], v73
  ds_read_b128 v[16:19], v78 offset:0
  s_cbranch_vccnz Lc_last1_pbr0
  s_waitcnt lgkmcnt(2)
Lc_last1_pbok:
  s_barrier
  ds_read_b128 v[40:43], v75 offset:5120
  ds_read_b128 v[68:71], v75 offset:5632
  ds_read_b128 v[32:35], v75 offset:6144
  s_waitcnt lgkmcnt(4)
  v_smfmac_f32_16x16x64_bf16 v[48:51], v[36:39], v[8:15], v73
  ds_read_b128 v[20:23], v78 offset:1024
  ds_read_b128 v[0:3], v78 offset:8192
  ds_read_b128 v[36:39], v75 offset:6656
  s_waitcnt lgkmcnt(5)
  v_smfmac_f32_16x16x64_bf16 v[48:51], v[40:43], v[184:191], v73
  ds_read_b128 v[4:7], v78 offset:9216
  ds_read_b128 v[40:43], v75 offset:7168
  s_waitcnt lgkmcnt(6)
  v_smfmac_f32_16x16x64_bf16 v[48:51], v[68:71], v[200:207], v73
  ds_read_b128 v[8:11], v78 offset:16384
  ds_read_b128 v[68:71], v75 offset:7680
  s_waitcnt lgkmcnt(7)
  v_smfmac_f32_16x16x64_bf16 v[48:51], v[32:35], v[208:215], v73
  ds_read_b128 v[12:15], v78 offset:17408
  ds_read_b128 v[16:19], v78 offset:24576
  ds_read_b128 v[32:35], v75 offset:8192
  s_waitcnt lgkmcnt(7)
  v_smfmac_f32_16x16x64_bf16 v[48:51], v[36:39], v[216:223], v73
  ds_read_b128 v[20:23], v78 offset:25600
  v_mov_b64_e64 v[0:1], 0
  ds_read_b128 v[36:39], v75 offset:8704
  s_waitcnt lgkmcnt(4)
  v_smfmac_f32_16x16x64_bf16 v[48:51], v[40:43], v[8:15], v73
  v_mov_b64 v[2:3], 0
  ds_read_b128 v[40:43], v79 offset:0
  s_waitcnt lgkmcnt(2)
  v_smfmac_f32_16x16x64_bf16 v[48:51], v[68:71], v[16:23], v73
  v_mov_b64 v[4:5], 0
  ds_read_b128 v[68:71], v79 offset:1024
  v_smfmac_f32_16x16x64_bf16 v[48:51], v[32:35], v[248:255], v73
  v_mov_b64_e64 v[6:7], 0
  ds_read_b128 v[32:35], v79 offset:2048
  s_waitcnt lgkmcnt(3)
  v_smfmac_f32_16x16x64_bf16 v[48:51], v[36:39], a[8:15], v73
  v_add_u32_e64 v8, s37, v77
  s_waitcnt lgkmcnt(2)
  v_smfmac_f32_16x16x64_bf16 v[0:3], v[40:43], a[16:23], v73
  v_smfmac_f32_16x16x64_bf16 v[4:7], v[40:43], a[24:31], v73
  ds_read_b128 v[36:39], v79 offset:3072
  v_cvt_pk_bf16_f32 v48, v48, v49
  v_cvt_pk_bf16_f32 v49, v50, v51
  ds_write_b64 v8, v[48:49] offset:2048
  v_add_u32 v51, 65536, v78
  ds_read_b128 v[8:11], v51 offset:0
  ds_read_b128 v[12:15], v51 offset:1024
  ds_read_b128 v[16:19], v51 offset:8192
  ds_read_b128 v[20:23], v51 offset:9216
  s_waitcnt lgkmcnt(7)
  v_smfmac_f32_16x16x64_bf16 v[0:3], v[68:71], a[32:39], v73
  v_smfmac_f32_16x16x64_bf16 v[4:7], v[68:71], a[40:47], v73
  ds_read_b128 v[40:43], v79 offset:4096
  s_waitcnt lgkmcnt(7)
  v_smfmac_f32_16x16x64_bf16 v[0:3], v[32:35], a[48:55], v73
  v_smfmac_f32_16x16x64_bf16 v[4:7], v[32:35], a[56:63], v73
  ds_read_b128 v[68:71], v79 offset:5120
  s_waitcnt lgkmcnt(0)
  s_barrier
  v_smfmac_f32_16x16x64_bf16 v[0:3], v[36:39], a[64:71], v73
  v_smfmac_f32_16x16x64_bf16 v[4:7], v[36:39], a[72:79], v73
  ds_read_b128 v[32:35], v79 offset:6144
  v_smfmac_f32_16x16x64_bf16 v[0:3], v[40:43], a[80:87], v73
  v_smfmac_f32_16x16x64_bf16 v[4:7], v[40:43], a[88:95], v73
  ds_read_b128 v[36:39], v79 offset:7168
  v_smfmac_f32_16x16x64_bf16 v[0:3], v[68:71], a[96:103], v73
  v_smfmac_f32_16x16x64_bf16 v[4:7], v[68:71], a[104:111], v73
  ds_read_b128 v[40:43], v79 offset:8192
  s_waitcnt lgkmcnt(2)
  v_smfmac_f32_16x16x64_bf16 v[0:3], v[32:35], a[112:119], v73
  v_smfmac_f32_16x16x64_bf16 v[4:7], v[32:35], a[120:127], v73
  s_waitcnt lgkmcnt(1)
  v_smfmac_f32_16x16x64_bf16 v[0:3], v[36:39], a[128:135], v73
  v_smfmac_f32_16x16x64_bf16 v[4:7], v[36:39], a[136:143], v73
  s_waitcnt lgkmcnt(0)
  v_smfmac_f32_16x16x64_bf16 v[0:3], v[40:43], v[8:15], v73
  v_smfmac_f32_16x16x64_bf16 v[4:7], v[40:43], v[16:23], v73
  s_nop 3
  v_cvt_pk_bf16_f32 v36, v0, v1
  v_cvt_pk_bf16_f32 v37, v2, v3
  s_nop 1
  v_cvt_pk_bf16_f32 v38, v4, v5
  v_cvt_pk_bf16_f32 v39, v6, v7
  buffer_store_dwordx4 v[36:39], v74, s[8:11], s36 offen sc1
  s_branch Lc_fin
Lc_last1_pbr0:
  buffer_load_dwordx4 v[28:31], v72, s[8:11], s75 offen sc1
Lc_last1_pbr:
  buffer_load_dwordx4 v[24:27], v72, s[8:11], s75 offen sc1
  s_waitcnt vmcnt(1)
  ds_write_b128 v72, v[28:31]
  s_waitcnt lgkmcnt(0)
  v_max3_u32 v28, v28, v29, v30
  v_max_u32 v28, v28, v31
  v_cmp_eq_u32_e64 vcc, -1, v28
  s_cbranch_vccz Lc_last1_pbd
  buffer_load_dwordx4 v[28:31], v72, s[8:11], s75 offen sc1
  s_waitcnt vmcnt(1)
  ds_write_b128 v72, v[24:27]
  s_waitcnt lgkmcnt(0)
  v_max3_u32 v24, v24, v25, v26
  v_max_u32 v24, v24, v27
  v_cmp_eq_u32 vcc, -1, v24
  s_cbranch_vccz Lc_last1_pbd
  s_sub_u32 s15, s15, 1
  s_cbranch_scc0 Lc_last1_pbr
  s_mov_b32 s15, 0
Lc_last1_pbd:
  s_waitcnt lgkmcnt(0)
  s_branch Lc_last1_pbok
Lc_last2_top:
  s_barrier
  ds_read_b128 v[32:35], v75 offset:0
  ds_read_b128 v[36:39], v75 offset:512
  ds_read_b128 v[40:43], v75 offset:1024
  ds_read_b128 v[68:71], v75 offset:1536
  buffer_load_dwordx4 v[24:27], v72, s[8:11], s75 offen sc1
  s_waitcnt lgkmcnt(3)
  v_smfmac_f32_16x16x64_bf16 v[48:51], v[32:35], v[80:87], v73
  ds_read_b128 v[0:3], v78 offset:24576
  ds_read_b128 v[4:7], v78 offset:25600
  ds_read_b128 v[32:35], v75 offset:2048
  s_waitcnt lgkmcnt(5)
  v_smfmac_f32_16x16x64_bf16 v[48:51], v[36:39], v[88:95], v73
  ds_read_b128 v[8:11], v78 offset:32768
  ds_read_b128 v[36:39], v75 offset:2560
  s_waitcnt lgkmcnt(6)
  v_smfmac_f32_16x16x64_bf16 v[48:51], v[40:43], v[16:23], v73
  ds_read_b128 v[12:15], v78 offset:33792
  ds_read_b128 v[40:43], v75 offset:3072
  s_waitcnt lgkmcnt(5)
  v_smfmac_f32_16x16x64_bf16 v[48:51], v[68:71], v[0:7], v73
  ds_read_b128 v[16:19], v78 offset:40960
  ds_read_b128 v[68:71], v75 offset:3584
  s_waitcnt lgkmcnt(6)
  v_smfmac_f32_16x16x64_bf16 v[48:51], v[32:35], v[120:127], v73
  ds_read_b128 v[20:23], v78 offset:41984
  ds_read_b128 v[32:35], v75 offset:4096
  s_waitcnt lgkmcnt(6)
  v_smfmac_f32_16x16x64_bf16 v[48:51], v[36:39], v[136:143], v73
  ds_read_b128 v[0:3], v78 offset:49152
  ds_read_b128 v[36:39], v75 offset:4608
  s_waitcnt lgkmcnt(6)
  v_smfmac_f32_16x16x64_bf16 v[48:51], v[40:43], v[144:151], v73
  ds_read_b128 v[4:7], v78 offset:50176
  ds_read_b128 v[8:11], v78 offset:57344
  s_waitcnt vmcnt(0)
  ds_write_b128 v72, v[24:27]
  s_waitcnt lgkmcnt(7)
  v_smfmac_f32_16x16x64_bf16 v[48:51], v[68:71], v[152:159], v73
  ds_read_b128 v[12:15], v78 offset:58368
  v_max3_u32 v28, v24, v25, v26
  v_max_u32_e64 v28, v28, v27
  v_add_u32 v78, 65536, v78
  v_cmp_eq_u32 vcc, -1, v28
  s_waitcnt lgkmcnt(3)
  v_smfmac_f32_16x16x64_bf16 v[48:51], v[32:35], v[0:7], v73
  ds_read_b128 v[16:19], v78 offset:0
  s_cbranch_vccnz Lc_last2_pbr0
  s_waitcnt lgkmcnt(2)
Lc_last2_pbok:
  s_barrier
  ds_read_b128 v[40:43], v75 offset:5120
  ds_read_b128 v[68:71], v75 offset:5632
  ds_read_b128 v[32:35], v75 offset:6144
  s_waitcnt lgkmcnt(4)
  v_smfmac_f32_16x16x64_bf16 v[48:51], v[36:39], v[8:15], v73
  ds_read_b128 v[20:23], v78 offset:1024
  ds_read_b128 v[0:3], v78 offset:8192
  ds_read_b128 v[36:39], v75 offset:6656
  s_waitcnt lgkmcnt(5)
  v_smfmac_f32_16x16x64_bf16 v[48:51], v[40:43], v[184:191], v73
  ds_read_b128 v[4:7], v78 offset:9216
  ds_read_b128 v[40:43], v75 offset:7168
  s_waitcnt lgkmcnt(6)
  v_smfmac_f32_16x16x64_bf16 v[48:51], v[68:71], v[200:207], v73
  ds_read_b128 v[8:11], v78 offset:16384
  ds_read_b128 v[68:71], v75 offset:7680
  s_waitcnt lgkmcnt(7)
  v_smfmac_f32_16x16x64_bf16 v[48:51], v[32:35], v[208:215], v73
  ds_read_b128 v[12:15], v78 offset:17408
  ds_read_b128 v[16:19], v78 offset:24576
  ds_read_b128 v[32:35], v75 offset:8192
  s_waitcnt lgkmcnt(7)
  v_smfmac_f32_16x16x64_bf16 v[48:51], v[36:39], v[216:223], v73
  ds_read_b128 v[20:23], v78 offset:25600
  v_mov_b64_e64 v[0:1], 0
  ds_read_b128 v[36:39], v75 offset:8704
  s_waitcnt lgkmcnt(4)
  v_smfmac_f32_16x16x64_bf16 v[48:51], v[40:43], v[8:15], v73
  v_mov_b64 v[2:3], 0
  ds_read_b128 v[40:43], v79 offset:0
  s_waitcnt lgkmcnt(2)
  v_smfmac_f32_16x16x64_bf16 v[48:51], v[68:71], v[16:23], v73
  v_mov_b64 v[4:5], 0
  ds_read_b128 v[68:71], v79 offset:1024
  v_smfmac_f32_16x16x64_bf16 v[48:51], v[32:35], v[248:255], v73
  v_mov_b64_e64 v[6:7], 0
  ds_read_b128 v[32:35], v79 offset:2048
  s_waitcnt lgkmcnt(3)
  v_smfmac_f32_16x16x64_bf16 v[48:51], v[36:39], a[8:15], v73
  v_add_u32_e64 v8, s37, v77
  s_waitcnt lgkmcnt(2)
  v_smfmac_f32_16x16x64_bf16 v[0:3], v[40:43], a[16:23], v73
  v_smfmac_f32_16x16x64_bf16 v[4:7], v[40:43], a[24:31], v73
  ds_read_b128 v[36:39], v79 offset:3072
  v_cvt_pk_bf16_f32 v48, v48, v49
  v_cvt_pk_bf16_f32 v49, v50, v51
  ds_write_b64 v8, v[48:49] offset:2048
  v_add_u32 v51, 65536, v78
  ds_read_b128 v[8:11], v51 offset:0
  ds_read_b128 v[12:15], v51 offset:1024
  ds_read_b128 v[16:19], v51 offset:8192
  ds_read_b128 v[20:23], v51 offset:9216
  s_waitcnt lgkmcnt(7)
  v_smfmac_f32_16x16x64_bf16 v[0:3], v[68:71], a[32:39], v73
  v_smfmac_f32_16x16x64_bf16 v[4:7], v[68:71], a[40:47], v73
  ds_read_b128 v[40:43], v79 offset:4096
  s_waitcnt lgkmcnt(7)
  v_smfmac_f32_16x16x64_bf16 v[0:3], v[32:35], a[48:55], v73
  v_smfmac_f32_16x16x64_bf16 v[4:7], v[32:35], a[56:63], v73
  ds_read_b128 v[68:71], v79 offset:5120
  s_waitcnt lgkmcnt(0)
  s_barrier
  v_smfmac_f32_16x16x64_bf16 v[0:3], v[36:39], a[64:71], v73
  v_smfmac_f32_16x16x64_bf16 v[4:7], v[36:39], a[72:79], v73
  ds_read_b128 v[32:35], v79 offset:6144
  v_smfmac_f32_16x16x64_bf16 v[0:3], v[40:43], a[80:87], v73
  v_smfmac_f32_16x16x64_bf16 v[4:7], v[40:43], a[88:95], v73
  ds_read_b128 v[36:39], v79 offset:7168
  v_smfmac_f32_16x16x64_bf16 v[0:3], v[68:71], a[96:103], v73
  v_smfmac_f32_16x16x64_bf16 v[4:7], v[68:71], a[104:111], v73
  ds_read_b128 v[40:43], v79 offset:8192
  s_waitcnt lgkmcnt(2)
  v_smfmac_f32_16x16x64_bf16 v[0:3], v[32:35], a[112:119], v73
  v_smfmac_f32_16x16x64_bf16 v[4:7], v[32:35], a[120:127], v73
  s_waitcnt lgkmcnt(1)
  v_smfmac_f32_16x16x64_bf16 v[0:3], v[36:39], a[128:135], v73
  v_smfmac_f32_16x16x64_bf16 v[4:7], v[36:39], a[136:143], v73
  s_waitcnt lgkmcnt(0)
  v_smfmac_f32_16x16x64_bf16 v[0:3], v[40:43], v[8:15], v73
  v_smfmac_f32_16x16x64_bf16 v[4:7], v[40:43], v[16:23], v73
  s_nop 3
  v_cvt_pk_bf16_f32 v36, v0, v1
  v_cvt_pk_bf16_f32 v37, v2, v3
  s_nop 1
  v_cvt_pk_bf16_f32 v38, v4, v5
  v_cvt_pk_bf16_f32 v39, v6, v7
  buffer_store_dwordx4 v[36:39], v74, s[8:11], s36 offen sc1
  s_branch Lc_fin
Lc_last2_pbr0:
  buffer_load_dwordx4 v[28:31], v72, s[8:11], s75 offen sc1
Lc_last2_pbr:
  buffer_load_dwordx4 v[24:27], v72, s[8:11], s75 offen sc1
  s_waitcnt vmcnt(1)
  ds_write_b128 v72, v[28:31]
  s_waitcnt lgkmcnt(0)
  v_max3_u32 v28, v28, v29, v30
  v_max_u32 v28, v28, v31
  v_cmp_eq_u32_e64 vcc, -1, v28
  s_cbranch_vccz Lc_last2_pbd
  buffer_load_dwordx4 v[28:31], v72, s[8:11], s75 offen sc1
  s_waitcnt vmcnt(1)
  ds_write_b128 v72, v[24:27]
  s_waitcnt lgkmcnt(0)
  v_max3_u32 v24, v24, v25, v26
  v_max_u32 v24, v24, v27
  v_cmp_eq_u32 vcc, -1, v24
  s_cbranch_vccz Lc_last2_pbd
  s_sub_u32 s15, s15, 1
  s_cbranch_scc0 Lc_last2_pbr
  s_mov_b32 s15, 0
Lc_last2_pbd:
  s_waitcnt lgkmcnt(0)
  s_branch Lc_last2_pbok
Lc_last3_top:
  s_barrier
  ds_read_b128 v[32:35], v75 offset:0
  ds_read_b128 v[36:39], v75 offset:512
  ds_read_b128 v[40:43], v75 offset:1024
  ds_read_b128 v[68:71], v75 offset:1536
  buffer_load_dwordx4 v[24:27], v72, s[8:11], s75 offen sc1
  s_waitcnt lgkmcnt(3)
  v_smfmac_f32_16x16x64_bf16 v[48:51], v[32:35], v[80:87], v73
  ds_read_b128 v[0:3], v78 offset:24576
  ds_read_b128 v[4:7], v78 offset:25600
  ds_read_b128 v[32:35], v75 offset:2048
  s_waitcnt lgkmcnt(5)
  v_smfmac_f32_16x16x64_bf16 v[48:51], v[36:39], v[88:95], v73
  ds_read_b128 v[8:11], v78 offset:32768
  ds_read_b128 v[36:39], v75 offset:2560
  s_waitcnt lgkmcnt(6)
  v_smfmac_f32_16x16x64_bf16 v[48:51], v[40:43], v[16:23], v73
  ds_read_b128 v[12:15], v78 offset:33792
  ds_read_b128 v[40:43], v75 offset:3072
  s_waitcnt lgkmcnt(5)
  v_smfmac_f32_16x16x64_bf16 v[48:51], v[68:71], v[0:7], v73
  ds_read_b128 v[16:19], v78 offset:40960
  ds_read_b128 v[68:71], v75 offset:3584
  s_waitcnt lgkmcnt(6)
  v_smfmac_f32_16x16x64_bf16 v[48:51], v[32:35], v[120:127], v73
  ds_read_b128 v[20:23], v78 offset:41984
  ds_read_b128 v[32:35], v75 offset:4096
  s_waitcnt lgkmcnt(6)
  v_smfmac_f32_16x16x64_bf16 v[48:51], v[36:39], v[136:143], v73
  ds_read_b128 v[0:3], v78 offset:49152
  ds_read_b128 v[36:39], v75 offset:4608
  s_waitcnt lgkmcnt(6)
  v_smfmac_f32_16x16x64_bf16 v[48:51], v[40:43], v[144:151], v73
  ds_read_b128 v[4:7], v78 offset:50176
  ds_read_b128 v[8:11], v78 offset:57344
  s_waitcnt vmcnt(0)
  ds_write_b128 v72, v[24:27]
  s_waitcnt lgkmcnt(7)
  v_smfmac_f32_16x16x64_bf16 v[48:51], v[68:71], v[152:159], v73
  ds_read_b128 v[12:15], v78 offset:58368
  v_max3_u32 v28, v24, v25, v26
  v_max_u32_e64 v28, v28, v27
  v_add_u32 v78, 65536, v78
  v_cmp_eq_u32 vcc, -1, v28
  s_waitcnt lgkmcnt(3)
  v_smfmac_f32_16x16x64_bf16 v[48:51], v[32:35], v[0:7], v73
  ds_read_b128 v[16:19], v78 offset:0
  s_cbranch_vccnz Lc_last3_pbr0
  s_waitcnt lgkmcnt(2)
Lc_last3_pbok:
  s_barrier
  ds_read_b128 v[40:43], v75 offset:5120
  ds_read_b128 v[68:71], v75 offset:5632
  ds_read_b128 v[32:35], v75 offset:6144
  s_waitcnt lgkmcnt(4)
  v_smfmac_f32_16x16x64_bf16 v[48:51], v[36:39], v[8:15], v73
  ds_read_b128 v[20:23], v78 offset:1024
  ds_read_b128 v[0:3], v78 offset:8192
  ds_read_b128 v[36:39], v75 offset:6656
  s_waitcnt lgkmcnt(5)
  v_smfmac_f32_16x16x64_bf16 v[48:51], v[40:43], v[184:191], v73
  ds_read_b128 v[4:7], v78 offset:9216
  ds_read_b128 v[40:43], v75 offset:7168
  s_waitcnt lgkmcnt(6)
  v_smfmac_f32_16x16x64_bf16 v[48:51], v[68:71], v[200:207], v73
  ds_read_b128 v[8:11], v78 offset:16384
  ds_read_b128 v[68:71], v75 offset:7680
  s_waitcnt lgkmcnt(7)
  v_smfmac_f32_16x16x64_bf16 v[48:51], v[32:35], v[208:215], v73
  ds_read_b128 v[12:15], v78 offset:17408
  ds_read_b128 v[16:19], v78 offset:24576
  ds_read_b128 v[32:35], v75 offset:8192
  s_waitcnt lgkmcnt(7)
  v_smfmac_f32_16x16x64_bf16 v[48:51], v[36:39], v[216:223], v73
  ds_read_b128 v[20:23], v78 offset:25600
  v_mov_b64_e64 v[0:1], 0
  ds_read_b128 v[36:39], v75 offset:8704
  s_waitcnt lgkmcnt(4)
  v_smfmac_f32_16x16x64_bf16 v[48:51], v[40:43], v[8:15], v73
  v_mov_b64 v[2:3], 0
  ds_read_b128 v[40:43], v79 offset:0
  s_waitcnt lgkmcnt(2)
  v_smfmac_f32_16x16x64_bf16 v[48:51], v[68:71], v[16:23], v73
  v_mov_b64 v[4:5], 0
  ds_read_b128 v[68:71], v79 offset:1024
  v_smfmac_f32_16x16x64_bf16 v[48:51], v[32:35], v[248:255], v73
  v_mov_b64_e64 v[6:7], 0
  ds_read_b128 v[32:35], v79 offset:2048
  s_waitcnt lgkmcnt(3)
  v_smfmac_f32_16x16x64_bf16 v[48:51], v[36:39], a[8:15], v73
  v_add_u32_e64 v8, s37, v77
  s_waitcnt lgkmcnt(2)
  v_smfmac_f32_16x16x64_bf16 v[0:3], v[40:43], a[16:23], v73
  v_smfmac_f32_16x16x64_bf16 v[4:7], v[40:43], a[24:31], v73
  ds_read_b128 v[36:39], v79 offset:3072
  v_cvt_pk_bf16_f32 v48, v48, v49
  v_cvt_pk_bf16_f32 v49, v50, v51
  ds_write_b64 v8, v[48:49] offset:2048
  v_add_u32 v51, 65536, v78
  ds_read_b128 v[8:11], v51 offset:0
  ds_read_b128 v[12:15], v51 offset:1024
  ds_read_b128 v[16:19], v51 offset:8192
  ds_read_b128 v[20:23], v51 offset:9216
  s_waitcnt lgkmcnt(7)
  v_smfmac_f32_16x16x64_bf16 v[0:3], v[68:71], a[32:39], v73
  v_smfmac_f32_16x16x64_bf16 v[4:7], v[68:71], a[40:47], v73
  ds_read_b128 v[40:43], v79 offset:4096
  s_waitcnt lgkmcnt(7)
  v_smfmac_f32_16x16x64_bf16 v[0:3], v[32:35], a[48:55], v73
  v_smfmac_f32_16x16x64_bf16 v[4:7], v[32:35], a[56:63], v73
  ds_read_b128 v[68:71], v79 offset:5120
  s_waitcnt lgkmcnt(0)
  s_barrier
  ds_read_b64_tr_b16 v[52:53], v76 offset:2048
  ds_read_b64_tr_b16 v[54:55], v76 offset:2176
  ds_read_b64_tr_b16 v[56:57], v76 offset:2560
  ds_read_b64_tr_b16 v[58:59], v76 offset:2688
  v_smfmac_f32_16x16x64_bf16 v[0:3], v[36:39], a[64:71], v73
  v_smfmac_f32_16x16x64_bf16 v[4:7], v[36:39], a[72:79], v73
  ds_read_b128 v[32:35], v79 offset:6144
  v_smfmac_f32_16x16x64_bf16 v[0:3], v[40:43], a[80:87], v73
  v_smfmac_f32_16x16x64_bf16 v[4:7], v[40:43], a[88:95], v73
  ds_read_b128 v[36:39], v79 offset:7168
  s_waitcnt lgkmcnt(2)
  s_mov_b64 exec, s[20:21]
  buffer_store_dwordx4 v[52:55], v75, s[8:11], s35 offen offset:0 sc1
  buffer_store_dwordx4 v[56:59], v75, s[8:11], s35 offen offset:512 sc1
  s_mov_b64 exec, -1
  v_smfmac_f32_16x16x64_bf16 v[0:3], v[68:71], a[96:103], v73
  v_smfmac_f32_16x16x64_bf16 v[4:7], v[68:71], a[104:111], v73
  ds_read_b128 v[40:43], v79 offset:8192
  s_waitcnt lgkmcnt(2)
  v_smfmac_f32_16x16x64_bf16 v[0:3], v[32:35], a[112:119], v73
  v_smfmac_f32_16x16x64_bf16 v[4:7], v[32:35], a[120:127], v73
  s_waitcnt lgkmcnt(1)
  v_smfmac_f32_16x16x64_bf16 v[0:3], v[36:39], a[128:135], v73
  v_smfmac_f32_16x16x64_bf16 v[4:7], v[36:39], a[136:143], v73
  s_waitcnt lgkmcnt(0)
  v_smfmac_f32_16x16x64_bf16 v[0:3], v[40:43], v[8:15], v73
  v_smfmac_f32_16x16x64_bf16 v[4:7], v[40:43], v[16:23], v73
  s_nop 3
  v_cvt_pk_bf16_f32 v36, v0, v1
  v_cvt_pk_bf16_f32 v37, v2, v3
  s_nop 1
  v_cvt_pk_bf16_f32 v38, v4, v5
  v_cvt_pk_bf16_f32 v39, v6, v7
  buffer_store_dwordx4 v[36:39], v74, s[8:11], s36 offen sc1
  s_branch Lc_fin
Lc_last3_pbr0:
  buffer_load_dwordx4 v[28:31], v72, s[8:11], s75 offen sc1
Lc_last3_pbr:
  buffer_load_dwordx4 v[24:27], v72, s[8:11], s75 offen sc1
  s_waitcnt vmcnt(1)
  ds_write_b128 v72, v[28:31]
  s_waitcnt lgkmcnt(0)
  v_max3_u32 v28, v28, v29, v30
  v_max_u32 v28, v28, v31
  v_cmp_eq_u32 vcc, -1, v28
  s_cbranch_vccz Lc_last3_pbd
  buffer_load_dwordx4 v[28:31], v72, s[8:11], s75 offen sc1
  s_waitcnt vmcnt(1)
  ds_write_b128 v72, v[24:27]
  s_waitcnt lgkmcnt(0)
  v_max3_u32 v24, v24, v25, v26
  v_max_u32 v24, v24, v27
  v_cmp_eq_u32 vcc, -1, v24
  s_cbranch_vccz Lc_last3_pbd
  s_sub_u32 s15, s15, 1
  s_cbranch_scc0 Lc_last3_pbr
  s_mov_b32 s15, 0
Lc_last3_pbd:
  s_waitcnt lgkmcnt(0)
  s_branch Lc_last3_pbok
Lc_fin:
Lc_fin2:
  s_branch Lend
Lend:
  s_endpgm
.section .rodata,"a"
.p2align 6
.amdhsa_kernel adaLN_cond__memory_aug_recurrent_mem_tr__glu_gated_glu__prompt_kernel
  .amdhsa_next_free_vgpr 512
  .amdhsa_next_free_sgpr 100
  .amdhsa_accum_offset 256
  .amdhsa_group_segment_fixed_size 0
  .amdhsa_kernarg_size 128
  .amdhsa_user_sgpr_count 2
  .amdhsa_user_sgpr_kernarg_segment_ptr 1
  .amdhsa_system_sgpr_workgroup_id_x 1
.end_amdhsa_kernel
```
